```python
import torch

def _softmax(x, axis=-1):
    return torch.softmax(x, dim=axis)

def _gelu(x):
    return torch.nn.functional.gelu(x, approximate='tanh')

def _silu(x):
    return torch.nn.functional.silu(x)

def _sigmoid(x):
    return torch.sigmoid(x)

def _layernorm(x, axis=-1, eps=1e-05):
    m = x.mean(dim=axis, keepdim=True)
    v = x.var(dim=axis, keepdim=True, unbiased=False)
    return (x - m) / torch.sqrt(v + eps)

def _scatter_add(tgt, idx, src, axis=0):
    return tgt.clone().index_add_(axis, idx, src)

def _segment_sum(src, seg, n):
    out = torch.zeros((n,) + src.shape[1:], dtype=src.dtype)
    return out.index_add_(0, seg, src)

def _pad(x, pw):
    flat = tuple((v for pair in reversed(pw) for v in pair))
    return torch.nn.functional.pad(x, flat)
kernel_name = 'adaLN_cond__ssm_conv_h3__mixer_gmlp__prompt'

def setup_inputs():

    _w = lambda a: (lambda t: t.to(torch.bfloat16) if t.is_floating_point() else t)(torch.as_tensor(a))

    def _A_setup():
        B, S, D = (1, 2048, 576)
        ks = 4
        return {'q': _w((lambda *s: torch.randn(*s, dtype=torch.bfloat16) * 0.05)(B, S, D)), 'k': _w((lambda *s: torch.randn(*s, dtype=torch.bfloat16) * 0.8)(B, S, D)), 'v': _w((lambda *s: torch.randn(*s, dtype=torch.bfloat16) * 0.8)(B, S, D)), 'shift_k': _w((lambda *s: torch.randn(*s, dtype=torch.bfloat16) * 0.8)(D, ks) * 0.5), 'ssm_k': _w((lambda *s: torch.randn(*s, dtype=torch.bfloat16) * 0.8)(D, S) * (1.0 / S ** 0.5)), 'ssm_D': _w((lambda *s: torch.randn(*s, dtype=torch.bfloat16) * 0.8)(D))}
    _A_in = _A_setup()

    def _B_setup():
        B, S, D, F = (1, 2048, 576, 4608)
        Fh = F // 2
        return {'x': _w((lambda *s: torch.randn(*s, dtype=torch.bfloat16) * 0.05)(B, S, D)), 'w_in': _w((lambda *s: torch.randn(*s, dtype=torch.bfloat16) * 0.4)(D, 2 * Fh)), 'w_sp': _w(0.01 * (lambda *s: torch.randn(*s, dtype=torch.bfloat16) * 0.4)(S, S)), 'b_sp': _w(1.0 + 0.01 * (lambda *s: torch.randn(*s, dtype=torch.bfloat16) * 0.05)(S)), 'w_out': _w((lambda *s: torch.randn(*s, dtype=torch.bfloat16) * 0.05)(Fh, D))}
    _B_in = _B_setup()
    return {'A_q': _A_in['q'], 'A_k': _A_in['k'], 'A_v': _A_in['v'], 'A_shift_k': _A_in['shift_k'], 'A_ssm_k': _A_in['ssm_k'], 'A_ssm_D': _A_in['ssm_D'], 'B_x': _B_in['x'], 'B_w_in': _B_in['w_in'], 'B_w_sp': _B_in['w_sp'], 'B_b_sp': _B_in['b_sp'], 'B_w_out': _B_in['w_out'], 'c': _w((lambda *s: torch.randn(*s, dtype=torch.bfloat16) * 0.1)(1, 576) * 8.0), 'w_mod': _w((lambda *s: torch.randn(*s, dtype=torch.bfloat16) * 0.1)(576, 6 * 576) * 576 ** (-0.5) * 8.0)}

def reference(A_q, A_k, A_v, A_shift_k, A_ssm_k, A_ssm_D, B_x, B_w_in, B_w_sp, B_b_sp, B_w_out, c, w_mod):

    def _A_ref(q, k, v, shift_k, ssm_k, ssm_D):
        B, S, D = q.shape
        ks = shift_k.shape[-1]
        k_pad = _pad(k, ((0, 0), (ks - 1, 0), (0, 0)))
        k_shift = torch.zeros_like(k)
        for t in range(ks):
            k_shift = k_shift + k_pad[:, t:t + S, :] * shift_k[:, ks - 1 - t][None, None, :]
        kv = k_shift * v
        L = 2 * S
        kv_pad = _pad(kv, ((0, 0), (0, S), (0, 0)))
        kf_pad = _pad(ssm_k, ((0, 0), (0, S)))
        kv_f = (lambda x, axes=(-2, -1): torch.fft.rfft2(x.float(), dim=axes))(kv_pad[:, None, :, :], axes=(1, 2))
        kf_f = (lambda x, axes=(-2, -1): torch.fft.rfft2(x.float(), dim=axes))(kf_pad[:, None, :], axes=(1, 2))
        kf_f = (lambda x, *d: x.permute(*d))(kf_f, 1, 2, 0)
        y_f = kv_f * kf_f[None, :, :, :]
        y = (lambda x, s, axes=(-2, -1): torch.fft.irfft2(x, s=s, dim=axes).to(torch.bfloat16))(y_f, (1, L), axes=(1, 2))[:, 0, :S, :]
        y = y + kv * ssm_D[None, None, :]
        return q * y

    def _B_ref(x, w_in, w_sp, b_sp, w_out):
        B, S, D = x.shape
        F = w_in.shape[-1]
        Fh = F // 2
        z = _gelu(torch.einsum('bsd,df->bsf', x, w_in))
        z1 = z[..., :Fh].clone()
        z2 = _layernorm(z[..., Fh:], axis=-1)
        g = torch.einsum('ts,bsf->btf', w_sp, z2) + b_sp[None, :, None]
        return torch.einsum('bsf,fd->bsd', z1 * g, w_out)
    x = A_q
    mod = (_silu(c) @ w_mod).reshape(c.shape[0], 6, 1, -1)
    sa, ca, ga, sb, cb, gb = (mod[:, 0].clone(), mod[:, 1].clone(), mod[:, 2].clone(), mod[:, 3].clone(), mod[:, 4].clone(), mod[:, 5].clone())
    h = _layernorm(x, axis=-1) * (1 + ca) + sa
    x = x + ga * _A_ref(h, A_k, A_v, A_shift_k, A_ssm_k, A_ssm_D)
    h = _layernorm(x, axis=-1) * (1 + cb) + sb
    x = x + gb * _B_ref(h, B_w_in, B_w_sp, B_b_sp, B_w_out)
    return x
```

```asm
; @launch grid=(256,1,1) block=(256,1,1) lds=163840
.amdgcn_target "amdgcn-amd-amdhsa--gfx950"
.text
.globl adaLN_cond__ssm_conv_h3__mixer_gmlp__prompt_kernel
.p2align 8
.type adaLN_cond__ssm_conv_h3__mixer_gmlp__prompt_kernel,@function
adaLN_cond__ssm_conv_h3__mixer_gmlp__prompt_kernel:
  s_cmp_ge_u32 s2, 256
  s_cbranch_scc1 GM_END
  s_load_dwordx16 s[64:79], s[0:1], 0
  s_load_dwordx16 s[80:95], s[0:1], 64
  s_memrealtime s[40:41]
  s_and_b32 s4, s2, 7
  s_mul_i32 s4, s4, 18
  s_lshr_b32 s5, s2, 3
  s_add_u32 s4, s4, s5
  s_and_b32 s5, s4, 15
  s_lshr_b32 s6, s4, 4
  v_and_b32 v4, 15, v0
  v_lshrrev_b32 v6, 4, v0
  s_lshl_b32 s7, s5, 7
  v_lshl_add_u32 v8, v6, 3, s7
  s_lshl_b32 s7, s6, 7
  v_lshl_add_u32 v9, v4, 3, s7
  v_mul_u32_u24 v11, 1152, v8
  v_add_u32 v11, v11, v9
  v_subrev_u32 v10, 4608, v11
  v_add_u32 v12, 4608, v11
  v_lshlrev_b32 v15, 2, v9
  s_cmp_ge_u32 s2, 144
  s_waitcnt lgkmcnt(0)
  s_cbranch_scc1 F_COMMON
  s_mov_b32 s20, s70
  s_and_b32 s21, s71, 0xffff
  s_mov_b32 s22, 4608
  s_mov_b32 s23, 0x20000
  buffer_load_dwordx4 v[16:19], v15, s[20:23], 0 offen
  buffer_load_dwordx4 v[20:23], v15, s[20:23], 0 offen offset:16
  s_mov_b32 s12, s66
  s_and_b32 s13, s67, 0xffff
  s_mov_b32 s14, 2359296
  s_mov_b32 s15, 0x20000
  s_mov_b32 s16, s68
  s_and_b32 s17, s69, 0xffff
  s_mov_b32 s18, 2359296
  s_mov_b32 s19, 0x20000
  buffer_load_dwordx2 v[26:27], v10, s[12:15], 0 offen offset:1152
  buffer_load_dwordx2 v[28:29], v10, s[12:15], 0 offen offset:2304
  buffer_load_dwordx2 v[30:31], v10, s[12:15], 0 offen offset:3456
  buffer_load_dwordx2 v[32:33], v11, s[12:15], 0 offen offset:0
  buffer_load_dwordx2 v[48:49], v11, s[16:19], 0 offen offset:0
  buffer_load_dwordx2 v[34:35], v11, s[12:15], 0 offen offset:1152
  buffer_load_dwordx2 v[50:51], v11, s[16:19], 0 offen offset:1152
  buffer_load_dwordx2 v[36:37], v11, s[12:15], 0 offen offset:2304
  buffer_load_dwordx2 v[52:53], v11, s[16:19], 0 offen offset:2304
  buffer_load_dwordx2 v[38:39], v11, s[12:15], 0 offen offset:3456
  buffer_load_dwordx2 v[54:55], v11, s[16:19], 0 offen offset:3456
  buffer_load_dwordx2 v[40:41], v12, s[12:15], 0 offen offset:0
  buffer_load_dwordx2 v[56:57], v12, s[16:19], 0 offen offset:0
  buffer_load_dwordx2 v[42:43], v12, s[12:15], 0 offen offset:1152
  buffer_load_dwordx2 v[58:59], v12, s[16:19], 0 offen offset:1152
  buffer_load_dwordx2 v[44:45], v12, s[12:15], 0 offen offset:2304
  buffer_load_dwordx2 v[60:61], v12, s[16:19], 0 offen offset:2304
  buffer_load_dwordx2 v[46:47], v12, s[12:15], 0 offen offset:3456
  buffer_load_dwordx2 v[62:63], v12, s[16:19], 0 offen offset:3456
F_COMMON:
  s_mov_b32 s96, 64
  v_lshrrev_b32 v1, 6, v0
  v_and_b32 v2, 63, v0
  v_readfirstlane_b32 s3, v1
  v_lshlrev_b32 v3, 4, v2
  v_lshrrev_b32 v5, 4, v2
  s_mov_b32 s8, s94
  s_and_b32 s9, s95, 0xffff
  s_mov_b32 s10, 268435456
  s_mov_b32 s11, 0x20000
  s_mov_b32 s28, s92
  s_and_b32 s29, s93, 0xffff
  s_mov_b32 s30, 256
  s_mov_b32 s31, 0x20000
  v_cmp_eq_u32 vcc, 0, v2
  v_mov_b32 v250, 2147483392
  v_mov_b32 v251, 0
  v_cndmask_b32 v250, v250, 0, vcc
  s_cmp_lg_u32 s2, 255
  s_cbranch_scc1 F_NOTAG
  s_cmp_lg_u32 s3, 0
  s_cbranch_scc1 F_NOTAG
  s_mul_i32 s41, s41, 0x9e3779b1
  s_xor_b32 s40, s40, s41
  s_or_b32 s40, s40, 1
  v_mov_b32 v8, s40
  buffer_store_dword v8, v250, s[28:31], 0 offen sc1
F_NOTAG:
  s_cmp_ge_u32 s2, 144
  s_cbranch_scc1 F_OTHER
  s_mov_b32 s24, s64
  s_and_b32 s25, s65, 0xffff
  s_mov_b32 s26, 2359296
  s_mov_b32 s27, 0x20000
  s_mov_b32 s32, s72
  s_and_b32 s33, s73, 0xffff
  s_mov_b32 s34, 2359296
  s_mov_b32 s35, 0x20000
  s_mov_b32 s97, 0xffff0000
  s_mul_i32 s38, s3, 25792
  s_lshl_b32 s7, s4, 2
  s_add_u32 s7, s7, s3
  s_lshl_b32 s44, s7, 12
  s_mul_i32 s46, s7, 4608
  v_sub_u32 v13, 15, v6
  v_and_b32 v11, 7, v4
  v_xor_b32 v13, v13, v11
  v_lshlrev_b32 v13, 4, v13
  v_lshl_add_u32 v13, v4, 10, v13
  v_add_u32 v13, 103168, v13
  v_mul_u32_u24 v15, 1152, v5
  v_lshl_add_u32 v15, v4, 3, v15
  s_mov_b32 s7, 0
  s_waitcnt vmcnt(0)
  buffer_load_dwordx2 v[224:225], v15, s[24:27], s46 offen offset:0
  buffer_load_dwordx2 v[226:227], v15, s[24:27], s46 offen offset:128
  buffer_load_dwordx2 v[228:229], v15, s[24:27], s46 offen offset:256
  buffer_load_dwordx2 v[230:231], v15, s[24:27], s46 offen offset:384
  buffer_load_dwordx2 v[232:233], v15, s[24:27], s46 offen offset:512
  buffer_load_dwordx2 v[234:235], v15, s[24:27], s46 offen offset:640
  buffer_load_dwordx2 v[236:237], v15, s[24:27], s46 offen offset:768
  buffer_load_dwordx2 v[238:239], v15, s[24:27], s46 offen offset:896
  buffer_load_dwordx2 v[240:241], v15, s[24:27], s46 offen offset:1024
  s_add_u32 m0, s38, 60
  s_nop 0
  buffer_load_dwordx4 v3, s[32:35], s44 offen offset:0 lds
  buffer_load_dwordx4 v3, s[32:35], s44 offen offset:1024 lds
  buffer_load_dwordx4 v3, s[32:35], s44 offen offset:2048 lds
  buffer_load_dwordx4 v3, s[32:35], s44 offen offset:3072 lds
F_KV:
  v_lshlrev_b32 v64, 16, v16
  v_lshlrev_b32 v65, 16, v18
  v_and_b32 v66, s97, v16
  v_and_b32 v67, s97, v18
  v_lshlrev_b32 v68, 16, v17
  v_lshlrev_b32 v69, 16, v19
  v_and_b32 v70, s97, v17
  v_and_b32 v71, s97, v19
  v_lshlrev_b32 v82, 16, v26
  v_and_b32 v83, s97, v26
  v_mov_b32 v26, v27
  v_lshlrev_b32 v84, 16, v28
  v_and_b32 v85, s97, v28
  v_mov_b32 v28, v29
  v_lshlrev_b32 v86, 16, v30
  v_and_b32 v87, s97, v30
  v_mov_b32 v30, v31
  v_lshlrev_b32 v88, 16, v32
  v_and_b32 v89, s97, v32
  v_mov_b32 v32, v33
  v_lshlrev_b32 v90, 16, v34
  v_and_b32 v91, s97, v34
  v_mov_b32 v34, v35
  v_lshlrev_b32 v92, 16, v36
  v_and_b32 v93, s97, v36
  v_mov_b32 v36, v37
  v_lshlrev_b32 v94, 16, v38
  v_and_b32 v95, s97, v38
  v_mov_b32 v38, v39
  v_lshlrev_b32 v96, 16, v40
  v_and_b32 v97, s97, v40
  v_mov_b32 v40, v41
  v_lshlrev_b32 v98, 16, v42
  v_and_b32 v99, s97, v42
  v_mov_b32 v42, v43
  v_lshlrev_b32 v100, 16, v44
  v_and_b32 v101, s97, v44
  v_mov_b32 v44, v45
  v_lshlrev_b32 v102, 16, v46
  v_and_b32 v103, s97, v46
  v_mov_b32 v46, v47
  v_lshlrev_b32 v128, 16, v48
  v_and_b32 v129, s97, v48
  v_mov_b32 v48, v49
  v_lshlrev_b32 v130, 16, v50
  v_and_b32 v131, s97, v50
  v_mov_b32 v50, v51
  v_lshlrev_b32 v132, 16, v52
  v_and_b32 v133, s97, v52
  v_mov_b32 v52, v53
  v_lshlrev_b32 v134, 16, v54
  v_and_b32 v135, s97, v54
  v_mov_b32 v54, v55
  v_lshlrev_b32 v136, 16, v56
  v_and_b32 v137, s97, v56
  v_mov_b32 v56, v57
  v_lshlrev_b32 v138, 16, v58
  v_and_b32 v139, s97, v58
  v_mov_b32 v58, v59
  v_lshlrev_b32 v140, 16, v60
  v_and_b32 v141, s97, v60
  v_mov_b32 v60, v61
  v_lshlrev_b32 v142, 16, v62
  v_and_b32 v143, s97, v62
  v_mov_b32 v62, v63
  v_mov_b32 v16, v20
  v_mov_b32 v17, v21
  v_mov_b32 v18, v22
  v_mov_b32 v19, v23
  v_pk_mul_f32 v[160:161], v[82:83], v[70:71]
  v_pk_fma_f32 v[160:161], v[84:85], v[68:69], v[160:161]
  v_pk_fma_f32 v[160:161], v[86:87], v[66:67], v[160:161]
  v_pk_fma_f32 v[160:161], v[88:89], v[64:65], v[160:161]
  v_pk_mul_f32 v[160:161], v[160:161], v[128:129]
  v_pk_mul_f32 v[162:163], v[84:85], v[70:71]
  v_pk_fma_f32 v[162:163], v[86:87], v[68:69], v[162:163]
  v_pk_fma_f32 v[162:163], v[88:89], v[66:67], v[162:163]
  v_pk_fma_f32 v[162:163], v[90:91], v[64:65], v[162:163]
  v_pk_mul_f32 v[162:163], v[162:163], v[130:131]
  v_pk_mul_f32 v[164:165], v[86:87], v[70:71]
  v_pk_fma_f32 v[164:165], v[88:89], v[68:69], v[164:165]
  v_pk_fma_f32 v[164:165], v[90:91], v[66:67], v[164:165]
  v_pk_fma_f32 v[164:165], v[92:93], v[64:65], v[164:165]
  v_pk_mul_f32 v[164:165], v[164:165], v[132:133]
  v_pk_mul_f32 v[166:167], v[88:89], v[70:71]
  v_pk_fma_f32 v[166:167], v[90:91], v[68:69], v[166:167]
  v_pk_fma_f32 v[166:167], v[92:93], v[66:67], v[166:167]
  v_pk_fma_f32 v[166:167], v[94:95], v[64:65], v[166:167]
  v_pk_mul_f32 v[166:167], v[166:167], v[134:135]
  v_pk_mul_f32 v[168:169], v[90:91], v[70:71]
  v_pk_fma_f32 v[168:169], v[92:93], v[68:69], v[168:169]
  v_pk_fma_f32 v[168:169], v[94:95], v[66:67], v[168:169]
  v_pk_fma_f32 v[168:169], v[96:97], v[64:65], v[168:169]
  v_pk_mul_f32 v[168:169], v[168:169], v[136:137]
  v_pk_mul_f32 v[170:171], v[92:93], v[70:71]
  v_pk_fma_f32 v[170:171], v[94:95], v[68:69], v[170:171]
  v_pk_fma_f32 v[170:171], v[96:97], v[66:67], v[170:171]
  v_pk_fma_f32 v[170:171], v[98:99], v[64:65], v[170:171]
  v_pk_mul_f32 v[170:171], v[170:171], v[138:139]
  v_pk_mul_f32 v[172:173], v[94:95], v[70:71]
  v_pk_fma_f32 v[172:173], v[96:97], v[68:69], v[172:173]
  v_pk_fma_f32 v[172:173], v[98:99], v[66:67], v[172:173]
  v_pk_fma_f32 v[172:173], v[100:101], v[64:65], v[172:173]
  v_pk_mul_f32 v[172:173], v[172:173], v[140:141]
  v_pk_mul_f32 v[174:175], v[96:97], v[70:71]
  v_pk_fma_f32 v[174:175], v[98:99], v[68:69], v[174:175]
  v_pk_fma_f32 v[174:175], v[100:101], v[66:67], v[174:175]
  v_pk_fma_f32 v[174:175], v[102:103], v[64:65], v[174:175]
  v_pk_mul_f32 v[174:175], v[174:175], v[142:143]
  v_cvt_pk_bf16_f32 v192, v174, v172
  v_cvt_pk_bf16_f32 v193, v170, v168
  v_cvt_pk_bf16_f32 v194, v166, v164
  v_cvt_pk_bf16_f32 v195, v162, v160
  ds_write_b128 v13, v[192:195] offset:0
  v_cvt_pk_bf16_f32 v196, v175, v173
  v_cvt_pk_bf16_f32 v197, v171, v169
  v_cvt_pk_bf16_f32 v198, v167, v165
  v_cvt_pk_bf16_f32 v199, v163, v161
  ds_write_b128 v13, v[196:199] offset:256
  v_add_u32 v13, 512, v13
  s_xor_b32 s7, s7, 1
  s_cbranch_scc1 F_KV
  buffer_load_dword v251, v251, s[28:31], 0 offen sc1
  v_xor_b32 v12, v4, v1
  v_lshlrev_b32 v12, 4, v12
  v_lshl_add_u32 v12, v6, 8, v12
  v_add_u32 v12, 103168, v12
  v_xor_b32 v10, 64, v12
  v_lshlrev_b32 v11, 12, v6
  v_lshl_add_u32 v11, v4, 4, v11
  s_lshl_b32 s46, s6, 18
  s_sub_u32 s47, 15, s5
  s_lshl_b32 s47, s47, 8
  s_add_u32 s46, s46, s47
  s_waitcnt lgkmcnt(0)
  s_barrier
  ds_read_b128 v[60:63], v12 offset:0
  ds_read_b128 v[64:67], v10 offset:4096
  ds_read_b128 v[68:71], v12 offset:8192
  ds_read_b128 v[72:75], v10 offset:12288
  s_waitcnt lgkmcnt(3)
  buffer_store_dwordx4 v[60:63], v11, s[8:11], s46 offen sc1
  s_add_u32 s46, s46, 65536
  s_waitcnt lgkmcnt(2)
  buffer_store_dwordx4 v[64:67], v11, s[8:11], s46 offen sc1
  s_add_u32 s46, s46, 65536
  s_waitcnt lgkmcnt(1)
  buffer_store_dwordx4 v[68:71], v11, s[8:11], s46 offen sc1
  s_add_u32 s46, s46, 65536
  s_waitcnt lgkmcnt(0)
  buffer_store_dwordx4 v[72:75], v11, s[8:11], s46 offen sc1
  s_add_u32 m0, s38, 4216
  s_nop 0
  buffer_load_dwordx4 v3, s[32:35], s44 offen offset:0 lds
  buffer_load_dwordx4 v3, s[32:35], s44 offen offset:1024 lds
  buffer_load_dwordx4 v3, s[32:35], s44 offen offset:2048 lds
  buffer_load_dwordx4 v3, s[32:35], s44 offen offset:3072 lds
  s_add_u32 m0, s38, 8372
  s_nop 0
  buffer_load_dwordx4 v3, s[32:35], s44 offen offset:0 lds
  buffer_load_dwordx4 v3, s[32:35], s44 offen offset:1024 lds
  buffer_load_dwordx4 v3, s[32:35], s44 offen offset:2048 lds
  buffer_load_dwordx4 v3, s[32:35], s44 offen offset:3072 lds
  s_add_u32 m0, s38, 12528
  s_nop 0
  buffer_load_dwordx4 v3, s[32:35], s44 offen offset:0 lds
  buffer_load_dwordx4 v3, s[32:35], s44 offen offset:1024 lds
  buffer_load_dwordx4 v3, s[32:35], s44 offen offset:2048 lds
  buffer_load_dwordx4 v3, s[32:35], s44 offen offset:3072 lds
  s_mov_b32 s45, s44
  v_and_b32 v7, 31, v0
  v_lshrrev_b32 v8, 1, v6
  v_and_b32 v9, 7, v4
  v_xor_b32 v8, v8, v9
  v_and_b32 v9, 1, v5
  v_lshlrev_b32 v9, 3, v9
  v_lshl_add_u32 v9, v4, 7, v9
  v_lshl_add_u32 v10, v8, 4, v9
  v_add_u32 v10, 140032, v10
  s_waitcnt vmcnt(21)
  ds_write_b64 v10, v[224:225] offset:0
  ds_write_b64 v10, v[226:227] offset:2048
  ds_write_b64 v10, v[228:229] offset:4096
  ds_write_b64 v10, v[230:231] offset:6144
  ds_write_b64 v10, v[232:233] offset:8192
  ds_write_b64 v10, v[234:235] offset:10240
  ds_write_b64 v10, v[236:237] offset:12288
  ds_write_b64 v10, v[238:239] offset:14336
  ds_write_b64 v10, v[240:241] offset:16384
  v_lshlrev_b32 v80, 16, v224
  v_and_b32 v81, s97, v224
  v_lshlrev_b32 v82, 16, v225
  v_and_b32 v83, s97, v225
  v_lshlrev_b32 v84, 16, v226
  v_and_b32 v85, s97, v226
  v_lshlrev_b32 v86, 16, v227
  v_and_b32 v87, s97, v227
  v_lshlrev_b32 v88, 16, v228
  v_and_b32 v89, s97, v228
  v_lshlrev_b32 v90, 16, v229
  v_and_b32 v91, s97, v229
  v_lshlrev_b32 v92, 16, v230
  v_and_b32 v93, s97, v230
  v_lshlrev_b32 v94, 16, v231
  v_and_b32 v95, s97, v231
  v_lshlrev_b32 v96, 16, v232
  v_and_b32 v97, s97, v232
  v_lshlrev_b32 v98, 16, v233
  v_and_b32 v99, s97, v233
  v_lshlrev_b32 v100, 16, v234
  v_and_b32 v101, s97, v234
  v_lshlrev_b32 v102, 16, v235
  v_and_b32 v103, s97, v235
  v_lshlrev_b32 v104, 16, v236
  v_and_b32 v105, s97, v236
  v_lshlrev_b32 v106, 16, v237
  v_and_b32 v107, s97, v237
  v_lshlrev_b32 v108, 16, v238
  v_and_b32 v109, s97, v238
  v_lshlrev_b32 v110, 16, v239
  v_and_b32 v111, s97, v239
  v_lshlrev_b32 v112, 16, v240
  v_and_b32 v113, s97, v240
  v_lshlrev_b32 v114, 16, v241
  v_and_b32 v115, s97, v241
  v_pk_add_f32 v[16:17], v[80:81], v[82:83]
  v_pk_add_f32 v[16:17], v[16:17], v[84:85]
  v_pk_add_f32 v[16:17], v[16:17], v[86:87]
  v_pk_add_f32 v[16:17], v[16:17], v[88:89]
  v_pk_add_f32 v[16:17], v[16:17], v[90:91]
  v_pk_add_f32 v[16:17], v[16:17], v[92:93]
  v_pk_add_f32 v[16:17], v[16:17], v[94:95]
  v_pk_add_f32 v[16:17], v[16:17], v[96:97]
  v_pk_add_f32 v[16:17], v[16:17], v[98:99]
  v_pk_add_f32 v[16:17], v[16:17], v[100:101]
  v_pk_add_f32 v[16:17], v[16:17], v[102:103]
  v_pk_add_f32 v[16:17], v[16:17], v[104:105]
  v_pk_add_f32 v[16:17], v[16:17], v[106:107]
  v_pk_add_f32 v[16:17], v[16:17], v[108:109]
  v_pk_add_f32 v[16:17], v[16:17], v[110:111]
  v_pk_add_f32 v[16:17], v[16:17], v[112:113]
  v_pk_add_f32 v[16:17], v[16:17], v[114:115]
  v_add_f32 v16, v16, v17
  s_waitcnt vmcnt(12)
  v_readfirstlane_b32 s42, v251
  s_nop 3
  s_cmp_lg_u32 s42, 0
  s_cbranch_scc1 F_C_NG
  s_mov_b32 s43, 0
  v_mov_b32 v251, 0
F_C_NP:
  buffer_load_dword v251, v251, s[28:31], 0 offen sc1
  s_waitcnt vmcnt(0)
  v_readfirstlane_b32 s42, v251
  s_add_u32 s43, s43, 1
  s_cmp_ge_u32 s43, 0x80000
  s_cbranch_scc1 F_C_NG
  s_cmp_lg_u32 s42, 0
  s_cbranch_scc1 F_C_NG
  s_sleep 2
  s_branch F_C_NP
F_C_NG:
  v_mov_b32 v24, s42
  s_lshr_b32 s7, s44, 5
  s_add_u32 s7, s7, 5111808
  buffer_store_dword v24, v250, s[8:11], s7 offen sc1
  s_nop 1
  v_add_f32_dpp v16, v16, v16 row_ror:8 row_mask:0xf bank_mask:0xf
  s_nop 1
  v_add_f32_dpp v16, v16, v16 row_ror:4 row_mask:0xf bank_mask:0xf
  s_nop 1
  v_add_f32_dpp v16, v16, v16 row_ror:2 row_mask:0xf bank_mask:0xf
  s_nop 1
  v_add_f32_dpp v16, v16, v16 row_ror:1 row_mask:0xf bank_mask:0xf
  v_mul_f32 v16, 0x3ae38e39, v16
  v_pk_add_f32 v[80:81], v[80:81], v[16:17] op_sel_hi:[1,0] neg_lo:[0,1] neg_hi:[0,1]
  v_pk_add_f32 v[82:83], v[82:83], v[16:17] op_sel_hi:[1,0] neg_lo:[0,1] neg_hi:[0,1]
  v_pk_add_f32 v[84:85], v[84:85], v[16:17] op_sel_hi:[1,0] neg_lo:[0,1] neg_hi:[0,1]
  v_pk_add_f32 v[86:87], v[86:87], v[16:17] op_sel_hi:[1,0] neg_lo:[0,1] neg_hi:[0,1]
  v_pk_add_f32 v[88:89], v[88:89], v[16:17] op_sel_hi:[1,0] neg_lo:[0,1] neg_hi:[0,1]
  v_pk_add_f32 v[90:91], v[90:91], v[16:17] op_sel_hi:[1,0] neg_lo:[0,1] neg_hi:[0,1]
  v_pk_add_f32 v[92:93], v[92:93], v[16:17] op_sel_hi:[1,0] neg_lo:[0,1] neg_hi:[0,1]
  v_pk_add_f32 v[94:95], v[94:95], v[16:17] op_sel_hi:[1,0] neg_lo:[0,1] neg_hi:[0,1]
  v_pk_add_f32 v[96:97], v[96:97], v[16:17] op_sel_hi:[1,0] neg_lo:[0,1] neg_hi:[0,1]
  v_pk_add_f32 v[98:99], v[98:99], v[16:17] op_sel_hi:[1,0] neg_lo:[0,1] neg_hi:[0,1]
  v_pk_add_f32 v[100:101], v[100:101], v[16:17] op_sel_hi:[1,0] neg_lo:[0,1] neg_hi:[0,1]
  v_pk_add_f32 v[102:103], v[102:103], v[16:17] op_sel_hi:[1,0] neg_lo:[0,1] neg_hi:[0,1]
  v_pk_add_f32 v[104:105], v[104:105], v[16:17] op_sel_hi:[1,0] neg_lo:[0,1] neg_hi:[0,1]
  v_pk_add_f32 v[106:107], v[106:107], v[16:17] op_sel_hi:[1,0] neg_lo:[0,1] neg_hi:[0,1]
  v_pk_add_f32 v[108:109], v[108:109], v[16:17] op_sel_hi:[1,0] neg_lo:[0,1] neg_hi:[0,1]
  v_pk_add_f32 v[110:111], v[110:111], v[16:17] op_sel_hi:[1,0] neg_lo:[0,1] neg_hi:[0,1]
  v_pk_add_f32 v[112:113], v[112:113], v[16:17] op_sel_hi:[1,0] neg_lo:[0,1] neg_hi:[0,1]
  v_pk_add_f32 v[114:115], v[114:115], v[16:17] op_sel_hi:[1,0] neg_lo:[0,1] neg_hi:[0,1]
  v_pk_mul_f32 v[20:21], v[80:81], v[80:81]
  v_pk_fma_f32 v[20:21], v[82:83], v[82:83], v[20:21]
  v_pk_fma_f32 v[20:21], v[84:85], v[84:85], v[20:21]
  v_pk_fma_f32 v[20:21], v[86:87], v[86:87], v[20:21]
  v_pk_fma_f32 v[20:21], v[88:89], v[88:89], v[20:21]
  v_pk_fma_f32 v[20:21], v[90:91], v[90:91], v[20:21]
  v_pk_fma_f32 v[20:21], v[92:93], v[92:93], v[20:21]
  v_pk_fma_f32 v[20:21], v[94:95], v[94:95], v[20:21]
  v_pk_fma_f32 v[20:21], v[96:97], v[96:97], v[20:21]
  v_pk_fma_f32 v[20:21], v[98:99], v[98:99], v[20:21]
  v_pk_fma_f32 v[20:21], v[100:101], v[100:101], v[20:21]
  v_pk_fma_f32 v[20:21], v[102:103], v[102:103], v[20:21]
  v_pk_fma_f32 v[20:21], v[104:105], v[104:105], v[20:21]
  v_pk_fma_f32 v[20:21], v[106:107], v[106:107], v[20:21]
  v_pk_fma_f32 v[20:21], v[108:109], v[108:109], v[20:21]
  v_pk_fma_f32 v[20:21], v[110:111], v[110:111], v[20:21]
  v_pk_fma_f32 v[20:21], v[112:113], v[112:113], v[20:21]
  v_pk_fma_f32 v[20:21], v[114:115], v[114:115], v[20:21]
  v_add_f32 v20, v20, v21
  s_nop 1
  v_add_f32_dpp v20, v20, v20 row_ror:8 row_mask:0xf bank_mask:0xf
  s_nop 1
  v_add_f32_dpp v20, v20, v20 row_ror:4 row_mask:0xf bank_mask:0xf
  s_nop 1
  v_add_f32_dpp v20, v20, v20 row_ror:2 row_mask:0xf bank_mask:0xf
  s_nop 1
  v_add_f32_dpp v20, v20, v20 row_ror:1 row_mask:0xf bank_mask:0xf
  v_mov_b32 v21, 0x3727c5ac
  v_fmac_f32 v21, 0x3ae38e39, v20
  v_rsq_f32 v20, v21
  v_lshlrev_b32 v8, 3, v6
  v_add_u32 v8, 158464, v8
  v_mul_f32 v21, -v16, v20
  ds_write_b64 v8, v[20:21]
  v_subrev_u32 v10, 64, v0
  v_lshrrev_b32 v10, 3, v10
  v_and_b32 v11, 7, v2
  v_xor_b32 v12, v11, v10
  v_and_b32 v12, 7, v12
  v_lshlrev_b32 v12, 4, v12
  v_lshl_add_u32 v12, v10, 7, v12
  v_add_u32 v12, 140032, v12
  v_lshlrev_b32 v10, 14, v10
  v_lshl_add_u32 v10, v11, 4, v10
  s_lshl_b32 s47, s4, 7
  s_add_u32 s46, s47, 4718592
  s_add_u32 s47, s47, 26214400
  s_waitcnt lgkmcnt(0)
  s_barrier
  s_cmp_ge_u32 s4, 128
  s_cbranch_scc1 F_Q_SKIP
  s_cmp_eq_u32 s3, 0
  s_cbranch_scc1 F_Q_SKIP
  ds_read_b128 v[60:63], v12 offset:0
  ds_read_b128 v[64:67], v12 offset:3072
  ds_read_b128 v[68:71], v12 offset:6144
  ds_read_b128 v[72:75], v12 offset:9216
  ds_read_b128 v[76:79], v12 offset:12288
  ds_read_b128 v[80:83], v12 offset:15360
  s_waitcnt lgkmcnt(5)
  buffer_store_dwordx4 v[60:63], v10, s[8:11], s47 offen sc1
  s_add_u32 s47, s47, 393216
  s_waitcnt lgkmcnt(4)
  buffer_store_dwordx4 v[64:67], v10, s[8:11], s47 offen sc1
  s_add_u32 s47, s47, 393216
  s_waitcnt lgkmcnt(3)
  buffer_store_dwordx4 v[68:71], v10, s[8:11], s47 offen sc1
  s_add_u32 s47, s47, 393216
  s_waitcnt lgkmcnt(2)
  buffer_store_dwordx4 v[72:75], v10, s[8:11], s47 offen sc1
  s_add_u32 s47, s47, 393216
  s_waitcnt lgkmcnt(1)
  buffer_store_dwordx4 v[76:79], v10, s[8:11], s47 offen sc1
  s_add_u32 s47, s47, 393216
  s_waitcnt lgkmcnt(0)
  buffer_store_dwordx4 v[80:83], v10, s[8:11], s47 offen sc1
  s_cmp_lg_u32 s3, 2
  s_cbranch_scc1 F_Q_SKIP
  v_lshlrev_b32 v11, 4, v11
  v_add_u32 v12, 158464, v11
  ds_read_b128 v[84:87], v12
  s_mov_b64 exec, 0xff
  s_waitcnt lgkmcnt(0)
  buffer_store_dwordx4 v[84:87], v11, s[8:11], s46 offen sc1
  s_mov_b64 exec, -1
F_Q_SKIP:
  s_lshl_b32 s7, s4, 3
  s_load_dwordx2 s[20:21], s[74:75], s7
  s_lshl_b32 s7, s6, 6
  s_and_b32 s22, s4, 3
  s_add_u32 s7, s7, s22
  v_lshl_add_u32 v14, v4, 2, s7
  v_lshlrev_b32 v14, 7, v14
  v_add_u32 v14, 5111808, v14
  v_mov_b32 v8, 0
  v_mov_b32 v9, 0
  v_mov_b32 v10, 0
  v_mov_b32 v11, 0
  v_mul_u32_u24 v12, 4160, v5
  v_lshl_add_u32 v12, v4, 2, v12
  v_add_u32 v12, s38, v12
  v_add_u32 v13, v4, v5
  v_lshrrev_b32 v16, 5, v2
  v_mul_u32_u24 v16, 4576, v16
  v_lshl_add_u32 v16, v7, 4, v16
  v_add_u32 v16, s38, v16
  v_cmp_gt_u32 vcc, 15, v13
  s_and_saveexec_b64 s[46:47], vcc
  ds_write_b32 v12, v8
  s_mov_b64 exec, s[46:47]
  v_cmp_gt_u32 vcc, 28, v7
  s_and_saveexec_b64 s[46:47], vcc
  ds_write_b128 v16, v[8:11] offset:20736
  s_mov_b64 exec, s[46:47]
  v_and_b32 v12, 3, v4
  v_mul_u32_u24 v12, 4160, v12
  v_lshrrev_b32 v13, 2, v4
  v_add_u32 v13, v13, v5
  v_lshl_add_u32 v12, v13, 4, v12
  v_add_u32 v12, s38, v12
  v_lshrrev_b32 v13, 3, v4
  v_mul_u32_u24 v13, 4576, v13
  v_lshl_add_u32 v13, v5, 4, v13
  v_and_b32 v16, 7, v4
  v_lshlrev_b32 v16, 6, v16
  v_sub_u32 v13, v13, v16
  s_add_u32 s7, s38, 17088
  v_add_u32 v13, s7, v13
  v_lshrrev_b32 v15, 3, v2
  v_lshlrev_b32 v15, 5, v15
  v_and_b32 v16, 7, v2
  s_lshl_b32 s7, s3, 3
  v_add3_u32 v15, v15, v16, s7
  v_and_b32 v16, 3, v2
  v_lshlrev_b32 v15, 7, v15
  v_add_u32 v15, 5185536, v15
  v_bfe_u32 v17, v2, 3, 2
  v_min_u32 v17, 2, v17
  v_mul_u32_u24 v17, 576, v17
  v_bfe_u32 v18, v2, 2, 1
  v_mul_u32_u24 v18, 3456, v18
  s_lshl_b32 s7, s4, 2
  v_add3_u32 v16, v16, v17, v18
  v_add_u32 v16, s7, v16
  v_lshlrev_b32 v16, 3, v16
  v_add_u32 v16, 8126464, v16
  v_cmp_gt_u32 vcc, 32, v2
  v_lshlrev_b32 v221, 4, v0
  v_lshrrev_b32 v17, 4, v0
  v_cndmask_b32 v220, v16, v15, vcc
  v_mul_u32_u24 v242, 144, v17
  v_bfe_u32 v15, v0, 2, 2
  v_and_b32 v16, 3, v0
  v_lshl_add_u32 v16, v15, 3, v16
  v_lshl_add_u32 v242, v16, 2, v242
  v_add_u32 v242, 103168, v242
  v_mul_u32_u24 v222, 36864, v17
  v_bfe_u32 v16, v0, 1, 1
  v_mul_u32_u24 v16, 18432, v16
  v_add_u32 v222, v222, v16
  v_lshl_add_u32 v222, v15, 5, v222
  v_and_b32 v15, 1, v0
  v_lshl_add_u32 v222, v15, 4, v222
  v_add_u32 v243, 9216, v242
  v_add_u32 v244, 18432, v242
  v_add_u32 v245, 27648, v242
  v_and_b32 v6, 7, v4
  v_mul_u32_u24 v6, 144, v6
  v_lshl_add_u32 v6, v5, 5, v6
  v_lshrrev_b32 v15, 3, v4
  v_lshl_add_u32 v6, v15, 4, v6
  s_mul_i32 s7, s3, 9216
  s_add_u32 s7, s7, 103168
  v_add_u32 v6, s7, v6
  s_lshl_b32 s36, s4, 14
  s_add_u32 s36, s36, 26214400
  s_mov_b32 s37, 4718592
  s_waitcnt lgkmcnt(0)
  s_cmp_ge_u32 s3, 2
  s_cselect_b32 s7, s21, s20
  s_and_b32 s22, s3, 1
  s_lshl_b32 s22, s22, 4
  s_lshr_b32 s7, s7, s22
  s_and_b32 s7, s7, 0xffff
  v_mov_b32 v15, s7
  v_lshl_add_u32 v16, v5, 2, v4
  v_cmp_eq_u32 vcc, 15, v16
  s_nop 1
  v_cndmask_b32 v8, 0, v15, vcc
  v_cmp_eq_u32 vcc, 14, v16
  s_nop 1
  v_cndmask_b32 v9, 0, v15, vcc
  v_cmp_eq_u32 vcc, 13, v16
  s_nop 1
  v_cndmask_b32 v10, 0, v15, vcc
  v_cmp_eq_u32 vcc, 12, v16
  s_nop 1
  v_cndmask_b32 v11, 0, v15, vcc
  s_cmp_lg_u32 s3, 0
  s_cbranch_scc1 F_U_GO
  s_mov_b32 s43, 0
F_U_POLL:
  buffer_load_dword v15, v14, s[8:11], 0 offen sc1
  s_waitcnt vmcnt(0)
  v_cmp_ne_u32 vcc, s42, v15
  s_add_u32 s43, s43, 1
  s_cmp_ge_u32 s43, 0x80000
  s_cbranch_scc1 F_U_GO
  s_nop 2
  s_cbranch_vccz F_U_GO
  s_sleep 1
  s_branch F_U_POLL
F_U_GO:
  s_waitcnt vmcnt(0)
  s_barrier
  buffer_load_dwordx4 v[112:115], v3, s[8:11], s45 offen offset:0 sc1
  buffer_load_dword v116, v3, s[8:11], s45 offen offset:16 sc1
  buffer_load_dwordx4 v[120:123], v3, s[8:11], s45 offen offset:1024 sc1
  buffer_load_dword v124, v3, s[8:11], s45 offen offset:1040 sc1
  buffer_load_dwordx4 v[128:131], v3, s[8:11], s45 offen offset:2048 sc1
  buffer_load_dword v132, v3, s[8:11], s45 offen offset:2064 sc1
  buffer_load_dwordx4 v[136:139], v3, s[8:11], s45 offen offset:3072 sc1
  buffer_load_dword v140, v3, s[8:11], s45 offen offset:3088 sc1
  s_lshl_b32 s7, s4, 7
  s_add_u32 s7, s7, 5185536
  s_cmp_lg_u32 s3, 1
  s_cselect_b32 s7, 0x40000000, s7
  buffer_store_dword v24, v250, s[8:11], s7 offen offset:4 sc1
  s_add_u32 s7, s38, 16640
  v_add_u32 v14, s7, v3
  v_cmp_eq_u32 vcc, 63, v2
  ds_read_b128 v[48:51], v12 offset:0
  ds_read_b128 v[52:55], v12 offset:512
  ds_read_b128 v[56:59], v12 offset:1024
  ds_read_b128 v[60:63], v12 offset:1536
  ds_read_b128 v[64:67], v12 offset:2048
  ds_read_b128 v[68:71], v12 offset:2560
  ds_read_b128 v[72:75], v12 offset:3072
  ds_read_b128 v[76:79], v12 offset:3584
  v_mov_b32 v248, 0
  v_lshlrev_b32 v249, 2, v0
  s_lshl_b32 s46, s2, 10
  s_add_u32 s46, s46, 4849664
  buffer_store_dword v248, v249, s[8:11], s46 offen sc1
  s_lshl_b32 s46, s2, 2
  s_add_u32 s46, s46, s3
  s_lshl_b32 s46, s46, 7
  s_add_u32 s46, s46, 7864320
  buffer_store_dword v248, v250, s[8:11], s46 offen sc1
  s_add_u32 s46, s46, 131072
  buffer_store_dword v248, v250, s[8:11], s46 offen sc1
  s_getpc_b64 s[12:13]
F_PC2:
  s_sub_u32 s12, s12, F_PC2-adaLN_cond__ssm_conv_h3__mixer_gmlp__prompt_kernel
  s_subb_u32 s13, s13, 0
  s_and_b32 s13, s13, 0xffff
  s_mov_b32 s14, GM_CODE_END-adaLN_cond__ssm_conv_h3__mixer_gmlp__prompt_kernel
  s_mov_b32 s15, 0x20000
  s_lshr_b32 s7, s2, 3
  s_lshl_b32 s7, s7, 7
  v_mul_u32_u24 v7, 2304, v0
  buffer_load_dword v246, v7, s[12:15], s7 offen
  s_waitcnt vmcnt(11)
  ds_write_b128 v14, v[112:115] offset:4576
  v_alignbit_b32 v144, v113, v112, 16
  v_alignbit_b32 v145, v114, v113, 16
  v_alignbit_b32 v146, v115, v114, 16
  v_alignbit_b32 v147, v116, v115, 16
  ds_write_b128 v14, v[144:147] offset:0
  s_waitcnt vmcnt(9)
  ds_write_b128 v14, v[120:123] offset:5600
  v_alignbit_b32 v148, v121, v120, 16
  v_alignbit_b32 v149, v122, v121, 16
  v_alignbit_b32 v150, v123, v122, 16
  v_alignbit_b32 v151, v124, v123, 16
  ds_write_b128 v14, v[148:151] offset:1024
  s_waitcnt lgkmcnt(0)
  s_waitcnt vmcnt(7)
  ds_write_b128 v14, v[128:131] offset:6624
  v_alignbit_b32 v152, v129, v128, 16
  v_alignbit_b32 v153, v130, v129, 16
  v_alignbit_b32 v154, v131, v130, 16
  v_alignbit_b32 v155, v132, v131, 16
  ds_write_b128 v14, v[152:155] offset:2048
  s_waitcnt vmcnt(5)
  v_cndmask_b32 v140, v140, 0, vcc
  ds_write_b128 v14, v[136:139] offset:7648
  v_alignbit_b32 v156, v137, v136, 16
  v_alignbit_b32 v157, v138, v137, 16
  v_alignbit_b32 v158, v139, v138, 16
  v_alignbit_b32 v159, v140, v139, 16
  ds_write_b128 v14, v[156:159] offset:3072
  s_waitcnt lgkmcnt(0)
  ds_read_b128 v[80:83], v13 offset:3584
  ds_read_b128 v[84:87], v13 offset:3072
  ds_read_b128 v[88:91], v13 offset:2560
  ds_read_b128 v[92:95], v13 offset:2048
  ds_read_b128 v[96:99], v13 offset:1536
  ds_read_b128 v[100:103], v13 offset:1024
  ds_read_b128 v[104:107], v13 offset:512
  ds_read_b128 v[108:111], v13 offset:0
  s_waitcnt lgkmcnt(0)
  v_mfma_f32_16x16x32_bf16 v[16:19], v[8:11], v[80:83], 0
  v_mfma_f32_16x16x32_bf16 v[20:23], v[8:11], v[84:87], 0
  v_mfma_f32_16x16x32_bf16 v[24:27], v[8:11], v[88:91], 0
  v_mfma_f32_16x16x32_bf16 v[28:31], v[8:11], v[92:95], 0
  v_mfma_f32_16x16x32_bf16 v[32:35], v[8:11], v[96:99], 0
  v_mfma_f32_16x16x32_bf16 v[36:39], v[8:11], v[100:103], 0
  v_mfma_f32_16x16x32_bf16 v[40:43], v[8:11], v[104:107], 0
  v_mfma_f32_16x16x32_bf16 v[44:47], v[8:11], v[108:111], 0
  s_mov_b32 s7, 0
F_CLOOP:
  v_mfma_f32_16x16x32_bf16 v[16:19], v[48:51], v[80:83], v[16:19]
  ds_read_b128 v[144:147], v13 offset:3648
  v_mfma_f32_16x16x32_bf16 v[20:23], v[48:51], v[84:87], v[20:23]
  ds_read_b128 v[112:115], v12 offset:64
  v_mfma_f32_16x16x32_bf16 v[24:27], v[48:51], v[88:91], v[24:27]
  ds_read_b128 v[148:151], v13 offset:3136
  v_mfma_f32_16x16x32_bf16 v[28:31], v[48:51], v[92:95], v[28:31]
  ds_read_b128 v[116:119], v12 offset:576
  v_mfma_f32_16x16x32_bf16 v[32:35], v[48:51], v[96:99], v[32:35]
  ds_read_b128 v[152:155], v13 offset:2624
  v_mfma_f32_16x16x32_bf16 v[36:39], v[48:51], v[100:103], v[36:39]
  ds_read_b128 v[120:123], v12 offset:1088
  v_mfma_f32_16x16x32_bf16 v[40:43], v[48:51], v[104:107], v[40:43]
  ds_read_b128 v[156:159], v13 offset:2112
  v_mfma_f32_16x16x32_bf16 v[44:47], v[48:51], v[108:111], v[44:47]
  ds_read_b128 v[124:127], v12 offset:1600
  v_mfma_f32_16x16x32_bf16 v[20:23], v[52:55], v[80:83], v[20:23]
  ds_read_b128 v[160:163], v13 offset:1600
  v_mfma_f32_16x16x32_bf16 v[24:27], v[52:55], v[84:87], v[24:27]
  ds_read_b128 v[128:131], v12 offset:2112
  v_mfma_f32_16x16x32_bf16 v[28:31], v[52:55], v[88:91], v[28:31]
  ds_read_b128 v[164:167], v13 offset:1088
  v_mfma_f32_16x16x32_bf16 v[32:35], v[52:55], v[92:95], v[32:35]
  ds_read_b128 v[132:135], v12 offset:2624
  v_mfma_f32_16x16x32_bf16 v[36:39], v[52:55], v[96:99], v[36:39]
  ds_read_b128 v[168:171], v13 offset:576
  v_mfma_f32_16x16x32_bf16 v[40:43], v[52:55], v[100:103], v[40:43]
  ds_read_b128 v[136:139], v12 offset:3136
  v_mfma_f32_16x16x32_bf16 v[44:47], v[52:55], v[104:107], v[44:47]
  ds_read_b128 v[172:175], v13 offset:64
  v_mfma_f32_16x16x32_bf16 v[24:27], v[56:59], v[80:83], v[24:27]
  ds_read_b128 v[140:143], v12 offset:3648
  v_mfma_f32_16x16x32_bf16 v[28:31], v[56:59], v[84:87], v[28:31]
  buffer_load_dwordx2 v[14:15], v220, s[8:11], 0 offen sc1
  v_mfma_f32_16x16x32_bf16 v[32:35], v[56:59], v[88:91], v[32:35]
  v_mfma_f32_16x16x32_bf16 v[36:39], v[56:59], v[92:95], v[36:39]
  v_mfma_f32_16x16x32_bf16 v[40:43], v[56:59], v[96:99], v[40:43]
  v_mfma_f32_16x16x32_bf16 v[44:47], v[56:59], v[100:103], v[44:47]
  v_mfma_f32_16x16x32_bf16 v[28:31], v[60:63], v[80:83], v[28:31]
  v_mfma_f32_16x16x32_bf16 v[32:35], v[60:63], v[84:87], v[32:35]
  v_mfma_f32_16x16x32_bf16 v[36:39], v[60:63], v[88:91], v[36:39]
  v_mfma_f32_16x16x32_bf16 v[40:43], v[60:63], v[92:95], v[40:43]
  v_mfma_f32_16x16x32_bf16 v[44:47], v[60:63], v[96:99], v[44:47]
  v_mfma_f32_16x16x32_bf16 v[32:35], v[64:67], v[80:83], v[32:35]
  v_mfma_f32_16x16x32_bf16 v[36:39], v[64:67], v[84:87], v[36:39]
  v_mfma_f32_16x16x32_bf16 v[40:43], v[64:67], v[88:91], v[40:43]
  v_mfma_f32_16x16x32_bf16 v[44:47], v[64:67], v[92:95], v[44:47]
  v_mfma_f32_16x16x32_bf16 v[36:39], v[68:71], v[80:83], v[36:39]
  v_mfma_f32_16x16x32_bf16 v[40:43], v[68:71], v[84:87], v[40:43]
  v_mfma_f32_16x16x32_bf16 v[44:47], v[68:71], v[88:91], v[44:47]
  v_mfma_f32_16x16x32_bf16 v[40:43], v[72:75], v[80:83], v[40:43]
  v_mfma_f32_16x16x32_bf16 v[44:47], v[72:75], v[84:87], v[44:47]
  v_mfma_f32_16x16x32_bf16 v[44:47], v[76:79], v[80:83], v[44:47]
  s_waitcnt lgkmcnt(0)
  v_mfma_f32_16x16x32_bf16 v[16:19], v[112:115], v[144:147], v[16:19]
  ds_read_b128 v[80:83], v13 offset:3712
  v_mfma_f32_16x16x32_bf16 v[20:23], v[112:115], v[148:151], v[20:23]
  ds_read_b128 v[48:51], v12 offset:128
  v_mfma_f32_16x16x32_bf16 v[24:27], v[112:115], v[152:155], v[24:27]
  ds_read_b128 v[84:87], v13 offset:3200
  v_mfma_f32_16x16x32_bf16 v[28:31], v[112:115], v[156:159], v[28:31]
  ds_read_b128 v[52:55], v12 offset:640
  v_mfma_f32_16x16x32_bf16 v[32:35], v[112:115], v[160:163], v[32:35]
  ds_read_b128 v[88:91], v13 offset:2688
  v_mfma_f32_16x16x32_bf16 v[36:39], v[112:115], v[164:167], v[36:39]
  ds_read_b128 v[56:59], v12 offset:1152
  v_mfma_f32_16x16x32_bf16 v[40:43], v[112:115], v[168:171], v[40:43]
  ds_read_b128 v[92:95], v13 offset:2176
  v_mfma_f32_16x16x32_bf16 v[44:47], v[112:115], v[172:175], v[44:47]
  ds_read_b128 v[60:63], v12 offset:1664
  v_mfma_f32_16x16x32_bf16 v[20:23], v[116:119], v[144:147], v[20:23]
  ds_read_b128 v[96:99], v13 offset:1664
  v_mfma_f32_16x16x32_bf16 v[24:27], v[116:119], v[148:151], v[24:27]
  ds_read_b128 v[64:67], v12 offset:2176
  v_mfma_f32_16x16x32_bf16 v[28:31], v[116:119], v[152:155], v[28:31]
  ds_read_b128 v[100:103], v13 offset:1152
  v_mfma_f32_16x16x32_bf16 v[32:35], v[116:119], v[156:159], v[32:35]
  ds_read_b128 v[68:71], v12 offset:2688
  v_mfma_f32_16x16x32_bf16 v[36:39], v[116:119], v[160:163], v[36:39]
  ds_read_b128 v[104:107], v13 offset:640
  v_mfma_f32_16x16x32_bf16 v[40:43], v[116:119], v[164:167], v[40:43]
  ds_read_b128 v[72:75], v12 offset:3200
  v_mfma_f32_16x16x32_bf16 v[44:47], v[116:119], v[168:171], v[44:47]
  ds_read_b128 v[108:111], v13 offset:128
  v_mfma_f32_16x16x32_bf16 v[24:27], v[120:123], v[144:147], v[24:27]
  ds_read_b128 v[76:79], v12 offset:3712
  v_mfma_f32_16x16x32_bf16 v[28:31], v[120:123], v[148:151], v[28:31]
  v_mfma_f32_16x16x32_bf16 v[32:35], v[120:123], v[152:155], v[32:35]
  v_mfma_f32_16x16x32_bf16 v[36:39], v[120:123], v[156:159], v[36:39]
  v_mfma_f32_16x16x32_bf16 v[40:43], v[120:123], v[160:163], v[40:43]
  v_mfma_f32_16x16x32_bf16 v[44:47], v[120:123], v[164:167], v[44:47]
  v_mfma_f32_16x16x32_bf16 v[28:31], v[124:127], v[144:147], v[28:31]
  v_mfma_f32_16x16x32_bf16 v[32:35], v[124:127], v[148:151], v[32:35]
  v_mfma_f32_16x16x32_bf16 v[36:39], v[124:127], v[152:155], v[36:39]
  v_mfma_f32_16x16x32_bf16 v[40:43], v[124:127], v[156:159], v[40:43]
  v_mfma_f32_16x16x32_bf16 v[44:47], v[124:127], v[160:163], v[44:47]
  v_mfma_f32_16x16x32_bf16 v[32:35], v[128:131], v[144:147], v[32:35]
  v_mfma_f32_16x16x32_bf16 v[36:39], v[128:131], v[148:151], v[36:39]
  v_mfma_f32_16x16x32_bf16 v[40:43], v[128:131], v[152:155], v[40:43]
  v_mfma_f32_16x16x32_bf16 v[44:47], v[128:131], v[156:159], v[44:47]
  v_mfma_f32_16x16x32_bf16 v[36:39], v[132:135], v[144:147], v[36:39]
  v_mfma_f32_16x16x32_bf16 v[40:43], v[132:135], v[148:151], v[40:43]
  v_mfma_f32_16x16x32_bf16 v[44:47], v[132:135], v[152:155], v[44:47]
  v_mfma_f32_16x16x32_bf16 v[40:43], v[136:139], v[144:147], v[40:43]
  v_mfma_f32_16x16x32_bf16 v[44:47], v[136:139], v[148:151], v[44:47]
  v_mfma_f32_16x16x32_bf16 v[44:47], v[140:143], v[144:147], v[44:47]
  v_add_u32 v12, 128, v12
  v_add_u32 v13, 128, v13
  s_add_u32 s7, s7, 1
  s_cmp_lt_u32 s7, 2
  s_waitcnt lgkmcnt(0)
  s_cbranch_scc1 F_CLOOP
  s_mov_b32 s43, 0
F_HR_CHK:
  s_waitcnt vmcnt(0)
  v_cmp_ne_u32 vcc, s42, v15
  s_add_u32 s43, s43, 1
  s_cmp_ge_u32 s43, 0x80000
  s_cbranch_scc1 F_HR_GO
  s_nop 2
  s_cmp_eq_u32 vcc_lo, 0
  s_cbranch_scc1 F_HR_GO
  s_sleep 2
  buffer_load_dwordx2 v[14:15], v220, s[8:11], 0 offen sc1
  s_branch F_HR_CHK
F_HR_GO:
  v_mfma_f32_16x16x32_bf16 v[16:19], v[48:51], v[80:83], v[16:19]
  ds_read_b128 v[144:147], v13 offset:3648
  v_mfma_f32_16x16x32_bf16 v[20:23], v[48:51], v[84:87], v[20:23]
  buffer_load_dwordx4 v[192:195], v221, s[8:11], s37 offen sc1
  v_mfma_f32_16x16x32_bf16 v[24:27], v[48:51], v[88:91], v[24:27]
  ds_read_b128 v[112:115], v12 offset:64
  v_mfma_f32_16x16x32_bf16 v[28:31], v[48:51], v[92:95], v[28:31]
  buffer_load_dwordx4 v[176:179], v221, s[8:11], s36 offen sc1
  v_mfma_f32_16x16x32_bf16 v[32:35], v[48:51], v[96:99], v[32:35]
  ds_read_b128 v[148:151], v13 offset:3136
  v_mfma_f32_16x16x32_bf16 v[36:39], v[48:51], v[100:103], v[36:39]
  s_add_u32 s37, s37, 4096
  v_mfma_f32_16x16x32_bf16 v[40:43], v[48:51], v[104:107], v[40:43]
  ds_read_b128 v[116:119], v12 offset:576
  v_mfma_f32_16x16x32_bf16 v[44:47], v[48:51], v[108:111], v[44:47]
  s_add_u32 s36, s36, 4096
  v_mfma_f32_16x16x32_bf16 v[20:23], v[52:55], v[80:83], v[20:23]
  ds_read_b128 v[152:155], v13 offset:2624
  v_mfma_f32_16x16x32_bf16 v[24:27], v[52:55], v[84:87], v[24:27]
  buffer_load_dwordx4 v[196:199], v221, s[8:11], s37 offen sc1
  v_mfma_f32_16x16x32_bf16 v[28:31], v[52:55], v[88:91], v[28:31]
  ds_read_b128 v[120:123], v12 offset:1088
  v_mfma_f32_16x16x32_bf16 v[32:35], v[52:55], v[92:95], v[32:35]
  buffer_load_dwordx4 v[180:183], v221, s[8:11], s36 offen sc1
  v_mfma_f32_16x16x32_bf16 v[36:39], v[52:55], v[96:99], v[36:39]
  ds_read_b128 v[156:159], v13 offset:2112
  v_mfma_f32_16x16x32_bf16 v[40:43], v[52:55], v[100:103], v[40:43]
  s_add_u32 s37, s37, 4096
  v_mfma_f32_16x16x32_bf16 v[44:47], v[52:55], v[104:107], v[44:47]
  ds_read_b128 v[124:127], v12 offset:1600
  v_mfma_f32_16x16x32_bf16 v[24:27], v[56:59], v[80:83], v[24:27]
  s_add_u32 s36, s36, 4096
  v_mfma_f32_16x16x32_bf16 v[28:31], v[56:59], v[84:87], v[28:31]
  ds_read_b128 v[160:163], v13 offset:1600
  v_mfma_f32_16x16x32_bf16 v[32:35], v[56:59], v[88:91], v[32:35]
  buffer_load_dwordx4 v[200:203], v221, s[8:11], s37 offen sc1
  v_mfma_f32_16x16x32_bf16 v[36:39], v[56:59], v[92:95], v[36:39]
  ds_read_b128 v[128:131], v12 offset:2112
  v_mfma_f32_16x16x32_bf16 v[40:43], v[56:59], v[96:99], v[40:43]
  buffer_load_dwordx4 v[184:187], v221, s[8:11], s36 offen sc1
  v_mfma_f32_16x16x32_bf16 v[44:47], v[56:59], v[100:103], v[44:47]
  ds_read_b128 v[164:167], v13 offset:1088
  v_mfma_f32_16x16x32_bf16 v[28:31], v[60:63], v[80:83], v[28:31]
  s_add_u32 s37, s37, 4096
  v_mfma_f32_16x16x32_bf16 v[32:35], v[60:63], v[84:87], v[32:35]
  ds_read_b128 v[132:135], v12 offset:2624
  v_mfma_f32_16x16x32_bf16 v[36:39], v[60:63], v[88:91], v[36:39]
  s_add_u32 s36, s36, 4096
  v_mfma_f32_16x16x32_bf16 v[40:43], v[60:63], v[92:95], v[40:43]
  ds_read_b128 v[168:171], v13 offset:576
  v_mfma_f32_16x16x32_bf16 v[44:47], v[60:63], v[96:99], v[44:47]
  buffer_load_dwordx4 v[204:207], v221, s[8:11], s37 offen sc1
  v_mfma_f32_16x16x32_bf16 v[32:35], v[64:67], v[80:83], v[32:35]
  ds_read_b128 v[136:139], v12 offset:3136
  v_mfma_f32_16x16x32_bf16 v[36:39], v[64:67], v[84:87], v[36:39]
  buffer_load_dwordx4 v[188:191], v221, s[8:11], s36 offen sc1
  v_mfma_f32_16x16x32_bf16 v[40:43], v[64:67], v[88:91], v[40:43]
  ds_read_b128 v[172:175], v13 offset:64
  v_mfma_f32_16x16x32_bf16 v[44:47], v[64:67], v[92:95], v[44:47]
  ds_read_b128 v[140:143], v12 offset:3648
  v_mfma_f32_16x16x32_bf16 v[36:39], v[68:71], v[80:83], v[36:39]
  v_mfma_f32_16x16x32_bf16 v[40:43], v[68:71], v[84:87], v[40:43]
  v_mfma_f32_16x16x32_bf16 v[44:47], v[68:71], v[88:91], v[44:47]
  v_mfma_f32_16x16x32_bf16 v[40:43], v[72:75], v[80:83], v[40:43]
  v_mfma_f32_16x16x32_bf16 v[44:47], v[72:75], v[84:87], v[44:47]
  v_mfma_f32_16x16x32_bf16 v[44:47], v[76:79], v[80:83], v[44:47]
  s_waitcnt lgkmcnt(0)
  v_mfma_f32_16x16x32_bf16 v[16:19], v[112:115], v[144:147], v[16:19]
  ds_read_b128 v[80:83], v13 offset:3712
  v_mfma_f32_16x16x32_bf16 v[20:23], v[112:115], v[148:151], v[20:23]
  ds_read_b128 v[48:51], v12 offset:128
  v_mfma_f32_16x16x32_bf16 v[24:27], v[112:115], v[152:155], v[24:27]
  ds_read_b128 v[84:87], v13 offset:3200
  v_mfma_f32_16x16x32_bf16 v[28:31], v[112:115], v[156:159], v[28:31]
  ds_read_b128 v[52:55], v12 offset:640
  v_mfma_f32_16x16x32_bf16 v[32:35], v[112:115], v[160:163], v[32:35]
  ds_read_b128 v[88:91], v13 offset:2688
  v_mfma_f32_16x16x32_bf16 v[36:39], v[112:115], v[164:167], v[36:39]
  ds_read_b128 v[56:59], v12 offset:1152
  v_mfma_f32_16x16x32_bf16 v[40:43], v[112:115], v[168:171], v[40:43]
  ds_read_b128 v[92:95], v13 offset:2176
  v_mfma_f32_16x16x32_bf16 v[44:47], v[112:115], v[172:175], v[44:47]
  ds_read_b128 v[60:63], v12 offset:1664
  v_mfma_f32_16x16x32_bf16 v[20:23], v[116:119], v[144:147], v[20:23]
  ds_read_b128 v[96:99], v13 offset:1664
  v_mfma_f32_16x16x32_bf16 v[24:27], v[116:119], v[148:151], v[24:27]
  ds_read_b128 v[64:67], v12 offset:2176
  v_mfma_f32_16x16x32_bf16 v[28:31], v[116:119], v[152:155], v[28:31]
  ds_read_b128 v[100:103], v13 offset:1152
  v_mfma_f32_16x16x32_bf16 v[32:35], v[116:119], v[156:159], v[32:35]
  ds_read_b128 v[68:71], v12 offset:2688
  v_mfma_f32_16x16x32_bf16 v[36:39], v[116:119], v[160:163], v[36:39]
  ds_read_b128 v[104:107], v13 offset:640
  v_mfma_f32_16x16x32_bf16 v[40:43], v[116:119], v[164:167], v[40:43]
  ds_read_b128 v[72:75], v12 offset:3200
  v_mfma_f32_16x16x32_bf16 v[44:47], v[116:119], v[168:171], v[44:47]
  ds_read_b128 v[108:111], v13 offset:128
  v_mfma_f32_16x16x32_bf16 v[24:27], v[120:123], v[144:147], v[24:27]
  ds_read_b128 v[76:79], v12 offset:3712
  v_mfma_f32_16x16x32_bf16 v[28:31], v[120:123], v[148:151], v[28:31]
  v_mfma_f32_16x16x32_bf16 v[32:35], v[120:123], v[152:155], v[32:35]
  v_mfma_f32_16x16x32_bf16 v[36:39], v[120:123], v[156:159], v[36:39]
  v_mfma_f32_16x16x32_bf16 v[40:43], v[120:123], v[160:163], v[40:43]
  v_mfma_f32_16x16x32_bf16 v[44:47], v[120:123], v[164:167], v[44:47]
  v_mfma_f32_16x16x32_bf16 v[28:31], v[124:127], v[144:147], v[28:31]
  v_mfma_f32_16x16x32_bf16 v[32:35], v[124:127], v[148:151], v[32:35]
  v_mfma_f32_16x16x32_bf16 v[36:39], v[124:127], v[152:155], v[36:39]
  v_mfma_f32_16x16x32_bf16 v[40:43], v[124:127], v[156:159], v[40:43]
  v_mfma_f32_16x16x32_bf16 v[44:47], v[124:127], v[160:163], v[44:47]
  v_mfma_f32_16x16x32_bf16 v[32:35], v[128:131], v[144:147], v[32:35]
  v_mfma_f32_16x16x32_bf16 v[36:39], v[128:131], v[148:151], v[36:39]
  v_mfma_f32_16x16x32_bf16 v[40:43], v[128:131], v[152:155], v[40:43]
  v_mfma_f32_16x16x32_bf16 v[44:47], v[128:131], v[156:159], v[44:47]
  v_mfma_f32_16x16x32_bf16 v[36:39], v[132:135], v[144:147], v[36:39]
  v_mfma_f32_16x16x32_bf16 v[40:43], v[132:135], v[148:151], v[40:43]
  v_mfma_f32_16x16x32_bf16 v[44:47], v[132:135], v[152:155], v[44:47]
  v_mfma_f32_16x16x32_bf16 v[40:43], v[136:139], v[144:147], v[40:43]
  v_mfma_f32_16x16x32_bf16 v[44:47], v[136:139], v[148:151], v[44:47]
  v_mfma_f32_16x16x32_bf16 v[44:47], v[140:143], v[144:147], v[44:47]
  s_waitcnt lgkmcnt(0)
  v_mfma_f32_16x16x32_bf16 v[16:19], v[48:51], v[80:83], v[16:19]
  ds_read_b128 v[144:147], v13 offset:3776
  v_mfma_f32_16x16x32_bf16 v[20:23], v[48:51], v[84:87], v[20:23]
  ds_read_b128 v[112:115], v12 offset:192
  v_mfma_f32_16x16x32_bf16 v[24:27], v[48:51], v[88:91], v[24:27]
  ds_read_b128 v[148:151], v13 offset:3264
  v_mfma_f32_16x16x32_bf16 v[28:31], v[48:51], v[92:95], v[28:31]
  ds_read_b128 v[116:119], v12 offset:704
  v_mfma_f32_16x16x32_bf16 v[32:35], v[48:51], v[96:99], v[32:35]
  ds_read_b128 v[152:155], v13 offset:2752
  v_mfma_f32_16x16x32_bf16 v[36:39], v[48:51], v[100:103], v[36:39]
  ds_read_b128 v[120:123], v12 offset:1216
  v_mfma_f32_16x16x32_bf16 v[40:43], v[48:51], v[104:107], v[40:43]
  ds_read_b128 v[156:159], v13 offset:2240
  v_mfma_f32_16x16x32_bf16 v[44:47], v[48:51], v[108:111], v[44:47]
  ds_read_b128 v[124:127], v12 offset:1728
  v_mfma_f32_16x16x32_bf16 v[20:23], v[52:55], v[80:83], v[20:23]
  ds_read_b128 v[160:163], v13 offset:1728
  v_mfma_f32_16x16x32_bf16 v[24:27], v[52:55], v[84:87], v[24:27]
  ds_read_b128 v[128:131], v12 offset:2240
  v_mfma_f32_16x16x32_bf16 v[28:31], v[52:55], v[88:91], v[28:31]
  ds_read_b128 v[164:167], v13 offset:1216
  v_mfma_f32_16x16x32_bf16 v[32:35], v[52:55], v[92:95], v[32:35]
  ds_read_b128 v[132:135], v12 offset:2752
  v_mfma_f32_16x16x32_bf16 v[36:39], v[52:55], v[96:99], v[36:39]
  ds_read_b128 v[168:171], v13 offset:704
  v_mfma_f32_16x16x32_bf16 v[40:43], v[52:55], v[100:103], v[40:43]
  ds_read_b128 v[136:139], v12 offset:3264
  v_mfma_f32_16x16x32_bf16 v[44:47], v[52:55], v[104:107], v[44:47]
  ds_read_b128 v[172:175], v13 offset:192
  v_mfma_f32_16x16x32_bf16 v[24:27], v[56:59], v[80:83], v[24:27]
  ds_read_b128 v[140:143], v12 offset:3776
  v_mfma_f32_16x16x32_bf16 v[28:31], v[56:59], v[84:87], v[28:31]
  buffer_load_dwordx2 v[14:15], v220, s[8:11], 0 offen sc1
  v_mfma_f32_16x16x32_bf16 v[32:35], v[56:59], v[88:91], v[32:35]
  v_mfma_f32_16x16x32_bf16 v[36:39], v[56:59], v[92:95], v[36:39]
  v_mfma_f32_16x16x32_bf16 v[40:43], v[56:59], v[96:99], v[40:43]
  v_mfma_f32_16x16x32_bf16 v[44:47], v[56:59], v[100:103], v[44:47]
  v_mfma_f32_16x16x32_bf16 v[28:31], v[60:63], v[80:83], v[28:31]
  v_mfma_f32_16x16x32_bf16 v[32:35], v[60:63], v[84:87], v[32:35]
  v_mfma_f32_16x16x32_bf16 v[36:39], v[60:63], v[88:91], v[36:39]
  v_mfma_f32_16x16x32_bf16 v[40:43], v[60:63], v[92:95], v[40:43]
  v_mfma_f32_16x16x32_bf16 v[44:47], v[60:63], v[96:99], v[44:47]
  v_mfma_f32_16x16x32_bf16 v[32:35], v[64:67], v[80:83], v[32:35]
  v_mfma_f32_16x16x32_bf16 v[36:39], v[64:67], v[84:87], v[36:39]
  v_mfma_f32_16x16x32_bf16 v[40:43], v[64:67], v[88:91], v[40:43]
  v_mfma_f32_16x16x32_bf16 v[44:47], v[64:67], v[92:95], v[44:47]
  v_mfma_f32_16x16x32_bf16 v[36:39], v[68:71], v[80:83], v[36:39]
  v_mfma_f32_16x16x32_bf16 v[40:43], v[68:71], v[84:87], v[40:43]
  v_mfma_f32_16x16x32_bf16 v[44:47], v[68:71], v[88:91], v[44:47]
  v_mfma_f32_16x16x32_bf16 v[40:43], v[72:75], v[80:83], v[40:43]
  v_mfma_f32_16x16x32_bf16 v[44:47], v[72:75], v[84:87], v[44:47]
  v_mfma_f32_16x16x32_bf16 v[44:47], v[76:79], v[80:83], v[44:47]
  s_waitcnt lgkmcnt(0)
  v_mfma_f32_16x16x32_bf16 v[16:19], v[112:115], v[144:147], v[16:19]
  s_waitcnt vmcnt(1)
  v_lshlrev_b32 v48, 16, v176
  v_mfma_f32_16x16x32_bf16 v[20:23], v[112:115], v[148:151], v[20:23]
  v_and_b32 v49, 0xffff0000, v176
  v_lshlrev_b32 v50, 16, v177
  v_mfma_f32_16x16x32_bf16 v[24:27], v[112:115], v[152:155], v[24:27]
  v_and_b32 v51, 0xffff0000, v177
  v_fma_f32 v52, v48, v192, v193
  v_mfma_f32_16x16x32_bf16 v[28:31], v[112:115], v[156:159], v[28:31]
  v_fma_f32 v53, v49, v192, v193
  v_fma_f32 v54, v50, v192, v193
  v_mfma_f32_16x16x32_bf16 v[32:35], v[112:115], v[160:163], v[32:35]
  v_fma_f32 v55, v51, v192, v193
  v_lshlrev_b32 v56, 16, v178
  v_mfma_f32_16x16x32_bf16 v[36:39], v[112:115], v[164:167], v[36:39]
  v_and_b32 v57, 0xffff0000, v178
  v_mfma_f32_16x16x32_bf16 v[40:43], v[112:115], v[168:171], v[40:43]
  v_lshlrev_b32 v58, 16, v179
  v_and_b32 v59, 0xffff0000, v179
  v_mfma_f32_16x16x32_bf16 v[44:47], v[112:115], v[172:175], v[44:47]
  v_fma_f32 v60, v56, v194, v195
  v_fma_f32 v61, v57, v194, v195
  v_mfma_f32_16x16x32_bf16 v[20:23], v[116:119], v[144:147], v[20:23]
  v_fma_f32 v62, v58, v194, v195
  v_fma_f32 v63, v59, v194, v195
  v_mfma_f32_16x16x32_bf16 v[24:27], v[116:119], v[148:151], v[24:27]
  v_lshlrev_b32 v64, 16, v180
  v_and_b32 v65, 0xffff0000, v180
  v_mfma_f32_16x16x32_bf16 v[28:31], v[116:119], v[152:155], v[28:31]
  v_lshlrev_b32 v66, 16, v181
  v_mfma_f32_16x16x32_bf16 v[32:35], v[116:119], v[156:159], v[32:35]
  v_and_b32 v67, 0xffff0000, v181
  v_fma_f32 v68, v64, v196, v197
  v_mfma_f32_16x16x32_bf16 v[36:39], v[116:119], v[160:163], v[36:39]
  v_fma_f32 v69, v65, v196, v197
  v_fma_f32 v70, v66, v196, v197
  v_mfma_f32_16x16x32_bf16 v[40:43], v[116:119], v[164:167], v[40:43]
  v_fma_f32 v71, v67, v196, v197
  v_lshlrev_b32 v72, 16, v182
  v_mfma_f32_16x16x32_bf16 v[44:47], v[116:119], v[168:171], v[44:47]
  v_and_b32 v73, 0xffff0000, v182
  v_lshlrev_b32 v74, 16, v183
  v_mfma_f32_16x16x32_bf16 v[24:27], v[120:123], v[144:147], v[24:27]
  v_and_b32 v75, 0xffff0000, v183
  v_mfma_f32_16x16x32_bf16 v[28:31], v[120:123], v[148:151], v[28:31]
  v_fma_f32 v76, v72, v198, v199
  v_fma_f32 v77, v73, v198, v199
  v_mfma_f32_16x16x32_bf16 v[32:35], v[120:123], v[152:155], v[32:35]
  v_fma_f32 v78, v74, v198, v199
  v_fma_f32 v79, v75, v198, v199
  v_mfma_f32_16x16x32_bf16 v[36:39], v[120:123], v[156:159], v[36:39]
  v_lshlrev_b32 v80, 16, v184
  v_and_b32 v81, 0xffff0000, v184
  v_mfma_f32_16x16x32_bf16 v[40:43], v[120:123], v[160:163], v[40:43]
  v_lshlrev_b32 v82, 16, v185
  v_and_b32 v83, 0xffff0000, v185
  v_mfma_f32_16x16x32_bf16 v[44:47], v[120:123], v[164:167], v[44:47]
  v_fma_f32 v84, v80, v200, v201
  v_mfma_f32_16x16x32_bf16 v[28:31], v[124:127], v[144:147], v[28:31]
  v_fma_f32 v85, v81, v200, v201
  v_fma_f32 v86, v82, v200, v201
  v_mfma_f32_16x16x32_bf16 v[32:35], v[124:127], v[148:151], v[32:35]
  v_fma_f32 v87, v83, v200, v201
  v_lshlrev_b32 v88, 16, v186
  v_mfma_f32_16x16x32_bf16 v[36:39], v[124:127], v[152:155], v[36:39]
  v_and_b32 v89, 0xffff0000, v186
  v_lshlrev_b32 v90, 16, v187
  v_mfma_f32_16x16x32_bf16 v[40:43], v[124:127], v[156:159], v[40:43]
  v_and_b32 v91, 0xffff0000, v187
  v_fma_f32 v92, v88, v202, v203
  v_mfma_f32_16x16x32_bf16 v[44:47], v[124:127], v[160:163], v[44:47]
  v_fma_f32 v93, v89, v202, v203
  v_mfma_f32_16x16x32_bf16 v[32:35], v[128:131], v[144:147], v[32:35]
  v_fma_f32 v94, v90, v202, v203
  v_fma_f32 v95, v91, v202, v203
  v_mfma_f32_16x16x32_bf16 v[36:39], v[128:131], v[148:151], v[36:39]
  v_lshlrev_b32 v96, 16, v188
  v_and_b32 v97, 0xffff0000, v188
  v_mfma_f32_16x16x32_bf16 v[40:43], v[128:131], v[152:155], v[40:43]
  v_lshlrev_b32 v98, 16, v189
  v_and_b32 v99, 0xffff0000, v189
  v_mfma_f32_16x16x32_bf16 v[44:47], v[128:131], v[156:159], v[44:47]
  v_fma_f32 v100, v96, v204, v205
  v_fma_f32 v101, v97, v204, v205
  v_mfma_f32_16x16x32_bf16 v[36:39], v[132:135], v[144:147], v[36:39]
  v_fma_f32 v102, v98, v204, v205
  v_mfma_f32_16x16x32_bf16 v[40:43], v[132:135], v[148:151], v[40:43]
  v_fma_f32 v103, v99, v204, v205
  v_lshlrev_b32 v104, 16, v190
  v_mfma_f32_16x16x32_bf16 v[44:47], v[132:135], v[152:155], v[44:47]
  v_and_b32 v105, 0xffff0000, v190
  v_lshlrev_b32 v106, 16, v191
  v_mfma_f32_16x16x32_bf16 v[40:43], v[136:139], v[144:147], v[40:43]
  v_and_b32 v107, 0xffff0000, v191
  v_fma_f32 v108, v104, v206, v207
  v_mfma_f32_16x16x32_bf16 v[44:47], v[136:139], v[148:151], v[44:47]
  v_fma_f32 v109, v105, v206, v207
  v_fma_f32 v110, v106, v206, v207
  v_mfma_f32_16x16x32_bf16 v[44:47], v[140:143], v[144:147], v[44:47]
  v_fma_f32 v111, v107, v206, v207
  s_waitcnt vmcnt(0)
  v_cmp_ne_u32 vcc, s42, v15
  ds_write_b128 v6, v[16:19] offset:0
  ds_write_b128 v6, v[20:23] offset:1152
  ds_write_b128 v6, v[24:27] offset:2304
  ds_write_b128 v6, v[28:31] offset:3456
  ds_write_b128 v6, v[32:35] offset:4608
  ds_write_b128 v6, v[36:39] offset:5760
  s_cbranch_vccz F_HP_GO
  s_mov_b32 s43, 0
F_HP_POLL:
  buffer_load_dwordx2 v[14:15], v220, s[8:11], 0 offen sc1
  s_waitcnt vmcnt(0)
  v_cmp_ne_u32 vcc, s42, v15
  s_add_u32 s43, s43, 1
  s_cmp_ge_u32 s43, 0x80000
  s_cbranch_scc1 F_HP_GO
  s_nop 2
  s_cbranch_vccz F_HP_GO
  s_sleep 2
  s_branch F_HP_POLL
F_HP_GO:
  ds_write_b128 v6, v[40:43] offset:6912
  ds_write_b128 v6, v[44:47] offset:8064
  v_add_f32_dpp v14, v14, v14 row_shl:4 row_mask:0xf bank_mask:0xf
  v_bfe_u32 v15, v2, 3, 2
  v_cmp_eq_u32 vcc, 1, v15
  v_cvt_pk_bf16_f32 v14, v14, v14
  v_lshlrev_b32 v14, 16, v14
  v_cndmask_b32 v15, 0, 1.0, vcc
  v_add_f32 v14, v14, v15
  v_cvt_pk_bf16_f32 v14, v14, v14
  v_lshlrev_b32 v14, 16, v14
  s_nop 0
  v_readlane_b32 s12, v14, 32
  v_readlane_b32 s13, v14, 33
  v_readlane_b32 s14, v14, 34
  v_readlane_b32 s15, v14, 35
  v_readlane_b32 s16, v14, 40
  v_readlane_b32 s17, v14, 41
  v_readlane_b32 s18, v14, 42
  v_readlane_b32 s19, v14, 43
  v_readlane_b32 s20, v14, 48
  v_readlane_b32 s21, v14, 49
  v_readlane_b32 s22, v14, 50
  v_readlane_b32 s23, v14, 51
  s_lshl_b32 s7, s4, 7
  s_add_u32 s7, s7, 5242880
  v_mov_b32 v216, s20
  v_mov_b32 v217, s21
  v_mov_b32 v218, s22
  v_mov_b32 v219, s23
  v_mul_f32 v208, s12, v216
  v_mul_f32 v209, s13, v217
  v_mul_f32 v210, s14, v218
  v_mul_f32 v211, s15, v219
  v_mul_f32 v212, s16, v216
  v_mul_f32 v213, s17, v217
  v_mul_f32 v214, s18, v218
  v_mul_f32 v215, s19, v219
  s_waitcnt lgkmcnt(0)
  s_barrier
  ds_read2_b32 v[112:113], v242 offset1:4
  ds_read2_b32 v[114:115], v243 offset1:4
  ds_read2_b32 v[116:117], v244 offset1:4
  ds_read2_b32 v[118:119], v245 offset1:4
  v_add_u32 v242, 2304, v242
  ds_read2_b32 v[120:121], v242 offset1:4
  v_add_u32 v243, 2304, v243
  ds_read2_b32 v[122:123], v243 offset1:4
  v_add_u32 v244, 2304, v244
  ds_read2_b32 v[124:125], v244 offset1:4
  v_add_u32 v245, 2304, v245
  ds_read2_b32 v[126:127], v245 offset1:4
  v_add_u32 v242, 2304, v242
  ds_read2_b32 v[128:129], v242 offset1:4
  v_add_u32 v243, 2304, v243
  ds_read2_b32 v[130:131], v243 offset1:4
  v_add_u32 v244, 2304, v244
  ds_read2_b32 v[132:133], v244 offset1:4
  v_add_u32 v245, 2304, v245
  ds_read2_b32 v[134:135], v245 offset1:4
  s_waitcnt lgkmcnt(8)
  v_add_u32 v242, 2304, v242
  ds_read2_b32 v[136:137], v242 offset1:4
  v_add_u32 v243, 2304, v243
  ds_read2_b32 v[138:139], v243 offset1:4
  v_add_u32 v244, 2304, v244
  ds_read2_b32 v[140:141], v244 offset1:4
  v_add_u32 v245, 2304, v245
  ds_read2_b32 v[142:143], v245 offset1:4
  v_pk_fma_f32 v[52:53], v[52:53], v[212:213], v[208:209]
  v_pk_fma_f32 v[54:55], v[54:55], v[214:215], v[210:211]
  v_pk_fma_f32 v[60:61], v[60:61], v[212:213], v[208:209]
  v_pk_fma_f32 v[62:63], v[62:63], v[214:215], v[210:211]
  v_pk_fma_f32 v[68:69], v[68:69], v[212:213], v[208:209]
  v_pk_fma_f32 v[70:71], v[70:71], v[214:215], v[210:211]
  v_pk_fma_f32 v[76:77], v[76:77], v[212:213], v[208:209]
  v_pk_fma_f32 v[78:79], v[78:79], v[214:215], v[210:211]
  v_pk_fma_f32 v[84:85], v[84:85], v[212:213], v[208:209]
  v_pk_fma_f32 v[86:87], v[86:87], v[214:215], v[210:211]
  v_pk_fma_f32 v[92:93], v[92:93], v[212:213], v[208:209]
  v_pk_fma_f32 v[94:95], v[94:95], v[214:215], v[210:211]
  v_pk_fma_f32 v[100:101], v[100:101], v[212:213], v[208:209]
  v_pk_fma_f32 v[102:103], v[102:103], v[214:215], v[210:211]
  v_pk_fma_f32 v[108:109], v[108:109], v[212:213], v[208:209]
  v_pk_fma_f32 v[110:111], v[110:111], v[214:215], v[210:211]
  s_waitcnt lgkmcnt(8)
  v_fma_f32 v48, v52, v112, v48
  v_fma_f32 v49, v53, v114, v49
  v_fma_f32 v50, v54, v116, v50
  v_fma_f32 v51, v55, v118, v51
  v_cvt_pk_bf16_f32 v176, v48, v49
  v_cvt_pk_bf16_f32 v177, v50, v51
  v_fma_f32 v56, v60, v113, v56
  v_fma_f32 v57, v61, v115, v57
  v_fma_f32 v58, v62, v117, v58
  v_fma_f32 v59, v63, v119, v59
  v_cvt_pk_bf16_f32 v178, v56, v57
  v_cvt_pk_bf16_f32 v179, v58, v59
  buffer_store_dwordx4 v[176:179], v222, s[8:11], s7 offen sc1
  s_add_u32 s7, s7, 589824
  s_waitcnt lgkmcnt(8)
  v_fma_f32 v64, v68, v120, v64
  v_fma_f32 v65, v69, v122, v65
  v_fma_f32 v66, v70, v124, v66
  v_fma_f32 v67, v71, v126, v67
  v_cvt_pk_bf16_f32 v180, v64, v65
  v_cvt_pk_bf16_f32 v181, v66, v67
  v_fma_f32 v72, v76, v121, v72
  v_fma_f32 v73, v77, v123, v73
  v_fma_f32 v74, v78, v125, v74
  v_fma_f32 v75, v79, v127, v75
  v_cvt_pk_bf16_f32 v182, v72, v73
  v_cvt_pk_bf16_f32 v183, v74, v75
  buffer_store_dwordx4 v[180:183], v222, s[8:11], s7 offen sc1
  s_add_u32 s7, s7, 589824
  s_waitcnt lgkmcnt(4)
  v_fma_f32 v80, v84, v128, v80
  v_fma_f32 v81, v85, v130, v81
  v_fma_f32 v82, v86, v132, v82
  v_fma_f32 v83, v87, v134, v83
  v_cvt_pk_bf16_f32 v184, v80, v81
  v_cvt_pk_bf16_f32 v185, v82, v83
  v_fma_f32 v88, v92, v129, v88
  v_fma_f32 v89, v93, v131, v89
  v_fma_f32 v90, v94, v133, v90
  v_fma_f32 v91, v95, v135, v91
  v_cvt_pk_bf16_f32 v186, v88, v89
  v_cvt_pk_bf16_f32 v187, v90, v91
  buffer_store_dwordx4 v[184:187], v222, s[8:11], s7 offen sc1
  s_add_u32 s7, s7, 589824
  s_waitcnt lgkmcnt(0)
  v_fma_f32 v96, v100, v136, v96
  v_fma_f32 v97, v101, v138, v97
  v_fma_f32 v98, v102, v140, v98
  v_fma_f32 v99, v103, v142, v99
  v_cvt_pk_bf16_f32 v188, v96, v97
  v_cvt_pk_bf16_f32 v189, v98, v99
  v_fma_f32 v104, v108, v137, v104
  v_fma_f32 v105, v109, v139, v105
  v_fma_f32 v106, v110, v141, v106
  v_fma_f32 v107, v111, v143, v107
  v_cvt_pk_bf16_f32 v190, v104, v105
  v_cvt_pk_bf16_f32 v191, v106, v107
  buffer_store_dwordx4 v[188:191], v222, s[8:11], s7 offen sc1
  s_branch F_JOIN
F_OTHER:
  s_mov_b32 s32, s84
  s_and_b32 s33, s85, 0xffff
  s_mov_b32 s34, 2654208
  s_mov_b32 s35, 0x20000
  v_lshrrev_b32 v10, 3, v2
  v_and_b32 v11, 7, v2
  v_and_b32 v12, 6, v10
  v_xor_b32 v11, v11, v12
  v_lshlrev_b32 v11, 4, v11
  v_lshrrev_b32 v9, 2, v2
  v_lshlrev_b32 v9, 7, v9
  v_and_b32 v12, 3, v10
  v_xor_b32 v12, s3, v12
  v_lshl_add_u32 v9, v12, 5, v9
  v_and_b32 v12, 3, v2
  v_lshl_add_u32 v9, v12, 3, v9
  v_add_u32 v247, 36864, v9
  v_add_u32 v244, 81920, v9
  v_mul_u32_u24 v245, 1152, v10
  v_add_u32 v245, v245, v11
  s_mul_i32 s6, s3, 18432
  s_cmp_ge_u32 s2, 252
  s_cbranch_scc1 F_LAST
  s_cmp_lt_u32 s2, 216
  s_cbranch_scc1 F_WIN
  s_mov_b32 s12, s88
  s_and_b32 s13, s89, 0xffff
  s_mov_b32 s14, 3981312
  s_mov_b32 s15, 0x20000
  s_mov_b32 s16, s86
  s_and_b32 s17, s87, 0xffff
  s_mov_b32 s18, 1152
  s_mov_b32 s19, 0x20000
  s_sub_u32 s4, s2, 216
  s_mov_b32 s36, s4
  s_mov_b32 s96, s4
  s_and_b32 s5, s4, 1
  s_lshr_b32 s4, s4, 1
  s_mul_i32 s26, s5, 288
  v_and_b32 v6, 7, v0
  v_lshrrev_b32 v7, 3, v0
  v_add_u32 v10, s26, v7
  v_mul_u32_u24 v8, 6912, v10
  v_lshl_add_u32 v8, v6, 4, v8
  v_lshlrev_b32 v12, 1, v10
  s_add_u32 s20, s4, 27
  s_mov_b32 s21, s4
  s_add_u32 s22, s4, 18
  s_add_u32 s23, s4, 36
  s_cmp_lt_u32 s4, 9
  s_cselect_b32 s22, s22, s23
  buffer_load_ushort v16, v12, s[16:19], 0 offen offset:0
  buffer_load_ushort v17, v12, s[16:19], 0 offen offset:64
  buffer_load_ushort v18, v12, s[16:19], 0 offen offset:128
  buffer_load_ushort v19, v12, s[16:19], 0 offen offset:192
  buffer_load_ushort v20, v12, s[16:19], 0 offen offset:256
  buffer_load_ushort v21, v12, s[16:19], 0 offen offset:320
  buffer_load_ushort v22, v12, s[16:19], 0 offen offset:384
  buffer_load_ushort v23, v12, s[16:19], 0 offen offset:448
  buffer_load_ushort v24, v12, s[16:19], 0 offen offset:512
  s_lshl_b32 s24, s20, 7
  buffer_load_dwordx4 v[56:59], v8, s[12:15], s24 offen
  s_add_u32 s24, s24, 221184
  buffer_load_dwordx4 v[60:63], v8, s[12:15], s24 offen
  s_add_u32 s24, s24, 221184
  buffer_load_dwordx4 v[64:67], v8, s[12:15], s24 offen
  s_add_u32 s24, s24, 221184
  buffer_load_dwordx4 v[68:71], v8, s[12:15], s24 offen
  s_add_u32 s24, s24, 221184
  buffer_load_dwordx4 v[72:75], v8, s[12:15], s24 offen
  s_add_u32 s24, s24, 221184
  buffer_load_dwordx4 v[76:79], v8, s[12:15], s24 offen
  s_add_u32 s24, s24, 221184
  buffer_load_dwordx4 v[80:83], v8, s[12:15], s24 offen
  s_add_u32 s24, s24, 221184
  buffer_load_dwordx4 v[84:87], v8, s[12:15], s24 offen
  s_add_u32 s24, s24, 221184
  buffer_load_dwordx4 v[88:91], v8, s[12:15], s24 offen
  buffer_load_dword v251, v251, s[28:31], 0 offen sc1
  s_waitcnt vmcnt(10)
  v_lshlrev_b32 v16, 16, v16
  v_lshlrev_b32 v17, 16, v17
  v_lshlrev_b32 v18, 16, v18
  v_lshlrev_b32 v19, 16, v19
  v_lshlrev_b32 v20, 16, v20
  v_lshlrev_b32 v21, 16, v21
  v_lshlrev_b32 v22, 16, v22
  v_lshlrev_b32 v23, 16, v23
  v_lshlrev_b32 v24, 16, v24
  v_mul_f32 v26, 0xbfb8aa3b, v16
  v_mul_f32 v27, 0xbfb8aa3b, v17
  v_mul_f32 v28, 0xbfb8aa3b, v18
  v_mul_f32 v29, 0xbfb8aa3b, v19
  v_mul_f32 v30, 0xbfb8aa3b, v20
  v_mul_f32 v31, 0xbfb8aa3b, v21
  v_mul_f32 v32, 0xbfb8aa3b, v22
  v_mul_f32 v33, 0xbfb8aa3b, v23
  v_mul_f32 v34, 0xbfb8aa3b, v24
  v_exp_f32 v26, v26
  v_exp_f32 v27, v27
  v_exp_f32 v28, v28
  v_exp_f32 v29, v29
  v_exp_f32 v30, v30
  v_exp_f32 v31, v31
  v_exp_f32 v32, v32
  v_exp_f32 v33, v33
  v_exp_f32 v34, v34
  v_add_f32 v26, 1.0, v26
  v_add_f32 v27, 1.0, v27
  v_add_f32 v28, 1.0, v28
  v_add_f32 v29, 1.0, v29
  v_add_f32 v30, 1.0, v30
  v_add_f32 v31, 1.0, v31
  v_add_f32 v32, 1.0, v32
  v_add_f32 v33, 1.0, v33
  v_add_f32 v34, 1.0, v34
  v_rcp_f32 v26, v26
  v_rcp_f32 v27, v27
  v_rcp_f32 v28, v28
  v_rcp_f32 v29, v29
  v_rcp_f32 v30, v30
  v_rcp_f32 v31, v31
  v_rcp_f32 v32, v32
  v_rcp_f32 v33, v33
  v_rcp_f32 v34, v34
  v_mul_f32 v16, v16, v26
  v_mul_f32 v17, v17, v27
  v_mul_f32 v18, v18, v28
  v_mul_f32 v19, v19, v29
  v_mul_f32 v20, v20, v30
  v_mul_f32 v21, v21, v31
  v_mul_f32 v22, v22, v32
  v_mul_f32 v23, v23, v33
  v_mul_f32 v24, v24, v34
  v_cvt_pk_bf16_f32 v16, v16, v16
  v_cvt_pk_bf16_f32 v17, v17, v17
  v_cvt_pk_bf16_f32 v18, v18, v18
  v_cvt_pk_bf16_f32 v19, v19, v19
  v_cvt_pk_bf16_f32 v20, v20, v20
  v_cvt_pk_bf16_f32 v21, v21, v21
  v_cvt_pk_bf16_f32 v22, v22, v22
  v_cvt_pk_bf16_f32 v23, v23, v23
  v_cvt_pk_bf16_f32 v24, v24, v24
  v_lshlrev_b32 v16, 16, v16
  v_lshlrev_b32 v17, 16, v17
  v_lshlrev_b32 v18, 16, v18
  v_lshlrev_b32 v19, 16, v19
  v_lshlrev_b32 v20, 16, v20
  v_lshlrev_b32 v21, 16, v21
  v_lshlrev_b32 v22, 16, v22
  v_lshlrev_b32 v23, 16, v23
  v_lshlrev_b32 v24, 16, v24
  v_lshlrev_b32 v13, 8, v1
  v_lshl_add_u32 v13, v6, 5, v13
  v_add_u32 v13, 73728, v13
  v_lshlrev_b32 v14, 2, v2
  v_add_u32 v14, 73728, v14
  v_lshlrev_b32 v15, 3, v2
  s_mul_i32 s25, s5, 27648
  s_add_u32 s25, s25, 8126464
  s_waitcnt vmcnt(0)
  v_readfirstlane_b32 s42, v251
  s_nop 3
  s_cmp_lg_u32 s42, 0
  s_cbranch_scc1 F_M_NG
  s_mov_b32 s43, 0
  v_mov_b32 v251, 0
F_M_NP:
  buffer_load_dword v251, v251, s[28:31], 0 offen sc1
  s_waitcnt vmcnt(0)
  v_readfirstlane_b32 s42, v251
  s_add_u32 s43, s43, 1
  s_cmp_ge_u32 s43, 0x80000
  s_cbranch_scc1 F_M_NG
  s_cmp_lg_u32 s42, 0
  s_cbranch_scc1 F_M_NG
  s_sleep 2
  s_branch F_M_NP
F_M_NG:
  s_lshl_b32 s24, s21, 7
  buffer_load_dwordx4 v[92:95], v8, s[12:15], s24 offen
  s_add_u32 s24, s24, 221184
  buffer_load_dwordx4 v[96:99], v8, s[12:15], s24 offen
  s_add_u32 s24, s24, 221184
  buffer_load_dwordx4 v[100:103], v8, s[12:15], s24 offen
  s_add_u32 s24, s24, 221184
  buffer_load_dwordx4 v[104:107], v8, s[12:15], s24 offen
  s_add_u32 s24, s24, 221184
  buffer_load_dwordx4 v[108:111], v8, s[12:15], s24 offen
  s_add_u32 s24, s24, 221184
  buffer_load_dwordx4 v[112:115], v8, s[12:15], s24 offen
  s_add_u32 s24, s24, 221184
  buffer_load_dwordx4 v[116:119], v8, s[12:15], s24 offen
  s_add_u32 s24, s24, 221184
  buffer_load_dwordx4 v[120:123], v8, s[12:15], s24 offen
  s_add_u32 s24, s24, 221184
  buffer_load_dwordx4 v[124:127], v8, s[12:15], s24 offen
  v_lshlrev_b32 v26, 16, v56
  v_and_b32 v27, 0xffff0000, v56
  v_mul_f32 v36, v16, v26
  v_mul_f32 v37, v16, v27
  v_lshlrev_b32 v26, 16, v57
  v_and_b32 v27, 0xffff0000, v57
  v_mul_f32 v38, v16, v26
  v_mul_f32 v39, v16, v27
  v_lshlrev_b32 v26, 16, v58
  v_and_b32 v27, 0xffff0000, v58
  v_mul_f32 v40, v16, v26
  v_mul_f32 v41, v16, v27
  v_lshlrev_b32 v26, 16, v59
  v_and_b32 v27, 0xffff0000, v59
  v_mul_f32 v42, v16, v26
  v_mul_f32 v43, v16, v27
  v_lshlrev_b32 v26, 16, v60
  v_and_b32 v27, 0xffff0000, v60
  v_fmac_f32 v36, v17, v26
  v_fmac_f32 v37, v17, v27
  v_lshlrev_b32 v26, 16, v61
  v_and_b32 v27, 0xffff0000, v61
  v_fmac_f32 v38, v17, v26
  v_fmac_f32 v39, v17, v27
  v_lshlrev_b32 v26, 16, v62
  v_and_b32 v27, 0xffff0000, v62
  v_fmac_f32 v40, v17, v26
  v_fmac_f32 v41, v17, v27
  v_lshlrev_b32 v26, 16, v63
  v_and_b32 v27, 0xffff0000, v63
  v_fmac_f32 v42, v17, v26
  v_fmac_f32 v43, v17, v27
  v_lshlrev_b32 v26, 16, v64
  v_and_b32 v27, 0xffff0000, v64
  v_fmac_f32 v36, v18, v26
  v_fmac_f32 v37, v18, v27
  v_lshlrev_b32 v26, 16, v65
  v_and_b32 v27, 0xffff0000, v65
  v_fmac_f32 v38, v18, v26
  v_fmac_f32 v39, v18, v27
  v_lshlrev_b32 v26, 16, v66
  v_and_b32 v27, 0xffff0000, v66
  v_fmac_f32 v40, v18, v26
  v_fmac_f32 v41, v18, v27
  v_lshlrev_b32 v26, 16, v67
  v_and_b32 v27, 0xffff0000, v67
  v_fmac_f32 v42, v18, v26
  v_fmac_f32 v43, v18, v27
  v_lshlrev_b32 v26, 16, v68
  v_and_b32 v27, 0xffff0000, v68
  v_fmac_f32 v36, v19, v26
  v_fmac_f32 v37, v19, v27
  v_lshlrev_b32 v26, 16, v69
  v_and_b32 v27, 0xffff0000, v69
  v_fmac_f32 v38, v19, v26
  v_fmac_f32 v39, v19, v27
  v_lshlrev_b32 v26, 16, v70
  v_and_b32 v27, 0xffff0000, v70
  v_fmac_f32 v40, v19, v26
  v_fmac_f32 v41, v19, v27
  v_lshlrev_b32 v26, 16, v71
  v_and_b32 v27, 0xffff0000, v71
  v_fmac_f32 v42, v19, v26
  v_fmac_f32 v43, v19, v27
  v_lshlrev_b32 v26, 16, v72
  v_and_b32 v27, 0xffff0000, v72
  v_fmac_f32 v36, v20, v26
  v_fmac_f32 v37, v20, v27
  v_lshlrev_b32 v26, 16, v73
  v_and_b32 v27, 0xffff0000, v73
  v_fmac_f32 v38, v20, v26
  v_fmac_f32 v39, v20, v27
  v_lshlrev_b32 v26, 16, v74
  v_and_b32 v27, 0xffff0000, v74
  v_fmac_f32 v40, v20, v26
  v_fmac_f32 v41, v20, v27
  v_lshlrev_b32 v26, 16, v75
  v_and_b32 v27, 0xffff0000, v75
  v_fmac_f32 v42, v20, v26
  v_fmac_f32 v43, v20, v27
  v_lshlrev_b32 v26, 16, v76
  v_and_b32 v27, 0xffff0000, v76
  v_fmac_f32 v36, v21, v26
  v_fmac_f32 v37, v21, v27
  v_lshlrev_b32 v26, 16, v77
  v_and_b32 v27, 0xffff0000, v77
  v_fmac_f32 v38, v21, v26
  v_fmac_f32 v39, v21, v27
  v_lshlrev_b32 v26, 16, v78
  v_and_b32 v27, 0xffff0000, v78
  v_fmac_f32 v40, v21, v26
  v_fmac_f32 v41, v21, v27
  v_lshlrev_b32 v26, 16, v79
  v_and_b32 v27, 0xffff0000, v79
  v_fmac_f32 v42, v21, v26
  v_fmac_f32 v43, v21, v27
  v_lshlrev_b32 v26, 16, v80
  v_and_b32 v27, 0xffff0000, v80
  v_fmac_f32 v36, v22, v26
  v_fmac_f32 v37, v22, v27
  v_lshlrev_b32 v26, 16, v81
  v_and_b32 v27, 0xffff0000, v81
  v_fmac_f32 v38, v22, v26
  v_fmac_f32 v39, v22, v27
  v_lshlrev_b32 v26, 16, v82
  v_and_b32 v27, 0xffff0000, v82
  v_fmac_f32 v40, v22, v26
  v_fmac_f32 v41, v22, v27
  v_lshlrev_b32 v26, 16, v83
  v_and_b32 v27, 0xffff0000, v83
  v_fmac_f32 v42, v22, v26
  v_fmac_f32 v43, v22, v27
  v_lshlrev_b32 v26, 16, v84
  v_and_b32 v27, 0xffff0000, v84
  v_fmac_f32 v36, v23, v26
  v_fmac_f32 v37, v23, v27
  v_lshlrev_b32 v26, 16, v85
  v_and_b32 v27, 0xffff0000, v85
  v_fmac_f32 v38, v23, v26
  v_fmac_f32 v39, v23, v27
  v_lshlrev_b32 v26, 16, v86
  v_and_b32 v27, 0xffff0000, v86
  v_fmac_f32 v40, v23, v26
  v_fmac_f32 v41, v23, v27
  v_lshlrev_b32 v26, 16, v87
  v_and_b32 v27, 0xffff0000, v87
  v_fmac_f32 v42, v23, v26
  v_fmac_f32 v43, v23, v27
  v_lshlrev_b32 v26, 16, v88
  v_and_b32 v27, 0xffff0000, v88
  v_fmac_f32 v36, v24, v26
  v_fmac_f32 v37, v24, v27
  v_lshlrev_b32 v26, 16, v89
  v_and_b32 v27, 0xffff0000, v89
  v_fmac_f32 v38, v24, v26
  v_fmac_f32 v39, v24, v27
  v_lshlrev_b32 v26, 16, v90
  v_and_b32 v27, 0xffff0000, v90
  v_fmac_f32 v40, v24, v26
  v_fmac_f32 v41, v24, v27
  v_lshlrev_b32 v26, 16, v91
  v_and_b32 v27, 0xffff0000, v91
  v_fmac_f32 v42, v24, v26
  v_fmac_f32 v43, v24, v27
  s_nop 1
  v_add_f32_dpp v36, v36, v36 row_ror:8 row_mask:0xf bank_mask:0xf
  v_add_f32_dpp v37, v37, v37 row_ror:8 row_mask:0xf bank_mask:0xf
  v_add_f32_dpp v38, v38, v38 row_ror:8 row_mask:0xf bank_mask:0xf
  v_add_f32_dpp v39, v39, v39 row_ror:8 row_mask:0xf bank_mask:0xf
  v_add_f32_dpp v40, v40, v40 row_ror:8 row_mask:0xf bank_mask:0xf
  v_add_f32_dpp v41, v41, v41 row_ror:8 row_mask:0xf bank_mask:0xf
  v_add_f32_dpp v42, v42, v42 row_ror:8 row_mask:0xf bank_mask:0xf
  v_add_f32_dpp v43, v43, v43 row_ror:8 row_mask:0xf bank_mask:0xf
  v_mov_b32 v44, v36
  v_mov_b32 v45, v37
  v_mov_b32 v46, v38
  v_mov_b32 v47, v39
  v_mov_b32 v48, v40
  v_mov_b32 v49, v41
  v_mov_b32 v50, v42
  v_mov_b32 v51, v43
  s_nop 1
  v_permlane16_swap_b32 v36, v44
  v_permlane16_swap_b32 v37, v45
  v_permlane16_swap_b32 v38, v46
  v_permlane16_swap_b32 v39, v47
  v_permlane16_swap_b32 v40, v48
  v_permlane16_swap_b32 v41, v49
  v_permlane16_swap_b32 v42, v50
  v_permlane16_swap_b32 v43, v51
  s_nop 1
  v_add_f32 v36, v36, v44
  v_add_f32 v37, v37, v45
  v_add_f32 v38, v38, v46
  v_add_f32 v39, v39, v47
  v_add_f32 v40, v40, v48
  v_add_f32 v41, v41, v49
  v_add_f32 v42, v42, v50
  v_add_f32 v43, v43, v51
  v_mov_b32 v44, v36
  v_mov_b32 v45, v37
  v_mov_b32 v46, v38
  v_mov_b32 v47, v39
  v_mov_b32 v48, v40
  v_mov_b32 v49, v41
  v_mov_b32 v50, v42
  v_mov_b32 v51, v43
  s_nop 1
  v_permlane32_swap_b32 v36, v44
  v_permlane32_swap_b32 v37, v45
  v_permlane32_swap_b32 v38, v46
  v_permlane32_swap_b32 v39, v47
  v_permlane32_swap_b32 v40, v48
  v_permlane32_swap_b32 v41, v49
  v_permlane32_swap_b32 v42, v50
  v_permlane32_swap_b32 v43, v51
  s_nop 1
  v_add_f32 v36, v36, v44
  v_add_f32 v37, v37, v45
  v_add_f32 v38, v38, v46
  v_add_f32 v39, v39, v47
  v_add_f32 v40, v40, v48
  v_add_f32 v41, v41, v49
  v_add_f32 v42, v42, v50
  v_add_f32 v43, v43, v51
  s_mov_b64 exec, 0xff
  ds_write_b128 v13, v[36:39] offset:0
  ds_write_b128 v13, v[40:43] offset:16
  s_mov_b64 exec, -1
  s_waitcnt lgkmcnt(0)
  s_barrier
  s_cmp_lg_u32 s3, 3
  s_cbranch_scc1 F_MOD_N0
  ds_read_b32 v36, v14 offset:0
  ds_read_b32 v37, v14 offset:256
  ds_read_b32 v38, v14 offset:512
  ds_read_b32 v39, v14 offset:768
  s_lshl_b32 s24, s20, 9
  s_add_u32 s24, s24, s25
  s_waitcnt lgkmcnt(0)
  v_add_f32 v36, v36, v37
  v_add_f32 v38, v38, v39
  v_add_f32 v36, v36, v38
  v_mov_b32 v37, s42
  buffer_store_dwordx2 v[36:37], v15, s[8:11], s24 offen sc1
  s_nop 1
F_MOD_N0:
  s_waitcnt vmcnt(0)
  s_lshl_b32 s24, s22, 7
  buffer_load_dwordx4 v[56:59], v8, s[12:15], s24 offen
  s_add_u32 s24, s24, 221184
  buffer_load_dwordx4 v[60:63], v8, s[12:15], s24 offen
  s_add_u32 s24, s24, 221184
  buffer_load_dwordx4 v[64:67], v8, s[12:15], s24 offen
  s_add_u32 s24, s24, 221184
  buffer_load_dwordx4 v[68:71], v8, s[12:15], s24 offen
  s_add_u32 s24, s24, 221184
  buffer_load_dwordx4 v[72:75], v8, s[12:15], s24 offen
  s_add_u32 s24, s24, 221184
  buffer_load_dwordx4 v[76:79], v8, s[12:15], s24 offen
  s_add_u32 s24, s24, 221184
  buffer_load_dwordx4 v[80:83], v8, s[12:15], s24 offen
  s_add_u32 s24, s24, 221184
  buffer_load_dwordx4 v[84:87], v8, s[12:15], s24 offen
  s_add_u32 s24, s24, 221184
  buffer_load_dwordx4 v[88:91], v8, s[12:15], s24 offen
  v_lshlrev_b32 v26, 16, v92
  v_and_b32 v27, 0xffff0000, v92
  v_mul_f32 v36, v16, v26
  v_mul_f32 v37, v16, v27
  v_lshlrev_b32 v26, 16, v93
  v_and_b32 v27, 0xffff0000, v93
  v_mul_f32 v38, v16, v26
  v_mul_f32 v39, v16, v27
  v_lshlrev_b32 v26, 16, v94
  v_and_b32 v27, 0xffff0000, v94
  v_mul_f32 v40, v16, v26
  v_mul_f32 v41, v16, v27
  v_lshlrev_b32 v26, 16, v95
  v_and_b32 v27, 0xffff0000, v95
  v_mul_f32 v42, v16, v26
  v_mul_f32 v43, v16, v27
  v_lshlrev_b32 v26, 16, v96
  v_and_b32 v27, 0xffff0000, v96
  v_fmac_f32 v36, v17, v26
  v_fmac_f32 v37, v17, v27
  v_lshlrev_b32 v26, 16, v97
  v_and_b32 v27, 0xffff0000, v97
  v_fmac_f32 v38, v17, v26
  v_fmac_f32 v39, v17, v27
  v_lshlrev_b32 v26, 16, v98
  v_and_b32 v27, 0xffff0000, v98
  v_fmac_f32 v40, v17, v26
  v_fmac_f32 v41, v17, v27
  v_lshlrev_b32 v26, 16, v99
  v_and_b32 v27, 0xffff0000, v99
  v_fmac_f32 v42, v17, v26
  v_fmac_f32 v43, v17, v27
  v_lshlrev_b32 v26, 16, v100
  v_and_b32 v27, 0xffff0000, v100
  v_fmac_f32 v36, v18, v26
  v_fmac_f32 v37, v18, v27
  v_lshlrev_b32 v26, 16, v101
  v_and_b32 v27, 0xffff0000, v101
  v_fmac_f32 v38, v18, v26
  v_fmac_f32 v39, v18, v27
  v_lshlrev_b32 v26, 16, v102
  v_and_b32 v27, 0xffff0000, v102
  v_fmac_f32 v40, v18, v26
  v_fmac_f32 v41, v18, v27
  v_lshlrev_b32 v26, 16, v103
  v_and_b32 v27, 0xffff0000, v103
  v_fmac_f32 v42, v18, v26
  v_fmac_f32 v43, v18, v27
  v_lshlrev_b32 v26, 16, v104
  v_and_b32 v27, 0xffff0000, v104
  v_fmac_f32 v36, v19, v26
  v_fmac_f32 v37, v19, v27
  v_lshlrev_b32 v26, 16, v105
  v_and_b32 v27, 0xffff0000, v105
  v_fmac_f32 v38, v19, v26
  v_fmac_f32 v39, v19, v27
  v_lshlrev_b32 v26, 16, v106
  v_and_b32 v27, 0xffff0000, v106
  v_fmac_f32 v40, v19, v26
  v_fmac_f32 v41, v19, v27
  v_lshlrev_b32 v26, 16, v107
  v_and_b32 v27, 0xffff0000, v107
  v_fmac_f32 v42, v19, v26
  v_fmac_f32 v43, v19, v27
  v_lshlrev_b32 v26, 16, v108
  v_and_b32 v27, 0xffff0000, v108
  v_fmac_f32 v36, v20, v26
  v_fmac_f32 v37, v20, v27
  v_lshlrev_b32 v26, 16, v109
  v_and_b32 v27, 0xffff0000, v109
  v_fmac_f32 v38, v20, v26
  v_fmac_f32 v39, v20, v27
  v_lshlrev_b32 v26, 16, v110
  v_and_b32 v27, 0xffff0000, v110
  v_fmac_f32 v40, v20, v26
  v_fmac_f32 v41, v20, v27
  v_lshlrev_b32 v26, 16, v111
  v_and_b32 v27, 0xffff0000, v111
  v_fmac_f32 v42, v20, v26
  v_fmac_f32 v43, v20, v27
  v_lshlrev_b32 v26, 16, v112
  v_and_b32 v27, 0xffff0000, v112
  v_fmac_f32 v36, v21, v26
  v_fmac_f32 v37, v21, v27
  v_lshlrev_b32 v26, 16, v113
  v_and_b32 v27, 0xffff0000, v113
  v_fmac_f32 v38, v21, v26
  v_fmac_f32 v39, v21, v27
  v_lshlrev_b32 v26, 16, v114
  v_and_b32 v27, 0xffff0000, v114
  v_fmac_f32 v40, v21, v26
  v_fmac_f32 v41, v21, v27
  v_lshlrev_b32 v26, 16, v115
  v_and_b32 v27, 0xffff0000, v115
  v_fmac_f32 v42, v21, v26
  v_fmac_f32 v43, v21, v27
  v_lshlrev_b32 v26, 16, v116
  v_and_b32 v27, 0xffff0000, v116
  v_fmac_f32 v36, v22, v26
  v_fmac_f32 v37, v22, v27
  v_lshlrev_b32 v26, 16, v117
  v_and_b32 v27, 0xffff0000, v117
  v_fmac_f32 v38, v22, v26
  v_fmac_f32 v39, v22, v27
  v_lshlrev_b32 v26, 16, v118
  v_and_b32 v27, 0xffff0000, v118
  v_fmac_f32 v40, v22, v26
  v_fmac_f32 v41, v22, v27
  v_lshlrev_b32 v26, 16, v119
  v_and_b32 v27, 0xffff0000, v119
  v_fmac_f32 v42, v22, v26
  v_fmac_f32 v43, v22, v27
  v_lshlrev_b32 v26, 16, v120
  v_and_b32 v27, 0xffff0000, v120
  v_fmac_f32 v36, v23, v26
  v_fmac_f32 v37, v23, v27
  v_lshlrev_b32 v26, 16, v121
  v_and_b32 v27, 0xffff0000, v121
  v_fmac_f32 v38, v23, v26
  v_fmac_f32 v39, v23, v27
  v_lshlrev_b32 v26, 16, v122
  v_and_b32 v27, 0xffff0000, v122
  v_fmac_f32 v40, v23, v26
  v_fmac_f32 v41, v23, v27
  v_lshlrev_b32 v26, 16, v123
  v_and_b32 v27, 0xffff0000, v123
  v_fmac_f32 v42, v23, v26
  v_fmac_f32 v43, v23, v27
  v_lshlrev_b32 v26, 16, v124
  v_and_b32 v27, 0xffff0000, v124
  v_fmac_f32 v36, v24, v26
  v_fmac_f32 v37, v24, v27
  v_lshlrev_b32 v26, 16, v125
  v_and_b32 v27, 0xffff0000, v125
  v_fmac_f32 v38, v24, v26
  v_fmac_f32 v39, v24, v27
  v_lshlrev_b32 v26, 16, v126
  v_and_b32 v27, 0xffff0000, v126
  v_fmac_f32 v40, v24, v26
  v_fmac_f32 v41, v24, v27
  v_lshlrev_b32 v26, 16, v127
  v_and_b32 v27, 0xffff0000, v127
  v_fmac_f32 v42, v24, v26
  v_fmac_f32 v43, v24, v27
  s_nop 1
  v_add_f32_dpp v36, v36, v36 row_ror:8 row_mask:0xf bank_mask:0xf
  v_add_f32_dpp v37, v37, v37 row_ror:8 row_mask:0xf bank_mask:0xf
  v_add_f32_dpp v38, v38, v38 row_ror:8 row_mask:0xf bank_mask:0xf
  v_add_f32_dpp v39, v39, v39 row_ror:8 row_mask:0xf bank_mask:0xf
  v_add_f32_dpp v40, v40, v40 row_ror:8 row_mask:0xf bank_mask:0xf
  v_add_f32_dpp v41, v41, v41 row_ror:8 row_mask:0xf bank_mask:0xf
  v_add_f32_dpp v42, v42, v42 row_ror:8 row_mask:0xf bank_mask:0xf
  v_add_f32_dpp v43, v43, v43 row_ror:8 row_mask:0xf bank_mask:0xf
  v_mov_b32 v44, v36
  v_mov_b32 v45, v37
  v_mov_b32 v46, v38
  v_mov_b32 v47, v39
  v_mov_b32 v48, v40
  v_mov_b32 v49, v41
  v_mov_b32 v50, v42
  v_mov_b32 v51, v43
  s_nop 1
  v_permlane16_swap_b32 v36, v44
  v_permlane16_swap_b32 v37, v45
  v_permlane16_swap_b32 v38, v46
  v_permlane16_swap_b32 v39, v47
  v_permlane16_swap_b32 v40, v48
  v_permlane16_swap_b32 v41, v49
  v_permlane16_swap_b32 v42, v50
  v_permlane16_swap_b32 v43, v51
  s_nop 1
  v_add_f32 v36, v36, v44
  v_add_f32 v37, v37, v45
  v_add_f32 v38, v38, v46
  v_add_f32 v39, v39, v47
  v_add_f32 v40, v40, v48
  v_add_f32 v41, v41, v49
  v_add_f32 v42, v42, v50
  v_add_f32 v43, v43, v51
  v_mov_b32 v44, v36
  v_mov_b32 v45, v37
  v_mov_b32 v46, v38
  v_mov_b32 v47, v39
  v_mov_b32 v48, v40
  v_mov_b32 v49, v41
  v_mov_b32 v50, v42
  v_mov_b32 v51, v43
  s_nop 1
  v_permlane32_swap_b32 v36, v44
  v_permlane32_swap_b32 v37, v45
  v_permlane32_swap_b32 v38, v46
  v_permlane32_swap_b32 v39, v47
  v_permlane32_swap_b32 v40, v48
  v_permlane32_swap_b32 v41, v49
  v_permlane32_swap_b32 v42, v50
  v_permlane32_swap_b32 v43, v51
  s_nop 1
  v_add_f32 v36, v36, v44
  v_add_f32 v37, v37, v45
  v_add_f32 v38, v38, v46
  v_add_f32 v39, v39, v47
  v_add_f32 v40, v40, v48
  v_add_f32 v41, v41, v49
  v_add_f32 v42, v42, v50
  v_add_f32 v43, v43, v51
  s_mov_b64 exec, 0xff
  ds_write_b128 v13, v[36:39] offset:1024
  ds_write_b128 v13, v[40:43] offset:1040
  s_mov_b64 exec, -1
  s_waitcnt lgkmcnt(0)
  s_barrier
  s_cmp_lg_u32 s3, 2
  s_cbranch_scc1 F_MOD_N1
  ds_read_b32 v36, v14 offset:1024
  ds_read_b32 v37, v14 offset:1280
  ds_read_b32 v38, v14 offset:1536
  ds_read_b32 v39, v14 offset:1792
  s_lshl_b32 s24, s21, 9
  s_add_u32 s24, s24, s25
  s_waitcnt lgkmcnt(0)
  v_add_f32 v36, v36, v37
  v_add_f32 v38, v38, v39
  v_add_f32 v36, v36, v38
  v_mov_b32 v37, s42
  buffer_store_dwordx2 v[36:37], v15, s[8:11], s24 offen sc1
  s_nop 1
F_MOD_N1:
  s_waitcnt vmcnt(0)
  s_mul_i32 s37, s36, 7282
  s_lshr_b32 s37, s37, 16
  s_mul_i32 s38, s37, 9
  s_sub_u32 s39, s36, s38
  s_lshl_b32 s44, s37, 2
  s_add_u32 s44, s44, s3
  s_mul_i32 s44, s44, 82944
  s_lshl_b32 s45, s39, 7
  s_add_u32 s44, s44, s45
  s_mul_i32 s38, s38, 36864
  s_lshl_b32 s39, s39, 2
  s_add_u32 s39, s39, s3
  s_lshl_b32 s39, s39, 10
  s_add_u32 s38, s38, s39
  s_add_u32 s38, s38, 14680064
  s_mul_i32 s45, s3, 9216
  s_add_u32 s45, s45, 81920
  s_add_u32 m0, s45, 0
  s_nop 0
  buffer_load_dwordx4 v245, s[32:35], s44 offen lds
  s_add_u32 s44, s44, 9216
  s_add_u32 m0, s45, 1024
  s_nop 0
  buffer_load_dwordx4 v245, s[32:35], s44 offen lds
  s_add_u32 s44, s44, 9216
  s_add_u32 m0, s45, 2048
  s_nop 0
  buffer_load_dwordx4 v245, s[32:35], s44 offen lds
  s_add_u32 s44, s44, 9216
  s_add_u32 m0, s45, 3072
  s_nop 0
  buffer_load_dwordx4 v245, s[32:35], s44 offen lds
  s_add_u32 s44, s44, 9216
  s_add_u32 m0, s45, 4096
  s_nop 0
  buffer_load_dwordx4 v245, s[32:35], s44 offen lds
  s_add_u32 s44, s44, 9216
  s_add_u32 m0, s45, 5120
  s_nop 0
  buffer_load_dwordx4 v245, s[32:35], s44 offen lds
  s_add_u32 s44, s44, 9216
  s_add_u32 m0, s45, 6144
  s_nop 0
  buffer_load_dwordx4 v245, s[32:35], s44 offen lds
  s_add_u32 s44, s44, 9216
  s_add_u32 m0, s45, 7168
  s_nop 0
  buffer_load_dwordx4 v245, s[32:35], s44 offen lds
  s_add_u32 s44, s44, 9216
  s_add_u32 m0, s45, 8192
  s_nop 0
  buffer_load_dwordx4 v245, s[32:35], s44 offen lds
  v_lshlrev_b32 v26, 16, v56
  v_and_b32 v27, 0xffff0000, v56
  v_mul_f32 v36, v16, v26
  v_mul_f32 v37, v16, v27
  v_lshlrev_b32 v26, 16, v57
  v_and_b32 v27, 0xffff0000, v57
  v_mul_f32 v38, v16, v26
  v_mul_f32 v39, v16, v27
  v_lshlrev_b32 v26, 16, v58
  v_and_b32 v27, 0xffff0000, v58
  v_mul_f32 v40, v16, v26
  v_mul_f32 v41, v16, v27
  v_lshlrev_b32 v26, 16, v59
  v_and_b32 v27, 0xffff0000, v59
  v_mul_f32 v42, v16, v26
  v_mul_f32 v43, v16, v27
  v_lshlrev_b32 v26, 16, v60
  v_and_b32 v27, 0xffff0000, v60
  v_fmac_f32 v36, v17, v26
  v_fmac_f32 v37, v17, v27
  v_lshlrev_b32 v26, 16, v61
  v_and_b32 v27, 0xffff0000, v61
  v_fmac_f32 v38, v17, v26
  v_fmac_f32 v39, v17, v27
  v_lshlrev_b32 v26, 16, v62
  v_and_b32 v27, 0xffff0000, v62
  v_fmac_f32 v40, v17, v26
  v_fmac_f32 v41, v17, v27
  v_lshlrev_b32 v26, 16, v63
  v_and_b32 v27, 0xffff0000, v63
  v_fmac_f32 v42, v17, v26
  v_fmac_f32 v43, v17, v27
  v_lshlrev_b32 v26, 16, v64
  v_and_b32 v27, 0xffff0000, v64
  v_fmac_f32 v36, v18, v26
  v_fmac_f32 v37, v18, v27
  v_lshlrev_b32 v26, 16, v65
  v_and_b32 v27, 0xffff0000, v65
  v_fmac_f32 v38, v18, v26
  v_fmac_f32 v39, v18, v27
  v_lshlrev_b32 v26, 16, v66
  v_and_b32 v27, 0xffff0000, v66
  v_fmac_f32 v40, v18, v26
  v_fmac_f32 v41, v18, v27
  v_lshlrev_b32 v26, 16, v67
  v_and_b32 v27, 0xffff0000, v67
  v_fmac_f32 v42, v18, v26
  v_fmac_f32 v43, v18, v27
  v_lshlrev_b32 v26, 16, v68
  v_and_b32 v27, 0xffff0000, v68
  v_fmac_f32 v36, v19, v26
  v_fmac_f32 v37, v19, v27
  v_lshlrev_b32 v26, 16, v69
  v_and_b32 v27, 0xffff0000, v69
  v_fmac_f32 v38, v19, v26
  v_fmac_f32 v39, v19, v27
  v_lshlrev_b32 v26, 16, v70
  v_and_b32 v27, 0xffff0000, v70
  v_fmac_f32 v40, v19, v26
  v_fmac_f32 v41, v19, v27
  v_lshlrev_b32 v26, 16, v71
  v_and_b32 v27, 0xffff0000, v71
  v_fmac_f32 v42, v19, v26
  v_fmac_f32 v43, v19, v27
  v_lshlrev_b32 v26, 16, v72
  v_and_b32 v27, 0xffff0000, v72
  v_fmac_f32 v36, v20, v26
  v_fmac_f32 v37, v20, v27
  v_lshlrev_b32 v26, 16, v73
  v_and_b32 v27, 0xffff0000, v73
  v_fmac_f32 v38, v20, v26
  v_fmac_f32 v39, v20, v27
  v_lshlrev_b32 v26, 16, v74
  v_and_b32 v27, 0xffff0000, v74
  v_fmac_f32 v40, v20, v26
  v_fmac_f32 v41, v20, v27
  v_lshlrev_b32 v26, 16, v75
  v_and_b32 v27, 0xffff0000, v75
  v_fmac_f32 v42, v20, v26
  v_fmac_f32 v43, v20, v27
  v_lshlrev_b32 v26, 16, v76
  v_and_b32 v27, 0xffff0000, v76
  v_fmac_f32 v36, v21, v26
  v_fmac_f32 v37, v21, v27
  v_lshlrev_b32 v26, 16, v77
  v_and_b32 v27, 0xffff0000, v77
  v_fmac_f32 v38, v21, v26
  v_fmac_f32 v39, v21, v27
  v_lshlrev_b32 v26, 16, v78
  v_and_b32 v27, 0xffff0000, v78
  v_fmac_f32 v40, v21, v26
  v_fmac_f32 v41, v21, v27
  v_lshlrev_b32 v26, 16, v79
  v_and_b32 v27, 0xffff0000, v79
  v_fmac_f32 v42, v21, v26
  v_fmac_f32 v43, v21, v27
  v_lshlrev_b32 v26, 16, v80
  v_and_b32 v27, 0xffff0000, v80
  v_fmac_f32 v36, v22, v26
  v_fmac_f32 v37, v22, v27
  v_lshlrev_b32 v26, 16, v81
  v_and_b32 v27, 0xffff0000, v81
  v_fmac_f32 v38, v22, v26
  v_fmac_f32 v39, v22, v27
  v_lshlrev_b32 v26, 16, v82
  v_and_b32 v27, 0xffff0000, v82
  v_fmac_f32 v40, v22, v26
  v_fmac_f32 v41, v22, v27
  v_lshlrev_b32 v26, 16, v83
  v_and_b32 v27, 0xffff0000, v83
  v_fmac_f32 v42, v22, v26
  v_fmac_f32 v43, v22, v27
  v_lshlrev_b32 v26, 16, v84
  v_and_b32 v27, 0xffff0000, v84
  v_fmac_f32 v36, v23, v26
  v_fmac_f32 v37, v23, v27
  v_lshlrev_b32 v26, 16, v85
  v_and_b32 v27, 0xffff0000, v85
  v_fmac_f32 v38, v23, v26
  v_fmac_f32 v39, v23, v27
  v_lshlrev_b32 v26, 16, v86
  v_and_b32 v27, 0xffff0000, v86
  v_fmac_f32 v40, v23, v26
  v_fmac_f32 v41, v23, v27
  v_lshlrev_b32 v26, 16, v87
  v_and_b32 v27, 0xffff0000, v87
  v_fmac_f32 v42, v23, v26
  v_fmac_f32 v43, v23, v27
  v_lshlrev_b32 v26, 16, v88
  v_and_b32 v27, 0xffff0000, v88
  v_fmac_f32 v36, v24, v26
  v_fmac_f32 v37, v24, v27
  v_lshlrev_b32 v26, 16, v89
  v_and_b32 v27, 0xffff0000, v89
  v_fmac_f32 v38, v24, v26
  v_fmac_f32 v39, v24, v27
  v_lshlrev_b32 v26, 16, v90
  v_and_b32 v27, 0xffff0000, v90
  v_fmac_f32 v40, v24, v26
  v_fmac_f32 v41, v24, v27
  v_lshlrev_b32 v26, 16, v91
  v_and_b32 v27, 0xffff0000, v91
  v_fmac_f32 v42, v24, v26
  v_fmac_f32 v43, v24, v27
  s_nop 1
  v_add_f32_dpp v36, v36, v36 row_ror:8 row_mask:0xf bank_mask:0xf
  v_add_f32_dpp v37, v37, v37 row_ror:8 row_mask:0xf bank_mask:0xf
  v_add_f32_dpp v38, v38, v38 row_ror:8 row_mask:0xf bank_mask:0xf
  v_add_f32_dpp v39, v39, v39 row_ror:8 row_mask:0xf bank_mask:0xf
  v_add_f32_dpp v40, v40, v40 row_ror:8 row_mask:0xf bank_mask:0xf
  v_add_f32_dpp v41, v41, v41 row_ror:8 row_mask:0xf bank_mask:0xf
  v_add_f32_dpp v42, v42, v42 row_ror:8 row_mask:0xf bank_mask:0xf
  v_add_f32_dpp v43, v43, v43 row_ror:8 row_mask:0xf bank_mask:0xf
  v_mov_b32 v44, v36
  v_mov_b32 v45, v37
  v_mov_b32 v46, v38
  v_mov_b32 v47, v39
  v_mov_b32 v48, v40
  v_mov_b32 v49, v41
  v_mov_b32 v50, v42
  v_mov_b32 v51, v43
  s_nop 1
  v_permlane16_swap_b32 v36, v44
  v_permlane16_swap_b32 v37, v45
  v_permlane16_swap_b32 v38, v46
  v_permlane16_swap_b32 v39, v47
  v_permlane16_swap_b32 v40, v48
  v_permlane16_swap_b32 v41, v49
  v_permlane16_swap_b32 v42, v50
  v_permlane16_swap_b32 v43, v51
  s_nop 1
  v_add_f32 v36, v36, v44
  v_add_f32 v37, v37, v45
  v_add_f32 v38, v38, v46
  v_add_f32 v39, v39, v47
  v_add_f32 v40, v40, v48
  v_add_f32 v41, v41, v49
  v_add_f32 v42, v42, v50
  v_add_f32 v43, v43, v51
  v_mov_b32 v44, v36
  v_mov_b32 v45, v37
  v_mov_b32 v46, v38
  v_mov_b32 v47, v39
  v_mov_b32 v48, v40
  v_mov_b32 v49, v41
  v_mov_b32 v50, v42
  v_mov_b32 v51, v43
  s_nop 1
  v_permlane32_swap_b32 v36, v44
  v_permlane32_swap_b32 v37, v45
  v_permlane32_swap_b32 v38, v46
  v_permlane32_swap_b32 v39, v47
  v_permlane32_swap_b32 v40, v48
  v_permlane32_swap_b32 v41, v49
  v_permlane32_swap_b32 v42, v50
  v_permlane32_swap_b32 v43, v51
  s_nop 1
  v_add_f32 v36, v36, v44
  v_add_f32 v37, v37, v45
  v_add_f32 v38, v38, v46
  v_add_f32 v39, v39, v47
  v_add_f32 v40, v40, v48
  v_add_f32 v41, v41, v49
  v_add_f32 v42, v42, v50
  v_add_f32 v43, v43, v51
  s_mov_b64 exec, 0xff
  ds_write_b128 v13, v[36:39] offset:2048
  ds_write_b128 v13, v[40:43] offset:2064
  s_mov_b64 exec, -1
  s_waitcnt lgkmcnt(0)
  s_barrier
  s_cmp_lg_u32 s3, 1
  s_cbranch_scc1 F_MOD_N2
  ds_read_b32 v36, v14 offset:2048
  ds_read_b32 v37, v14 offset:2304
  ds_read_b32 v38, v14 offset:2560
  ds_read_b32 v39, v14 offset:2816
  s_lshl_b32 s24, s22, 9
  s_add_u32 s24, s24, s25
  s_waitcnt lgkmcnt(0)
  v_add_f32 v36, v36, v37
  v_add_f32 v38, v38, v39
  v_add_f32 v36, v36, v38
  v_mov_b32 v37, s42
  buffer_store_dwordx2 v[36:37], v15, s[8:11], s24 offen sc1
  s_nop 1
F_MOD_N2:
  v_mov_b32 v248, 0
  v_lshlrev_b32 v249, 2, v0
  s_lshl_b32 s46, s2, 10
  s_add_u32 s46, s46, 4849664
  buffer_store_dword v248, v249, s[8:11], s46 offen sc1
  s_lshl_b32 s46, s2, 2
  s_add_u32 s46, s46, s3
  s_lshl_b32 s46, s46, 7
  s_add_u32 s46, s46, 7864320
  buffer_store_dword v248, v250, s[8:11], s46 offen sc1
  s_add_u32 s46, s46, 131072
  buffer_store_dword v248, v250, s[8:11], s46 offen sc1
  s_waitcnt vmcnt(0)
  s_barrier
  ds_read_b64_tr_b16 v[16:17], v244 offset:0
  ds_read_b64_tr_b16 v[18:19], v244 offset:2048
  ds_read_b64_tr_b16 v[20:21], v244 offset:4096
  ds_read_b64_tr_b16 v[22:23], v244 offset:6144
  ds_read_b64_tr_b16 v[24:25], v244 offset:8192
  ds_read_b64_tr_b16 v[26:27], v244 offset:10240
  ds_read_b64_tr_b16 v[28:29], v244 offset:12288
  ds_read_b64_tr_b16 v[30:31], v244 offset:14336
  ds_read_b64_tr_b16 v[32:33], v244 offset:18432
  ds_read_b64_tr_b16 v[34:35], v244 offset:20480
  s_waitcnt lgkmcnt(0)
  ds_read_b64_tr_b16 v[36:37], v244 offset:22528
  ds_read_b64_tr_b16 v[38:39], v244 offset:24576
  ds_read_b64_tr_b16 v[40:41], v244 offset:26624
  ds_read_b64_tr_b16 v[42:43], v244 offset:28672
  ds_read_b64_tr_b16 v[44:45], v244 offset:30720
  ds_read_b64_tr_b16 v[46:47], v244 offset:32768
  ds_read_b64_tr_b16 v[48:49], v244 offset:16384
  ds_read_b64_tr_b16 v[50:51], v244 offset:34816
  s_waitcnt lgkmcnt(0)
  buffer_store_dwordx4 v[16:19], v3, s[8:11], s38 offen sc1
  s_add_u32 s38, s38, 36864
  buffer_store_dwordx4 v[20:23], v3, s[8:11], s38 offen sc1
  s_add_u32 s38, s38, 36864
  buffer_store_dwordx4 v[24:27], v3, s[8:11], s38 offen sc1
  s_add_u32 s38, s38, 36864
  buffer_store_dwordx4 v[28:31], v3, s[8:11], s38 offen sc1
  s_add_u32 s38, s38, 36864
  buffer_store_dwordx4 v[32:35], v3, s[8:11], s38 offen sc1
  s_add_u32 s38, s38, 36864
  buffer_store_dwordx4 v[36:39], v3, s[8:11], s38 offen sc1
  s_add_u32 s38, s38, 36864
  buffer_store_dwordx4 v[40:43], v3, s[8:11], s38 offen sc1
  s_add_u32 s38, s38, 36864
  buffer_store_dwordx4 v[44:47], v3, s[8:11], s38 offen sc1
  s_add_u32 s38, s38, 36864
  buffer_store_dwordx4 v[48:51], v3, s[8:11], s38 offen sc1
  s_branch F_JOIN
F_WIN:
  s_mov_b32 s20, s78
  s_and_b32 s21, s79, 0xffff
  s_mov_b32 s22, 5308416
  s_mov_b32 s23, 0x20000
  s_mov_b32 s16, s72
  s_and_b32 s17, s73, 0xffff
  s_mov_b32 s18, 2359296
  s_mov_b32 s19, 0x20000
  s_sub_u32 s4, s2, 144
  s_lshr_b32 s5, s4, 3
  s_and_b32 s4, s4, 7
  s_mul_i32 s4, s4, 9
  s_add_u32 s4, s4, s5
  s_mul_i32 s7, s3, 1327104
  s_lshl_b32 s5, s4, 7
  s_add_u32 s7, s7, s5
  v_mul_u32_u24 v10, 9216, v10
  v_add_u32 v11, v11, v10
  v_lshlrev_b32 v14, 4, v0
  s_lshl_b32 s5, s4, 15
  buffer_load_dwordx4 v[16:19], v14, s[16:19], s5 offen
  s_add_u32 s5, s5, 4096
  buffer_load_dwordx4 v[16:19], v14, s[16:19], s5 offen
  s_add_u32 s5, s5, 4096
  buffer_load_dwordx4 v[16:19], v14, s[16:19], s5 offen
  s_add_u32 s5, s5, 4096
  buffer_load_dwordx4 v[16:19], v14, s[16:19], s5 offen
  s_add_u32 s5, s5, 4096
  buffer_load_dwordx4 v[16:19], v14, s[16:19], s5 offen
  s_add_u32 s5, s5, 4096
  buffer_load_dwordx4 v[16:19], v14, s[16:19], s5 offen
  s_add_u32 s5, s5, 4096
  buffer_load_dwordx4 v[16:19], v14, s[16:19], s5 offen
  s_add_u32 s5, s5, 4096
  buffer_load_dwordx4 v[16:19], v14, s[16:19], s5 offen
  s_add_u32 m0, s6, 0
  s_nop 0
  buffer_load_dwordx4 v11, s[20:23], s7 offen lds
  s_add_u32 s7, s7, 73728
  s_add_u32 m0, s6, 1024
  s_nop 0
  buffer_load_dwordx4 v11, s[20:23], s7 offen lds
  s_add_u32 s7, s7, 73728
  s_add_u32 m0, s6, 2048
  s_nop 0
  buffer_load_dwordx4 v11, s[20:23], s7 offen lds
  s_add_u32 s7, s7, 73728
  s_add_u32 m0, s6, 3072
  s_nop 0
  buffer_load_dwordx4 v11, s[20:23], s7 offen lds
  s_add_u32 s7, s7, 73728
  s_add_u32 m0, s6, 4096
  s_nop 0
  buffer_load_dwordx4 v11, s[20:23], s7 offen lds
  s_add_u32 s7, s7, 73728
  s_add_u32 m0, s6, 5120
  s_nop 0
  buffer_load_dwordx4 v11, s[20:23], s7 offen lds
  s_add_u32 s7, s7, 73728
  s_add_u32 m0, s6, 6144
  s_nop 0
  buffer_load_dwordx4 v11, s[20:23], s7 offen lds
  s_add_u32 s7, s7, 73728
  s_add_u32 m0, s6, 7168
  s_nop 0
  buffer_load_dwordx4 v11, s[20:23], s7 offen lds
  s_add_u32 s7, s7, 73728
  s_add_u32 m0, s6, 8192
  s_nop 0
  buffer_load_dwordx4 v11, s[20:23], s7 offen lds
  s_add_u32 s7, s7, 73728
  s_add_u32 m0, s6, 9216
  s_nop 0
  buffer_load_dwordx4 v11, s[20:23], s7 offen lds
  s_add_u32 s7, s7, 73728
  s_add_u32 m0, s6, 10240
  s_nop 0
  buffer_load_dwordx4 v11, s[20:23], s7 offen lds
  s_add_u32 s7, s7, 73728
  s_add_u32 m0, s6, 11264
  s_nop 0
  buffer_load_dwordx4 v11, s[20:23], s7 offen lds
  s_add_u32 s7, s7, 73728
  s_add_u32 m0, s6, 12288
  s_nop 0
  buffer_load_dwordx4 v11, s[20:23], s7 offen lds
  s_add_u32 s7, s7, 73728
  s_add_u32 m0, s6, 13312
  s_nop 0
  buffer_load_dwordx4 v11, s[20:23], s7 offen lds
  s_add_u32 s7, s7, 73728
  s_add_u32 m0, s6, 14336
  s_nop 0
  buffer_load_dwordx4 v11, s[20:23], s7 offen lds
  s_add_u32 s7, s7, 73728
  s_add_u32 m0, s6, 15360
  s_nop 0
  buffer_load_dwordx4 v11, s[20:23], s7 offen lds
  s_add_u32 s7, s7, 73728
  s_add_u32 m0, s6, 16384
  s_nop 0
  buffer_load_dwordx4 v11, s[20:23], s7 offen lds
  s_add_u32 s7, s7, 73728
  s_add_u32 m0, s6, 17408
  s_nop 0
  buffer_load_dwordx4 v11, s[20:23], s7 offen lds
  s_lshr_b32 s36, s4, 1
  s_add_u32 s36, s36, 48
  s_bitcmp1_b32 s4, 0
  s_cselect_b32 s36, 72, s36
  s_sub_u32 s96, s4, 12
  s_cmp_lt_u32 s4, 48
  s_cselect_b32 s96, 64, s96
  s_cmp_eq_u32 s4, 37
  s_cselect_b32 s96, 60, s96
  s_cmp_eq_u32 s4, 39
  s_cselect_b32 s96, 61, s96
  s_cmp_eq_u32 s4, 41
  s_cselect_b32 s96, 62, s96
  s_cmp_eq_u32 s4, 45
  s_cselect_b32 s96, 63, s96
  s_cmp_ge_u32 s36, 72
  s_cbranch_scc1 F_WIN_R
  s_mul_i32 s37, s36, 7282
  s_lshr_b32 s37, s37, 16
  s_mul_i32 s38, s37, 9
  s_sub_u32 s39, s36, s38
  s_lshl_b32 s44, s37, 2
  s_add_u32 s44, s44, s3
  s_mul_i32 s44, s44, 82944
  s_lshl_b32 s45, s39, 7
  s_add_u32 s44, s44, s45
  s_mul_i32 s38, s38, 36864
  s_lshl_b32 s39, s39, 2
  s_add_u32 s39, s39, s3
  s_lshl_b32 s39, s39, 10
  s_add_u32 s38, s38, s39
  s_add_u32 s38, s38, 14680064
  s_mul_i32 s45, s3, 9216
  s_add_u32 s45, s45, 81920
  s_add_u32 m0, s45, 0
  s_nop 0
  buffer_load_dwordx4 v245, s[32:35], s44 offen lds
  s_add_u32 s44, s44, 9216
  s_add_u32 m0, s45, 1024
  s_nop 0
  buffer_load_dwordx4 v245, s[32:35], s44 offen lds
  s_add_u32 s44, s44, 9216
  s_add_u32 m0, s45, 2048
  s_nop 0
  buffer_load_dwordx4 v245, s[32:35], s44 offen lds
  s_add_u32 s44, s44, 9216
  s_add_u32 m0, s45, 3072
  s_nop 0
  buffer_load_dwordx4 v245, s[32:35], s44 offen lds
  s_add_u32 s44, s44, 9216
  s_add_u32 m0, s45, 4096
  s_nop 0
  buffer_load_dwordx4 v245, s[32:35], s44 offen lds
  s_add_u32 s44, s44, 9216
  s_add_u32 m0, s45, 5120
  s_nop 0
  buffer_load_dwordx4 v245, s[32:35], s44 offen lds
  s_add_u32 s44, s44, 9216
  s_add_u32 m0, s45, 6144
  s_nop 0
  buffer_load_dwordx4 v245, s[32:35], s44 offen lds
  s_add_u32 s44, s44, 9216
  s_add_u32 m0, s45, 7168
  s_nop 0
  buffer_load_dwordx4 v245, s[32:35], s44 offen lds
  s_add_u32 s44, s44, 9216
  s_add_u32 m0, s45, 8192
  s_nop 0
  buffer_load_dwordx4 v245, s[32:35], s44 offen lds
F_WIN_R:
  v_mov_b32 v248, 0
  v_lshlrev_b32 v249, 2, v0
  s_lshl_b32 s46, s2, 10
  s_add_u32 s46, s46, 4849664
  buffer_store_dword v248, v249, s[8:11], s46 offen sc1
  s_lshl_b32 s46, s2, 2
  s_add_u32 s46, s46, s3
  s_lshl_b32 s46, s46, 7
  s_add_u32 s46, s46, 7864320
  buffer_store_dword v248, v250, s[8:11], s46 offen sc1
  s_add_u32 s46, s46, 131072
  buffer_store_dword v248, v250, s[8:11], s46 offen sc1
  s_mov_b32 s43, 0
  v_mov_b32 v14, 0
F_W_NP:
  buffer_load_dword v14, v14, s[28:31], 0 offen sc1
  s_waitcnt vmcnt(0)
  v_readfirstlane_b32 s42, v14
  s_add_u32 s43, s43, 1
  s_cmp_ge_u32 s43, 0x80000
  s_cbranch_scc1 F_W_NG
  s_cmp_lg_u32 s42, 0
  s_cbranch_scc1 F_W_NG
  s_sleep 2
  s_branch F_W_NP
F_W_NG:
  v_add_u32 v7, 256, v0
  v_min_u32 v7, 287, v7
  v_lshlrev_b32 v12, 4, v0
  v_lshlrev_b32 v13, 4, v7
  s_mov_b32 s16, 8140288
  s_mov_b32 s17, 8167936
  s_mov_b32 s18, 8144896
  s_mov_b32 s19, 8172544
  s_mov_b32 s43, 0
F_WG_POLL:
  buffer_load_dwordx4 v[16:19], v12, s[8:11], s16 offen sc1
  buffer_load_dwordx4 v[20:23], v12, s[8:11], s17 offen sc1
  buffer_load_dwordx4 v[24:27], v12, s[8:11], s18 offen sc1
  buffer_load_dwordx4 v[28:31], v12, s[8:11], s19 offen sc1
  buffer_load_dwordx4 v[32:35], v13, s[8:11], s16 offen sc1
  buffer_load_dwordx4 v[36:39], v13, s[8:11], s17 offen sc1
  buffer_load_dwordx4 v[40:43], v13, s[8:11], s18 offen sc1
  buffer_load_dwordx4 v[44:47], v13, s[8:11], s19 offen sc1
  s_waitcnt vmcnt(0)
  v_xor_b32 v14, s42, v17
  v_xor_b32 v15, s42, v19
  v_or_b32 v14, v14, v15
  v_xor_b32 v15, s42, v21
  v_or_b32 v14, v14, v15
  v_xor_b32 v15, s42, v23
  v_or_b32 v14, v14, v15
  v_xor_b32 v15, s42, v25
  v_or_b32 v14, v14, v15
  v_xor_b32 v15, s42, v27
  v_or_b32 v14, v14, v15
  v_xor_b32 v15, s42, v29
  v_or_b32 v14, v14, v15
  v_xor_b32 v15, s42, v31
  v_or_b32 v14, v14, v15
  v_xor_b32 v15, s42, v33
  v_or_b32 v14, v14, v15
  v_xor_b32 v15, s42, v35
  v_or_b32 v14, v14, v15
  v_xor_b32 v15, s42, v37
  v_or_b32 v14, v14, v15
  v_xor_b32 v15, s42, v39
  v_or_b32 v14, v14, v15
  v_xor_b32 v15, s42, v41
  v_or_b32 v14, v14, v15
  v_xor_b32 v15, s42, v43
  v_or_b32 v14, v14, v15
  v_xor_b32 v15, s42, v45
  v_or_b32 v14, v14, v15
  v_xor_b32 v15, s42, v47
  v_or_b32 v14, v14, v15
  v_cmp_ne_u32 vcc, 0, v14
  s_add_u32 s43, s43, 1
  s_cmp_ge_u32 s43, 0x80000
  s_cbranch_scc1 F_WG_GO
  s_nop 2
  s_cbranch_vccz F_WG_GO
  s_sleep 2
  s_branch F_WG_POLL
F_WG_GO:
  v_add_f32 v16, v16, v20
  v_add_f32 v18, v18, v22
  v_add_f32 v24, v24, v28
  v_add_f32 v26, v26, v30
  v_cvt_pk_bf16_f32 v16, v16, v18
  v_cvt_pk_bf16_f32 v24, v24, v26
  v_and_b32 v25, 0xffff0000, v24
  v_lshlrev_b32 v24, 16, v24
  v_add_f32 v24, 1.0, v24
  v_add_f32 v25, 1.0, v25
  v_cvt_pk_bf16_f32 v24, v24, v25
  v_and_b32 v25, 0xffff0000, v24
  v_lshlrev_b32 v24, 16, v24
  v_lshlrev_b32 v13, 3, v0
  v_lshlrev_b32 v14, 2, v0
  v_add_u32 v13, 73728, v13
  v_add_u32 v14, 76800, v14
  ds_write_b64 v13, v[24:25]
  ds_write_b32 v14, v16
  v_add_f32 v32, v32, v36
  v_add_f32 v34, v34, v38
  v_add_f32 v40, v40, v44
  v_add_f32 v42, v42, v46
  v_cvt_pk_bf16_f32 v32, v32, v34
  v_cvt_pk_bf16_f32 v40, v40, v42
  v_and_b32 v41, 0xffff0000, v40
  v_lshlrev_b32 v40, 16, v40
  v_add_f32 v40, 1.0, v40
  v_add_f32 v41, 1.0, v41
  v_cvt_pk_bf16_f32 v40, v40, v41
  v_and_b32 v41, 0xffff0000, v40
  v_lshlrev_b32 v40, 16, v40
  v_lshlrev_b32 v13, 3, v7
  v_lshlrev_b32 v14, 2, v7
  v_add_u32 v13, 73728, v13
  v_add_u32 v14, 76800, v14
  ds_write_b64 v13, v[40:41]
  ds_write_b32 v14, v32
  s_lshl_b32 s16, s4, 2
  s_add_u32 s16, s16, s3
  s_cmp_ge_u32 s16, 144
  s_cselect_b32 s17, 144, 0
  s_cselect_b32 s18, 0, 165888
  s_cselect_b32 s23, 1, 0
  s_sub_u32 s26, s16, s17
  s_mul_i32 s19, s26, 7282
  s_lshr_b32 s19, s19, 16
  s_mul_i32 s20, s19, 9
  s_sub_u32 s20, s26, s20
  s_mul_i32 s19, s19, 331776
  s_lshl_b32 s20, s20, 10
  s_add_u32 s19, s19, s20
  s_add_u32 s19, s19, s18
  s_add_u32 s27, s19, 8388608
  v_lshlrev_b32 v12, 4, v5
  v_add_u32 v12, 73728, v12
  v_lshlrev_b32 v13, 3, v5
  v_add_u32 v13, 76800, v13
  v_mov_b32 v14, 0
  v_mov_b32 v15, 0
  s_mov_b32 s21, 0x3f803f80
  s_waitcnt lgkmcnt(0)
  s_barrier
  ds_read_b64_tr_b16 v[16:17], v9 offset:0
  ds_read_b64_tr_b16 v[18:19], v9 offset:2048
  ds_read_b128 v[20:23], v12 offset:0
  ds_read_b128 v[24:27], v12 offset:64
  ds_read_b64 v[28:29], v13 offset:0
  ds_read_b64 v[30:31], v13 offset:32
  ds_read_b64_tr_b16 v[32:33], v9 offset:4096
  ds_read_b64_tr_b16 v[34:35], v9 offset:6144
  ds_read_b128 v[36:39], v12 offset:128
  ds_read_b128 v[40:43], v12 offset:192
  ds_read_b64 v[44:45], v13 offset:64
  ds_read_b64 v[46:47], v13 offset:96
  s_waitcnt lgkmcnt(6)
  ds_read_b64_tr_b16 v[48:49], v9 offset:8192
  ds_read_b64_tr_b16 v[50:51], v9 offset:10240
  ds_read_b128 v[52:55], v12 offset:256
  ds_read_b128 v[56:59], v12 offset:320
  ds_read_b64 v[60:61], v13 offset:128
  ds_read_b64 v[62:63], v13 offset:160
  v_lshlrev_b32 v64, 16, v16
  v_and_b32 v65, 0xffff0000, v16
  v_lshlrev_b32 v66, 16, v17
  v_and_b32 v67, 0xffff0000, v17
  v_lshlrev_b32 v68, 16, v18
  v_and_b32 v69, 0xffff0000, v18
  v_lshlrev_b32 v70, 16, v19
  v_and_b32 v71, 0xffff0000, v19
  v_dot2c_f32_bf16 v15, v16, v28
  v_dot2c_f32_bf16 v15, v17, v29
  v_dot2c_f32_bf16 v15, v18, v30
  v_dot2c_f32_bf16 v15, v19, v31
  v_pk_mul_f32 v[64:65], v[64:65], v[20:21]
  v_pk_mul_f32 v[66:67], v[66:67], v[22:23]
  v_pk_mul_f32 v[68:69], v[68:69], v[24:25]
  v_pk_mul_f32 v[70:71], v[70:71], v[26:27]
  v_cvt_pk_bf16_f32 v72, v64, v65
  v_cvt_pk_bf16_f32 v73, v66, v67
  v_cvt_pk_bf16_f32 v74, v68, v69
  v_cvt_pk_bf16_f32 v75, v70, v71
  buffer_store_dwordx4 v[72:75], v3, s[8:11], s27 offen sc1
  v_dot2c_f32_bf16 v14, s21, v72
  v_dot2c_f32_bf16 v14, s21, v73
  v_dot2c_f32_bf16 v14, s21, v74
  v_dot2c_f32_bf16 v14, s21, v75
  s_add_u32 s27, s27, 9216
  s_waitcnt lgkmcnt(6)
  ds_read_b64_tr_b16 v[16:17], v9 offset:12288
  ds_read_b64_tr_b16 v[18:19], v9 offset:14336
  ds_read_b128 v[20:23], v12 offset:384
  ds_read_b128 v[24:27], v12 offset:448
  ds_read_b64 v[28:29], v13 offset:192
  ds_read_b64 v[30:31], v13 offset:224
  v_lshlrev_b32 v64, 16, v32
  v_and_b32 v65, 0xffff0000, v32
  v_lshlrev_b32 v66, 16, v33
  v_and_b32 v67, 0xffff0000, v33
  v_lshlrev_b32 v68, 16, v34
  v_and_b32 v69, 0xffff0000, v34
  v_lshlrev_b32 v70, 16, v35
  v_and_b32 v71, 0xffff0000, v35
  v_dot2c_f32_bf16 v15, v32, v44
  v_dot2c_f32_bf16 v15, v33, v45
  v_dot2c_f32_bf16 v15, v34, v46
  v_dot2c_f32_bf16 v15, v35, v47
  v_pk_mul_f32 v[64:65], v[64:65], v[36:37]
  v_pk_mul_f32 v[66:67], v[66:67], v[38:39]
  v_pk_mul_f32 v[68:69], v[68:69], v[40:41]
  v_pk_mul_f32 v[70:71], v[70:71], v[42:43]
  v_cvt_pk_bf16_f32 v76, v64, v65
  v_cvt_pk_bf16_f32 v77, v66, v67
  v_cvt_pk_bf16_f32 v78, v68, v69
  v_cvt_pk_bf16_f32 v79, v70, v71
  buffer_store_dwordx4 v[76:79], v3, s[8:11], s27 offen sc1
  v_dot2c_f32_bf16 v14, s21, v76
  v_dot2c_f32_bf16 v14, s21, v77
  v_dot2c_f32_bf16 v14, s21, v78
  v_dot2c_f32_bf16 v14, s21, v79
  s_add_u32 s27, s27, 9216
  s_waitcnt lgkmcnt(6)
  ds_read_b64_tr_b16 v[32:33], v9 offset:16384
  ds_read_b64_tr_b16 v[34:35], v9 offset:18432
  ds_read_b128 v[36:39], v12 offset:512
  ds_read_b128 v[40:43], v12 offset:576
  ds_read_b64 v[44:45], v13 offset:256
  ds_read_b64 v[46:47], v13 offset:288
  v_lshlrev_b32 v64, 16, v48
  v_and_b32 v65, 0xffff0000, v48
  v_lshlrev_b32 v66, 16, v49
  v_and_b32 v67, 0xffff0000, v49
  v_lshlrev_b32 v68, 16, v50
  v_and_b32 v69, 0xffff0000, v50
  v_lshlrev_b32 v70, 16, v51
  v_and_b32 v71, 0xffff0000, v51
  v_dot2c_f32_bf16 v15, v48, v60
  v_dot2c_f32_bf16 v15, v49, v61
  v_dot2c_f32_bf16 v15, v50, v62
  v_dot2c_f32_bf16 v15, v51, v63
  v_pk_mul_f32 v[64:65], v[64:65], v[52:53]
  v_pk_mul_f32 v[66:67], v[66:67], v[54:55]
  v_pk_mul_f32 v[68:69], v[68:69], v[56:57]
  v_pk_mul_f32 v[70:71], v[70:71], v[58:59]
  v_cvt_pk_bf16_f32 v72, v64, v65
  v_cvt_pk_bf16_f32 v73, v66, v67
  v_cvt_pk_bf16_f32 v74, v68, v69
  v_cvt_pk_bf16_f32 v75, v70, v71
  buffer_store_dwordx4 v[72:75], v3, s[8:11], s27 offen sc1
  v_dot2c_f32_bf16 v14, s21, v72
  v_dot2c_f32_bf16 v14, s21, v73
  v_dot2c_f32_bf16 v14, s21, v74
  v_dot2c_f32_bf16 v14, s21, v75
  s_add_u32 s27, s27, 9216
  s_waitcnt lgkmcnt(6)
  ds_read_b64_tr_b16 v[48:49], v9 offset:20480
  ds_read_b64_tr_b16 v[50:51], v9 offset:22528
  ds_read_b128 v[52:55], v12 offset:640
  ds_read_b128 v[56:59], v12 offset:704
  ds_read_b64 v[60:61], v13 offset:320
  ds_read_b64 v[62:63], v13 offset:352
  v_lshlrev_b32 v64, 16, v16
  v_and_b32 v65, 0xffff0000, v16
  v_lshlrev_b32 v66, 16, v17
  v_and_b32 v67, 0xffff0000, v17
  v_lshlrev_b32 v68, 16, v18
  v_and_b32 v69, 0xffff0000, v18
  v_lshlrev_b32 v70, 16, v19
  v_and_b32 v71, 0xffff0000, v19
  v_dot2c_f32_bf16 v15, v16, v28
  v_dot2c_f32_bf16 v15, v17, v29
  v_dot2c_f32_bf16 v15, v18, v30
  v_dot2c_f32_bf16 v15, v19, v31
  v_pk_mul_f32 v[64:65], v[64:65], v[20:21]
  v_pk_mul_f32 v[66:67], v[66:67], v[22:23]
  v_pk_mul_f32 v[68:69], v[68:69], v[24:25]
  v_pk_mul_f32 v[70:71], v[70:71], v[26:27]
  v_cvt_pk_bf16_f32 v76, v64, v65
  v_cvt_pk_bf16_f32 v77, v66, v67
  v_cvt_pk_bf16_f32 v78, v68, v69
  v_cvt_pk_bf16_f32 v79, v70, v71
  buffer_store_dwordx4 v[76:79], v3, s[8:11], s27 offen sc1
  v_dot2c_f32_bf16 v14, s21, v76
  v_dot2c_f32_bf16 v14, s21, v77
  v_dot2c_f32_bf16 v14, s21, v78
  v_dot2c_f32_bf16 v14, s21, v79
  s_add_u32 s27, s27, 9216
  s_waitcnt lgkmcnt(6)
  ds_read_b64_tr_b16 v[16:17], v9 offset:24576
  ds_read_b64_tr_b16 v[18:19], v9 offset:26624
  ds_read_b128 v[20:23], v12 offset:768
  ds_read_b128 v[24:27], v12 offset:832
  ds_read_b64 v[28:29], v13 offset:384
  ds_read_b64 v[30:31], v13 offset:416
  v_lshlrev_b32 v64, 16, v32
  v_and_b32 v65, 0xffff0000, v32
  v_lshlrev_b32 v66, 16, v33
  v_and_b32 v67, 0xffff0000, v33
  v_lshlrev_b32 v68, 16, v34
  v_and_b32 v69, 0xffff0000, v34
  v_lshlrev_b32 v70, 16, v35
  v_and_b32 v71, 0xffff0000, v35
  v_dot2c_f32_bf16 v15, v32, v44
  v_dot2c_f32_bf16 v15, v33, v45
  v_dot2c_f32_bf16 v15, v34, v46
  v_dot2c_f32_bf16 v15, v35, v47
  v_pk_mul_f32 v[64:65], v[64:65], v[36:37]
  v_pk_mul_f32 v[66:67], v[66:67], v[38:39]
  v_pk_mul_f32 v[68:69], v[68:69], v[40:41]
  v_pk_mul_f32 v[70:71], v[70:71], v[42:43]
  v_cvt_pk_bf16_f32 v72, v64, v65
  v_cvt_pk_bf16_f32 v73, v66, v67
  v_cvt_pk_bf16_f32 v74, v68, v69
  v_cvt_pk_bf16_f32 v75, v70, v71
  buffer_store_dwordx4 v[72:75], v3, s[8:11], s27 offen sc1
  v_dot2c_f32_bf16 v14, s21, v72
  v_dot2c_f32_bf16 v14, s21, v73
  v_dot2c_f32_bf16 v14, s21, v74
  v_dot2c_f32_bf16 v14, s21, v75
  s_add_u32 s27, s27, 9216
  s_waitcnt lgkmcnt(6)
  ds_read_b64_tr_b16 v[32:33], v9 offset:28672
  ds_read_b64_tr_b16 v[34:35], v9 offset:30720
  ds_read_b128 v[36:39], v12 offset:896
  ds_read_b128 v[40:43], v12 offset:960
  ds_read_b64 v[44:45], v13 offset:448
  ds_read_b64 v[46:47], v13 offset:480
  v_lshlrev_b32 v64, 16, v48
  v_and_b32 v65, 0xffff0000, v48
  v_lshlrev_b32 v66, 16, v49
  v_and_b32 v67, 0xffff0000, v49
  v_lshlrev_b32 v68, 16, v50
  v_and_b32 v69, 0xffff0000, v50
  v_lshlrev_b32 v70, 16, v51
  v_and_b32 v71, 0xffff0000, v51
  v_dot2c_f32_bf16 v15, v48, v60
  v_dot2c_f32_bf16 v15, v49, v61
  v_dot2c_f32_bf16 v15, v50, v62
  v_dot2c_f32_bf16 v15, v51, v63
  v_pk_mul_f32 v[64:65], v[64:65], v[52:53]
  v_pk_mul_f32 v[66:67], v[66:67], v[54:55]
  v_pk_mul_f32 v[68:69], v[68:69], v[56:57]
  v_pk_mul_f32 v[70:71], v[70:71], v[58:59]
  v_cvt_pk_bf16_f32 v76, v64, v65
  v_cvt_pk_bf16_f32 v77, v66, v67
  v_cvt_pk_bf16_f32 v78, v68, v69
  v_cvt_pk_bf16_f32 v79, v70, v71
  buffer_store_dwordx4 v[76:79], v3, s[8:11], s27 offen sc1
  v_dot2c_f32_bf16 v14, s21, v76
  v_dot2c_f32_bf16 v14, s21, v77
  v_dot2c_f32_bf16 v14, s21, v78
  v_dot2c_f32_bf16 v14, s21, v79
  s_add_u32 s27, s27, 9216
  s_waitcnt lgkmcnt(6)
  ds_read_b64_tr_b16 v[48:49], v9 offset:32768
  ds_read_b64_tr_b16 v[50:51], v9 offset:34816
  ds_read_b128 v[52:55], v12 offset:1024
  ds_read_b128 v[56:59], v12 offset:1088
  ds_read_b64 v[60:61], v13 offset:512
  ds_read_b64 v[62:63], v13 offset:544
  v_lshlrev_b32 v64, 16, v16
  v_and_b32 v65, 0xffff0000, v16
  v_lshlrev_b32 v66, 16, v17
  v_and_b32 v67, 0xffff0000, v17
  v_lshlrev_b32 v68, 16, v18
  v_and_b32 v69, 0xffff0000, v18
  v_lshlrev_b32 v70, 16, v19
  v_and_b32 v71, 0xffff0000, v19
  v_dot2c_f32_bf16 v15, v16, v28
  v_dot2c_f32_bf16 v15, v17, v29
  v_dot2c_f32_bf16 v15, v18, v30
  v_dot2c_f32_bf16 v15, v19, v31
  v_pk_mul_f32 v[64:65], v[64:65], v[20:21]
  v_pk_mul_f32 v[66:67], v[66:67], v[22:23]
  v_pk_mul_f32 v[68:69], v[68:69], v[24:25]
  v_pk_mul_f32 v[70:71], v[70:71], v[26:27]
  v_cvt_pk_bf16_f32 v72, v64, v65
  v_cvt_pk_bf16_f32 v73, v66, v67
  v_cvt_pk_bf16_f32 v74, v68, v69
  v_cvt_pk_bf16_f32 v75, v70, v71
  buffer_store_dwordx4 v[72:75], v3, s[8:11], s27 offen sc1
  v_dot2c_f32_bf16 v14, s21, v72
  v_dot2c_f32_bf16 v14, s21, v73
  v_dot2c_f32_bf16 v14, s21, v74
  v_dot2c_f32_bf16 v14, s21, v75
  s_add_u32 s27, s27, 9216
  s_waitcnt lgkmcnt(6)
  ds_read_b64_tr_b16 v[16:17], v247 offset:0
  ds_read_b64_tr_b16 v[18:19], v247 offset:2048
  ds_read_b128 v[20:23], v12 offset:1152
  ds_read_b128 v[24:27], v12 offset:1216
  ds_read_b64 v[28:29], v13 offset:576
  ds_read_b64 v[30:31], v13 offset:608
  v_lshlrev_b32 v64, 16, v32
  v_and_b32 v65, 0xffff0000, v32
  v_lshlrev_b32 v66, 16, v33
  v_and_b32 v67, 0xffff0000, v33
  v_lshlrev_b32 v68, 16, v34
  v_and_b32 v69, 0xffff0000, v34
  v_lshlrev_b32 v70, 16, v35
  v_and_b32 v71, 0xffff0000, v35
  v_dot2c_f32_bf16 v15, v32, v44
  v_dot2c_f32_bf16 v15, v33, v45
  v_dot2c_f32_bf16 v15, v34, v46
  v_dot2c_f32_bf16 v15, v35, v47
  v_pk_mul_f32 v[64:65], v[64:65], v[36:37]
  v_pk_mul_f32 v[66:67], v[66:67], v[38:39]
  v_pk_mul_f32 v[68:69], v[68:69], v[40:41]
  v_pk_mul_f32 v[70:71], v[70:71], v[42:43]
  v_cvt_pk_bf16_f32 v76, v64, v65
  v_cvt_pk_bf16_f32 v77, v66, v67
  v_cvt_pk_bf16_f32 v78, v68, v69
  v_cvt_pk_bf16_f32 v79, v70, v71
  buffer_store_dwordx4 v[76:79], v3, s[8:11], s27 offen sc1
  v_dot2c_f32_bf16 v14, s21, v76
  v_dot2c_f32_bf16 v14, s21, v77
  v_dot2c_f32_bf16 v14, s21, v78
  v_dot2c_f32_bf16 v14, s21, v79
  s_add_u32 s27, s27, 9216
  s_waitcnt lgkmcnt(6)
  ds_read_b64_tr_b16 v[32:33], v247 offset:4096
  ds_read_b64_tr_b16 v[34:35], v247 offset:6144
  ds_read_b128 v[36:39], v12 offset:1280
  ds_read_b128 v[40:43], v12 offset:1344
  ds_read_b64 v[44:45], v13 offset:640
  ds_read_b64 v[46:47], v13 offset:672
  v_lshlrev_b32 v64, 16, v48
  v_and_b32 v65, 0xffff0000, v48
  v_lshlrev_b32 v66, 16, v49
  v_and_b32 v67, 0xffff0000, v49
  v_lshlrev_b32 v68, 16, v50
  v_and_b32 v69, 0xffff0000, v50
  v_lshlrev_b32 v70, 16, v51
  v_and_b32 v71, 0xffff0000, v51
  v_dot2c_f32_bf16 v15, v48, v60
  v_dot2c_f32_bf16 v15, v49, v61
  v_dot2c_f32_bf16 v15, v50, v62
  v_dot2c_f32_bf16 v15, v51, v63
  v_pk_mul_f32 v[64:65], v[64:65], v[52:53]
  v_pk_mul_f32 v[66:67], v[66:67], v[54:55]
  v_pk_mul_f32 v[68:69], v[68:69], v[56:57]
  v_pk_mul_f32 v[70:71], v[70:71], v[58:59]
  v_cvt_pk_bf16_f32 v72, v64, v65
  v_cvt_pk_bf16_f32 v73, v66, v67
  v_cvt_pk_bf16_f32 v74, v68, v69
  v_cvt_pk_bf16_f32 v75, v70, v71
  buffer_store_dwordx4 v[72:75], v3, s[8:11], s27 offen sc1
  v_dot2c_f32_bf16 v14, s21, v72
  v_dot2c_f32_bf16 v14, s21, v73
  v_dot2c_f32_bf16 v14, s21, v74
  v_dot2c_f32_bf16 v14, s21, v75
  s_add_u32 s27, s27, 9216
  s_waitcnt lgkmcnt(6)
  ds_read_b64_tr_b16 v[48:49], v247 offset:8192
  ds_read_b64_tr_b16 v[50:51], v247 offset:10240
  ds_read_b128 v[52:55], v12 offset:1408
  ds_read_b128 v[56:59], v12 offset:1472
  ds_read_b64 v[60:61], v13 offset:704
  ds_read_b64 v[62:63], v13 offset:736
  v_lshlrev_b32 v64, 16, v16
  v_and_b32 v65, 0xffff0000, v16
  v_lshlrev_b32 v66, 16, v17
  v_and_b32 v67, 0xffff0000, v17
  v_lshlrev_b32 v68, 16, v18
  v_and_b32 v69, 0xffff0000, v18
  v_lshlrev_b32 v70, 16, v19
  v_and_b32 v71, 0xffff0000, v19
  v_dot2c_f32_bf16 v15, v16, v28
  v_dot2c_f32_bf16 v15, v17, v29
  v_dot2c_f32_bf16 v15, v18, v30
  v_dot2c_f32_bf16 v15, v19, v31
  v_pk_mul_f32 v[64:65], v[64:65], v[20:21]
  v_pk_mul_f32 v[66:67], v[66:67], v[22:23]
  v_pk_mul_f32 v[68:69], v[68:69], v[24:25]
  v_pk_mul_f32 v[70:71], v[70:71], v[26:27]
  v_cvt_pk_bf16_f32 v76, v64, v65
  v_cvt_pk_bf16_f32 v77, v66, v67
  v_cvt_pk_bf16_f32 v78, v68, v69
  v_cvt_pk_bf16_f32 v79, v70, v71
  buffer_store_dwordx4 v[76:79], v3, s[8:11], s27 offen sc1
  v_dot2c_f32_bf16 v14, s21, v76
  v_dot2c_f32_bf16 v14, s21, v77
  v_dot2c_f32_bf16 v14, s21, v78
  v_dot2c_f32_bf16 v14, s21, v79
  s_add_u32 s27, s27, 9216
  s_waitcnt lgkmcnt(6)
  ds_read_b64_tr_b16 v[16:17], v247 offset:12288
  ds_read_b64_tr_b16 v[18:19], v247 offset:14336
  ds_read_b128 v[20:23], v12 offset:1536
  ds_read_b128 v[24:27], v12 offset:1600
  ds_read_b64 v[28:29], v13 offset:768
  ds_read_b64 v[30:31], v13 offset:800
  v_lshlrev_b32 v64, 16, v32
  v_and_b32 v65, 0xffff0000, v32
  v_lshlrev_b32 v66, 16, v33
  v_and_b32 v67, 0xffff0000, v33
  v_lshlrev_b32 v68, 16, v34
  v_and_b32 v69, 0xffff0000, v34
  v_lshlrev_b32 v70, 16, v35
  v_and_b32 v71, 0xffff0000, v35
  v_dot2c_f32_bf16 v15, v32, v44
  v_dot2c_f32_bf16 v15, v33, v45
  v_dot2c_f32_bf16 v15, v34, v46
  v_dot2c_f32_bf16 v15, v35, v47
  v_pk_mul_f32 v[64:65], v[64:65], v[36:37]
  v_pk_mul_f32 v[66:67], v[66:67], v[38:39]
  v_pk_mul_f32 v[68:69], v[68:69], v[40:41]
  v_pk_mul_f32 v[70:71], v[70:71], v[42:43]
  v_cvt_pk_bf16_f32 v72, v64, v65
  v_cvt_pk_bf16_f32 v73, v66, v67
  v_cvt_pk_bf16_f32 v74, v68, v69
  v_cvt_pk_bf16_f32 v75, v70, v71
  buffer_store_dwordx4 v[72:75], v3, s[8:11], s27 offen sc1
  v_dot2c_f32_bf16 v14, s21, v72
  v_dot2c_f32_bf16 v14, s21, v73
  v_dot2c_f32_bf16 v14, s21, v74
  v_dot2c_f32_bf16 v14, s21, v75
  s_add_u32 s27, s27, 9216
  s_waitcnt lgkmcnt(6)
  ds_read_b64_tr_b16 v[32:33], v247 offset:16384
  ds_read_b64_tr_b16 v[34:35], v247 offset:18432
  ds_read_b128 v[36:39], v12 offset:1664
  ds_read_b128 v[40:43], v12 offset:1728
  ds_read_b64 v[44:45], v13 offset:832
  ds_read_b64 v[46:47], v13 offset:864
  v_lshlrev_b32 v64, 16, v48
  v_and_b32 v65, 0xffff0000, v48
  v_lshlrev_b32 v66, 16, v49
  v_and_b32 v67, 0xffff0000, v49
  v_lshlrev_b32 v68, 16, v50
  v_and_b32 v69, 0xffff0000, v50
  v_lshlrev_b32 v70, 16, v51
  v_and_b32 v71, 0xffff0000, v51
  v_dot2c_f32_bf16 v15, v48, v60
  v_dot2c_f32_bf16 v15, v49, v61
  v_dot2c_f32_bf16 v15, v50, v62
  v_dot2c_f32_bf16 v15, v51, v63
  v_pk_mul_f32 v[64:65], v[64:65], v[52:53]
  v_pk_mul_f32 v[66:67], v[66:67], v[54:55]
  v_pk_mul_f32 v[68:69], v[68:69], v[56:57]
  v_pk_mul_f32 v[70:71], v[70:71], v[58:59]
  v_cvt_pk_bf16_f32 v76, v64, v65
  v_cvt_pk_bf16_f32 v77, v66, v67
  v_cvt_pk_bf16_f32 v78, v68, v69
  v_cvt_pk_bf16_f32 v79, v70, v71
  buffer_store_dwordx4 v[76:79], v3, s[8:11], s27 offen sc1
  v_dot2c_f32_bf16 v14, s21, v76
  v_dot2c_f32_bf16 v14, s21, v77
  v_dot2c_f32_bf16 v14, s21, v78
  v_dot2c_f32_bf16 v14, s21, v79
  s_add_u32 s27, s27, 9216
  s_waitcnt lgkmcnt(6)
  ds_read_b64_tr_b16 v[48:49], v247 offset:20480
  ds_read_b64_tr_b16 v[50:51], v247 offset:22528
  ds_read_b128 v[52:55], v12 offset:1792
  ds_read_b128 v[56:59], v12 offset:1856
  ds_read_b64 v[60:61], v13 offset:896
  ds_read_b64 v[62:63], v13 offset:928
  v_lshlrev_b32 v64, 16, v16
  v_and_b32 v65, 0xffff0000, v16
  v_lshlrev_b32 v66, 16, v17
  v_and_b32 v67, 0xffff0000, v17
  v_lshlrev_b32 v68, 16, v18
  v_and_b32 v69, 0xffff0000, v18
  v_lshlrev_b32 v70, 16, v19
  v_and_b32 v71, 0xffff0000, v19
  v_dot2c_f32_bf16 v15, v16, v28
  v_dot2c_f32_bf16 v15, v17, v29
  v_dot2c_f32_bf16 v15, v18, v30
  v_dot2c_f32_bf16 v15, v19, v31
  v_pk_mul_f32 v[64:65], v[64:65], v[20:21]
  v_pk_mul_f32 v[66:67], v[66:67], v[22:23]
  v_pk_mul_f32 v[68:69], v[68:69], v[24:25]
  v_pk_mul_f32 v[70:71], v[70:71], v[26:27]
  v_cvt_pk_bf16_f32 v72, v64, v65
  v_cvt_pk_bf16_f32 v73, v66, v67
  v_cvt_pk_bf16_f32 v74, v68, v69
  v_cvt_pk_bf16_f32 v75, v70, v71
  buffer_store_dwordx4 v[72:75], v3, s[8:11], s27 offen sc1
  v_dot2c_f32_bf16 v14, s21, v72
  v_dot2c_f32_bf16 v14, s21, v73
  v_dot2c_f32_bf16 v14, s21, v74
  v_dot2c_f32_bf16 v14, s21, v75
  s_add_u32 s27, s27, 9216
  s_waitcnt lgkmcnt(6)
  ds_read_b64_tr_b16 v[16:17], v247 offset:24576
  ds_read_b64_tr_b16 v[18:19], v247 offset:26624
  ds_read_b128 v[20:23], v12 offset:1920
  ds_read_b128 v[24:27], v12 offset:1984
  ds_read_b64 v[28:29], v13 offset:960
  ds_read_b64 v[30:31], v13 offset:992
  v_lshlrev_b32 v64, 16, v32
  v_and_b32 v65, 0xffff0000, v32
  v_lshlrev_b32 v66, 16, v33
  v_and_b32 v67, 0xffff0000, v33
  v_lshlrev_b32 v68, 16, v34
  v_and_b32 v69, 0xffff0000, v34
  v_lshlrev_b32 v70, 16, v35
  v_and_b32 v71, 0xffff0000, v35
  v_dot2c_f32_bf16 v15, v32, v44
  v_dot2c_f32_bf16 v15, v33, v45
  v_dot2c_f32_bf16 v15, v34, v46
  v_dot2c_f32_bf16 v15, v35, v47
  v_pk_mul_f32 v[64:65], v[64:65], v[36:37]
  v_pk_mul_f32 v[66:67], v[66:67], v[38:39]
  v_pk_mul_f32 v[68:69], v[68:69], v[40:41]
  v_pk_mul_f32 v[70:71], v[70:71], v[42:43]
  v_cvt_pk_bf16_f32 v76, v64, v65
  v_cvt_pk_bf16_f32 v77, v66, v67
  v_cvt_pk_bf16_f32 v78, v68, v69
  v_cvt_pk_bf16_f32 v79, v70, v71
  buffer_store_dwordx4 v[76:79], v3, s[8:11], s27 offen sc1
  v_dot2c_f32_bf16 v14, s21, v76
  v_dot2c_f32_bf16 v14, s21, v77
  v_dot2c_f32_bf16 v14, s21, v78
  v_dot2c_f32_bf16 v14, s21, v79
  s_add_u32 s27, s27, 9216
  s_waitcnt lgkmcnt(6)
  ds_read_b64_tr_b16 v[32:33], v247 offset:28672
  ds_read_b64_tr_b16 v[34:35], v247 offset:30720
  ds_read_b128 v[36:39], v12 offset:2048
  ds_read_b128 v[40:43], v12 offset:2112
  ds_read_b64 v[44:45], v13 offset:1024
  ds_read_b64 v[46:47], v13 offset:1056
  v_lshlrev_b32 v64, 16, v48
  v_and_b32 v65, 0xffff0000, v48
  v_lshlrev_b32 v66, 16, v49
  v_and_b32 v67, 0xffff0000, v49
  v_lshlrev_b32 v68, 16, v50
  v_and_b32 v69, 0xffff0000, v50
  v_lshlrev_b32 v70, 16, v51
  v_and_b32 v71, 0xffff0000, v51
  v_dot2c_f32_bf16 v15, v48, v60
  v_dot2c_f32_bf16 v15, v49, v61
  v_dot2c_f32_bf16 v15, v50, v62
  v_dot2c_f32_bf16 v15, v51, v63
  v_pk_mul_f32 v[64:65], v[64:65], v[52:53]
  v_pk_mul_f32 v[66:67], v[66:67], v[54:55]
  v_pk_mul_f32 v[68:69], v[68:69], v[56:57]
  v_pk_mul_f32 v[70:71], v[70:71], v[58:59]
  v_cvt_pk_bf16_f32 v72, v64, v65
  v_cvt_pk_bf16_f32 v73, v66, v67
  v_cvt_pk_bf16_f32 v74, v68, v69
  v_cvt_pk_bf16_f32 v75, v70, v71
  buffer_store_dwordx4 v[72:75], v3, s[8:11], s27 offen sc1
  v_dot2c_f32_bf16 v14, s21, v72
  v_dot2c_f32_bf16 v14, s21, v73
  v_dot2c_f32_bf16 v14, s21, v74
  v_dot2c_f32_bf16 v14, s21, v75
  s_add_u32 s27, s27, 9216
  s_waitcnt lgkmcnt(6)
  ds_read_b64_tr_b16 v[48:49], v247 offset:32768
  ds_read_b64_tr_b16 v[50:51], v247 offset:34816
  ds_read_b128 v[52:55], v12 offset:2176
  ds_read_b128 v[56:59], v12 offset:2240
  ds_read_b64 v[60:61], v13 offset:1088
  ds_read_b64 v[62:63], v13 offset:1120
  v_lshlrev_b32 v64, 16, v16
  v_and_b32 v65, 0xffff0000, v16
  v_lshlrev_b32 v66, 16, v17
  v_and_b32 v67, 0xffff0000, v17
  v_lshlrev_b32 v68, 16, v18
  v_and_b32 v69, 0xffff0000, v18
  v_lshlrev_b32 v70, 16, v19
  v_and_b32 v71, 0xffff0000, v19
  v_dot2c_f32_bf16 v15, v16, v28
  v_dot2c_f32_bf16 v15, v17, v29
  v_dot2c_f32_bf16 v15, v18, v30
  v_dot2c_f32_bf16 v15, v19, v31
  v_pk_mul_f32 v[64:65], v[64:65], v[20:21]
  v_pk_mul_f32 v[66:67], v[66:67], v[22:23]
  v_pk_mul_f32 v[68:69], v[68:69], v[24:25]
  v_pk_mul_f32 v[70:71], v[70:71], v[26:27]
  v_cvt_pk_bf16_f32 v76, v64, v65
  v_cvt_pk_bf16_f32 v77, v66, v67
  v_cvt_pk_bf16_f32 v78, v68, v69
  v_cvt_pk_bf16_f32 v79, v70, v71
  buffer_store_dwordx4 v[76:79], v3, s[8:11], s27 offen sc1
  v_dot2c_f32_bf16 v14, s21, v76
  v_dot2c_f32_bf16 v14, s21, v77
  v_dot2c_f32_bf16 v14, s21, v78
  v_dot2c_f32_bf16 v14, s21, v79
  s_add_u32 s27, s27, 9216
  s_waitcnt lgkmcnt(6)
  v_lshlrev_b32 v64, 16, v32
  v_and_b32 v65, 0xffff0000, v32
  v_lshlrev_b32 v66, 16, v33
  v_and_b32 v67, 0xffff0000, v33
  v_lshlrev_b32 v68, 16, v34
  v_and_b32 v69, 0xffff0000, v34
  v_lshlrev_b32 v70, 16, v35
  v_and_b32 v71, 0xffff0000, v35
  v_dot2c_f32_bf16 v15, v32, v44
  v_dot2c_f32_bf16 v15, v33, v45
  v_dot2c_f32_bf16 v15, v34, v46
  v_dot2c_f32_bf16 v15, v35, v47
  v_pk_mul_f32 v[64:65], v[64:65], v[36:37]
  v_pk_mul_f32 v[66:67], v[66:67], v[38:39]
  v_pk_mul_f32 v[68:69], v[68:69], v[40:41]
  v_pk_mul_f32 v[70:71], v[70:71], v[42:43]
  v_cvt_pk_bf16_f32 v72, v64, v65
  v_cvt_pk_bf16_f32 v73, v66, v67
  v_cvt_pk_bf16_f32 v74, v68, v69
  v_cvt_pk_bf16_f32 v75, v70, v71
  buffer_store_dwordx4 v[72:75], v3, s[8:11], s27 offen sc1
  v_dot2c_f32_bf16 v14, s21, v72
  v_dot2c_f32_bf16 v14, s21, v73
  v_dot2c_f32_bf16 v14, s21, v74
  v_dot2c_f32_bf16 v14, s21, v75
  s_add_u32 s27, s27, 9216
  s_waitcnt lgkmcnt(0)
  v_lshlrev_b32 v64, 16, v48
  v_and_b32 v65, 0xffff0000, v48
  v_lshlrev_b32 v66, 16, v49
  v_and_b32 v67, 0xffff0000, v49
  v_lshlrev_b32 v68, 16, v50
  v_and_b32 v69, 0xffff0000, v50
  v_lshlrev_b32 v70, 16, v51
  v_and_b32 v71, 0xffff0000, v51
  v_dot2c_f32_bf16 v15, v48, v60
  v_dot2c_f32_bf16 v15, v49, v61
  v_dot2c_f32_bf16 v15, v50, v62
  v_dot2c_f32_bf16 v15, v51, v63
  v_pk_mul_f32 v[64:65], v[64:65], v[52:53]
  v_pk_mul_f32 v[66:67], v[66:67], v[54:55]
  v_pk_mul_f32 v[68:69], v[68:69], v[56:57]
  v_pk_mul_f32 v[70:71], v[70:71], v[58:59]
  v_cvt_pk_bf16_f32 v76, v64, v65
  v_cvt_pk_bf16_f32 v77, v66, v67
  v_cvt_pk_bf16_f32 v78, v68, v69
  v_cvt_pk_bf16_f32 v79, v70, v71
  buffer_store_dwordx4 v[76:79], v3, s[8:11], s27 offen sc1
  v_dot2c_f32_bf16 v14, s21, v76
  v_dot2c_f32_bf16 v14, s21, v77
  v_dot2c_f32_bf16 v14, s21, v78
  v_dot2c_f32_bf16 v14, s21, v79
  s_nop 2
  v_mov_b32 v16, v14
  v_mov_b32 v17, v15
  s_nop 1
  v_permlane16_swap_b32 v14, v16
  v_permlane16_swap_b32 v15, v17
  s_nop 1
  v_add_f32 v14, v14, v16
  v_add_f32 v15, v15, v17
  v_mov_b32 v16, v14
  v_mov_b32 v17, v15
  s_nop 1
  v_permlane32_swap_b32 v14, v16
  v_permlane32_swap_b32 v15, v17
  s_nop 1
  v_add_f32 v14, v14, v16
  v_add_f32 v15, v15, v17
  v_lshlrev_b32 v16, 2, v4
  v_lshlrev_b32 v17, 3, v4
  s_mov_b64 exec, 0xffff
  s_cmp_eq_u32 s23, 1
  s_cbranch_scc1 F_WIN_Z2
  s_lshl_b32 s16, s26, 6
  s_add_u32 s16, s16, 4784128
  buffer_store_dword v14, v16, s[8:11], s16 offen sc1
  s_add_u32 s16, s16, 9216
  buffer_store_dword v15, v16, s[8:11], s16 offen sc1
  s_branch F_WIN_E
F_WIN_Z2:
  s_lshl_b32 s16, s26, 7
  s_add_u32 s16, s16, 4804608
  buffer_store_dwordx2 v[14:15], v17, s[8:11], s16 offen sc1
F_WIN_E:
  s_mov_b64 exec, -1
  s_cmp_ge_u32 s36, 72
  s_cbranch_scc1 F_JOIN
  s_branch F_WO_F
F_LAST:
  v_mov_b32 v248, 0
  v_lshlrev_b32 v249, 2, v0
  s_lshl_b32 s46, s2, 10
  s_add_u32 s46, s46, 4849664
  buffer_store_dword v248, v249, s[8:11], s46 offen sc1
  s_lshl_b32 s46, s2, 2
  s_add_u32 s46, s46, s3
  s_lshl_b32 s46, s46, 7
  s_add_u32 s46, s46, 7864320
  buffer_store_dword v248, v250, s[8:11], s46 offen sc1
  s_add_u32 s46, s46, 131072
  buffer_store_dword v248, v250, s[8:11], s46 offen sc1
  s_mov_b32 s42, 0
  s_sub_u32 s36, s2, 216
F_WO:
  s_barrier
  s_mul_i32 s37, s36, 7282
  s_lshr_b32 s37, s37, 16
  s_mul_i32 s38, s37, 9
  s_sub_u32 s39, s36, s38
  s_lshl_b32 s44, s37, 2
  s_add_u32 s44, s44, s3
  s_mul_i32 s44, s44, 82944
  s_lshl_b32 s45, s39, 7
  s_add_u32 s44, s44, s45
  s_mul_i32 s38, s38, 36864
  s_lshl_b32 s39, s39, 2
  s_add_u32 s39, s39, s3
  s_lshl_b32 s39, s39, 10
  s_add_u32 s38, s38, s39
  s_add_u32 s38, s38, 14680064
  s_mul_i32 s45, s3, 9216
  s_add_u32 s45, s45, 81920
  s_add_u32 m0, s45, 0
  s_nop 0
  buffer_load_dwordx4 v245, s[32:35], s44 offen lds
  s_add_u32 s44, s44, 9216
  s_add_u32 m0, s45, 1024
  s_nop 0
  buffer_load_dwordx4 v245, s[32:35], s44 offen lds
  s_add_u32 s44, s44, 9216
  s_add_u32 m0, s45, 2048
  s_nop 0
  buffer_load_dwordx4 v245, s[32:35], s44 offen lds
  s_add_u32 s44, s44, 9216
  s_add_u32 m0, s45, 3072
  s_nop 0
  buffer_load_dwordx4 v245, s[32:35], s44 offen lds
  s_add_u32 s44, s44, 9216
  s_add_u32 m0, s45, 4096
  s_nop 0
  buffer_load_dwordx4 v245, s[32:35], s44 offen lds
  s_add_u32 s44, s44, 9216
  s_add_u32 m0, s45, 5120
  s_nop 0
  buffer_load_dwordx4 v245, s[32:35], s44 offen lds
  s_add_u32 s44, s44, 9216
  s_add_u32 m0, s45, 6144
  s_nop 0
  buffer_load_dwordx4 v245, s[32:35], s44 offen lds
  s_add_u32 s44, s44, 9216
  s_add_u32 m0, s45, 7168
  s_nop 0
  buffer_load_dwordx4 v245, s[32:35], s44 offen lds
  s_add_u32 s44, s44, 9216
  s_add_u32 m0, s45, 8192
  s_nop 0
  buffer_load_dwordx4 v245, s[32:35], s44 offen lds
F_WO_F:
  s_waitcnt vmcnt(0)
  s_barrier
  ds_read_b64_tr_b16 v[16:17], v244 offset:0
  ds_read_b64_tr_b16 v[18:19], v244 offset:2048
  ds_read_b64_tr_b16 v[20:21], v244 offset:4096
  ds_read_b64_tr_b16 v[22:23], v244 offset:6144
  ds_read_b64_tr_b16 v[24:25], v244 offset:8192
  ds_read_b64_tr_b16 v[26:27], v244 offset:10240
  ds_read_b64_tr_b16 v[28:29], v244 offset:12288
  ds_read_b64_tr_b16 v[30:31], v244 offset:14336
  ds_read_b64_tr_b16 v[32:33], v244 offset:18432
  ds_read_b64_tr_b16 v[34:35], v244 offset:20480
  s_waitcnt lgkmcnt(0)
  ds_read_b64_tr_b16 v[36:37], v244 offset:22528
  ds_read_b64_tr_b16 v[38:39], v244 offset:24576
  ds_read_b64_tr_b16 v[40:41], v244 offset:26624
  ds_read_b64_tr_b16 v[42:43], v244 offset:28672
  ds_read_b64_tr_b16 v[44:45], v244 offset:30720
  ds_read_b64_tr_b16 v[46:47], v244 offset:32768
  ds_read_b64_tr_b16 v[48:49], v244 offset:16384
  ds_read_b64_tr_b16 v[50:51], v244 offset:34816
  s_waitcnt lgkmcnt(0)
  buffer_store_dwordx4 v[16:19], v3, s[8:11], s38 offen sc1
  s_add_u32 s38, s38, 36864
  buffer_store_dwordx4 v[20:23], v3, s[8:11], s38 offen sc1
  s_add_u32 s38, s38, 36864
  buffer_store_dwordx4 v[24:27], v3, s[8:11], s38 offen sc1
  s_add_u32 s38, s38, 36864
  buffer_store_dwordx4 v[28:31], v3, s[8:11], s38 offen sc1
  s_add_u32 s38, s38, 36864
  buffer_store_dwordx4 v[32:35], v3, s[8:11], s38 offen sc1
  s_add_u32 s38, s38, 36864
  buffer_store_dwordx4 v[36:39], v3, s[8:11], s38 offen sc1
  s_add_u32 s38, s38, 36864
  buffer_store_dwordx4 v[40:43], v3, s[8:11], s38 offen sc1
  s_add_u32 s38, s38, 36864
  buffer_store_dwordx4 v[44:47], v3, s[8:11], s38 offen sc1
  s_add_u32 s38, s38, 36864
  buffer_store_dwordx4 v[48:51], v3, s[8:11], s38 offen sc1
  s_add_u32 s36, s36, 4
  s_cmp_lt_u32 s36, 48
  s_cbranch_scc1 F_WO
  s_cmp_lg_u32 s42, 0
  s_cbranch_scc1 F_JOIN
  s_mov_b32 s43, 0
  v_mov_b32 v14, 0
F_L_NP:
  buffer_load_dword v14, v14, s[28:31], 0 offen sc1
  s_waitcnt vmcnt(0)
  v_readfirstlane_b32 s42, v14
  s_add_u32 s43, s43, 1
  s_cmp_ge_u32 s43, 0x80000
  s_cbranch_scc1 F_L_NG
  s_cmp_lg_u32 s42, 0
  s_cbranch_scc1 F_L_NG
  s_sleep 2
  s_branch F_L_NP
F_L_NG:
F_JOIN:
gm_kernel:
  v_lshrrev_b32 v1, 6, v0
  v_and_b32 v2, 63, v0
  v_readfirstlane_b32 s3, v1
  v_lshlrev_b32 v1, 4, v2
  v_and_b32 v3, 15, v2
  v_lshrrev_b32 v12, 4, v2
  s_and_b32 s6, s2, 7
  s_lshr_b32 s7, s2, 3
  s_lshr_b32 s4, s6, 1
  s_lshl_b32 s4, s4, 2
  s_and_b32 s5, s7, 3
  s_add_u32 s4, s4, s5
  s_and_b32 s5, s6, 1
  s_lshl_b32 s5, s5, 3
  s_lshr_b32 s7, s7, 2
  s_add_u32 s5, s5, s7
  s_lshl_b32 s6, s4, 2
  s_add_u32 s6, s6, s3
  s_mul_i32 s7, s3, 9216
  s_mul_i32 s20, s5, 331776
  s_add_u32 s20, s20, s7
  s_add_u32 s20, s20, 8388608
  s_mul_i32 s21, s6, 36864
  s_add_u32 s21, s21, 5242880
  s_mul_i32 s30, s3, 12288
  s_add_u32 s30, s30, 110592
  v_lshl_add_u32 v13, v2, 3, s30
  v_add_u32 v8, 17408, v1
  s_mul_i32 s28, s5, 589824
  s_add_u32 s28, s28, 35651584
  s_lshl_b32 s29, s6, 17
  s_waitcnt lgkmcnt(0)
  s_mul_i32 s22, s5, 9
  s_lshr_b32 s22, s22, 2
  s_add_u32 s22, s22, 36
  v_and_b32 v4, 3, v2
  v_add_u32 v4, s22, v4
  v_min_u32 v4, 71, v4
  v_mul_u32_u24 v5, 7282, v4
  v_lshrrev_b32 v5, 16, v5
  v_mul_u32_u24 v6, 9, v5
  v_sub_u32 v4, v4, v6
  v_lshl_add_u32 v4, v4, 3, v5
  v_lshlrev_b32 v4, 7, v4
  v_add_u32 v4, 5228544, v4
  v_lshlrev_b32 v5, 7, v0
  v_add_u32 v5, 5210112, v5
  buffer_load_dword v6, v4, s[8:11], 0 offen sc1
  v_mov_b32 v7, s42
  s_lshl_b32 s22, s2, 7
  s_add_u32 s22, s22, 5210112
  s_waitcnt vmcnt(0)
  s_barrier
  s_cmp_lg_u32 s3, 0
  s_cbranch_scc1 GM_NOD
  buffer_store_dword v7, v250, s[8:11], s22 offen sc1
GM_NOD:
  v_cmp_ne_u32 vcc, s42, v6
  s_getpc_b64 s[32:33]
GM_PC:
  s_sub_u32 s32, s32, GM_PC-gm_kernel
  s_subb_u32 s33, s33, 0
  s_and_b32 s33, s33, 0xffff
  s_mov_b32 s34, GM_CODE_END-gm_kernel
  s_mov_b32 s35, 0x20000
  s_lshr_b32 s31, s2, 3
  s_lshl_b32 s31, s31, 7
  v_lshlrev_b32 v255, 12, v0
  v_add_u32 v255, s31, v255
  s_mov_b32 s16, s80
  s_and_b32 s17, s81, 0xffff
  s_mov_b32 s18, 8388608
  s_mov_b32 s19, 0x20000
  s_cmp_ge_u32 s96, 64
  s_cbranch_scc1 GM_NOFT
  s_lshl_b32 s97, s96, 2
  s_add_u32 s97, s97, s3
  s_lshl_b32 s97, s97, 15
  buffer_load_dwordx4 a[216:219], v1, s[16:19], s97 offen offset:0
  buffer_load_dwordx4 a[216:219], v1, s[16:19], s97 offen offset:1024
  s_add_u32 s97, s97, 4096
  buffer_load_dwordx4 a[216:219], v1, s[16:19], s97 offen offset:0
  buffer_load_dwordx4 a[216:219], v1, s[16:19], s97 offen offset:1024
  s_add_u32 s97, s97, 4096
  buffer_load_dwordx4 a[216:219], v1, s[16:19], s97 offen offset:0
  buffer_load_dwordx4 a[216:219], v1, s[16:19], s97 offen offset:1024
  s_add_u32 s97, s97, 4096
  buffer_load_dwordx4 a[216:219], v1, s[16:19], s97 offen offset:0
  buffer_load_dwordx4 a[216:219], v1, s[16:19], s97 offen offset:1024
  s_add_u32 s97, s97, 4096
  buffer_load_dwordx4 a[216:219], v1, s[16:19], s97 offen offset:0
  buffer_load_dwordx4 a[216:219], v1, s[16:19], s97 offen offset:1024
  s_add_u32 s97, s97, 4096
  buffer_load_dwordx4 a[216:219], v1, s[16:19], s97 offen offset:0
  buffer_load_dwordx4 a[216:219], v1, s[16:19], s97 offen offset:1024
  s_add_u32 s97, s97, 4096
  buffer_load_dwordx4 a[216:219], v1, s[16:19], s97 offen offset:0
  buffer_load_dwordx4 a[216:219], v1, s[16:19], s97 offen offset:1024
  s_add_u32 s97, s97, 4096
  buffer_load_dwordx4 a[216:219], v1, s[16:19], s97 offen offset:0
  buffer_load_dwordx4 a[216:219], v1, s[16:19], s97 offen offset:1024
  s_add_u32 s97, s97, 4096
GM_NOFT:
  s_nop 4
  s_cbranch_vccz GM_W_GO
  s_mov_b32 s43, 0
GM_W_POLL:
  buffer_load_dword v6, v4, s[8:11], 0 offen sc1
  s_waitcnt vmcnt(0)
  v_cmp_ne_u32 vcc, s42, v6
  s_add_u32 s43, s43, 1
  s_cmp_ge_u32 s43, 0x80000
  s_cbranch_scc1 GM_W_GO
  s_nop 2
  s_cbranch_vccz GM_W_GO
  s_sleep 8
  s_branch GM_W_POLL
GM_W_GO:
  s_add_u32 m0, s7, 0
  s_nop 0
  buffer_load_dwordx4 v1, s[8:11], s20 offen offset:0 sc1 lds
  buffer_load_dwordx4 v1, s[8:11], s20 offen offset:1024 sc1 lds
  buffer_load_dwordx4 v1, s[8:11], s20 offen offset:2048 sc1 lds
  s_add_u32 s20, s20, 3072
  s_add_u32 m0, s7, 3072
  s_nop 0
  buffer_load_dwordx4 v1, s[8:11], s20 offen offset:0 sc1 lds
  buffer_load_dwordx4 v1, s[8:11], s20 offen offset:1024 sc1 lds
  s_add_u32 s20, s20, 2048
  s_add_u32 m0, s7, 5120
  s_nop 0
  buffer_load_dwordx4 v1, s[8:11], s20 offen offset:0 sc1 lds
  buffer_load_dwordx4 v1, s[8:11], s20 offen offset:1024 sc1 lds
  s_add_u32 s20, s20, 2048
  s_add_u32 m0, s7, 7168
  s_nop 0
  buffer_load_dwordx4 v1, s[8:11], s20 offen offset:0 sc1 lds
  buffer_load_dwordx4 v1, s[8:11], s20 offen offset:1024 sc1 lds
  s_add_u32 s20, s20, 29696
  buffer_load_dword v6, v5, s[8:11], 0 offen sc1
  s_add_u32 m0, s7, 36864
  s_nop 0
  buffer_load_dwordx4 v1, s[8:11], s20 offen offset:0 sc1 lds
  buffer_load_dwordx4 v1, s[8:11], s20 offen offset:1024 sc1 lds
  buffer_load_dwordx4 v1, s[8:11], s20 offen offset:2048 sc1 lds
  s_add_u32 s20, s20, 3072
  s_add_u32 m0, s7, 39936
  s_nop 0
  buffer_load_dwordx4 v1, s[8:11], s20 offen offset:0 sc1 lds
  buffer_load_dwordx4 v1, s[8:11], s20 offen offset:1024 sc1 lds
  s_add_u32 s20, s20, 2048
  s_add_u32 m0, s7, 41984
  s_nop 0
  buffer_load_dwordx4 v1, s[8:11], s20 offen offset:0 sc1 lds
  buffer_load_dwordx4 v1, s[8:11], s20 offen offset:1024 sc1 lds
  s_add_u32 s20, s20, 2048
  s_add_u32 m0, s7, 44032
  s_nop 0
  buffer_load_dwordx4 v1, s[8:11], s20 offen offset:0 sc1 lds
  buffer_load_dwordx4 v1, s[8:11], s20 offen offset:1024 sc1 lds
  s_add_u32 s20, s20, 29696
  buffer_load_dword v11, v255, s[32:35], 0 offen
  s_waitcnt vmcnt(10)
  v_cmp_ne_u32 vcc, s42, v6
  s_nop 4
  s_cbranch_vccz GM_D_GO
  s_mov_b32 s43, 0
GM_D_POLL:
  buffer_load_dword v6, v5, s[8:11], 0 offen sc1
  s_waitcnt vmcnt(0)
  v_cmp_ne_u32 vcc, s42, v6
  s_add_u32 s43, s43, 1
  s_cmp_ge_u32 s43, 0x80000
  s_cbranch_scc1 GM_D_GO
  s_nop 2
  s_cbranch_vccz GM_D_GO
  s_sleep 1
  s_branch GM_D_POLL
GM_D_GO:
  s_barrier
  s_add_u32 m0, s30, 0
  s_nop 0
  buffer_load_dwordx4 v1, s[8:11], s21 offen sc1 lds
  buffer_load_dwordx4 v8, s[8:11], s21 offen offset:1024 sc1 lds
  s_add_u32 s21, s21, 1024
  s_add_u32 m0, s30, 2048
  s_nop 0
  buffer_load_dwordx4 v1, s[8:11], s21 offen sc1 lds
  buffer_load_dwordx4 v8, s[8:11], s21 offen offset:1024 sc1 lds
  s_add_u32 s21, s21, 1024
  s_add_u32 m0, s30, 4096
  s_nop 0
  buffer_load_dwordx4 v1, s[8:11], s21 offen sc1 lds
  buffer_load_dwordx4 v8, s[8:11], s21 offen offset:1024 sc1 lds
  s_add_u32 s21, s21, 1024
  s_add_u32 m0, s30, 6144
  s_nop 0
  buffer_load_dwordx4 v1, s[8:11], s21 offen sc1 lds
  buffer_load_dwordx4 v8, s[8:11], s21 offen offset:1024 sc1 lds
  s_add_u32 s21, s21, 1024
  s_add_u32 m0, s30, 8192
  s_nop 0
  buffer_load_dwordx4 v1, s[8:11], s21 offen sc1 lds
  buffer_load_dwordx4 v8, s[8:11], s21 offen offset:1024 sc1 lds
  s_add_u32 s21, s21, 1024
  s_add_u32 m0, s30, 10240
  s_nop 0
  buffer_load_dwordx4 v1, s[8:11], s21 offen sc1 lds
  buffer_load_dwordx4 v8, s[8:11], s21 offen offset:1024 sc1 lds
  s_add_u32 s21, s21, 1024
  s_cmp_lg_u32 s2, 255
  s_cbranch_scc1 GM_NOCLR
  s_mov_b32 s12, s92
  s_and_b32 s13, s93, 0xffff
  s_mov_b32 s14, 256
  s_mov_b32 s15, 0x20000
  v_mov_b32 v6, 0
  v_lshlrev_b32 v7, 8, v0
  buffer_store_dword v6, v7, s[12:15], 0 offen sc1
  s_nop 1
GM_NOCLR:
  s_add_u32 s12, s94, s28
  s_addc_u32 s13, s95, 0
  s_and_b32 s13, s13, 0xffff
  s_mov_b32 s14, 589824
  s_mov_b32 s15, 0x20000
  s_mov_b32 s16, s80
  s_and_b32 s17, s81, 0xffff
  s_mov_b32 s18, 8388608
  s_mov_b32 s19, 0x20000
  s_mov_b32 s36, s82
  s_and_b32 s37, s83, 0xffff
  s_mov_b32 s38, 4096
  s_mov_b32 s39, 0x20000
  v_mov_b32 v252, v1
  v_add_u32 v253, 36864, v1
  v_add_u32 v254, 73728, v1
  v_mov_b32 v4, 0x3f803f80
  v_mov_b32 v5, 0x3f803f80
  v_mov_b32 v6, 0x3f803f80
  v_mov_b32 v7, 0x3f803f80
  s_mov_b32 s40, 0xbdd2d3e8
  s_mov_b32 s41, 0xbdd2d3e8
  v_mov_b32 v14, 0xc0135761
  v_mov_b32 v15, 0xc0135761
  s_mul_i32 s22, s5, 1152
  s_add_u32 s22, s22, 4804608
  v_lshlrev_b32 v9, 3, v3
  v_add_u32 v9, 159744, v9
  v_lshrrev_b32 v248, 2, v3
  v_lshlrev_b32 v248, 3, v248
  v_and_b32 v249, 3, v3
  v_add_u32 v248, v248, v249
  v_add_u32 v251, 4096, v1
  s_waitcnt vmcnt(10)
  s_waitcnt vmcnt(23)
  s_barrier
  ds_read_b64 a[0:1], v13 offset:0
  ds_read_b64 a[2:3], v13 offset:512
  ds_read_b64 a[4:5], v13 offset:1024
  ds_read_b64 a[6:7], v13 offset:1536
  ds_read_b128 a[144:147], v252 offset:0
  ds_read_b128 a[148:151], v252 offset:1024
  ds_read_b128 a[152:155], v252 offset:2048
  ds_read_b128 a[156:159], v252 offset:3072
  ds_read_b128 a[160:163], v252 offset:4096
  ds_read_b128 a[164:167], v252 offset:5120
  ds_read_b128 a[168:171], v252 offset:6144
  ds_read_b128 a[172:175], v252 offset:7168
  ds_read_b128 a[176:179], v252 offset:8192
  s_waitcnt vmcnt(8) lgkmcnt(0)
  v_mfma_f32_16x16x32_bf16 v[16:19], a[0:3], a[144:147], 0
  ds_read_b128 a[180:183], v252 offset:9216
  v_mfma_f32_16x16x32_bf16 v[20:23], a[4:7], a[144:147], 0
  ds_read_b128 a[184:187], v252 offset:10240
  s_add_u32 m0, s7, 73728
  v_mfma_f32_16x16x32_bf16 v[24:27], a[0:3], a[148:151], 0
  ds_read_b128 a[188:191], v252 offset:11264
  buffer_load_dwordx4 v1, s[8:11], s20 offen offset:0 sc1 lds
  v_mfma_f32_16x16x32_bf16 v[28:31], a[4:7], a[148:151], 0
  ds_read_b128 a[192:195], v252 offset:12288
  v_mfma_f32_16x16x32_bf16 v[32:35], a[0:3], a[152:155], 0
  ds_read_b128 a[196:199], v252 offset:13312
  v_mfma_f32_16x16x32_bf16 v[36:39], a[4:7], a[152:155], 0
  ds_read_b128 a[200:203], v252 offset:14336
  v_mfma_f32_16x16x32_bf16 v[40:43], a[0:3], a[156:159], 0
  ds_read_b128 a[204:207], v252 offset:15360
  buffer_load_dwordx4 v1, s[8:11], s20 offen offset:1024 sc1 lds
  v_mfma_f32_16x16x32_bf16 v[44:47], a[4:7], a[156:159], 0
  ds_read_b128 a[208:211], v252 offset:16384
  v_mfma_f32_16x16x32_bf16 v[48:51], a[0:3], a[160:163], 0
  ds_read_b128 a[212:215], v252 offset:17408
  v_mfma_f32_16x16x32_bf16 v[52:55], a[4:7], a[160:163], 0
  ds_read_b64 a[8:9], v13 offset:2048
  v_mfma_f32_16x16x32_bf16 v[56:59], a[0:3], a[164:167], 0
  ds_read_b64 a[10:11], v13 offset:2560
  buffer_load_dwordx4 v1, s[8:11], s20 offen offset:2048 sc1 lds
  v_mfma_f32_16x16x32_bf16 v[60:63], a[4:7], a[164:167], 0
  ds_read_b64 a[12:13], v13 offset:3072
  v_mfma_f32_16x16x32_bf16 v[64:67], a[0:3], a[168:171], 0
  ds_read_b64 a[14:15], v13 offset:3584
  v_mfma_f32_16x16x32_bf16 v[68:71], a[4:7], a[168:171], 0
  s_add_u32 s20, s20, 3072
  s_add_u32 m0, s7, 76800
  v_mfma_f32_16x16x32_bf16 v[72:75], a[0:3], a[172:175], 0
  buffer_load_dwordx4 v1, s[8:11], s20 offen offset:0 sc1 lds
  v_mfma_f32_16x16x32_bf16 v[76:79], a[4:7], a[172:175], 0
  v_mfma_f32_16x16x32_bf16 v[80:83], a[0:3], a[176:179], 0
  v_mfma_f32_16x16x32_bf16 v[84:87], a[4:7], a[176:179], 0
  v_mfma_f32_16x16x32_bf16 v[160:163], a[0:3], v[4:7], 0
  buffer_load_dwordx4 v1, s[8:11], s20 offen offset:1024 sc1 lds
  v_mfma_f32_16x16x32_bf16 v[168:171], a[0:3], a[0:3], 0
  v_mfma_f32_16x16x32_bf16 v[164:167], a[4:7], v[4:7], 0
  v_mfma_f32_16x16x32_bf16 v[172:175], a[4:7], a[4:7], 0
  s_add_u32 s20, s20, 2048
  s_waitcnt vmcnt(11) lgkmcnt(0)
  v_mfma_f32_16x16x32_bf16 v[16:19], a[8:11], a[180:183], v[16:19]
  ds_read_b128 a[144:147], v252 offset:18432
  v_mfma_f32_16x16x32_bf16 v[20:23], a[12:15], a[180:183], v[20:23]
  ds_read_b128 a[148:151], v252 offset:19456
  s_add_u32 m0, s30, 0
  v_mfma_f32_16x16x32_bf16 v[24:27], a[8:11], a[184:187], v[24:27]
  ds_read_b128 a[152:155], v252 offset:20480
  buffer_load_dwordx4 v1, s[8:11], s21 offen sc1 lds
  v_mfma_f32_16x16x32_bf16 v[28:31], a[12:15], a[184:187], v[28:31]
  ds_read_b128 a[156:159], v252 offset:21504
  v_mfma_f32_16x16x32_bf16 v[32:35], a[8:11], a[188:191], v[32:35]
  ds_read_b128 a[160:163], v252 offset:22528
  v_mfma_f32_16x16x32_bf16 v[36:39], a[12:15], a[188:191], v[36:39]
  ds_read_b128 a[164:167], v252 offset:23552
  v_mfma_f32_16x16x32_bf16 v[40:43], a[8:11], a[192:195], v[40:43]
  ds_read_b128 a[168:171], v252 offset:24576
  v_mfma_f32_16x16x32_bf16 v[44:47], a[12:15], a[192:195], v[44:47]
  ds_read_b128 a[172:175], v252 offset:25600
  buffer_load_dwordx4 v8, s[8:11], s21 offen offset:1024 sc1 lds
  v_mfma_f32_16x16x32_bf16 v[48:51], a[8:11], a[196:199], v[48:51]
  ds_read_b128 a[176:179], v252 offset:26624
  v_mfma_f32_16x16x32_bf16 v[52:55], a[12:15], a[196:199], v[52:55]
  ds_read_b64 a[16:17], v13 offset:4096
  v_mfma_f32_16x16x32_bf16 v[56:59], a[8:11], a[200:203], v[56:59]
  ds_read_b64 a[18:19], v13 offset:4608
  v_mfma_f32_16x16x32_bf16 v[60:63], a[12:15], a[200:203], v[60:63]
  ds_read_b64 a[20:21], v13 offset:5120
  s_add_u32 s21, s21, 1024
  s_add_u32 m0, s7, 78848
  v_mfma_f32_16x16x32_bf16 v[64:67], a[8:11], a[204:207], v[64:67]
  ds_read_b64 a[22:23], v13 offset:5632
  buffer_load_dwordx4 v1, s[8:11], s20 offen offset:0 sc1 lds
  v_mfma_f32_16x16x32_bf16 v[68:71], a[12:15], a[204:207], v[68:71]
  v_mfma_f32_16x16x32_bf16 v[72:75], a[8:11], a[208:211], v[72:75]
  v_mfma_f32_16x16x32_bf16 v[76:79], a[12:15], a[208:211], v[76:79]
  v_mfma_f32_16x16x32_bf16 v[80:83], a[8:11], a[212:215], v[80:83]
  v_mfma_f32_16x16x32_bf16 v[84:87], a[12:15], a[212:215], v[84:87]
  buffer_load_dwordx4 v1, s[8:11], s20 offen offset:1024 sc1 lds
  v_mfma_f32_16x16x32_bf16 v[160:163], a[8:11], v[4:7], v[160:163]
  v_mfma_f32_16x16x32_bf16 v[168:171], a[8:11], a[8:11], v[168:171]
  v_mfma_f32_16x16x32_bf16 v[164:167], a[12:15], v[4:7], v[164:167]
  v_mfma_f32_16x16x32_bf16 v[172:175], a[12:15], a[12:15], v[172:175]
  s_add_u32 s20, s20, 2048
  s_waitcnt vmcnt(13) lgkmcnt(0)
  v_mfma_f32_16x16x32_bf16 v[16:19], a[16:19], a[144:147], v[16:19]
  ds_read_b128 a[180:183], v252 offset:27648
  v_mfma_f32_16x16x32_bf16 v[20:23], a[20:23], a[144:147], v[20:23]
  ds_read_b128 a[184:187], v252 offset:28672
  s_add_u32 m0, s7, 80896
  v_mfma_f32_16x16x32_bf16 v[24:27], a[16:19], a[148:151], v[24:27]
  ds_read_b128 a[188:191], v252 offset:29696
  buffer_load_dwordx4 v1, s[8:11], s20 offen offset:0 sc1 lds
  v_mfma_f32_16x16x32_bf16 v[28:31], a[20:23], a[148:151], v[28:31]
  ds_read_b128 a[192:195], v252 offset:30720
  v_mfma_f32_16x16x32_bf16 v[32:35], a[16:19], a[152:155], v[32:35]
  ds_read_b128 a[196:199], v252 offset:31744
  v_mfma_f32_16x16x32_bf16 v[36:39], a[20:23], a[152:155], v[36:39]
  ds_read_b128 a[200:203], v252 offset:32768
  v_mfma_f32_16x16x32_bf16 v[40:43], a[16:19], a[156:159], v[40:43]
  ds_read_b128 a[204:207], v252 offset:33792
  v_mfma_f32_16x16x32_bf16 v[44:47], a[20:23], a[156:159], v[44:47]
  ds_read_b128 a[208:211], v252 offset:34816
  buffer_load_dwordx4 v1, s[8:11], s20 offen offset:1024 sc1 lds
  v_mfma_f32_16x16x32_bf16 v[48:51], a[16:19], a[160:163], v[48:51]
  ds_read_b128 a[212:215], v252 offset:35840
  v_mfma_f32_16x16x32_bf16 v[52:55], a[20:23], a[160:163], v[52:55]
  ds_read_b64 a[24:25], v13 offset:6144
  v_mfma_f32_16x16x32_bf16 v[56:59], a[16:19], a[164:167], v[56:59]
  ds_read_b64 a[26:27], v13 offset:6656
  v_mfma_f32_16x16x32_bf16 v[60:63], a[20:23], a[164:167], v[60:63]
  ds_read_b64 a[28:29], v13 offset:7168
  s_add_u32 s20, s20, 29696
  s_add_u32 m0, s30, 2048
  v_mfma_f32_16x16x32_bf16 v[64:67], a[16:19], a[168:171], v[64:67]
  ds_read_b64 a[30:31], v13 offset:7680
  buffer_load_dwordx4 v1, s[8:11], s21 offen sc1 lds
  v_mfma_f32_16x16x32_bf16 v[68:71], a[20:23], a[168:171], v[68:71]
  v_mfma_f32_16x16x32_bf16 v[72:75], a[16:19], a[172:175], v[72:75]
  v_mfma_f32_16x16x32_bf16 v[76:79], a[20:23], a[172:175], v[76:79]
  v_mfma_f32_16x16x32_bf16 v[80:83], a[16:19], a[176:179], v[80:83]
  v_mfma_f32_16x16x32_bf16 v[84:87], a[20:23], a[176:179], v[84:87]
  buffer_load_dwordx4 v8, s[8:11], s21 offen offset:1024 sc1 lds
  v_mfma_f32_16x16x32_bf16 v[160:163], a[16:19], v[4:7], v[160:163]
  v_mfma_f32_16x16x32_bf16 v[168:171], a[16:19], a[16:19], v[168:171]
  v_mfma_f32_16x16x32_bf16 v[164:167], a[20:23], v[4:7], v[164:167]
  v_mfma_f32_16x16x32_bf16 v[172:175], a[20:23], a[20:23], v[172:175]
  s_add_u32 s21, s21, 1024
  s_waitcnt vmcnt(15) lgkmcnt(0)
  s_barrier
  v_mfma_f32_16x16x32_bf16 v[16:19], a[24:27], a[180:183], v[16:19]
  ds_read_b128 a[144:147], v253 offset:0
  v_mfma_f32_16x16x32_bf16 v[20:23], a[28:31], a[180:183], v[20:23]
  ds_read_b128 a[148:151], v253 offset:1024
  s_add_u32 m0, s30, 4096
  v_mfma_f32_16x16x32_bf16 v[24:27], a[24:27], a[184:187], v[24:27]
  ds_read_b128 a[152:155], v253 offset:2048
  buffer_load_dwordx4 v1, s[8:11], s21 offen sc1 lds
  v_mfma_f32_16x16x32_bf16 v[28:31], a[28:31], a[184:187], v[28:31]
  ds_read_b128 a[156:159], v253 offset:3072
  v_mfma_f32_16x16x32_bf16 v[32:35], a[24:27], a[188:191], v[32:35]
  ds_read_b128 a[160:163], v253 offset:4096
  v_mfma_f32_16x16x32_bf16 v[36:39], a[28:31], a[188:191], v[36:39]
  ds_read_b128 a[164:167], v253 offset:5120
  v_mfma_f32_16x16x32_bf16 v[40:43], a[24:27], a[192:195], v[40:43]
  ds_read_b128 a[168:171], v253 offset:6144
  buffer_load_dwordx4 v8, s[8:11], s21 offen offset:1024 sc1 lds
  v_mfma_f32_16x16x32_bf16 v[44:47], a[28:31], a[192:195], v[44:47]
  ds_read_b128 a[172:175], v253 offset:7168
  v_mfma_f32_16x16x32_bf16 v[48:51], a[24:27], a[196:199], v[48:51]
  ds_read_b128 a[176:179], v253 offset:8192
  v_mfma_f32_16x16x32_bf16 v[52:55], a[28:31], a[196:199], v[52:55]
  ds_read_b64 a[32:33], v13 offset:8192
  s_add_u32 s21, s21, 1024
  s_add_u32 m0, s7, 0
  v_mfma_f32_16x16x32_bf16 v[56:59], a[24:27], a[200:203], v[56:59]
  ds_read_b64 a[34:35], v13 offset:8704
  buffer_load_dwordx4 v1, s[8:11], s20 offen offset:0 sc1 lds
  v_mfma_f32_16x16x32_bf16 v[60:63], a[28:31], a[200:203], v[60:63]
  ds_read_b64 a[36:37], v13 offset:9216
  v_mfma_f32_16x16x32_bf16 v[64:67], a[24:27], a[204:207], v[64:67]
  ds_read_b64 a[38:39], v13 offset:9728
  v_mfma_f32_16x16x32_bf16 v[68:71], a[28:31], a[204:207], v[68:71]
  v_mfma_f32_16x16x32_bf16 v[72:75], a[24:27], a[208:211], v[72:75]
  buffer_load_dwordx4 v1, s[8:11], s20 offen offset:1024 sc1 lds
  v_mfma_f32_16x16x32_bf16 v[76:79], a[28:31], a[208:211], v[76:79]
  v_mfma_f32_16x16x32_bf16 v[80:83], a[24:27], a[212:215], v[80:83]
  v_mfma_f32_16x16x32_bf16 v[84:87], a[28:31], a[212:215], v[84:87]
  v_mfma_f32_16x16x32_bf16 v[160:163], a[24:27], v[4:7], v[160:163]
  buffer_load_dwordx4 v1, s[8:11], s20 offen offset:2048 sc1 lds
  v_mfma_f32_16x16x32_bf16 v[168:171], a[24:27], a[24:27], v[168:171]
  v_mfma_f32_16x16x32_bf16 v[164:167], a[28:31], v[4:7], v[164:167]
  v_mfma_f32_16x16x32_bf16 v[172:175], a[28:31], a[28:31], v[172:175]
  s_add_u32 s20, s20, 3072
  s_waitcnt vmcnt(18) lgkmcnt(0)
  v_mfma_f32_16x16x32_bf16 v[16:19], a[32:35], a[144:147], v[16:19]
  ds_read_b128 a[180:183], v253 offset:9216
  v_mfma_f32_16x16x32_bf16 v[20:23], a[36:39], a[144:147], v[20:23]
  ds_read_b128 a[184:187], v253 offset:10240
  s_add_u32 m0, s30, 6144
  v_mfma_f32_16x16x32_bf16 v[24:27], a[32:35], a[148:151], v[24:27]
  ds_read_b128 a[188:191], v253 offset:11264
  buffer_load_dwordx4 v1, s[8:11], s21 offen sc1 lds
  v_mfma_f32_16x16x32_bf16 v[28:31], a[36:39], a[148:151], v[28:31]
  ds_read_b128 a[192:195], v253 offset:12288
  v_mfma_f32_16x16x32_bf16 v[32:35], a[32:35], a[152:155], v[32:35]
  ds_read_b128 a[196:199], v253 offset:13312
  v_mfma_f32_16x16x32_bf16 v[36:39], a[36:39], a[152:155], v[36:39]
  ds_read_b128 a[200:203], v253 offset:14336
  v_mfma_f32_16x16x32_bf16 v[40:43], a[32:35], a[156:159], v[40:43]
  ds_read_b128 a[204:207], v253 offset:15360
  v_mfma_f32_16x16x32_bf16 v[44:47], a[36:39], a[156:159], v[44:47]
  ds_read_b128 a[208:211], v253 offset:16384
  buffer_load_dwordx4 v8, s[8:11], s21 offen offset:1024 sc1 lds
  v_mfma_f32_16x16x32_bf16 v[48:51], a[32:35], a[160:163], v[48:51]
  ds_read_b128 a[212:215], v253 offset:17408
  v_mfma_f32_16x16x32_bf16 v[52:55], a[36:39], a[160:163], v[52:55]
  ds_read_b64 a[40:41], v13 offset:10240
  v_mfma_f32_16x16x32_bf16 v[56:59], a[32:35], a[164:167], v[56:59]
  ds_read_b64 a[42:43], v13 offset:10752
  v_mfma_f32_16x16x32_bf16 v[60:63], a[36:39], a[164:167], v[60:63]
  ds_read_b64 a[44:45], v13 offset:11264
  s_add_u32 s21, s21, 1024
  s_add_u32 m0, s7, 3072
  v_mfma_f32_16x16x32_bf16 v[64:67], a[32:35], a[168:171], v[64:67]
  ds_read_b64 a[46:47], v13 offset:11776
  buffer_load_dwordx4 v1, s[8:11], s20 offen offset:0 sc1 lds
  v_mfma_f32_16x16x32_bf16 v[68:71], a[36:39], a[168:171], v[68:71]
  v_mfma_f32_16x16x32_bf16 v[72:75], a[32:35], a[172:175], v[72:75]
  v_mfma_f32_16x16x32_bf16 v[76:79], a[36:39], a[172:175], v[76:79]
  v_mfma_f32_16x16x32_bf16 v[80:83], a[32:35], a[176:179], v[80:83]
  v_mfma_f32_16x16x32_bf16 v[84:87], a[36:39], a[176:179], v[84:87]
  buffer_load_dwordx4 v1, s[8:11], s20 offen offset:1024 sc1 lds
  v_mfma_f32_16x16x32_bf16 v[160:163], a[32:35], v[4:7], v[160:163]
  v_mfma_f32_16x16x32_bf16 v[168:171], a[32:35], a[32:35], v[168:171]
  v_mfma_f32_16x16x32_bf16 v[164:167], a[36:39], v[4:7], v[164:167]
  v_mfma_f32_16x16x32_bf16 v[172:175], a[36:39], a[36:39], v[172:175]
  s_add_u32 s20, s20, 2048
  s_waitcnt vmcnt(15) lgkmcnt(0)
  v_mfma_f32_16x16x32_bf16 v[16:19], a[40:43], a[180:183], v[16:19]
  ds_read_b128 a[144:147], v253 offset:18432
  v_mfma_f32_16x16x32_bf16 v[20:23], a[44:47], a[180:183], v[20:23]
  ds_read_b128 a[148:151], v253 offset:19456
  s_add_u32 m0, s30, 8192
  v_mfma_f32_16x16x32_bf16 v[24:27], a[40:43], a[184:187], v[24:27]
  ds_read_b128 a[152:155], v253 offset:20480
  buffer_load_dwordx4 v1, s[8:11], s21 offen sc1 lds
  v_mfma_f32_16x16x32_bf16 v[28:31], a[44:47], a[184:187], v[28:31]
  ds_read_b128 a[156:159], v253 offset:21504
  v_mfma_f32_16x16x32_bf16 v[32:35], a[40:43], a[188:191], v[32:35]
  ds_read_b128 a[160:163], v253 offset:22528
  v_mfma_f32_16x16x32_bf16 v[36:39], a[44:47], a[188:191], v[36:39]
  ds_read_b128 a[164:167], v253 offset:23552
  v_mfma_f32_16x16x32_bf16 v[40:43], a[40:43], a[192:195], v[40:43]
  ds_read_b128 a[168:171], v253 offset:24576
  v_mfma_f32_16x16x32_bf16 v[44:47], a[44:47], a[192:195], v[44:47]
  ds_read_b128 a[172:175], v253 offset:25600
  buffer_load_dwordx4 v8, s[8:11], s21 offen offset:1024 sc1 lds
  v_mfma_f32_16x16x32_bf16 v[48:51], a[40:43], a[196:199], v[48:51]
  ds_read_b128 a[176:179], v253 offset:26624
  v_mfma_f32_16x16x32_bf16 v[52:55], a[44:47], a[196:199], v[52:55]
  ds_read_b64 a[48:49], v13 offset:0
  v_mfma_f32_16x16x32_bf16 v[56:59], a[40:43], a[200:203], v[56:59]
  ds_read_b64 a[50:51], v13 offset:512
  v_mfma_f32_16x16x32_bf16 v[60:63], a[44:47], a[200:203], v[60:63]
  ds_read_b64 a[52:53], v13 offset:1024
  s_add_u32 s21, s21, 1024
  s_add_u32 m0, s7, 5120
  v_mfma_f32_16x16x32_bf16 v[64:67], a[40:43], a[204:207], v[64:67]
  ds_read_b64 a[54:55], v13 offset:1536
  buffer_load_dwordx4 v1, s[8:11], s20 offen offset:0 sc1 lds
  v_mfma_f32_16x16x32_bf16 v[68:71], a[44:47], a[204:207], v[68:71]
  v_mfma_f32_16x16x32_bf16 v[72:75], a[40:43], a[208:211], v[72:75]
  v_mfma_f32_16x16x32_bf16 v[76:79], a[44:47], a[208:211], v[76:79]
  v_mfma_f32_16x16x32_bf16 v[80:83], a[40:43], a[212:215], v[80:83]
  v_mfma_f32_16x16x32_bf16 v[84:87], a[44:47], a[212:215], v[84:87]
  buffer_load_dwordx4 v1, s[8:11], s20 offen offset:1024 sc1 lds
  v_mfma_f32_16x16x32_bf16 v[160:163], a[40:43], v[4:7], v[160:163]
  v_mfma_f32_16x16x32_bf16 v[168:171], a[40:43], a[40:43], v[168:171]
  v_mfma_f32_16x16x32_bf16 v[164:167], a[44:47], v[4:7], v[164:167]
  v_mfma_f32_16x16x32_bf16 v[172:175], a[44:47], a[44:47], v[172:175]
  s_add_u32 s20, s20, 2048
  s_waitcnt vmcnt(13) lgkmcnt(0)
  v_mfma_f32_16x16x32_bf16 v[16:19], a[48:51], a[144:147], v[16:19]
  ds_read_b128 a[180:183], v253 offset:27648
  v_mul_u32_u24 v11, 80, v12
  v_mfma_f32_16x16x32_bf16 v[20:23], a[52:55], a[144:147], v[20:23]
  ds_read_b128 a[184:187], v253 offset:28672
  s_add_u32 m0, s30, 10240
  v_mfma_f32_16x16x32_bf16 v[24:27], a[48:51], a[148:151], v[24:27]
  ds_read_b128 a[188:191], v253 offset:29696
  buffer_load_dwordx4 v1, s[8:11], s21 offen sc1 lds
  v_mfma_f32_16x16x32_bf16 v[28:31], a[52:55], a[148:151], v[28:31]
  ds_read_b128 a[192:195], v253 offset:30720
  v_mfma_f32_16x16x32_bf16 v[32:35], a[48:51], a[152:155], v[32:35]
  ds_read_b128 a[196:199], v253 offset:31744
  v_mfma_f32_16x16x32_bf16 v[36:39], a[52:55], a[152:155], v[36:39]
  ds_read_b128 a[200:203], v253 offset:32768
  v_mfma_f32_16x16x32_bf16 v[40:43], a[48:51], a[156:159], v[40:43]
  ds_read_b128 a[204:207], v253 offset:33792
  v_mfma_f32_16x16x32_bf16 v[44:47], a[52:55], a[156:159], v[44:47]
  ds_read_b128 a[208:211], v253 offset:34816
  buffer_load_dwordx4 v8, s[8:11], s21 offen offset:1024 sc1 lds
  v_mfma_f32_16x16x32_bf16 v[48:51], a[48:51], a[160:163], v[48:51]
  ds_read_b128 a[212:215], v253 offset:35840
  v_mfma_f32_16x16x32_bf16 v[52:55], a[52:55], a[160:163], v[52:55]
  ds_read_b64 a[56:57], v13 offset:2048
  v_mfma_f32_16x16x32_bf16 v[56:59], a[48:51], a[164:167], v[56:59]
  ds_read_b64 a[58:59], v13 offset:2560
  v_mfma_f32_16x16x32_bf16 v[60:63], a[52:55], a[164:167], v[60:63]
  ds_read_b64 a[60:61], v13 offset:3072
  s_add_u32 s21, s21, 1024
  s_add_u32 m0, s7, 7168
  v_mfma_f32_16x16x32_bf16 v[64:67], a[48:51], a[168:171], v[64:67]
  ds_read_b64 a[62:63], v13 offset:3584
  buffer_load_dwordx4 v1, s[8:11], s20 offen offset:0 sc1 lds
  v_mfma_f32_16x16x32_bf16 v[68:71], a[52:55], a[168:171], v[68:71]
  v_mfma_f32_16x16x32_bf16 v[72:75], a[48:51], a[172:175], v[72:75]
  v_mfma_f32_16x16x32_bf16 v[76:79], a[52:55], a[172:175], v[76:79]
  v_mfma_f32_16x16x32_bf16 v[80:83], a[48:51], a[176:179], v[80:83]
  v_mfma_f32_16x16x32_bf16 v[84:87], a[52:55], a[176:179], v[84:87]
  buffer_load_dwordx4 v1, s[8:11], s20 offen offset:1024 sc1 lds
  v_mfma_f32_16x16x32_bf16 v[160:163], a[48:51], v[4:7], v[160:163]
  v_mfma_f32_16x16x32_bf16 v[168:171], a[48:51], a[48:51], v[168:171]
  v_mfma_f32_16x16x32_bf16 v[164:167], a[52:55], v[4:7], v[164:167]
  v_mfma_f32_16x16x32_bf16 v[172:175], a[52:55], a[52:55], v[172:175]
  s_add_u32 s20, s20, 29696
  s_waitcnt vmcnt(15) lgkmcnt(0)
  s_barrier
  v_mfma_f32_16x16x32_bf16 v[16:19], a[56:59], a[180:183], v[16:19]
  ds_read_b128 a[144:147], v254 offset:0
  v_mfma_f32_16x16x32_bf16 v[20:23], a[60:63], a[180:183], v[20:23]
  ds_read_b128 a[148:151], v254 offset:1024
  s_add_u32 m0, s30, 0
  v_mfma_f32_16x16x32_bf16 v[24:27], a[56:59], a[184:187], v[24:27]
  ds_read_b128 a[152:155], v254 offset:2048
  buffer_load_dwordx4 v1, s[8:11], s21 offen sc1 lds
  v_mfma_f32_16x16x32_bf16 v[28:31], a[60:63], a[184:187], v[28:31]
  ds_read_b128 a[156:159], v254 offset:3072
  v_mfma_f32_16x16x32_bf16 v[32:35], a[56:59], a[188:191], v[32:35]
  ds_read_b128 a[160:163], v254 offset:4096
  v_mfma_f32_16x16x32_bf16 v[36:39], a[60:63], a[188:191], v[36:39]
  ds_read_b128 a[164:167], v254 offset:5120
  v_mfma_f32_16x16x32_bf16 v[40:43], a[56:59], a[192:195], v[40:43]
  ds_read_b128 a[168:171], v254 offset:6144
  buffer_load_dwordx4 v8, s[8:11], s21 offen offset:1024 sc1 lds
  v_mfma_f32_16x16x32_bf16 v[44:47], a[60:63], a[192:195], v[44:47]
  ds_read_b128 a[172:175], v254 offset:7168
  v_mfma_f32_16x16x32_bf16 v[48:51], a[56:59], a[196:199], v[48:51]
  ds_read_b128 a[176:179], v254 offset:8192
  v_mfma_f32_16x16x32_bf16 v[52:55], a[60:63], a[196:199], v[52:55]
  ds_read_b64 a[64:65], v13 offset:4096
  s_add_u32 s21, s21, 1024
  s_add_u32 m0, s7, 36864
  v_mfma_f32_16x16x32_bf16 v[56:59], a[56:59], a[200:203], v[56:59]
  ds_read_b64 a[66:67], v13 offset:4608
  buffer_load_dwordx4 v1, s[8:11], s20 offen offset:0 sc1 lds
  v_mfma_f32_16x16x32_bf16 v[60:63], a[60:63], a[200:203], v[60:63]
  ds_read_b64 a[68:69], v13 offset:5120
  v_mfma_f32_16x16x32_bf16 v[64:67], a[56:59], a[204:207], v[64:67]
  ds_read_b64 a[70:71], v13 offset:5632
  v_mfma_f32_16x16x32_bf16 v[68:71], a[60:63], a[204:207], v[68:71]
  v_mfma_f32_16x16x32_bf16 v[72:75], a[56:59], a[208:211], v[72:75]
  buffer_load_dwordx4 v1, s[8:11], s20 offen offset:1024 sc1 lds
  v_mfma_f32_16x16x32_bf16 v[76:79], a[60:63], a[208:211], v[76:79]
  v_mfma_f32_16x16x32_bf16 v[80:83], a[56:59], a[212:215], v[80:83]
  v_mfma_f32_16x16x32_bf16 v[84:87], a[60:63], a[212:215], v[84:87]
  v_mfma_f32_16x16x32_bf16 v[160:163], a[56:59], v[4:7], v[160:163]
  buffer_load_dwordx4 v1, s[8:11], s20 offen offset:2048 sc1 lds
  v_mfma_f32_16x16x32_bf16 v[168:171], a[56:59], a[56:59], v[168:171]
  v_mfma_f32_16x16x32_bf16 v[164:167], a[60:63], v[4:7], v[164:167]
  v_mfma_f32_16x16x32_bf16 v[172:175], a[60:63], a[60:63], v[172:175]
  s_add_u32 s20, s20, 3072
  s_waitcnt vmcnt(15) lgkmcnt(0)
  v_mfma_f32_16x16x32_bf16 v[16:19], a[64:67], a[144:147], v[16:19]
  ds_read_b128 a[180:183], v254 offset:9216
  v_mfma_f32_16x16x32_bf16 v[20:23], a[68:71], a[144:147], v[20:23]
  ds_read_b128 a[184:187], v254 offset:10240
  s_add_u32 m0, s30, 2048
  v_mfma_f32_16x16x32_bf16 v[24:27], a[64:67], a[148:151], v[24:27]
  ds_read_b128 a[188:191], v254 offset:11264
  buffer_load_dwordx4 v1, s[8:11], s21 offen sc1 lds
  v_mfma_f32_16x16x32_bf16 v[28:31], a[68:71], a[148:151], v[28:31]
  ds_read_b128 a[192:195], v254 offset:12288
  v_mfma_f32_16x16x32_bf16 v[32:35], a[64:67], a[152:155], v[32:35]
  ds_read_b128 a[196:199], v254 offset:13312
  v_mfma_f32_16x16x32_bf16 v[36:39], a[68:71], a[152:155], v[36:39]
  ds_read_b128 a[200:203], v254 offset:14336
  v_mfma_f32_16x16x32_bf16 v[40:43], a[64:67], a[156:159], v[40:43]
  ds_read_b128 a[204:207], v254 offset:15360
  v_mfma_f32_16x16x32_bf16 v[44:47], a[68:71], a[156:159], v[44:47]
  ds_read_b128 a[208:211], v254 offset:16384
  buffer_load_dwordx4 v8, s[8:11], s21 offen offset:1024 sc1 lds
  v_mfma_f32_16x16x32_bf16 v[48:51], a[64:67], a[160:163], v[48:51]
  ds_read_b128 a[212:215], v254 offset:17408
  v_mfma_f32_16x16x32_bf16 v[52:55], a[68:71], a[160:163], v[52:55]
  ds_read_b64 a[72:73], v13 offset:6144
  v_mfma_f32_16x16x32_bf16 v[56:59], a[64:67], a[164:167], v[56:59]
  ds_read_b64 a[74:75], v13 offset:6656
  v_mfma_f32_16x16x32_bf16 v[60:63], a[68:71], a[164:167], v[60:63]
  ds_read_b64 a[76:77], v13 offset:7168
  s_add_u32 s21, s21, 1024
  s_add_u32 m0, s7, 39936
  v_mfma_f32_16x16x32_bf16 v[64:67], a[64:67], a[168:171], v[64:67]
  ds_read_b64 a[78:79], v13 offset:7680
  buffer_load_dwordx4 v1, s[8:11], s20 offen offset:0 sc1 lds
  v_mfma_f32_16x16x32_bf16 v[68:71], a[68:71], a[168:171], v[68:71]
  v_mfma_f32_16x16x32_bf16 v[72:75], a[64:67], a[172:175], v[72:75]
  v_mfma_f32_16x16x32_bf16 v[76:79], a[68:71], a[172:175], v[76:79]
  v_mfma_f32_16x16x32_bf16 v[80:83], a[64:67], a[176:179], v[80:83]
  v_mfma_f32_16x16x32_bf16 v[84:87], a[68:71], a[176:179], v[84:87]
  buffer_load_dwordx4 v1, s[8:11], s20 offen offset:1024 sc1 lds
  v_mfma_f32_16x16x32_bf16 v[160:163], a[64:67], v[4:7], v[160:163]
  v_mfma_f32_16x16x32_bf16 v[168:171], a[64:67], a[64:67], v[168:171]
  v_mfma_f32_16x16x32_bf16 v[164:167], a[68:71], v[4:7], v[164:167]
  v_mfma_f32_16x16x32_bf16 v[172:175], a[68:71], a[68:71], v[172:175]
  s_add_u32 s20, s20, 2048
  s_waitcnt vmcnt(15) lgkmcnt(0)
  v_mfma_f32_16x16x32_bf16 v[16:19], a[72:75], a[180:183], v[16:19]
  ds_read_b128 a[144:147], v254 offset:18432
  v_mfma_f32_16x16x32_bf16 v[20:23], a[76:79], a[180:183], v[20:23]
  ds_read_b128 a[148:151], v254 offset:19456
  s_add_u32 m0, s30, 4096
  v_mfma_f32_16x16x32_bf16 v[24:27], a[72:75], a[184:187], v[24:27]
  ds_read_b128 a[152:155], v254 offset:20480
  buffer_load_dwordx4 v1, s[8:11], s21 offen sc1 lds
  v_mfma_f32_16x16x32_bf16 v[28:31], a[76:79], a[184:187], v[28:31]
  ds_read_b128 a[156:159], v254 offset:21504
  v_mfma_f32_16x16x32_bf16 v[32:35], a[72:75], a[188:191], v[32:35]
  ds_read_b128 a[160:163], v254 offset:22528
  v_mfma_f32_16x16x32_bf16 v[36:39], a[76:79], a[188:191], v[36:39]
  ds_read_b128 a[164:167], v254 offset:23552
  v_mfma_f32_16x16x32_bf16 v[40:43], a[72:75], a[192:195], v[40:43]
  ds_read_b128 a[168:171], v254 offset:24576
  v_mfma_f32_16x16x32_bf16 v[44:47], a[76:79], a[192:195], v[44:47]
  ds_read_b128 a[172:175], v254 offset:25600
  buffer_load_dwordx4 v8, s[8:11], s21 offen offset:1024 sc1 lds
  v_mfma_f32_16x16x32_bf16 v[48:51], a[72:75], a[196:199], v[48:51]
  ds_read_b128 a[176:179], v254 offset:26624
  v_mfma_f32_16x16x32_bf16 v[52:55], a[76:79], a[196:199], v[52:55]
  ds_read_b64 a[80:81], v13 offset:8192
  v_mfma_f32_16x16x32_bf16 v[56:59], a[72:75], a[200:203], v[56:59]
  ds_read_b64 a[82:83], v13 offset:8704
  v_mfma_f32_16x16x32_bf16 v[60:63], a[76:79], a[200:203], v[60:63]
  ds_read_b64 a[84:85], v13 offset:9216
  s_add_u32 s21, s21, 1024
  s_add_u32 m0, s7, 41984
  v_mfma_f32_16x16x32_bf16 v[64:67], a[72:75], a[204:207], v[64:67]
  ds_read_b64 a[86:87], v13 offset:9728
  buffer_load_dwordx4 v1, s[8:11], s20 offen offset:0 sc1 lds
  v_mfma_f32_16x16x32_bf16 v[68:71], a[76:79], a[204:207], v[68:71]
  v_mfma_f32_16x16x32_bf16 v[72:75], a[72:75], a[208:211], v[72:75]
  v_mfma_f32_16x16x32_bf16 v[76:79], a[76:79], a[208:211], v[76:79]
  v_mfma_f32_16x16x32_bf16 v[80:83], a[72:75], a[212:215], v[80:83]
  v_mfma_f32_16x16x32_bf16 v[84:87], a[76:79], a[212:215], v[84:87]
  buffer_load_dwordx4 v1, s[8:11], s20 offen offset:1024 sc1 lds
  v_mfma_f32_16x16x32_bf16 v[160:163], a[72:75], v[4:7], v[160:163]
  v_mfma_f32_16x16x32_bf16 v[168:171], a[72:75], a[72:75], v[168:171]
  v_mfma_f32_16x16x32_bf16 v[164:167], a[76:79], v[4:7], v[164:167]
  v_mfma_f32_16x16x32_bf16 v[172:175], a[76:79], a[76:79], v[172:175]
  s_add_u32 s20, s20, 2048
  s_waitcnt vmcnt(15) lgkmcnt(0)
  v_mfma_f32_16x16x32_bf16 v[16:19], a[80:83], a[144:147], v[16:19]
  ds_read_b128 a[180:183], v254 offset:27648
  v_mfma_f32_16x16x32_bf16 v[20:23], a[84:87], a[144:147], v[20:23]
  ds_read_b128 a[184:187], v254 offset:28672
  s_add_u32 m0, s30, 6144
  v_mfma_f32_16x16x32_bf16 v[24:27], a[80:83], a[148:151], v[24:27]
  ds_read_b128 a[188:191], v254 offset:29696
  buffer_load_dwordx4 v1, s[8:11], s21 offen sc1 lds
  v_mfma_f32_16x16x32_bf16 v[28:31], a[84:87], a[148:151], v[28:31]
  ds_read_b128 a[192:195], v254 offset:30720
  v_mfma_f32_16x16x32_bf16 v[32:35], a[80:83], a[152:155], v[32:35]
  ds_read_b128 a[196:199], v254 offset:31744
  v_mfma_f32_16x16x32_bf16 v[36:39], a[84:87], a[152:155], v[36:39]
  ds_read_b128 a[200:203], v254 offset:32768
  v_mfma_f32_16x16x32_bf16 v[40:43], a[80:83], a[156:159], v[40:43]
  ds_read_b128 a[204:207], v254 offset:33792
  v_mfma_f32_16x16x32_bf16 v[44:47], a[84:87], a[156:159], v[44:47]
  ds_read_b128 a[208:211], v254 offset:34816
  buffer_load_dwordx4 v8, s[8:11], s21 offen offset:1024 sc1 lds
  v_mfma_f32_16x16x32_bf16 v[48:51], a[80:83], a[160:163], v[48:51]
  ds_read_b128 a[212:215], v254 offset:35840
  v_mfma_f32_16x16x32_bf16 v[52:55], a[84:87], a[160:163], v[52:55]
  ds_read_b64 a[88:89], v13 offset:10240
  v_mfma_f32_16x16x32_bf16 v[56:59], a[80:83], a[164:167], v[56:59]
  ds_read_b64 a[90:91], v13 offset:10752
  v_mfma_f32_16x16x32_bf16 v[60:63], a[84:87], a[164:167], v[60:63]
  ds_read_b64 a[92:93], v13 offset:11264
  s_add_u32 s21, s21, 1024
  s_add_u32 m0, s7, 44032
  v_mfma_f32_16x16x32_bf16 v[64:67], a[80:83], a[168:171], v[64:67]
  ds_read_b64 a[94:95], v13 offset:11776
  buffer_load_dwordx4 v1, s[8:11], s20 offen offset:0 sc1 lds
  v_mfma_f32_16x16x32_bf16 v[68:71], a[84:87], a[168:171], v[68:71]
  v_mfma_f32_16x16x32_bf16 v[72:75], a[80:83], a[172:175], v[72:75]
  v_mfma_f32_16x16x32_bf16 v[76:79], a[84:87], a[172:175], v[76:79]
  v_mfma_f32_16x16x32_bf16 v[80:83], a[80:83], a[176:179], v[80:83]
  v_mfma_f32_16x16x32_bf16 v[84:87], a[84:87], a[176:179], v[84:87]
  buffer_load_dwordx4 v1, s[8:11], s20 offen offset:1024 sc1 lds
  v_mfma_f32_16x16x32_bf16 v[160:163], a[80:83], v[4:7], v[160:163]
  v_mfma_f32_16x16x32_bf16 v[168:171], a[80:83], a[80:83], v[168:171]
  v_mfma_f32_16x16x32_bf16 v[164:167], a[84:87], v[4:7], v[164:167]
  v_mfma_f32_16x16x32_bf16 v[172:175], a[84:87], a[84:87], v[172:175]
  s_add_u32 s20, s20, 29696
  s_waitcnt vmcnt(15) lgkmcnt(0)
  s_barrier
  v_mfma_f32_16x16x32_bf16 v[16:19], a[88:91], a[180:183], v[16:19]
  ds_read_b128 a[144:147], v252 offset:0
  v_mfma_f32_16x16x32_bf16 v[20:23], a[92:95], a[180:183], v[20:23]
  ds_read_b128 a[148:151], v252 offset:1024
  s_add_u32 m0, s30, 8192
  v_mfma_f32_16x16x32_bf16 v[24:27], a[88:91], a[184:187], v[24:27]
  ds_read_b128 a[152:155], v252 offset:2048
  buffer_load_dwordx4 v1, s[8:11], s21 offen sc1 lds
  v_mfma_f32_16x16x32_bf16 v[28:31], a[92:95], a[184:187], v[28:31]
  ds_read_b128 a[156:159], v252 offset:3072
  v_mfma_f32_16x16x32_bf16 v[32:35], a[88:91], a[188:191], v[32:35]
  ds_read_b128 a[160:163], v252 offset:4096
  buffer_load_dwordx4 v8, s[8:11], s21 offen offset:1024 sc1 lds
  v_mfma_f32_16x16x32_bf16 v[36:39], a[92:95], a[188:191], v[36:39]
  ds_read_b128 a[164:167], v252 offset:5120
  s_add_u32 s21, s21, 1024
  s_add_u32 m0, s7, 73728
  v_mfma_f32_16x16x32_bf16 v[40:43], a[88:91], a[192:195], v[40:43]
  ds_read_b128 a[168:171], v252 offset:6144
  buffer_load_dwordx4 v1, s[8:11], s20 offen offset:0 sc1 lds
  v_mfma_f32_16x16x32_bf16 v[44:47], a[92:95], a[192:195], v[44:47]
  ds_read_b128 a[172:175], v252 offset:7168
  v_mfma_f32_16x16x32_bf16 v[48:51], a[88:91], a[196:199], v[48:51]
  ds_read_b128 a[176:179], v252 offset:8192
  buffer_load_dwordx4 v1, s[8:11], s20 offen offset:1024 sc1 lds
  v_mfma_f32_16x16x32_bf16 v[52:55], a[92:95], a[196:199], v[52:55]
  ds_read_b64 a[96:97], v13 offset:0
  v_mfma_f32_16x16x32_bf16 v[56:59], a[88:91], a[200:203], v[56:59]
  ds_read_b64 a[98:99], v13 offset:512
  buffer_load_dwordx4 v1, s[8:11], s20 offen offset:2048 sc1 lds
  v_mfma_f32_16x16x32_bf16 v[60:63], a[92:95], a[200:203], v[60:63]
  ds_read_b64 a[100:101], v13 offset:1024
  v_mfma_f32_16x16x32_bf16 v[64:67], a[88:91], a[204:207], v[64:67]
  ds_read_b64 a[102:103], v13 offset:1536
  s_add_u32 s20, s20, 3072
  s_mov_b32 m0, 159744
  v_mfma_f32_16x16x32_bf16 v[68:71], a[92:95], a[204:207], v[68:71]
  buffer_load_dwordx4 v1, s[8:11], s22 offen sc1 lds
  v_mfma_f32_16x16x32_bf16 v[72:75], a[88:91], a[208:211], v[72:75]
  v_mfma_f32_16x16x32_bf16 v[76:79], a[92:95], a[208:211], v[76:79]
  buffer_load_dwordx4 v1, s[8:11], s22 offen offset:1024 sc1 lds
  v_mfma_f32_16x16x32_bf16 v[80:83], a[88:91], a[212:215], v[80:83]
  s_mul_i32 s22, s5, 576
  s_add_u32 s22, s22, 4784128
  s_mov_b32 m0, 161792
  v_mfma_f32_16x16x32_bf16 v[84:87], a[92:95], a[212:215], v[84:87]
  buffer_load_dwordx4 v1, s[8:11], s22 offen sc1 lds
  v_mfma_f32_16x16x32_bf16 v[160:163], a[88:91], v[4:7], v[160:163]
  s_add_u32 s22, s22, 8192
  v_mfma_f32_16x16x32_bf16 v[168:171], a[88:91], a[88:91], v[168:171]
  buffer_load_dwordx4 v1, s[8:11], s22 offen offset:1024 sc1 lds
  v_mfma_f32_16x16x32_bf16 v[164:167], a[92:95], v[4:7], v[164:167]
  v_mfma_f32_16x16x32_bf16 v[172:175], a[92:95], a[92:95], v[172:175]
  s_waitcnt vmcnt(19) lgkmcnt(0)
  v_mfma_f32_16x16x32_bf16 v[16:19], a[96:99], a[144:147], v[16:19]
  ds_read_b128 a[180:183], v252 offset:9216
  v_lshrrev_b32 v10, 3, v2
  v_mfma_f32_16x16x32_bf16 v[20:23], a[100:103], a[144:147], v[20:23]
  ds_read_b128 a[184:187], v252 offset:10240
  s_add_u32 m0, s30, 10240
  v_mfma_f32_16x16x32_bf16 v[24:27], a[96:99], a[148:151], v[24:27]
  ds_read_b128 a[188:191], v252 offset:11264
  buffer_load_dwordx4 v1, s[8:11], s21 offen sc1 lds
  v_mfma_f32_16x16x32_bf16 v[28:31], a[100:103], a[148:151], v[28:31]
  ds_read_b128 a[192:195], v252 offset:12288
  v_lshlrev_b32 v10, 12, v10
  v_mfma_f32_16x16x32_bf16 v[32:35], a[96:99], a[152:155], v[32:35]
  ds_read_b128 a[196:199], v252 offset:13312
  v_and_b32 v194, 7, v2
  v_mfma_f32_16x16x32_bf16 v[36:39], a[100:103], a[152:155], v[36:39]
  ds_read_b128 a[200:203], v252 offset:14336
  v_lshl_add_u32 v10, v194, 4, v10
  v_mfma_f32_16x16x32_bf16 v[40:43], a[96:99], a[156:159], v[40:43]
  ds_read_b128 a[204:207], v252 offset:15360
  v_mfma_f32_16x16x32_bf16 v[44:47], a[100:103], a[156:159], v[44:47]
  ds_read_b128 a[208:211], v252 offset:16384
  buffer_load_dwordx4 v8, s[8:11], s21 offen offset:1024 sc1 lds
  v_mfma_f32_16x16x32_bf16 v[48:51], a[96:99], a[160:163], v[48:51]
  ds_read_b128 a[212:215], v252 offset:17408
  v_mfma_f32_16x16x32_bf16 v[52:55], a[100:103], a[160:163], v[52:55]
  ds_read_b64 a[104:105], v13 offset:2048
  v_mfma_f32_16x16x32_bf16 v[56:59], a[96:99], a[164:167], v[56:59]
  ds_read_b64 a[106:107], v13 offset:2560
  v_mfma_f32_16x16x32_bf16 v[60:63], a[100:103], a[164:167], v[60:63]
  ds_read_b64 a[108:109], v13 offset:3072
  s_add_u32 s21, s21, 1024
  s_add_u32 m0, s7, 76800
  v_mfma_f32_16x16x32_bf16 v[64:67], a[96:99], a[168:171], v[64:67]
  ds_read_b64 a[110:111], v13 offset:3584
  buffer_load_dwordx4 v1, s[8:11], s20 offen offset:0 sc1 lds
  v_mfma_f32_16x16x32_bf16 v[68:71], a[100:103], a[168:171], v[68:71]
  v_mfma_f32_16x16x32_bf16 v[72:75], a[96:99], a[172:175], v[72:75]
  v_mfma_f32_16x16x32_bf16 v[76:79], a[100:103], a[172:175], v[76:79]
  v_mfma_f32_16x16x32_bf16 v[80:83], a[96:99], a[176:179], v[80:83]
  v_mfma_f32_16x16x32_bf16 v[84:87], a[100:103], a[176:179], v[84:87]
  buffer_load_dwordx4 v1, s[8:11], s20 offen offset:1024 sc1 lds
  v_mfma_f32_16x16x32_bf16 v[160:163], a[96:99], v[4:7], v[160:163]
  v_mfma_f32_16x16x32_bf16 v[168:171], a[96:99], a[96:99], v[168:171]
  v_mfma_f32_16x16x32_bf16 v[164:167], a[100:103], v[4:7], v[164:167]
  v_mfma_f32_16x16x32_bf16 v[172:175], a[100:103], a[100:103], v[172:175]
  s_add_u32 s20, s20, 2048
  s_waitcnt vmcnt(19) lgkmcnt(0)
  v_mfma_f32_16x16x32_bf16 v[16:19], a[104:107], a[180:183], v[16:19]
  ds_read_b128 a[144:147], v252 offset:18432
  v_mfma_f32_16x16x32_bf16 v[20:23], a[108:111], a[180:183], v[20:23]
  ds_read_b128 a[148:151], v252 offset:19456
  s_add_u32 m0, s7, 78848
  v_mfma_f32_16x16x32_bf16 v[24:27], a[104:107], a[184:187], v[24:27]
  ds_read_b128 a[152:155], v252 offset:20480
  buffer_load_dwordx4 v1, s[8:11], s20 offen offset:0 sc1 lds
  v_mfma_f32_16x16x32_bf16 v[28:31], a[108:111], a[184:187], v[28:31]
  ds_read_b128 a[156:159], v252 offset:21504
  v_mfma_f32_16x16x32_bf16 v[32:35], a[104:107], a[188:191], v[32:35]
  ds_read_b128 a[160:163], v252 offset:22528
  v_mfma_f32_16x16x32_bf16 v[36:39], a[108:111], a[188:191], v[36:39]
  ds_read_b128 a[164:167], v252 offset:23552
  v_mfma_f32_16x16x32_bf16 v[40:43], a[104:107], a[192:195], v[40:43]
  ds_read_b128 a[168:171], v252 offset:24576
  buffer_load_dwordx4 v1, s[8:11], s20 offen offset:1024 sc1 lds
  v_mfma_f32_16x16x32_bf16 v[44:47], a[108:111], a[192:195], v[44:47]
  ds_read_b128 a[172:175], v252 offset:25600
  v_mfma_f32_16x16x32_bf16 v[48:51], a[104:107], a[196:199], v[48:51]
  ds_read_b128 a[176:179], v252 offset:26624
  v_mfma_f32_16x16x32_bf16 v[52:55], a[108:111], a[196:199], v[52:55]
  ds_read_b64 a[112:113], v13 offset:4096
  s_add_u32 s20, s20, 2048
  s_lshl_b32 s31, s5, 7
  s_add_u32 s31, s31, s29
  v_mfma_f32_16x16x32_bf16 v[56:59], a[104:107], a[200:203], v[56:59]
  ds_read_b64 a[114:115], v13 offset:4608
  buffer_load_dwordx4 a[216:219], v10, s[16:19], s31 offen offset:2048
  v_mfma_f32_16x16x32_bf16 v[60:63], a[108:111], a[200:203], v[60:63]
  ds_read_b64 a[116:117], v13 offset:5120
  v_mfma_f32_16x16x32_bf16 v[64:67], a[104:107], a[204:207], v[64:67]
  ds_read_b64 a[118:119], v13 offset:5632
  v_mfma_f32_16x16x32_bf16 v[68:71], a[108:111], a[204:207], v[68:71]
  s_add_u32 s31, s31, 32768
  v_mfma_f32_16x16x32_bf16 v[72:75], a[104:107], a[208:211], v[72:75]
  buffer_load_dwordx4 a[216:219], v10, s[16:19], s31 offen offset:2048
  v_mfma_f32_16x16x32_bf16 v[76:79], a[108:111], a[208:211], v[76:79]
  v_mfma_f32_16x16x32_bf16 v[80:83], a[104:107], a[212:215], v[80:83]
  v_mfma_f32_16x16x32_bf16 v[84:87], a[108:111], a[212:215], v[84:87]
  s_add_u32 s31, s31, 32768
  v_mfma_f32_16x16x32_bf16 v[160:163], a[104:107], v[4:7], v[160:163]
  buffer_load_dwordx4 a[216:219], v10, s[16:19], s31 offen offset:2048
  v_mfma_f32_16x16x32_bf16 v[168:171], a[104:107], a[104:107], v[168:171]
  v_mfma_f32_16x16x32_bf16 v[164:167], a[108:111], v[4:7], v[164:167]
  v_mfma_f32_16x16x32_bf16 v[172:175], a[108:111], a[108:111], v[172:175]
  s_add_u32 s31, s31, 32768
  s_waitcnt vmcnt(20) lgkmcnt(0)
  v_mfma_f32_16x16x32_bf16 v[16:19], a[112:115], a[144:147], v[16:19]
  ds_read_b128 a[180:183], v252 offset:27648
  v_mfma_f32_16x16x32_bf16 v[20:23], a[116:119], a[144:147], v[20:23]
  ds_read_b128 a[184:187], v252 offset:28672
  s_add_u32 m0, s7, 80896
  v_mfma_f32_16x16x32_bf16 v[24:27], a[112:115], a[148:151], v[24:27]
  ds_read_b128 a[188:191], v252 offset:29696
  buffer_load_dwordx4 v1, s[8:11], s20 offen offset:0 sc1 lds
  v_mfma_f32_16x16x32_bf16 v[28:31], a[116:119], a[148:151], v[28:31]
  ds_read_b128 a[192:195], v252 offset:30720
  v_mfma_f32_16x16x32_bf16 v[32:35], a[112:115], a[152:155], v[32:35]
  ds_read_b128 a[196:199], v252 offset:31744
  v_mfma_f32_16x16x32_bf16 v[36:39], a[116:119], a[152:155], v[36:39]
  ds_read_b128 a[200:203], v252 offset:32768
  v_mfma_f32_16x16x32_bf16 v[40:43], a[112:115], a[156:159], v[40:43]
  ds_read_b128 a[204:207], v252 offset:33792
  v_mfma_f32_16x16x32_bf16 v[44:47], a[116:119], a[156:159], v[44:47]
  ds_read_b128 a[208:211], v252 offset:34816
  v_mfma_f32_16x16x32_bf16 v[48:51], a[112:115], a[160:163], v[48:51]
  ds_read_b128 a[212:215], v252 offset:35840
  buffer_load_dwordx4 v1, s[8:11], s20 offen offset:1024 sc1 lds
  v_mfma_f32_16x16x32_bf16 v[52:55], a[116:119], a[160:163], v[52:55]
  ds_read_b64 a[120:121], v13 offset:6144
  v_mfma_f32_16x16x32_bf16 v[56:59], a[112:115], a[164:167], v[56:59]
  ds_read_b64 a[122:123], v13 offset:6656
  v_mfma_f32_16x16x32_bf16 v[60:63], a[116:119], a[164:167], v[60:63]
  ds_read_b64 a[124:125], v13 offset:7168
  v_mfma_f32_16x16x32_bf16 v[64:67], a[112:115], a[168:171], v[64:67]
  ds_read_b64 a[126:127], v13 offset:7680
  v_mfma_f32_16x16x32_bf16 v[68:71], a[116:119], a[168:171], v[68:71]
  v_mfma_f32_16x16x32_bf16 v[72:75], a[112:115], a[172:175], v[72:75]
  s_add_u32 s20, s20, 29696
  v_mfma_f32_16x16x32_bf16 v[76:79], a[116:119], a[172:175], v[76:79]
  buffer_load_dwordx4 a[216:219], v10, s[16:19], s31 offen offset:2048
  v_mfma_f32_16x16x32_bf16 v[80:83], a[112:115], a[176:179], v[80:83]
  v_mfma_f32_16x16x32_bf16 v[84:87], a[116:119], a[176:179], v[84:87]
  v_mfma_f32_16x16x32_bf16 v[160:163], a[112:115], v[4:7], v[160:163]
  v_mfma_f32_16x16x32_bf16 v[168:171], a[112:115], a[112:115], v[168:171]
  v_mfma_f32_16x16x32_bf16 v[164:167], a[116:119], v[4:7], v[164:167]
  v_mfma_f32_16x16x32_bf16 v[172:175], a[116:119], a[116:119], v[172:175]
  s_add_u32 s31, s31, 32768
  s_waitcnt vmcnt(10) lgkmcnt(0)
  s_barrier
  v_mfma_f32_16x16x32_bf16 v[16:19], a[120:123], a[180:183], v[16:19]
  ds_read_b128 a[144:147], v253 offset:0
  v_mfma_f32_16x16x32_bf16 v[20:23], a[124:127], a[180:183], v[20:23]
  ds_read_b128 a[148:151], v253 offset:1024
  s_add_u32 m0, s7, 0
  v_mfma_f32_16x16x32_bf16 v[24:27], a[120:123], a[184:187], v[24:27]
  ds_read_b128 a[152:155], v253 offset:2048
  buffer_load_dwordx4 v1, s[8:11], s20 offen offset:0 sc1 lds
  v_mfma_f32_16x16x32_bf16 v[28:31], a[124:127], a[184:187], v[28:31]
  ds_read_b128 a[156:159], v253 offset:3072
  v_mfma_f32_16x16x32_bf16 v[32:35], a[120:123], a[188:191], v[32:35]
  ds_read_b128 a[160:163], v253 offset:4096
  v_mfma_f32_16x16x32_bf16 v[36:39], a[124:127], a[188:191], v[36:39]
  ds_read_b128 a[164:167], v253 offset:5120
  v_mfma_f32_16x16x32_bf16 v[40:43], a[120:123], a[192:195], v[40:43]
  ds_read_b128 a[168:171], v253 offset:6144
  v_mfma_f32_16x16x32_bf16 v[44:47], a[124:127], a[192:195], v[44:47]
  ds_read_b128 a[172:175], v253 offset:7168
  v_mfma_f32_16x16x32_bf16 v[48:51], a[120:123], a[196:199], v[48:51]
  ds_read_b128 a[176:179], v253 offset:8192
  buffer_load_dwordx4 v1, s[8:11], s20 offen offset:1024 sc1 lds
  v_mfma_f32_16x16x32_bf16 v[52:55], a[124:127], a[196:199], v[52:55]
  ds_read_b64 a[128:129], v13 offset:8192
  v_mfma_f32_16x16x32_bf16 v[56:59], a[120:123], a[200:203], v[56:59]
  ds_read_b64 a[130:131], v13 offset:8704
  v_mfma_f32_16x16x32_bf16 v[60:63], a[124:127], a[200:203], v[60:63]
  ds_read_b64 a[132:133], v13 offset:9216
  v_mfma_f32_16x16x32_bf16 v[64:67], a[120:123], a[204:207], v[64:67]
  ds_read_b64 a[134:135], v13 offset:9728
  v_mfma_f32_16x16x32_bf16 v[68:71], a[124:127], a[204:207], v[68:71]
  ds_read_b64 a[136:137], v13 offset:10240
  v_mfma_f32_16x16x32_bf16 v[72:75], a[120:123], a[208:211], v[72:75]
  ds_read_b64 a[138:139], v13 offset:10752
  v_mfma_f32_16x16x32_bf16 v[76:79], a[124:127], a[208:211], v[76:79]
  ds_read_b64 a[140:141], v13 offset:11264
  buffer_load_dwordx4 v1, s[8:11], s20 offen offset:2048 sc1 lds
  v_mfma_f32_16x16x32_bf16 v[80:83], a[120:123], a[212:215], v[80:83]
  ds_read_b64 a[142:143], v13 offset:11776
  v_mfma_f32_16x16x32_bf16 v[84:87], a[124:127], a[212:215], v[84:87]
  v_mfma_f32_16x16x32_bf16 v[160:163], a[120:123], v[4:7], v[160:163]
  v_mfma_f32_16x16x32_bf16 v[168:171], a[120:123], a[120:123], v[168:171]
  v_mfma_f32_16x16x32_bf16 v[164:167], a[124:127], v[4:7], v[164:167]
  v_mfma_f32_16x16x32_bf16 v[172:175], a[124:127], a[124:127], v[172:175]
  s_add_u32 s20, s20, 3072
  s_waitcnt lgkmcnt(0)
  v_mfma_f32_16x16x32_bf16 v[160:163], a[128:131], v[4:7], v[160:163]
  ds_read_b128 a[180:183], v253 offset:9216
  v_mfma_f32_16x16x32_bf16 v[168:171], a[128:131], a[128:131], v[168:171]
  ds_read_b128 a[184:187], v253 offset:10240
  s_add_u32 m0, s7, 3072
  v_mfma_f32_16x16x32_bf16 v[164:167], a[132:135], v[4:7], v[164:167]
  ds_read_b128 a[188:191], v253 offset:11264
  buffer_load_dwordx4 v1, s[8:11], s20 offen offset:0 sc1 lds
  v_mfma_f32_16x16x32_bf16 v[172:175], a[132:135], a[132:135], v[172:175]
  ds_read_b128 a[192:195], v253 offset:12288
  v_mfma_f32_16x16x32_bf16 v[160:163], a[136:139], v[4:7], v[160:163]
  ds_read_b128 a[196:199], v253 offset:13312
  v_mfma_f32_16x16x32_bf16 v[168:171], a[136:139], a[136:139], v[168:171]
  ds_read_b128 a[200:203], v253 offset:14336
  v_mfma_f32_16x16x32_bf16 v[164:167], a[140:143], v[4:7], v[164:167]
  ds_read_b128 a[204:207], v253 offset:15360
  v_mfma_f32_16x16x32_bf16 v[172:175], a[140:143], a[140:143], v[172:175]
  ds_read_b128 a[208:211], v253 offset:16384
  v_mfma_f32_16x16x32_bf16 v[16:19], a[128:131], a[144:147], v[16:19]
  ds_read_b128 a[212:215], v253 offset:17408
  v_mfma_f32_16x16x32_bf16 v[20:23], a[132:135], a[144:147], v[20:23]
  ds_bpermute_b32 v168, v11, v168 offset:0
  v_mfma_f32_16x16x32_bf16 v[24:27], a[128:131], a[148:151], v[24:27]
  ds_bpermute_b32 v169, v11, v169 offset:4
  v_mfma_f32_16x16x32_bf16 v[28:31], a[132:135], a[148:151], v[28:31]
  ds_bpermute_b32 v170, v11, v170 offset:8
  v_mfma_f32_16x16x32_bf16 v[32:35], a[128:131], a[152:155], v[32:35]
  ds_bpermute_b32 v171, v11, v171 offset:12
  v_mfma_f32_16x16x32_bf16 v[36:39], a[132:135], a[152:155], v[36:39]
  ds_bpermute_b32 v172, v11, v172 offset:0
  v_mfma_f32_16x16x32_bf16 v[40:43], a[128:131], a[156:159], v[40:43]
  ds_bpermute_b32 v173, v11, v173 offset:4
  buffer_load_dwordx4 v1, s[8:11], s20 offen offset:1024 sc1 lds
  v_mfma_f32_16x16x32_bf16 v[44:47], a[132:135], a[156:159], v[44:47]
  ds_bpermute_b32 v174, v11, v174 offset:8
  v_mfma_f32_16x16x32_bf16 v[48:51], a[128:131], a[160:163], v[48:51]
  ds_bpermute_b32 v175, v11, v175 offset:12
  v_mfma_f32_16x16x32_bf16 v[52:55], a[132:135], a[160:163], v[52:55]
  v_mfma_f32_16x16x32_bf16 v[56:59], a[128:131], a[164:167], v[56:59]
  v_mfma_f32_16x16x32_bf16 v[60:63], a[132:135], a[164:167], v[60:63]
  v_mfma_f32_16x16x32_bf16 v[64:67], a[128:131], a[168:171], v[64:67]
  v_mfma_f32_16x16x32_bf16 v[68:71], a[132:135], a[168:171], v[68:71]
  v_mfma_f32_16x16x32_bf16 v[72:75], a[128:131], a[172:175], v[72:75]
  v_mfma_f32_16x16x32_bf16 v[76:79], a[132:135], a[172:175], v[76:79]
  v_mfma_f32_16x16x32_bf16 v[80:83], a[128:131], a[176:179], v[80:83]
  v_mfma_f32_16x16x32_bf16 v[84:87], a[132:135], a[176:179], v[84:87]
  s_add_u32 s20, s20, 2048
  s_waitcnt vmcnt(17) lgkmcnt(0)
  v_mfma_f32_16x16x32_bf16 v[16:19], a[136:139], a[180:183], v[16:19]
  ds_read_b128 a[144:147], v253 offset:18432
  v_mul_f32 v160, 0x3ae38e39, v160
  v_mul_f32 v161, 0x3ae38e39, v161
  v_mul_f32 v162, 0x3ae38e39, v162
  v_mfma_f32_16x16x32_bf16 v[20:23], a[140:143], a[180:183], v[20:23]
  ds_read_b128 a[148:151], v253 offset:19456
  s_add_u32 m0, s7, 5120
  v_mul_f32 v163, 0x3ae38e39, v163
  v_mul_f32 v164, 0x3ae38e39, v164
  v_mfma_f32_16x16x32_bf16 v[24:27], a[136:139], a[184:187], v[24:27]
  ds_read_b128 a[152:155], v253 offset:20480
  buffer_load_dwordx4 v1, s[8:11], s20 offen offset:0 sc1 lds
  v_mul_f32 v165, 0x3ae38e39, v165
  v_mfma_f32_16x16x32_bf16 v[28:31], a[140:143], a[184:187], v[28:31]
  ds_read_b128 a[156:159], v253 offset:21504
  v_mul_f32 v166, 0x3ae38e39, v166
  v_mul_f32 v167, 0x3ae38e39, v167
  v_mul_f32 v168, 0x3ae38e39, v168
  v_mul_f32 v169, 0x3ae38e39, v169
  v_mfma_f32_16x16x32_bf16 v[32:35], a[136:139], a[188:191], v[32:35]
  ds_read_b128 a[160:163], v253 offset:22528
  v_mul_f32 v170, 0x3ae38e39, v170
  v_mul_f32 v171, 0x3ae38e39, v171
  v_mul_f32 v172, 0x3ae38e39, v172
  v_mul_f32 v173, 0x3ae38e39, v173
  v_mfma_f32_16x16x32_bf16 v[36:39], a[140:143], a[188:191], v[36:39]
  ds_read_b128 a[164:167], v253 offset:23552
  v_mul_f32 v174, 0x3ae38e39, v174
  v_mul_f32 v175, 0x3ae38e39, v175
  v_fma_f32 v168, -v160, v160, v168
  v_fma_f32 v169, -v161, v161, v169
  v_mfma_f32_16x16x32_bf16 v[40:43], a[136:139], a[192:195], v[40:43]
  ds_read_b128 a[168:171], v253 offset:24576
  v_fma_f32 v170, -v162, v162, v170
  v_fma_f32 v171, -v163, v163, v171
  v_fma_f32 v172, -v164, v164, v172
  v_fma_f32 v173, -v165, v165, v173
  v_mfma_f32_16x16x32_bf16 v[44:47], a[140:143], a[192:195], v[44:47]
  ds_read_b128 a[172:175], v253 offset:25600
  v_fma_f32 v174, -v166, v166, v174
  v_fma_f32 v175, -v167, v167, v175
  v_max_f32 v168, 0, v168
  v_max_f32 v169, 0, v169
  v_mfma_f32_16x16x32_bf16 v[48:51], a[136:139], a[196:199], v[48:51]
  ds_read_b128 a[176:179], v253 offset:26624
  v_max_f32 v170, 0, v170
  v_max_f32 v171, 0, v171
  v_max_f32 v172, 0, v172
  v_max_f32 v173, 0, v173
  v_mfma_f32_16x16x32_bf16 v[52:55], a[140:143], a[196:199], v[52:55]
  ds_read_b64 v[176:177], v9 offset:0
  v_max_f32 v174, 0, v174
  v_max_f32 v175, 0, v175
  v_add_f32 v168, 0x3727c5ac, v168
  v_add_f32 v169, 0x3727c5ac, v169
  v_mfma_f32_16x16x32_bf16 v[56:59], a[136:139], a[200:203], v[56:59]
  ds_read_b64 v[178:179], v9 offset:128
  buffer_load_dwordx4 v1, s[8:11], s20 offen offset:1024 sc1 lds
  v_add_f32 v170, 0x3727c5ac, v170
  v_add_f32 v171, 0x3727c5ac, v171
  v_mfma_f32_16x16x32_bf16 v[60:63], a[140:143], a[200:203], v[60:63]
  ds_read_b64 v[180:181], v9 offset:256
  v_add_f32 v172, 0x3727c5ac, v172
  v_add_f32 v173, 0x3727c5ac, v173
  v_add_f32 v174, 0x3727c5ac, v174
  v_add_f32 v175, 0x3727c5ac, v175
  v_mfma_f32_16x16x32_bf16 v[64:67], a[136:139], a[204:207], v[64:67]
  ds_read_b64 v[182:183], v9 offset:384
  v_rsq_f32 v168, v168
  v_rsq_f32 v169, v169
  v_mfma_f32_16x16x32_bf16 v[68:71], a[140:143], a[204:207], v[68:71]
  ds_read_b64 v[184:185], v9 offset:512
  v_rsq_f32 v170, v170
  v_rsq_f32 v171, v171
  v_mfma_f32_16x16x32_bf16 v[72:75], a[136:139], a[208:211], v[72:75]
  v_rsq_f32 v172, v172
  v_rsq_f32 v173, v173
  v_mfma_f32_16x16x32_bf16 v[76:79], a[140:143], a[208:211], v[76:79]
  v_rsq_f32 v174, v174
  v_rsq_f32 v175, v175
  s_nop 0
  v_mfma_f32_16x16x32_bf16 v[80:83], a[136:139], a[212:215], v[80:83]
  v_mul_f32 v160, -v160, v168
  v_mul_f32 v161, -v161, v169
  v_mul_f32 v162, -v162, v170
  v_mul_f32 v163, -v163, v171
  v_mul_f32 v164, -v164, v172
  v_mfma_f32_16x16x32_bf16 v[84:87], a[140:143], a[212:215], v[84:87]
  v_mul_f32 v165, -v165, v173
  v_mul_f32 v166, -v166, v174
  v_mul_f32 v167, -v167, v175
  s_add_u32 s20, s20, 2048
  s_waitcnt lgkmcnt(0)
  ds_read_b64 v[186:187], v9 offset:640
  ds_read_b64 v[188:189], v9 offset:768
  ds_read_b64 v[190:191], v9 offset:896
  ds_read_b64 v[192:193], v9 offset:1024
  s_nop 3
  v_mov_b32 v194, v177
  v_pk_fma_f32 v[212:213], v[160:161], v[176:177], v[194:195] op_sel_hi:[1,0,0]
  v_pk_fma_f32 v[214:215], v[162:163], v[176:177], v[194:195] op_sel_hi:[1,0,0]
  v_pk_fma_f32 v[216:217], v[164:165], v[176:177], v[194:195] op_sel_hi:[1,0,0]
  v_pk_fma_f32 v[218:219], v[166:167], v[176:177], v[194:195] op_sel_hi:[1,0,0]
  v_pk_fma_f32 v[16:17], v[16:17], v[168:169], v[212:213]
  v_pk_fma_f32 v[18:19], v[18:19], v[170:171], v[214:215]
  v_pk_fma_f32 v[20:21], v[20:21], v[172:173], v[216:217]
  v_pk_fma_f32 v[22:23], v[22:23], v[174:175], v[218:219]
  v_pk_mul_f32 v[212:213], v[16:17], v[16:17]
  v_pk_mul_f32 v[214:215], v[18:19], v[18:19]
  v_pk_mul_f32 v[216:217], v[20:21], v[20:21]
  v_pk_mul_f32 v[218:219], v[22:23], v[22:23]
  v_pk_fma_f32 v[212:213], v[212:213], s[40:41], v[14:15]
  v_pk_fma_f32 v[214:215], v[214:215], s[40:41], v[14:15]
  v_pk_fma_f32 v[216:217], v[216:217], s[40:41], v[14:15]
  v_pk_fma_f32 v[218:219], v[218:219], s[40:41], v[14:15]
  v_pk_mul_f32 v[212:213], v[212:213], v[16:17]
  v_pk_mul_f32 v[214:215], v[214:215], v[18:19]
  v_pk_mul_f32 v[216:217], v[216:217], v[20:21]
  v_pk_mul_f32 v[218:219], v[218:219], v[22:23]
  v_exp_f32 v212, v212
  v_exp_f32 v213, v213
  v_exp_f32 v214, v214
  v_exp_f32 v215, v215
  v_exp_f32 v216, v216
  v_exp_f32 v217, v217
  v_exp_f32 v218, v218
  v_exp_f32 v219, v219
  v_pk_add_f32 v[212:213], v[212:213], 1.0 op_sel_hi:[1,0]
  v_pk_add_f32 v[214:215], v[214:215], 1.0 op_sel_hi:[1,0]
  v_pk_add_f32 v[216:217], v[216:217], 1.0 op_sel_hi:[1,0]
  v_pk_add_f32 v[218:219], v[218:219], 1.0 op_sel_hi:[1,0]
  v_rcp_f32 v212, v212
  v_rcp_f32 v213, v213
  v_rcp_f32 v214, v214
  v_rcp_f32 v215, v215
  v_rcp_f32 v216, v216
  v_rcp_f32 v217, v217
  v_rcp_f32 v218, v218
  v_rcp_f32 v219, v219
  v_pk_mul_f32 v[16:17], v[16:17], v[212:213]
  v_pk_mul_f32 v[18:19], v[18:19], v[214:215]
  v_pk_mul_f32 v[20:21], v[20:21], v[216:217]
  v_pk_mul_f32 v[22:23], v[22:23], v[218:219]
  v_pk_mul_f32 v[204:205], v[16:17], v[16:17]
  v_pk_mul_f32 v[206:207], v[18:19], v[18:19]
  v_pk_mul_f32 v[208:209], v[20:21], v[20:21]
  v_pk_mul_f32 v[210:211], v[22:23], v[22:23]
  v_mov_b32 v194, v179
  v_pk_fma_f32 v[212:213], v[160:161], v[178:179], v[194:195] op_sel_hi:[1,0,0]
  v_pk_fma_f32 v[214:215], v[162:163], v[178:179], v[194:195] op_sel_hi:[1,0,0]
  v_pk_fma_f32 v[216:217], v[164:165], v[178:179], v[194:195] op_sel_hi:[1,0,0]
  v_pk_fma_f32 v[218:219], v[166:167], v[178:179], v[194:195] op_sel_hi:[1,0,0]
  v_pk_fma_f32 v[24:25], v[24:25], v[168:169], v[212:213]
  v_pk_fma_f32 v[26:27], v[26:27], v[170:171], v[214:215]
  v_pk_fma_f32 v[28:29], v[28:29], v[172:173], v[216:217]
  v_pk_fma_f32 v[30:31], v[30:31], v[174:175], v[218:219]
  v_pk_mul_f32 v[212:213], v[24:25], v[24:25]
  v_pk_mul_f32 v[214:215], v[26:27], v[26:27]
  v_pk_mul_f32 v[216:217], v[28:29], v[28:29]
  v_pk_mul_f32 v[218:219], v[30:31], v[30:31]
  v_pk_fma_f32 v[212:213], v[212:213], s[40:41], v[14:15]
  v_pk_fma_f32 v[214:215], v[214:215], s[40:41], v[14:15]
  v_pk_fma_f32 v[216:217], v[216:217], s[40:41], v[14:15]
  v_pk_fma_f32 v[218:219], v[218:219], s[40:41], v[14:15]
  v_pk_mul_f32 v[212:213], v[212:213], v[24:25]
  v_pk_mul_f32 v[214:215], v[214:215], v[26:27]
  v_pk_mul_f32 v[216:217], v[216:217], v[28:29]
  v_pk_mul_f32 v[218:219], v[218:219], v[30:31]
  v_exp_f32 v212, v212
  v_exp_f32 v213, v213
  v_exp_f32 v214, v214
  v_exp_f32 v215, v215
  v_exp_f32 v216, v216
  v_exp_f32 v217, v217
  v_exp_f32 v218, v218
  v_exp_f32 v219, v219
  v_pk_add_f32 v[212:213], v[212:213], 1.0 op_sel_hi:[1,0]
  v_pk_add_f32 v[214:215], v[214:215], 1.0 op_sel_hi:[1,0]
  v_pk_add_f32 v[216:217], v[216:217], 1.0 op_sel_hi:[1,0]
  v_pk_add_f32 v[218:219], v[218:219], 1.0 op_sel_hi:[1,0]
  v_rcp_f32 v212, v212
  v_rcp_f32 v213, v213
  v_rcp_f32 v214, v214
  v_rcp_f32 v215, v215
  v_rcp_f32 v216, v216
  v_rcp_f32 v217, v217
  v_rcp_f32 v218, v218
  v_rcp_f32 v219, v219
  v_pk_mul_f32 v[24:25], v[24:25], v[212:213]
  v_pk_mul_f32 v[26:27], v[26:27], v[214:215]
  v_pk_mul_f32 v[28:29], v[28:29], v[216:217]
  v_pk_mul_f32 v[30:31], v[30:31], v[218:219]
  v_pk_add_f32 v[196:197], v[24:25], v[16:17]
  v_pk_fma_f32 v[204:205], v[24:25], v[24:25], v[204:205]
  v_pk_add_f32 v[198:199], v[26:27], v[18:19]
  v_pk_fma_f32 v[206:207], v[26:27], v[26:27], v[206:207]
  v_pk_add_f32 v[200:201], v[28:29], v[20:21]
  v_pk_fma_f32 v[208:209], v[28:29], v[28:29], v[208:209]
  v_pk_add_f32 v[202:203], v[30:31], v[22:23]
  v_pk_fma_f32 v[210:211], v[30:31], v[30:31], v[210:211]
  v_mov_b32 v194, v181
  v_pk_fma_f32 v[212:213], v[160:161], v[180:181], v[194:195] op_sel_hi:[1,0,0]
  v_pk_fma_f32 v[214:215], v[162:163], v[180:181], v[194:195] op_sel_hi:[1,0,0]
  v_pk_fma_f32 v[216:217], v[164:165], v[180:181], v[194:195] op_sel_hi:[1,0,0]
  v_pk_fma_f32 v[218:219], v[166:167], v[180:181], v[194:195] op_sel_hi:[1,0,0]
  v_pk_fma_f32 v[32:33], v[32:33], v[168:169], v[212:213]
  v_pk_fma_f32 v[34:35], v[34:35], v[170:171], v[214:215]
  v_pk_fma_f32 v[36:37], v[36:37], v[172:173], v[216:217]
  v_pk_fma_f32 v[38:39], v[38:39], v[174:175], v[218:219]
  v_pk_mul_f32 v[212:213], v[32:33], v[32:33]
  v_pk_mul_f32 v[214:215], v[34:35], v[34:35]
  v_pk_mul_f32 v[216:217], v[36:37], v[36:37]
  v_pk_mul_f32 v[218:219], v[38:39], v[38:39]
  v_pk_fma_f32 v[212:213], v[212:213], s[40:41], v[14:15]
  v_pk_fma_f32 v[214:215], v[214:215], s[40:41], v[14:15]
  v_pk_fma_f32 v[216:217], v[216:217], s[40:41], v[14:15]
  v_pk_fma_f32 v[218:219], v[218:219], s[40:41], v[14:15]
  v_pk_mul_f32 v[212:213], v[212:213], v[32:33]
  v_pk_mul_f32 v[214:215], v[214:215], v[34:35]
  v_pk_mul_f32 v[216:217], v[216:217], v[36:37]
  v_pk_mul_f32 v[218:219], v[218:219], v[38:39]
  v_exp_f32 v212, v212
  v_exp_f32 v213, v213
  v_exp_f32 v214, v214
  v_exp_f32 v215, v215
  v_exp_f32 v216, v216
  v_exp_f32 v217, v217
  v_exp_f32 v218, v218
  v_exp_f32 v219, v219
  v_pk_add_f32 v[212:213], v[212:213], 1.0 op_sel_hi:[1,0]
  v_pk_add_f32 v[214:215], v[214:215], 1.0 op_sel_hi:[1,0]
  v_pk_add_f32 v[216:217], v[216:217], 1.0 op_sel_hi:[1,0]
  v_pk_add_f32 v[218:219], v[218:219], 1.0 op_sel_hi:[1,0]
  v_rcp_f32 v212, v212
  v_rcp_f32 v213, v213
  v_rcp_f32 v214, v214
  v_rcp_f32 v215, v215
  v_rcp_f32 v216, v216
  v_rcp_f32 v217, v217
  v_rcp_f32 v218, v218
  v_rcp_f32 v219, v219
  v_pk_mul_f32 v[32:33], v[32:33], v[212:213]
  v_pk_mul_f32 v[34:35], v[34:35], v[214:215]
  v_pk_mul_f32 v[36:37], v[36:37], v[216:217]
  v_pk_mul_f32 v[38:39], v[38:39], v[218:219]
  v_pk_add_f32 v[196:197], v[32:33], v[196:197]
  v_pk_fma_f32 v[204:205], v[32:33], v[32:33], v[204:205]
  v_pk_add_f32 v[198:199], v[34:35], v[198:199]
  v_pk_fma_f32 v[206:207], v[34:35], v[34:35], v[206:207]
  v_pk_add_f32 v[200:201], v[36:37], v[200:201]
  v_pk_fma_f32 v[208:209], v[36:37], v[36:37], v[208:209]
  v_pk_add_f32 v[202:203], v[38:39], v[202:203]
  v_pk_fma_f32 v[210:211], v[38:39], v[38:39], v[210:211]
  s_waitcnt lgkmcnt(0)
  v_mov_b32 v194, v183
  v_pk_fma_f32 v[212:213], v[160:161], v[182:183], v[194:195] op_sel_hi:[1,0,0]
  v_pk_fma_f32 v[214:215], v[162:163], v[182:183], v[194:195] op_sel_hi:[1,0,0]
  v_pk_fma_f32 v[216:217], v[164:165], v[182:183], v[194:195] op_sel_hi:[1,0,0]
  v_pk_fma_f32 v[218:219], v[166:167], v[182:183], v[194:195] op_sel_hi:[1,0,0]
  v_pk_fma_f32 v[40:41], v[40:41], v[168:169], v[212:213]
  v_pk_fma_f32 v[42:43], v[42:43], v[170:171], v[214:215]
  v_pk_fma_f32 v[44:45], v[44:45], v[172:173], v[216:217]
  v_pk_fma_f32 v[46:47], v[46:47], v[174:175], v[218:219]
  v_pk_mul_f32 v[212:213], v[40:41], v[40:41]
  v_pk_mul_f32 v[214:215], v[42:43], v[42:43]
  v_pk_mul_f32 v[216:217], v[44:45], v[44:45]
  v_pk_mul_f32 v[218:219], v[46:47], v[46:47]
  v_pk_fma_f32 v[212:213], v[212:213], s[40:41], v[14:15]
  v_pk_fma_f32 v[214:215], v[214:215], s[40:41], v[14:15]
  v_pk_fma_f32 v[216:217], v[216:217], s[40:41], v[14:15]
  v_pk_fma_f32 v[218:219], v[218:219], s[40:41], v[14:15]
  v_pk_mul_f32 v[212:213], v[212:213], v[40:41]
  v_pk_mul_f32 v[214:215], v[214:215], v[42:43]
  v_pk_mul_f32 v[216:217], v[216:217], v[44:45]
  v_pk_mul_f32 v[218:219], v[218:219], v[46:47]
  v_exp_f32 v212, v212
  v_exp_f32 v213, v213
  v_exp_f32 v214, v214
  v_exp_f32 v215, v215
  v_exp_f32 v216, v216
  v_exp_f32 v217, v217
  v_exp_f32 v218, v218
  v_exp_f32 v219, v219
  v_pk_add_f32 v[212:213], v[212:213], 1.0 op_sel_hi:[1,0]
  v_pk_add_f32 v[214:215], v[214:215], 1.0 op_sel_hi:[1,0]
  v_pk_add_f32 v[216:217], v[216:217], 1.0 op_sel_hi:[1,0]
  v_pk_add_f32 v[218:219], v[218:219], 1.0 op_sel_hi:[1,0]
  v_rcp_f32 v212, v212
  v_rcp_f32 v213, v213
  v_rcp_f32 v214, v214
  v_rcp_f32 v215, v215
  v_rcp_f32 v216, v216
  v_rcp_f32 v217, v217
  v_rcp_f32 v218, v218
  v_rcp_f32 v219, v219
  v_pk_mul_f32 v[40:41], v[40:41], v[212:213]
  v_pk_mul_f32 v[42:43], v[42:43], v[214:215]
  v_pk_mul_f32 v[44:45], v[44:45], v[216:217]
  v_pk_mul_f32 v[46:47], v[46:47], v[218:219]
  v_pk_add_f32 v[196:197], v[40:41], v[196:197]
  v_pk_fma_f32 v[204:205], v[40:41], v[40:41], v[204:205]
  v_pk_add_f32 v[198:199], v[42:43], v[198:199]
  v_pk_fma_f32 v[206:207], v[42:43], v[42:43], v[206:207]
  v_pk_add_f32 v[200:201], v[44:45], v[200:201]
  v_pk_fma_f32 v[208:209], v[44:45], v[44:45], v[208:209]
  v_pk_add_f32 v[202:203], v[46:47], v[202:203]
  v_pk_fma_f32 v[210:211], v[46:47], v[46:47], v[210:211]
  v_mov_b32 v194, v185
  v_pk_fma_f32 v[212:213], v[160:161], v[184:185], v[194:195] op_sel_hi:[1,0,0]
  v_pk_fma_f32 v[214:215], v[162:163], v[184:185], v[194:195] op_sel_hi:[1,0,0]
  v_pk_fma_f32 v[216:217], v[164:165], v[184:185], v[194:195] op_sel_hi:[1,0,0]
  v_pk_fma_f32 v[218:219], v[166:167], v[184:185], v[194:195] op_sel_hi:[1,0,0]
  v_pk_fma_f32 v[48:49], v[48:49], v[168:169], v[212:213]
  v_pk_fma_f32 v[50:51], v[50:51], v[170:171], v[214:215]
  v_pk_fma_f32 v[52:53], v[52:53], v[172:173], v[216:217]
  v_pk_fma_f32 v[54:55], v[54:55], v[174:175], v[218:219]
  v_pk_mul_f32 v[212:213], v[48:49], v[48:49]
  v_pk_mul_f32 v[214:215], v[50:51], v[50:51]
  v_pk_mul_f32 v[216:217], v[52:53], v[52:53]
  v_pk_mul_f32 v[218:219], v[54:55], v[54:55]
  v_pk_fma_f32 v[212:213], v[212:213], s[40:41], v[14:15]
  v_pk_fma_f32 v[214:215], v[214:215], s[40:41], v[14:15]
  v_pk_fma_f32 v[216:217], v[216:217], s[40:41], v[14:15]
  v_pk_fma_f32 v[218:219], v[218:219], s[40:41], v[14:15]
  v_pk_mul_f32 v[212:213], v[212:213], v[48:49]
  v_pk_mul_f32 v[214:215], v[214:215], v[50:51]
  v_pk_mul_f32 v[216:217], v[216:217], v[52:53]
  v_pk_mul_f32 v[218:219], v[218:219], v[54:55]
  v_exp_f32 v212, v212
  v_exp_f32 v213, v213
  v_exp_f32 v214, v214
  v_exp_f32 v215, v215
  v_exp_f32 v216, v216
  v_exp_f32 v217, v217
  v_exp_f32 v218, v218
  v_exp_f32 v219, v219
  v_pk_add_f32 v[212:213], v[212:213], 1.0 op_sel_hi:[1,0]
  v_pk_add_f32 v[214:215], v[214:215], 1.0 op_sel_hi:[1,0]
  v_pk_add_f32 v[216:217], v[216:217], 1.0 op_sel_hi:[1,0]
  v_pk_add_f32 v[218:219], v[218:219], 1.0 op_sel_hi:[1,0]
  v_rcp_f32 v212, v212
  v_rcp_f32 v213, v213
  v_rcp_f32 v214, v214
  v_rcp_f32 v215, v215
  v_rcp_f32 v216, v216
  v_rcp_f32 v217, v217
  v_rcp_f32 v218, v218
  v_rcp_f32 v219, v219
  v_pk_mul_f32 v[48:49], v[48:49], v[212:213]
  v_pk_mul_f32 v[50:51], v[50:51], v[214:215]
  v_pk_mul_f32 v[52:53], v[52:53], v[216:217]
  v_pk_mul_f32 v[54:55], v[54:55], v[218:219]
  v_pk_add_f32 v[196:197], v[48:49], v[196:197]
  v_pk_fma_f32 v[204:205], v[48:49], v[48:49], v[204:205]
  v_pk_add_f32 v[198:199], v[50:51], v[198:199]
  v_pk_fma_f32 v[206:207], v[50:51], v[50:51], v[206:207]
  v_pk_add_f32 v[200:201], v[52:53], v[200:201]
  v_pk_fma_f32 v[208:209], v[52:53], v[52:53], v[208:209]
  v_pk_add_f32 v[202:203], v[54:55], v[202:203]
  v_pk_fma_f32 v[210:211], v[54:55], v[54:55], v[210:211]
  v_mov_b32 v194, v187
  v_pk_fma_f32 v[212:213], v[160:161], v[186:187], v[194:195] op_sel_hi:[1,0,0]
  v_pk_fma_f32 v[214:215], v[162:163], v[186:187], v[194:195] op_sel_hi:[1,0,0]
  v_pk_fma_f32 v[216:217], v[164:165], v[186:187], v[194:195] op_sel_hi:[1,0,0]
  v_pk_fma_f32 v[218:219], v[166:167], v[186:187], v[194:195] op_sel_hi:[1,0,0]
  v_pk_fma_f32 v[56:57], v[56:57], v[168:169], v[212:213]
  v_pk_fma_f32 v[58:59], v[58:59], v[170:171], v[214:215]
  v_pk_fma_f32 v[60:61], v[60:61], v[172:173], v[216:217]
  v_pk_fma_f32 v[62:63], v[62:63], v[174:175], v[218:219]
  v_pk_mul_f32 v[212:213], v[56:57], v[56:57]
  v_pk_mul_f32 v[214:215], v[58:59], v[58:59]
  v_pk_mul_f32 v[216:217], v[60:61], v[60:61]
  v_pk_mul_f32 v[218:219], v[62:63], v[62:63]
  v_pk_fma_f32 v[212:213], v[212:213], s[40:41], v[14:15]
  v_pk_fma_f32 v[214:215], v[214:215], s[40:41], v[14:15]
  v_pk_fma_f32 v[216:217], v[216:217], s[40:41], v[14:15]
  v_pk_fma_f32 v[218:219], v[218:219], s[40:41], v[14:15]
  v_pk_mul_f32 v[212:213], v[212:213], v[56:57]
  v_pk_mul_f32 v[214:215], v[214:215], v[58:59]
  v_pk_mul_f32 v[216:217], v[216:217], v[60:61]
  v_pk_mul_f32 v[218:219], v[218:219], v[62:63]
  v_exp_f32 v212, v212
  v_exp_f32 v213, v213
  v_exp_f32 v214, v214
  v_exp_f32 v215, v215
  v_exp_f32 v216, v216
  v_exp_f32 v217, v217
  v_exp_f32 v218, v218
  v_exp_f32 v219, v219
  v_pk_add_f32 v[212:213], v[212:213], 1.0 op_sel_hi:[1,0]
  v_pk_add_f32 v[214:215], v[214:215], 1.0 op_sel_hi:[1,0]
  v_pk_add_f32 v[216:217], v[216:217], 1.0 op_sel_hi:[1,0]
  v_pk_add_f32 v[218:219], v[218:219], 1.0 op_sel_hi:[1,0]
  v_rcp_f32 v212, v212
  v_rcp_f32 v213, v213
  v_rcp_f32 v214, v214
  v_rcp_f32 v215, v215
  v_rcp_f32 v216, v216
  v_lshrrev_b32 v4, 3, v2
  v_lshrrev_b32 v249, 2, v4
  v_lshlrev_b32 v249, 3, v249
  v_and_b32 v250, 3, v4
  v_add_u32 v249, v249, v250
  v_lshlrev_b32 v249, 12, v249
  v_lshrrev_b32 v4, 1, v4
  v_and_b32 v250, 7, v2
  v_xor_b32 v4, v4, v250
  v_lshl_add_u32 v241, v4, 4, v249
  v_xor_b32 v4, 4, v4
  v_lshl_add_u32 v243, v4, 4, v249
  v_add_u32 v243, 64512, v243
  v_add_u32 v245, 14336, v241
  v_add_u32 v247, 14336, v243
  v_lshrrev_b32 v4, 1, v3
  v_xor_b32 v4, v4, v12
  v_lshlrev_b32 v4, 4, v4
  v_lshl_add_u32 v4, v3, 7, v4
  v_add_u32 v249, s7, v4
  v_xor_b32 v250, 64, v249
  v_add_u32 v4, s30, v4
  v_xor_b32 v8, 64, v4
  v_rcp_f32 v217, v217
  s_add_u32 m0, s30, 0
  v_rcp_f32 v218, v218
  v_rcp_f32 v219, v219
  v_pk_mul_f32 v[56:57], v[56:57], v[212:213]
  s_add_u32 s21, s29, 1792
  v_pk_mul_f32 v[58:59], v[58:59], v[214:215]
  v_pk_mul_f32 v[60:61], v[60:61], v[216:217]
  v_pk_mul_f32 v[62:63], v[62:63], v[218:219]
  buffer_load_dwordx4 v241, s[16:19], s21 offen offset:0 lds
  v_pk_add_f32 v[196:197], v[56:57], v[196:197]
  v_pk_fma_f32 v[204:205], v[56:57], v[56:57], v[204:205]
  v_pk_add_f32 v[198:199], v[58:59], v[198:199]
  v_pk_fma_f32 v[206:207], v[58:59], v[58:59], v[206:207]
  buffer_load_dwordx4 v243, s[16:19], s21 offen offset:1024 lds
  v_pk_add_f32 v[200:201], v[60:61], v[200:201]
  v_pk_fma_f32 v[208:209], v[60:61], v[60:61], v[208:209]
  v_pk_add_f32 v[202:203], v[62:63], v[202:203]
  buffer_load_dwordx4 v245, s[16:19], s21 offen offset:2048 lds
  v_pk_fma_f32 v[210:211], v[62:63], v[62:63], v[210:211]
  v_mov_b32 v194, v189
  v_pk_fma_f32 v[212:213], v[160:161], v[188:189], v[194:195] op_sel_hi:[1,0,0]
  buffer_load_dwordx4 v247, s[16:19], s21 offen offset:3072 lds
  v_pk_fma_f32 v[214:215], v[162:163], v[188:189], v[194:195] op_sel_hi:[1,0,0]
  v_pk_fma_f32 v[216:217], v[164:165], v[188:189], v[194:195] op_sel_hi:[1,0,0]
  v_pk_fma_f32 v[218:219], v[166:167], v[188:189], v[194:195] op_sel_hi:[1,0,0]
  v_pk_fma_f32 v[64:65], v[64:65], v[168:169], v[212:213]
  s_add_u32 m0, s30, 4096
  v_pk_fma_f32 v[66:67], v[66:67], v[170:171], v[214:215]
  v_pk_fma_f32 v[68:69], v[68:69], v[172:173], v[216:217]
  v_pk_fma_f32 v[70:71], v[70:71], v[174:175], v[218:219]
  s_add_u32 s21, s29, 1920
  v_pk_mul_f32 v[212:213], v[64:65], v[64:65]
  v_pk_mul_f32 v[214:215], v[66:67], v[66:67]
  v_pk_mul_f32 v[216:217], v[68:69], v[68:69]
  buffer_load_dwordx4 v241, s[16:19], s21 offen offset:0 lds
  v_pk_mul_f32 v[218:219], v[70:71], v[70:71]
  v_pk_fma_f32 v[212:213], v[212:213], s[40:41], v[14:15]
  v_pk_fma_f32 v[214:215], v[214:215], s[40:41], v[14:15]
  v_pk_fma_f32 v[216:217], v[216:217], s[40:41], v[14:15]
  buffer_load_dwordx4 v243, s[16:19], s21 offen offset:1024 lds
  v_pk_fma_f32 v[218:219], v[218:219], s[40:41], v[14:15]
  v_pk_mul_f32 v[212:213], v[212:213], v[64:65]
  v_pk_mul_f32 v[214:215], v[214:215], v[66:67]
  buffer_load_dwordx4 v245, s[16:19], s21 offen offset:2048 lds
  v_pk_mul_f32 v[216:217], v[216:217], v[68:69]
  v_pk_mul_f32 v[218:219], v[218:219], v[70:71]
  v_exp_f32 v212, v212
  buffer_load_dwordx4 v247, s[16:19], s21 offen offset:3072 lds
  v_exp_f32 v213, v213
  v_exp_f32 v214, v214
  v_exp_f32 v215, v215
  v_exp_f32 v216, v216
  s_add_u32 m0, s30, 8192
  v_exp_f32 v217, v217
  v_exp_f32 v218, v218
  v_exp_f32 v219, v219
  s_add_u32 s21, s29, 0
  v_pk_add_f32 v[212:213], v[212:213], 1.0 op_sel_hi:[1,0]
  v_pk_add_f32 v[214:215], v[214:215], 1.0 op_sel_hi:[1,0]
  v_pk_add_f32 v[216:217], v[216:217], 1.0 op_sel_hi:[1,0]
  buffer_load_dwordx4 v241, s[16:19], s21 offen offset:0 lds
  v_pk_add_f32 v[218:219], v[218:219], 1.0 op_sel_hi:[1,0]
  v_rcp_f32 v212, v212
  v_rcp_f32 v213, v213
  v_rcp_f32 v214, v214
  buffer_load_dwordx4 v243, s[16:19], s21 offen offset:1024 lds
  v_rcp_f32 v215, v215
  v_rcp_f32 v216, v216
  v_rcp_f32 v217, v217
  buffer_load_dwordx4 v245, s[16:19], s21 offen offset:2048 lds
  v_rcp_f32 v218, v218
  v_rcp_f32 v219, v219
  v_pk_mul_f32 v[64:65], v[64:65], v[212:213]
  buffer_load_dwordx4 v247, s[16:19], s21 offen offset:3072 lds
  v_pk_mul_f32 v[66:67], v[66:67], v[214:215]
  v_pk_mul_f32 v[68:69], v[68:69], v[216:217]
  v_pk_mul_f32 v[70:71], v[70:71], v[218:219]
  v_pk_add_f32 v[196:197], v[64:65], v[196:197]
  v_pk_fma_f32 v[204:205], v[64:65], v[64:65], v[204:205]
  v_pk_add_f32 v[198:199], v[66:67], v[198:199]
  v_pk_fma_f32 v[206:207], v[66:67], v[66:67], v[206:207]
  v_pk_add_f32 v[200:201], v[68:69], v[200:201]
  v_pk_fma_f32 v[208:209], v[68:69], v[68:69], v[208:209]
  v_pk_add_f32 v[202:203], v[70:71], v[202:203]
  v_pk_fma_f32 v[210:211], v[70:71], v[70:71], v[210:211]
  v_mov_b32 v194, v191
  v_pk_fma_f32 v[212:213], v[160:161], v[190:191], v[194:195] op_sel_hi:[1,0,0]
  v_pk_fma_f32 v[214:215], v[162:163], v[190:191], v[194:195] op_sel_hi:[1,0,0]
  v_pk_fma_f32 v[216:217], v[164:165], v[190:191], v[194:195] op_sel_hi:[1,0,0]
  v_pk_fma_f32 v[218:219], v[166:167], v[190:191], v[194:195] op_sel_hi:[1,0,0]
  v_pk_fma_f32 v[72:73], v[72:73], v[168:169], v[212:213]
  v_pk_fma_f32 v[74:75], v[74:75], v[170:171], v[214:215]
  v_pk_fma_f32 v[76:77], v[76:77], v[172:173], v[216:217]
  v_pk_fma_f32 v[78:79], v[78:79], v[174:175], v[218:219]
  v_pk_mul_f32 v[212:213], v[72:73], v[72:73]
  v_pk_mul_f32 v[214:215], v[74:75], v[74:75]
  v_pk_mul_f32 v[216:217], v[76:77], v[76:77]
  v_pk_mul_f32 v[218:219], v[78:79], v[78:79]
  v_pk_fma_f32 v[212:213], v[212:213], s[40:41], v[14:15]
  v_pk_fma_f32 v[214:215], v[214:215], s[40:41], v[14:15]
  v_pk_fma_f32 v[216:217], v[216:217], s[40:41], v[14:15]
  v_pk_fma_f32 v[218:219], v[218:219], s[40:41], v[14:15]
  v_pk_mul_f32 v[212:213], v[212:213], v[72:73]
  v_pk_mul_f32 v[214:215], v[214:215], v[74:75]
  v_pk_mul_f32 v[216:217], v[216:217], v[76:77]
  v_pk_mul_f32 v[218:219], v[218:219], v[78:79]
  v_exp_f32 v212, v212
  v_exp_f32 v213, v213
  v_exp_f32 v214, v214
  v_exp_f32 v215, v215
  v_exp_f32 v216, v216
  v_exp_f32 v217, v217
  v_exp_f32 v218, v218
  v_exp_f32 v219, v219
  v_pk_add_f32 v[212:213], v[212:213], 1.0 op_sel_hi:[1,0]
  v_pk_add_f32 v[214:215], v[214:215], 1.0 op_sel_hi:[1,0]
  v_pk_add_f32 v[216:217], v[216:217], 1.0 op_sel_hi:[1,0]
  v_pk_add_f32 v[218:219], v[218:219], 1.0 op_sel_hi:[1,0]
  v_rcp_f32 v212, v212
  v_rcp_f32 v213, v213
  v_rcp_f32 v214, v214
  v_rcp_f32 v215, v215
  v_rcp_f32 v216, v216
  v_rcp_f32 v217, v217
  v_rcp_f32 v218, v218
  v_rcp_f32 v219, v219
  v_pk_mul_f32 v[72:73], v[72:73], v[212:213]
  v_pk_mul_f32 v[74:75], v[74:75], v[214:215]
  v_pk_mul_f32 v[76:77], v[76:77], v[216:217]
  v_pk_mul_f32 v[78:79], v[78:79], v[218:219]
  v_pk_add_f32 v[196:197], v[72:73], v[196:197]
  v_pk_fma_f32 v[204:205], v[72:73], v[72:73], v[204:205]
  v_pk_add_f32 v[198:199], v[74:75], v[198:199]
  v_pk_fma_f32 v[206:207], v[74:75], v[74:75], v[206:207]
  v_pk_add_f32 v[200:201], v[76:77], v[200:201]
  v_pk_fma_f32 v[208:209], v[76:77], v[76:77], v[208:209]
  v_pk_add_f32 v[202:203], v[78:79], v[202:203]
  v_pk_fma_f32 v[210:211], v[78:79], v[78:79], v[210:211]
  v_mov_b32 v194, v193
  v_pk_fma_f32 v[212:213], v[160:161], v[192:193], v[194:195] op_sel_hi:[1,0,0]
  v_pk_fma_f32 v[214:215], v[162:163], v[192:193], v[194:195] op_sel_hi:[1,0,0]
  v_pk_fma_f32 v[216:217], v[164:165], v[192:193], v[194:195] op_sel_hi:[1,0,0]
  v_pk_fma_f32 v[218:219], v[166:167], v[192:193], v[194:195] op_sel_hi:[1,0,0]
  v_pk_fma_f32 v[80:81], v[80:81], v[168:169], v[212:213]
  v_pk_fma_f32 v[82:83], v[82:83], v[170:171], v[214:215]
  v_pk_fma_f32 v[84:85], v[84:85], v[172:173], v[216:217]
  v_pk_fma_f32 v[86:87], v[86:87], v[174:175], v[218:219]
  v_pk_mul_f32 v[212:213], v[80:81], v[80:81]
  v_pk_mul_f32 v[214:215], v[82:83], v[82:83]
  v_pk_mul_f32 v[216:217], v[84:85], v[84:85]
  v_pk_mul_f32 v[218:219], v[86:87], v[86:87]
  v_pk_fma_f32 v[212:213], v[212:213], s[40:41], v[14:15]
  v_pk_fma_f32 v[214:215], v[214:215], s[40:41], v[14:15]
  v_pk_fma_f32 v[216:217], v[216:217], s[40:41], v[14:15]
  v_pk_fma_f32 v[218:219], v[218:219], s[40:41], v[14:15]
  v_pk_mul_f32 v[212:213], v[212:213], v[80:81]
  v_pk_mul_f32 v[214:215], v[214:215], v[82:83]
  s_waitcnt vmcnt(4)
  ds_read_b128 a[224:227], v4 offset:0
  ds_read_b128 a[228:231], v4 offset:2048
  ds_read_b128 a[232:235], v8 offset:0
  ds_read_b128 a[236:239], v8 offset:2048
  ds_read_b128 a[240:243], v4 offset:4096
  ds_read_b128 a[244:247], v4 offset:6144
  ds_read_b128 a[248:251], v8 offset:4096
  ds_read_b128 a[252:255], v8 offset:6144
  v_pk_mul_f32 v[216:217], v[216:217], v[84:85]
  v_pk_mul_f32 v[218:219], v[218:219], v[86:87]
  v_exp_f32 v212, v212
  v_exp_f32 v213, v213
  v_exp_f32 v214, v214
  v_exp_f32 v215, v215
  v_exp_f32 v216, v216
  v_exp_f32 v217, v217
  v_exp_f32 v218, v218
  v_exp_f32 v219, v219
  v_pk_add_f32 v[212:213], v[212:213], 1.0 op_sel_hi:[1,0]
  v_pk_add_f32 v[214:215], v[214:215], 1.0 op_sel_hi:[1,0]
  v_pk_add_f32 v[216:217], v[216:217], 1.0 op_sel_hi:[1,0]
  v_pk_add_f32 v[218:219], v[218:219], 1.0 op_sel_hi:[1,0]
  v_rcp_f32 v212, v212
  v_rcp_f32 v213, v213
  v_rcp_f32 v214, v214
  v_rcp_f32 v215, v215
  v_rcp_f32 v216, v216
  v_rcp_f32 v217, v217
  v_rcp_f32 v218, v218
  v_rcp_f32 v219, v219
  v_pk_mul_f32 v[80:81], v[80:81], v[212:213]
  v_pk_mul_f32 v[82:83], v[82:83], v[214:215]
  v_pk_mul_f32 v[84:85], v[84:85], v[216:217]
  v_pk_mul_f32 v[86:87], v[86:87], v[218:219]
  v_pk_add_f32 v[196:197], v[80:81], v[196:197]
  v_pk_fma_f32 v[204:205], v[80:81], v[80:81], v[204:205]
  v_pk_add_f32 v[198:199], v[82:83], v[198:199]
  v_pk_fma_f32 v[206:207], v[82:83], v[82:83], v[206:207]
  s_waitcnt lgkmcnt(0)
  v_pk_add_f32 v[200:201], v[84:85], v[200:201]
  s_add_u32 m0, s30, 0
  s_add_u32 s21, s29, 128
  buffer_load_dwordx4 v241, s[16:19], s21 offen offset:0 lds
  v_pk_fma_f32 v[208:209], v[84:85], v[84:85], v[208:209]
  buffer_load_dwordx4 v243, s[16:19], s21 offen offset:1024 lds
  buffer_load_dwordx4 v245, s[16:19], s21 offen offset:2048 lds
  buffer_load_dwordx4 v247, s[16:19], s21 offen offset:3072 lds
  v_pk_add_f32 v[202:203], v[86:87], v[202:203]
  s_add_u32 m0, s30, 4096
  s_add_u32 s21, s29, 256
  buffer_load_dwordx4 v241, s[16:19], s21 offen offset:0 lds
  v_pk_fma_f32 v[210:211], v[86:87], v[86:87], v[210:211]
  buffer_load_dwordx4 v243, s[16:19], s21 offen offset:1024 lds
  buffer_load_dwordx4 v245, s[16:19], s21 offen offset:2048 lds
  buffer_load_dwordx4 v247, s[16:19], s21 offen offset:3072 lds
  v_and_b32 v11, 3, v3
  v_cmp_eq_u32 vcc, 0, v11
  v_add_f32_dpp v212, v196, v196 row_ror:8 row_mask:0xf bank_mask:0x3
  v_add_f32_dpp v212, v200, v200 row_ror:8 row_mask:0xf bank_mask:0xc
  v_add_f32_dpp v213, v204, v204 row_ror:8 row_mask:0xf bank_mask:0x3
  v_add_f32_dpp v213, v208, v208 row_ror:8 row_mask:0xf bank_mask:0xc
  v_add_f32_dpp v214, v197, v197 row_ror:8 row_mask:0xf bank_mask:0x3
  v_add_f32_dpp v214, v201, v201 row_ror:8 row_mask:0xf bank_mask:0xc
  v_add_f32_dpp v215, v205, v205 row_ror:8 row_mask:0xf bank_mask:0x3
  v_add_f32_dpp v215, v209, v209 row_ror:8 row_mask:0xf bank_mask:0xc
  v_add_f32_dpp v216, v198, v198 row_ror:8 row_mask:0xf bank_mask:0x3
  v_add_f32_dpp v216, v202, v202 row_ror:8 row_mask:0xf bank_mask:0xc
  v_add_f32_dpp v217, v206, v206 row_ror:8 row_mask:0xf bank_mask:0x3
  v_add_f32_dpp v217, v210, v210 row_ror:8 row_mask:0xf bank_mask:0xc
  v_add_f32_dpp v218, v199, v199 row_ror:8 row_mask:0xf bank_mask:0x3
  v_add_f32_dpp v218, v203, v203 row_ror:8 row_mask:0xf bank_mask:0xc
  v_add_f32_dpp v219, v207, v207 row_ror:8 row_mask:0xf bank_mask:0x3
  v_add_f32_dpp v219, v211, v211 row_ror:8 row_mask:0xf bank_mask:0xc
  v_add_f32_dpp v220, v212, v212 row_shl:4 row_mask:0xf bank_mask:0x5
  v_add_f32_dpp v221, v213, v213 row_shl:4 row_mask:0xf bank_mask:0x5
  v_add_f32_dpp v222, v214, v214 row_shl:4 row_mask:0xf bank_mask:0x5
  v_add_f32_dpp v223, v215, v215 row_shl:4 row_mask:0xf bank_mask:0x5
  v_add_f32_dpp v220, v216, v216 row_shr:4 row_mask:0xf bank_mask:0xa
  v_add_f32_dpp v221, v217, v217 row_shr:4 row_mask:0xf bank_mask:0xa
  v_add_f32_dpp v222, v218, v218 row_shr:4 row_mask:0xf bank_mask:0xa
  v_add_f32_dpp v223, v219, v219 row_shr:4 row_mask:0xf bank_mask:0xa
  v_add_f32_dpp v220, v220, v220 quad_perm:[1,0,3,2] row_mask:0xf bank_mask:0xf
  v_add_f32_dpp v221, v221, v221 quad_perm:[1,0,3,2] row_mask:0xf bank_mask:0xf
  v_add_f32_dpp v222, v222, v222 quad_perm:[1,0,3,2] row_mask:0xf bank_mask:0xf
  v_add_f32_dpp v223, v223, v223 quad_perm:[1,0,3,2] row_mask:0xf bank_mask:0xf
  v_add_f32_dpp v220, v220, v220 quad_perm:[2,3,0,1] row_mask:0xf bank_mask:0xf
  v_add_f32_dpp v221, v221, v221 quad_perm:[2,3,0,1] row_mask:0xf bank_mask:0xf
  v_add_f32_dpp v222, v222, v222 quad_perm:[2,3,0,1] row_mask:0xf bank_mask:0xf
  v_add_f32_dpp v223, v223, v223 quad_perm:[2,3,0,1] row_mask:0xf bank_mask:0xf
  v_or_b32 v221, 1, v221
  v_or_b32 v223, 1, v223
  s_lshl_b32 s23, s6, 12
  s_add_u32 s23, s23, 4849664
  s_lshl_b32 s24, s5, 8
  s_add_u32 s24, s24, s23
  v_lshlrev_b32 v10, 2, v2
  v_mov_b32 v194, 2147483392
  v_cndmask_b32 v10, v194, v10, vcc
  v_lshlrev_b32 v9, 4, v12
  v_add_u32 v9, 161792, v9
  buffer_store_dwordx4 v[220:223], v10, s[8:11], s24 offen sc1
  s_waitcnt lgkmcnt(0)
  v_mfma_f32_16x16x32_bf16 v[88:91], a[144:147], a[0:3], 0
  ds_read_b128 a[180:183], v253 offset:27648
  v_lshlrev_b32 v5, 1, v248
  v_mfma_f32_16x16x32_bf16 v[92:95], a[144:147], a[4:7], 0
  ds_read_b128 a[184:187], v253 offset:28672
  s_add_u32 m0, s7, 7168
  v_mfma_f32_16x16x32_bf16 v[96:99], a[148:151], a[0:3], 0
  ds_read_b128 a[188:191], v253 offset:29696
  buffer_load_dwordx4 v1, s[8:11], s20 offen offset:0 sc1 lds
  v_mfma_f32_16x16x32_bf16 v[100:103], a[148:151], a[4:7], 0
  ds_read_b128 a[192:195], v253 offset:30720
  s_lshl_b32 s26, s6, 6
  v_mfma_f32_16x16x32_bf16 v[104:107], a[152:155], a[0:3], 0
  ds_read_b128 a[196:199], v253 offset:31744
  v_mfma_f32_16x16x32_bf16 v[108:111], a[152:155], a[4:7], 0
  ds_read_b128 a[200:203], v253 offset:32768
  v_mfma_f32_16x16x32_bf16 v[112:115], a[156:159], a[0:3], 0
  ds_read_b128 a[204:207], v253 offset:33792
  v_mfma_f32_16x16x32_bf16 v[116:119], a[156:159], a[4:7], 0
  ds_read_b128 a[208:211], v253 offset:34816
  v_mfma_f32_16x16x32_bf16 v[120:123], a[160:163], a[0:3], 0
  ds_read_b128 a[212:215], v253 offset:35840
  v_mfma_f32_16x16x32_bf16 v[124:127], a[160:163], a[4:7], 0
  buffer_load_ushort v6, v5, s[36:39], s26 offen
  v_mfma_f32_16x16x32_bf16 v[128:131], a[164:167], a[0:3], 0
  buffer_load_dwordx4 v1, s[8:11], s20 offen offset:1024 sc1 lds
  v_mfma_f32_16x16x32_bf16 v[132:135], a[164:167], a[4:7], 0
  buffer_load_ushort v7, v5, s[36:39], s26 offen offset:8
  v_mfma_f32_16x16x32_bf16 v[136:139], a[168:171], a[0:3], 0
  v_mfma_f32_16x16x32_bf16 v[140:143], a[168:171], a[4:7], 0
  v_mfma_f32_16x16x32_bf16 v[144:147], a[172:175], a[0:3], 0
  v_mfma_f32_16x16x32_bf16 v[148:151], a[172:175], a[4:7], 0
  v_mfma_f32_16x16x32_bf16 v[152:155], a[176:179], a[0:3], 0
  v_mfma_f32_16x16x32_bf16 v[156:159], a[176:179], a[4:7], 0
  s_add_u32 s20, s20, 29696
  s_waitcnt vmcnt(33) lgkmcnt(0)
  s_barrier
  v_mfma_f32_16x16x32_bf16 v[88:91], a[180:183], a[8:11], v[88:91]
  ds_read_b128 a[144:147], v254 offset:0
  v_mfma_f32_16x16x32_bf16 v[92:95], a[180:183], a[12:15], v[92:95]
  ds_read_b128 a[148:151], v254 offset:1024
  v_mfma_f32_16x16x32_bf16 v[96:99], a[184:187], a[8:11], v[96:99]
  ds_read_b128 a[152:155], v254 offset:2048
  buffer_load_dword v15, v255, s[32:35], 0 offen
  v_mfma_f32_16x16x32_bf16 v[100:103], a[184:187], a[12:15], v[100:103]
  ds_read_b128 a[156:159], v254 offset:3072
  v_mfma_f32_16x16x32_bf16 v[104:107], a[188:191], a[8:11], v[104:107]
  ds_read_b128 a[160:163], v254 offset:4096
  v_mfma_f32_16x16x32_bf16 v[108:111], a[188:191], a[12:15], v[108:111]
  ds_read_b128 a[164:167], v254 offset:5120
  s_add_u32 m0, s7, 36864
  v_mfma_f32_16x16x32_bf16 v[112:115], a[192:195], a[8:11], v[112:115]
  ds_read_b128 a[168:171], v254 offset:6144
  buffer_load_dwordx4 v1, s[8:11], s20 offen offset:0 sc1 lds
  v_mfma_f32_16x16x32_bf16 v[116:119], a[192:195], a[12:15], v[116:119]
  ds_read_b128 a[172:175], v254 offset:7168
  v_mfma_f32_16x16x32_bf16 v[120:123], a[196:199], a[8:11], v[120:123]
  ds_read_b128 a[176:179], v254 offset:8192
  v_mfma_f32_16x16x32_bf16 v[124:127], a[196:199], a[12:15], v[124:127]
  v_mfma_f32_16x16x32_bf16 v[128:131], a[200:203], a[8:11], v[128:131]
  buffer_load_dwordx4 v1, s[8:11], s20 offen offset:1024 sc1 lds
  v_mfma_f32_16x16x32_bf16 v[132:135], a[200:203], a[12:15], v[132:135]
  v_mfma_f32_16x16x32_bf16 v[136:139], a[204:207], a[8:11], v[136:139]
  v_mfma_f32_16x16x32_bf16 v[140:143], a[204:207], a[12:15], v[140:143]
  v_mfma_f32_16x16x32_bf16 v[144:147], a[208:211], a[8:11], v[144:147]
  buffer_load_dwordx4 v1, s[8:11], s20 offen offset:2048 sc1 lds
  v_mfma_f32_16x16x32_bf16 v[148:151], a[208:211], a[12:15], v[148:151]
  v_mfma_f32_16x16x32_bf16 v[152:155], a[212:215], a[8:11], v[152:155]
  v_mfma_f32_16x16x32_bf16 v[156:159], a[212:215], a[12:15], v[156:159]
  s_add_u32 s20, s20, 3072
  s_waitcnt vmcnt(17) lgkmcnt(0)
  v_mfma_f32_16x16x32_bf16 v[88:91], a[144:147], a[16:19], v[88:91]
  ds_read_b128 a[180:183], v254 offset:9216
  v_and_b32 v210, 3, v3
  v_mfma_f32_16x16x32_bf16 v[92:95], a[144:147], a[20:23], v[92:95]
  ds_read_b128 a[184:187], v254 offset:10240
  s_add_u32 m0, s7, 39936
  v_mfma_f32_16x16x32_bf16 v[96:99], a[148:151], a[16:19], v[96:99]
  ds_read_b128 a[188:191], v254 offset:11264
  buffer_load_dwordx4 v1, s[8:11], s20 offen offset:0 sc1 lds
  v_mfma_f32_16x16x32_bf16 v[100:103], a[148:151], a[20:23], v[100:103]
  ds_read_b128 a[192:195], v254 offset:12288
  v_lshrrev_b32 v211, 2, v3
  v_mfma_f32_16x16x32_bf16 v[104:107], a[152:155], a[16:19], v[104:107]
  ds_read_b128 a[196:199], v254 offset:13312
  v_lshl_add_u32 v211, v211, 4, v3
  v_mfma_f32_16x16x32_bf16 v[108:111], a[152:155], a[20:23], v[108:111]
  ds_read_b128 a[200:203], v254 offset:14336
  v_lshlrev_b32 v211, 2, v211
  v_mfma_f32_16x16x32_bf16 v[112:115], a[156:159], a[16:19], v[112:115]
  ds_read_b128 a[204:207], v254 offset:15360
  v_mov_b32 v240, v168
  v_mfma_f32_16x16x32_bf16 v[116:119], a[156:159], a[20:23], v[116:119]
  ds_read_b128 a[208:211], v254 offset:16384
  v_mov_b32 v242, v160
  v_mfma_f32_16x16x32_bf16 v[120:123], a[160:163], a[16:19], v[120:123]
  ds_read_b128 a[212:215], v254 offset:17408
  v_mov_b32 v244, v172
  v_mfma_f32_16x16x32_bf16 v[124:127], a[160:163], a[20:23], v[124:127]
  ds_read_b128 a[0:3], v4 offset:8192
  v_mov_b32 v246, v164
  v_mfma_f32_16x16x32_bf16 v[128:131], a[164:167], a[16:19], v[128:131]
  ds_read_b128 a[4:7], v4 offset:10240
  buffer_load_dwordx4 v1, s[8:11], s20 offen offset:1024 sc1 lds
  v_mfma_f32_16x16x32_bf16 v[132:135], a[164:167], a[20:23], v[132:135]
  ds_read_b128 a[8:11], v8 offset:8192
  v_cmp_eq_u32 vcc, 1, v210
  v_mfma_f32_16x16x32_bf16 v[136:139], a[168:171], a[16:19], v[136:139]
  ds_read_b128 a[12:15], v8 offset:10240
  s_nop 1
  v_cndmask_b32 v240, v240, v169, vcc
  v_mfma_f32_16x16x32_bf16 v[140:143], a[168:171], a[20:23], v[140:143]
  v_cndmask_b32 v242, v242, v161, vcc
  v_cndmask_b32 v244, v244, v173, vcc
  v_cndmask_b32 v246, v246, v165, vcc
  v_mfma_f32_16x16x32_bf16 v[144:147], a[172:175], a[16:19], v[144:147]
  v_cmp_eq_u32 vcc, 2, v210
  s_nop 1
  v_cndmask_b32 v240, v240, v170, vcc
  v_mfma_f32_16x16x32_bf16 v[148:151], a[172:175], a[20:23], v[148:151]
  v_cndmask_b32 v242, v242, v162, vcc
  v_cndmask_b32 v244, v244, v174, vcc
  v_cndmask_b32 v246, v246, v166, vcc
  v_mfma_f32_16x16x32_bf16 v[152:155], a[176:179], a[16:19], v[152:155]
  v_cmp_eq_u32 vcc, 3, v210
  s_nop 1
  v_cndmask_b32 v240, v240, v171, vcc
  v_mfma_f32_16x16x32_bf16 v[156:159], a[176:179], a[20:23], v[156:159]
  v_cndmask_b32 v242, v242, v163, vcc
  v_cndmask_b32 v244, v244, v175, vcc
  v_cndmask_b32 v246, v246, v167, vcc
  s_add_u32 s20, s20, 2048
  s_waitcnt lgkmcnt(0)
  v_mfma_f32_16x16x32_bf16 v[88:91], a[180:183], a[24:27], v[88:91]
  ds_read_b128 a[144:147], v254 offset:18432
  v_mfma_f32_16x16x32_bf16 v[92:95], a[180:183], a[28:31], v[92:95]
  ds_read_b128 a[148:151], v254 offset:19456
  s_add_u32 m0, s7, 41984
  v_mfma_f32_16x16x32_bf16 v[96:99], a[184:187], a[24:27], v[96:99]
  ds_read_b128 a[152:155], v254 offset:20480
  buffer_load_dwordx4 v1, s[8:11], s20 offen offset:0 sc1 lds
  v_mfma_f32_16x16x32_bf16 v[100:103], a[184:187], a[28:31], v[100:103]
  ds_read_b128 a[156:159], v254 offset:21504
  buffer_load_dwordx4 v1, s[8:11], s20 offen offset:1024 sc1 lds
  v_mfma_f32_16x16x32_bf16 v[104:107], a[188:191], a[24:27], v[104:107]
  ds_read_b128 a[160:163], v254 offset:22528
  s_add_u32 s20, s20, 2048
  v_mfma_f32_16x16x32_bf16 v[108:111], a[188:191], a[28:31], v[108:111]
  ds_read_b128 a[164:167], v254 offset:23552
  buffer_load_dwordx4 v[176:179], v1, s[8:11], s23 offen offset:0 sc1
  v_mfma_f32_16x16x32_bf16 v[112:115], a[192:195], a[24:27], v[112:115]
  ds_read_b128 a[168:171], v254 offset:24576
  buffer_load_dwordx4 v[180:183], v1, s[8:11], s23 offen offset:1024 sc1
  v_mfma_f32_16x16x32_bf16 v[116:119], a[192:195], a[28:31], v[116:119]
  ds_read_b128 a[172:175], v254 offset:25600
  v_mfma_f32_16x16x32_bf16 v[120:123], a[196:199], a[24:27], v[120:123]
  ds_read_b128 a[176:179], v254 offset:26624
  buffer_load_dwordx4 v[184:187], v1, s[8:11], s23 offen offset:2048 sc1
  v_mfma_f32_16x16x32_bf16 v[124:127], a[196:199], a[28:31], v[124:127]
  ds_bpermute_b32 v240, v211, v240
  v_mfma_f32_16x16x32_bf16 v[128:131], a[200:203], a[24:27], v[128:131]
  ds_bpermute_b32 v244, v211, v244
  buffer_load_dwordx4 v[188:191], v1, s[8:11], s23 offen offset:3072 sc1
  s_add_u32 m0, s30, 8192
  s_add_u32 s21, s29, 384
  v_mfma_f32_16x16x32_bf16 v[132:135], a[200:203], a[28:31], v[132:135]
  ds_bpermute_b32 v242, v211, v242
  buffer_load_dwordx4 v241, s[16:19], s21 offen offset:0 lds
  v_mfma_f32_16x16x32_bf16 v[136:139], a[204:207], a[24:27], v[136:139]
  ds_bpermute_b32 v246, v211, v246
  v_mfma_f32_16x16x32_bf16 v[140:143], a[204:207], a[28:31], v[140:143]
  buffer_load_dwordx4 v243, s[16:19], s21 offen offset:1024 lds
  v_mfma_f32_16x16x32_bf16 v[144:147], a[208:211], a[24:27], v[144:147]
  buffer_load_dwordx4 v245, s[16:19], s21 offen offset:2048 lds
  v_mfma_f32_16x16x32_bf16 v[148:151], a[208:211], a[28:31], v[148:151]
  v_mfma_f32_16x16x32_bf16 v[152:155], a[212:215], a[24:27], v[152:155]
  buffer_load_dwordx4 v247, s[16:19], s21 offen offset:3072 lds
  v_mfma_f32_16x16x32_bf16 v[156:159], a[212:215], a[28:31], v[156:159]
  s_waitcnt vmcnt(25) lgkmcnt(0)
  v_mfma_f32_16x16x32_bf16 v[88:91], a[144:147], a[32:35], v[88:91]
  ds_read_b128 a[180:183], v254 offset:27648
  v_mfma_f32_16x16x32_bf16 v[92:95], a[144:147], a[36:39], v[92:95]
  ds_read_b128 a[184:187], v254 offset:28672
  s_add_u32 m0, s7, 44032
  v_mfma_f32_16x16x32_bf16 v[96:99], a[148:151], a[32:35], v[96:99]
  ds_read_b128 a[188:191], v254 offset:29696
  buffer_load_dwordx4 v1, s[8:11], s20 offen offset:0 sc1 lds
  v_mfma_f32_16x16x32_bf16 v[100:103], a[148:151], a[36:39], v[100:103]
  ds_read_b128 a[192:195], v254 offset:30720
  v_mfma_f32_16x16x32_bf16 v[104:107], a[152:155], a[32:35], v[104:107]
  ds_read_b128 a[196:199], v254 offset:31744
  v_mfma_f32_16x16x32_bf16 v[108:111], a[152:155], a[36:39], v[108:111]
  ds_read_b128 a[200:203], v254 offset:32768
  v_mfma_f32_16x16x32_bf16 v[112:115], a[156:159], a[32:35], v[112:115]
  ds_read_b128 a[204:207], v254 offset:33792
  v_mfma_f32_16x16x32_bf16 v[116:119], a[156:159], a[36:39], v[116:119]
  ds_read_b128 a[208:211], v254 offset:34816
  v_mfma_f32_16x16x32_bf16 v[120:123], a[160:163], a[32:35], v[120:123]
  ds_read_b128 a[212:215], v254 offset:35840
  v_mfma_f32_16x16x32_bf16 v[124:127], a[160:163], a[36:39], v[124:127]
  ds_read_b128 a[16:19], v4 offset:0
  v_mfma_f32_16x16x32_bf16 v[128:131], a[164:167], a[32:35], v[128:131]
  ds_read_b128 a[20:23], v4 offset:2048
  buffer_load_dwordx4 v1, s[8:11], s20 offen offset:1024 sc1 lds
  v_mfma_f32_16x16x32_bf16 v[132:135], a[164:167], a[36:39], v[132:135]
  ds_read_b128 a[24:27], v8 offset:0
  v_mfma_f32_16x16x32_bf16 v[136:139], a[168:171], a[32:35], v[136:139]
  ds_read_b128 a[28:31], v8 offset:2048
  v_mfma_f32_16x16x32_bf16 v[140:143], a[168:171], a[36:39], v[140:143]
  v_mfma_f32_16x16x32_bf16 v[144:147], a[172:175], a[32:35], v[144:147]
  v_mfma_f32_16x16x32_bf16 v[148:151], a[172:175], a[36:39], v[148:151]
  v_mfma_f32_16x16x32_bf16 v[152:155], a[176:179], a[32:35], v[152:155]
  v_mfma_f32_16x16x32_bf16 v[156:159], a[176:179], a[36:39], v[156:159]
  s_add_u32 s20, s20, 29696
  s_waitcnt vmcnt(6)
  v_min_u32 v209, v177, v179
  v_min_u32 v209, v209, v181
  v_min_u32 v209, v209, v183
  v_min_u32 v209, v209, v185
  v_min_u32 v209, v209, v187
  v_min_u32 v209, v209, v189
  v_min_u32 v209, v209, v191
  v_cmp_eq_u32 vcc, 0, v209
  s_mov_b32 s27, 0
  s_nop 3
  s_cbranch_vccz GM_S_GO
GM_S_POLL:
  buffer_load_dwordx4 v[176:179], v1, s[8:11], s23 offen offset:0 sc1
  buffer_load_dwordx4 v[180:183], v1, s[8:11], s23 offen offset:1024 sc1
  buffer_load_dwordx4 v[184:187], v1, s[8:11], s23 offen offset:2048 sc1
  buffer_load_dwordx4 v[188:191], v1, s[8:11], s23 offen offset:3072 sc1
  s_waitcnt vmcnt(0)
  v_min_u32 v209, v177, v179
  v_min_u32 v209, v209, v181
  v_min_u32 v209, v209, v183
  v_min_u32 v209, v209, v185
  v_min_u32 v209, v209, v187
  v_min_u32 v209, v209, v189
  v_min_u32 v209, v209, v191
  v_cmp_eq_u32 vcc, 0, v209
  s_add_u32 s27, s27, 1
  s_cmp_ge_u32 s27, 0x80000
  s_cbranch_scc1 GM_S_GO
  s_nop 2
  s_cbranch_vccz GM_S_GO
  s_sleep 2
  s_branch GM_S_POLL
GM_S_GO:
  s_waitcnt vmcnt(19) lgkmcnt(0)
  s_barrier
  v_mfma_f32_16x16x32_bf16 v[88:91], a[180:183], a[40:43], v[88:91]
  ds_read_b128 a[144:147], v252 offset:0
  v_add_f32 v176, v176, v180
  v_add_f32 v177, v177, v181
  v_add_f32 v178, v178, v182
  v_mfma_f32_16x16x32_bf16 v[92:95], a[180:183], a[44:47], v[92:95]
  ds_read_b128 a[148:151], v252 offset:1024
  s_add_u32 m0, s7, 73728
  v_add_f32 v179, v179, v183
  v_add_f32 v184, v184, v188
  v_mfma_f32_16x16x32_bf16 v[96:99], a[184:187], a[40:43], v[96:99]
  ds_read_b128 a[152:155], v252 offset:2048
  buffer_load_dwordx4 v1, s[8:11], s20 offen offset:0 sc1 lds
  v_add_f32 v185, v185, v189
  v_mfma_f32_16x16x32_bf16 v[100:103], a[184:187], a[44:47], v[100:103]
  ds_read_b128 a[156:159], v252 offset:3072
  v_add_f32 v186, v186, v190
  v_add_f32 v187, v187, v191
  v_add_f32 v176, v176, v184
  v_add_f32 v177, v177, v185
  v_mfma_f32_16x16x32_bf16 v[104:107], a[188:191], a[40:43], v[104:107]
  ds_read_b128 a[160:163], v252 offset:4096
  buffer_load_dwordx4 v1, s[8:11], s20 offen offset:1024 sc1 lds
  v_add_f32 v178, v178, v186
  v_add_f32 v179, v179, v187
  v_mfma_f32_16x16x32_bf16 v[108:111], a[188:191], a[44:47], v[108:111]
  ds_read_b128 a[164:167], v252 offset:5120
  v_mov_b32 v180, v176
  v_mov_b32 v181, v177
  v_mov_b32 v182, v178
  v_mov_b32 v183, v179
  v_mfma_f32_16x16x32_bf16 v[112:115], a[192:195], a[40:43], v[112:115]
  ds_read_b128 a[168:171], v252 offset:6144
  buffer_load_dwordx4 v1, s[8:11], s20 offen offset:2048 sc1 lds
  s_nop 1
  v_permlane16_swap_b32 v176, v180
  v_mfma_f32_16x16x32_bf16 v[116:119], a[192:195], a[44:47], v[116:119]
  ds_read_b128 a[172:175], v252 offset:7168
  s_add_u32 s20, s20, 3072
  s_add_u32 m0, s30, 0
  s_add_u32 s21, s29, 512
  v_permlane16_swap_b32 v177, v181
  v_mfma_f32_16x16x32_bf16 v[120:123], a[196:199], a[40:43], v[120:123]
  ds_read_b128 a[176:179], v252 offset:8192
  buffer_load_dwordx4 v241, s[16:19], s21 offen offset:0 lds
  v_permlane16_swap_b32 v178, v182
  v_permlane16_swap_b32 v179, v183
  v_mfma_f32_16x16x32_bf16 v[124:127], a[196:199], a[44:47], v[124:127]
  s_nop 1
  v_add_f32 v176, v176, v180
  v_add_f32 v177, v177, v181
  v_add_f32 v178, v178, v182
  v_add_f32 v179, v179, v183
  v_mfma_f32_16x16x32_bf16 v[128:131], a[200:203], a[40:43], v[128:131]
  v_mov_b32 v180, v176
  v_mov_b32 v181, v177
  v_mov_b32 v182, v178
  v_mov_b32 v183, v179
  s_nop 1
  v_mfma_f32_16x16x32_bf16 v[132:135], a[200:203], a[44:47], v[132:135]
  buffer_load_dwordx4 v243, s[16:19], s21 offen offset:1024 lds
  v_permlane32_swap_b32 v176, v180
  v_permlane32_swap_b32 v177, v181
  v_permlane32_swap_b32 v178, v182
  v_mfma_f32_16x16x32_bf16 v[136:139], a[204:207], a[40:43], v[136:139]
  v_permlane32_swap_b32 v179, v183
  s_nop 1
  v_add_f32 v176, v176, v180
  v_add_f32 v177, v177, v181
  v_add_f32 v178, v178, v182
  v_mfma_f32_16x16x32_bf16 v[140:143], a[204:207], a[44:47], v[140:143]
  buffer_load_dwordx4 v245, s[16:19], s21 offen offset:2048 lds
  v_add_f32 v179, v179, v183
  v_mul_f32 v176, 0x39e38e39, v176
  v_mul_f32 v178, 0x39e38e39, v178
  v_mfma_f32_16x16x32_bf16 v[144:147], a[208:211], a[40:43], v[144:147]
  v_mul_f32 v177, 0x39e38e39, v177
  v_mul_f32 v179, 0x39e38e39, v179
  v_fma_f32 v177, -v176, v176, v177
  v_fma_f32 v179, -v178, v178, v179
  v_max_f32 v177, 0, v177
  v_mfma_f32_16x16x32_bf16 v[148:151], a[208:211], a[44:47], v[148:151]
  buffer_load_dwordx4 v247, s[16:19], s21 offen offset:3072 lds
  v_max_f32 v179, 0, v179
  v_add_f32 v177, 0x3727c5ac, v177
  v_add_f32 v179, 0x3727c5ac, v179
  v_mfma_f32_16x16x32_bf16 v[152:155], a[212:215], a[40:43], v[152:155]
  v_rsq_f32 v177, v177
  v_rsq_f32 v179, v179
  s_nop 0
  v_mfma_f32_16x16x32_bf16 v[156:159], a[212:215], a[44:47], v[156:159]
  v_mul_f32 v176, -v176, v177
  v_mul_f32 v178, -v178, v179
  v_lshlrev_b32 v11, 4, v12
  s_mul_i32 s26, s6, 9216
  v_add_u32 v208, 8192, v1
  s_waitcnt lgkmcnt(0)
  ds_bpermute_b32 v200, v11, v176 offset:0
  ds_bpermute_b32 v192, v11, v177 offset:0
  ds_bpermute_b32 v201, v11, v178 offset:0
  ds_bpermute_b32 v193, v11, v179 offset:0
  ds_bpermute_b32 v202, v11, v176 offset:4
  ds_bpermute_b32 v194, v11, v177 offset:4
  ds_bpermute_b32 v203, v11, v178 offset:4
  ds_bpermute_b32 v195, v11, v179 offset:4
  ds_bpermute_b32 v204, v11, v176 offset:8
  ds_bpermute_b32 v196, v11, v177 offset:8
  ds_bpermute_b32 v205, v11, v178 offset:8
  ds_bpermute_b32 v197, v11, v179 offset:8
  s_waitcnt lgkmcnt(4)
  ds_bpermute_b32 v206, v11, v176 offset:12
  ds_bpermute_b32 v198, v11, v177 offset:12
  ds_bpermute_b32 v207, v11, v178 offset:12
  ds_bpermute_b32 v199, v11, v179 offset:12
  s_waitcnt vmcnt(30) lgkmcnt(0)
  v_mfma_f32_16x16x32_bf16 v[88:91], a[144:147], a[48:51], v[88:91]
  ds_read_b128 a[180:183], v252 offset:9216
  v_fma_f32 v16, v16, v192, v200
  v_mfma_f32_16x16x32_bf16 v[92:95], a[144:147], a[52:55], v[92:95]
  ds_read_b128 a[184:187], v252 offset:10240
  s_add_u32 m0, s7, 76800
  v_mfma_f32_16x16x32_bf16 v[96:99], a[148:151], a[48:51], v[96:99]
  ds_read_b128 a[188:191], v252 offset:11264
  buffer_load_dwordx4 v1, s[8:11], s20 offen offset:0 sc1 lds
  v_mfma_f32_16x16x32_bf16 v[100:103], a[148:151], a[52:55], v[100:103]
  ds_read_b128 a[192:195], v252 offset:12288
  v_fma_f32 v17, v17, v193, v201
  v_mfma_f32_16x16x32_bf16 v[104:107], a[152:155], a[48:51], v[104:107]
  ds_read_b128 a[196:199], v252 offset:13312
  v_fma_f32 v18, v18, v194, v202
  v_mfma_f32_16x16x32_bf16 v[108:111], a[152:155], a[52:55], v[108:111]
  ds_read_b128 a[200:203], v252 offset:14336
  v_fma_f32 v19, v19, v195, v203
  v_mfma_f32_16x16x32_bf16 v[112:115], a[156:159], a[48:51], v[112:115]
  ds_read_b128 a[204:207], v252 offset:15360
  v_fma_f32 v20, v20, v196, v204
  v_mfma_f32_16x16x32_bf16 v[116:119], a[156:159], a[52:55], v[116:119]
  ds_read_b128 a[208:211], v252 offset:16384
  v_fma_f32 v21, v21, v197, v205
  v_mfma_f32_16x16x32_bf16 v[120:123], a[160:163], a[48:51], v[120:123]
  ds_read_b128 a[212:215], v252 offset:17408
  v_fma_f32 v22, v22, v198, v206
  v_fma_f32 v23, v23, v199, v207
  v_mfma_f32_16x16x32_bf16 v[124:127], a[160:163], a[52:55], v[124:127]
  ds_read_b128 a[32:35], v4 offset:4096
  v_cvt_pk_bf16_f32 v16, v16, v17
  v_cvt_pk_bf16_f32 v17, v18, v19
  v_mfma_f32_16x16x32_bf16 v[128:131], a[164:167], a[48:51], v[128:131]
  ds_read_b128 a[36:39], v4 offset:6144
  buffer_load_dwordx4 v1, s[8:11], s20 offen offset:1024 sc1 lds
  v_mfma_f32_16x16x32_bf16 v[132:135], a[164:167], a[52:55], v[132:135]
  ds_read_b128 a[40:43], v8 offset:4096
  v_cvt_pk_bf16_f32 v18, v20, v21
  v_cvt_pk_bf16_f32 v19, v22, v23
  v_mfma_f32_16x16x32_bf16 v[136:139], a[168:171], a[48:51], v[136:139]
  ds_read_b128 a[44:47], v8 offset:6144
  buffer_store_dwordx4 v[16:19], v1, s[12:15], s26 offen offset:0 sc1
  v_mfma_f32_16x16x32_bf16 v[140:143], a[168:171], a[52:55], v[140:143]
  v_fma_f32 v24, v24, v192, v200
  v_fma_f32 v25, v25, v193, v201
  v_fma_f32 v26, v26, v194, v202
  v_mfma_f32_16x16x32_bf16 v[144:147], a[172:175], a[48:51], v[144:147]
  v_fma_f32 v27, v27, v195, v203
  v_fma_f32 v28, v28, v196, v204
  v_fma_f32 v29, v29, v197, v205
  v_mfma_f32_16x16x32_bf16 v[148:151], a[172:175], a[52:55], v[148:151]
  v_fma_f32 v30, v30, v198, v206
  v_fma_f32 v31, v31, v199, v207
  v_cvt_pk_bf16_f32 v24, v24, v25
  v_mfma_f32_16x16x32_bf16 v[152:155], a[176:179], a[48:51], v[152:155]
  v_cvt_pk_bf16_f32 v25, v26, v27
  v_cvt_pk_bf16_f32 v26, v28, v29
  v_cvt_pk_bf16_f32 v27, v30, v31
  v_mfma_f32_16x16x32_bf16 v[156:159], a[176:179], a[52:55], v[156:159]
  buffer_store_dwordx4 v[24:27], v1, s[12:15], s26 offen offset:1024 sc1
  s_add_u32 s20, s20, 2048
  s_waitcnt lgkmcnt(0)
  v_mfma_f32_16x16x32_bf16 v[88:91], a[180:183], a[56:59], v[88:91]
  ds_read_b128 a[144:147], v252 offset:18432
  v_fma_f32 v32, v32, v192, v200
  v_mfma_f32_16x16x32_bf16 v[92:95], a[180:183], a[60:63], v[92:95]
  ds_read_b128 a[148:151], v252 offset:19456
  s_add_u32 m0, s7, 78848
  v_mfma_f32_16x16x32_bf16 v[96:99], a[184:187], a[56:59], v[96:99]
  ds_read_b128 a[152:155], v252 offset:20480
  buffer_load_dwordx4 v1, s[8:11], s20 offen offset:0 sc1 lds
  v_mfma_f32_16x16x32_bf16 v[100:103], a[184:187], a[60:63], v[100:103]
  ds_read_b128 a[156:159], v252 offset:21504
  v_fma_f32 v33, v33, v193, v201
  v_mfma_f32_16x16x32_bf16 v[104:107], a[188:191], a[56:59], v[104:107]
  ds_read_b128 a[160:163], v252 offset:22528
  v_fma_f32 v34, v34, v194, v202
  v_mfma_f32_16x16x32_bf16 v[108:111], a[188:191], a[60:63], v[108:111]
  ds_read_b128 a[164:167], v252 offset:23552
  v_fma_f32 v35, v35, v195, v203
  v_mfma_f32_16x16x32_bf16 v[112:115], a[192:195], a[56:59], v[112:115]
  ds_read_b128 a[168:171], v252 offset:24576
  v_fma_f32 v36, v36, v196, v204
  v_mfma_f32_16x16x32_bf16 v[116:119], a[192:195], a[60:63], v[116:119]
  ds_read_b128 a[172:175], v252 offset:25600
  v_fma_f32 v37, v37, v197, v205
  v_mfma_f32_16x16x32_bf16 v[120:123], a[196:199], a[56:59], v[120:123]
  ds_read_b128 a[176:179], v252 offset:26624
  v_fma_f32 v38, v38, v198, v206
  v_mfma_f32_16x16x32_bf16 v[124:127], a[196:199], a[60:63], v[124:127]
  v_fma_f32 v39, v39, v199, v207
  v_cvt_pk_bf16_f32 v32, v32, v33
  v_mfma_f32_16x16x32_bf16 v[128:131], a[200:203], a[56:59], v[128:131]
  buffer_load_dwordx4 v1, s[8:11], s20 offen offset:1024 sc1 lds
  v_mfma_f32_16x16x32_bf16 v[132:135], a[200:203], a[60:63], v[132:135]
  v_cvt_pk_bf16_f32 v33, v34, v35
  v_cvt_pk_bf16_f32 v34, v36, v37
  v_mfma_f32_16x16x32_bf16 v[136:139], a[204:207], a[56:59], v[136:139]
  v_cvt_pk_bf16_f32 v35, v38, v39
  buffer_store_dwordx4 v[32:35], v1, s[12:15], s26 offen offset:2048 sc1
  v_mfma_f32_16x16x32_bf16 v[140:143], a[204:207], a[60:63], v[140:143]
  v_fma_f32 v40, v40, v192, v200
  v_fma_f32 v41, v41, v193, v201
  v_fma_f32 v42, v42, v194, v202
  v_mfma_f32_16x16x32_bf16 v[144:147], a[208:211], a[56:59], v[144:147]
  v_fma_f32 v43, v43, v195, v203
  v_fma_f32 v44, v44, v196, v204
  v_fma_f32 v45, v45, v197, v205
  v_mfma_f32_16x16x32_bf16 v[148:151], a[208:211], a[60:63], v[148:151]
  v_fma_f32 v46, v46, v198, v206
  v_fma_f32 v47, v47, v199, v207
  v_cvt_pk_bf16_f32 v40, v40, v41
  v_mfma_f32_16x16x32_bf16 v[152:155], a[212:215], a[56:59], v[152:155]
  v_cvt_pk_bf16_f32 v41, v42, v43
  v_cvt_pk_bf16_f32 v42, v44, v45
  v_cvt_pk_bf16_f32 v43, v46, v47
  v_mfma_f32_16x16x32_bf16 v[156:159], a[212:215], a[60:63], v[156:159]
  buffer_store_dwordx4 v[40:43], v1, s[12:15], s26 offen offset:3072 sc1
  s_add_u32 s20, s20, 2048
  s_waitcnt vmcnt(17) lgkmcnt(0)
  v_mfma_f32_16x16x32_bf16 v[88:91], a[144:147], a[64:67], v[88:91]
  ds_read_b128 a[180:183], v252 offset:27648
  v_fma_f32 v48, v48, v192, v200
  v_mfma_f32_16x16x32_bf16 v[92:95], a[144:147], a[68:71], v[92:95]
  ds_read_b128 a[184:187], v252 offset:28672
  s_add_u32 m0, s7, 80896
  v_mfma_f32_16x16x32_bf16 v[96:99], a[148:151], a[64:67], v[96:99]
  ds_read_b128 a[188:191], v252 offset:29696
  buffer_load_dwordx4 v1, s[8:11], s20 offen offset:0 sc1 lds
  v_mfma_f32_16x16x32_bf16 v[100:103], a[148:151], a[68:71], v[100:103]
  ds_read_b128 a[192:195], v252 offset:30720
  v_fma_f32 v49, v49, v193, v201
  v_mfma_f32_16x16x32_bf16 v[104:107], a[152:155], a[64:67], v[104:107]
  ds_read_b128 a[196:199], v252 offset:31744
  v_fma_f32 v50, v50, v194, v202
  v_mfma_f32_16x16x32_bf16 v[108:111], a[152:155], a[68:71], v[108:111]
  ds_read_b128 a[200:203], v252 offset:32768
  v_fma_f32 v51, v51, v195, v203
  v_mfma_f32_16x16x32_bf16 v[112:115], a[156:159], a[64:67], v[112:115]
  ds_read_b128 a[204:207], v252 offset:33792
  v_fma_f32 v52, v52, v196, v204
  v_mfma_f32_16x16x32_bf16 v[116:119], a[156:159], a[68:71], v[116:119]
  ds_read_b128 a[208:211], v252 offset:34816
  v_fma_f32 v53, v53, v197, v205
  v_mfma_f32_16x16x32_bf16 v[120:123], a[160:163], a[64:67], v[120:123]
  ds_read_b128 a[212:215], v252 offset:35840
  v_fma_f32 v54, v54, v198, v206
  v_fma_f32 v55, v55, v199, v207
  v_mfma_f32_16x16x32_bf16 v[124:127], a[160:163], a[68:71], v[124:127]
  ds_read_b128 a[48:51], v4 offset:8192
  v_cvt_pk_bf16_f32 v48, v48, v49
  v_cvt_pk_bf16_f32 v49, v50, v51
  v_mfma_f32_16x16x32_bf16 v[128:131], a[164:167], a[64:67], v[128:131]
  ds_read_b128 a[52:55], v4 offset:10240
  buffer_load_dwordx4 v1, s[8:11], s20 offen offset:1024 sc1 lds
  v_mfma_f32_16x16x32_bf16 v[132:135], a[164:167], a[68:71], v[132:135]
  ds_read_b128 a[56:59], v8 offset:8192
  v_cvt_pk_bf16_f32 v50, v52, v53
  v_cvt_pk_bf16_f32 v51, v54, v55
  v_mfma_f32_16x16x32_bf16 v[136:139], a[168:171], a[64:67], v[136:139]
  ds_read_b128 a[60:63], v8 offset:10240
  buffer_store_dwordx4 v[48:51], v251, s[12:15], s26 offen offset:0 sc1
  v_mfma_f32_16x16x32_bf16 v[140:143], a[168:171], a[68:71], v[140:143]
  v_fma_f32 v56, v56, v192, v200
  v_fma_f32 v57, v57, v193, v201
  v_fma_f32 v58, v58, v194, v202
  v_mfma_f32_16x16x32_bf16 v[144:147], a[172:175], a[64:67], v[144:147]
  v_fma_f32 v59, v59, v195, v203
  v_fma_f32 v60, v60, v196, v204
  v_fma_f32 v61, v61, v197, v205
  v_mfma_f32_16x16x32_bf16 v[148:151], a[172:175], a[68:71], v[148:151]
  v_fma_f32 v62, v62, v198, v206
  v_fma_f32 v63, v63, v199, v207
  v_cvt_pk_bf16_f32 v56, v56, v57
  v_mfma_f32_16x16x32_bf16 v[152:155], a[176:179], a[64:67], v[152:155]
  v_cvt_pk_bf16_f32 v57, v58, v59
  v_cvt_pk_bf16_f32 v58, v60, v61
  v_cvt_pk_bf16_f32 v59, v62, v63
  v_mfma_f32_16x16x32_bf16 v[156:159], a[176:179], a[68:71], v[156:159]
  buffer_store_dwordx4 v[56:59], v251, s[12:15], s26 offen offset:1024 sc1
  s_add_u32 s20, s20, 29696
  s_waitcnt vmcnt(19) lgkmcnt(0)
  s_barrier
  v_mfma_f32_16x16x32_bf16 v[88:91], a[180:183], a[72:75], v[88:91]
  ds_read_b128 a[144:147], v253 offset:0
  v_fma_f32 v64, v64, v192, v200
  v_mfma_f32_16x16x32_bf16 v[92:95], a[180:183], a[76:79], v[92:95]
  ds_read_b128 a[148:151], v253 offset:1024
  v_fma_f32 v65, v65, v193, v201
  v_mfma_f32_16x16x32_bf16 v[96:99], a[184:187], a[72:75], v[96:99]
  ds_read_b128 a[152:155], v253 offset:2048
  v_fma_f32 v66, v66, v194, v202
  v_mfma_f32_16x16x32_bf16 v[100:103], a[184:187], a[76:79], v[100:103]
  ds_read_b128 a[156:159], v253 offset:3072
  v_fma_f32 v67, v67, v195, v203
  v_mfma_f32_16x16x32_bf16 v[104:107], a[188:191], a[72:75], v[104:107]
  ds_read_b128 a[160:163], v253 offset:4096
  v_fma_f32 v68, v68, v196, v204
  v_mfma_f32_16x16x32_bf16 v[108:111], a[188:191], a[76:79], v[108:111]
  ds_read_b128 a[164:167], v253 offset:5120
  v_fma_f32 v69, v69, v197, v205
  v_mfma_f32_16x16x32_bf16 v[112:115], a[192:195], a[72:75], v[112:115]
  ds_read_b128 a[168:171], v253 offset:6144
  v_fma_f32 v70, v70, v198, v206
  v_mfma_f32_16x16x32_bf16 v[116:119], a[192:195], a[76:79], v[116:119]
  ds_read_b128 a[172:175], v253 offset:7168
  v_fma_f32 v71, v71, v199, v207
  v_mfma_f32_16x16x32_bf16 v[120:123], a[196:199], a[72:75], v[120:123]
  ds_read_b128 a[176:179], v253 offset:8192
  v_cvt_pk_bf16_f32 v64, v64, v65
  v_mfma_f32_16x16x32_bf16 v[124:127], a[196:199], a[76:79], v[124:127]
  v_cvt_pk_bf16_f32 v65, v66, v67
  v_cvt_pk_bf16_f32 v66, v68, v69
  v_mfma_f32_16x16x32_bf16 v[128:131], a[200:203], a[72:75], v[128:131]
  v_cvt_pk_bf16_f32 v67, v70, v71
  v_mfma_f32_16x16x32_bf16 v[132:135], a[200:203], a[76:79], v[132:135]
  buffer_store_dwordx4 v[64:67], v251, s[12:15], s26 offen offset:2048 sc1
  v_mfma_f32_16x16x32_bf16 v[136:139], a[204:207], a[72:75], v[136:139]
  v_fma_f32 v72, v72, v192, v200
  v_fma_f32 v73, v73, v193, v201
  v_mfma_f32_16x16x32_bf16 v[140:143], a[204:207], a[76:79], v[140:143]
  v_fma_f32 v74, v74, v194, v202
  v_fma_f32 v75, v75, v195, v203
  v_mfma_f32_16x16x32_bf16 v[144:147], a[208:211], a[72:75], v[144:147]
  v_fma_f32 v76, v76, v196, v204
  v_fma_f32 v77, v77, v197, v205
  v_mfma_f32_16x16x32_bf16 v[148:151], a[208:211], a[76:79], v[148:151]
  v_fma_f32 v78, v78, v198, v206
  v_fma_f32 v79, v79, v199, v207
  v_mfma_f32_16x16x32_bf16 v[152:155], a[212:215], a[72:75], v[152:155]
  v_cvt_pk_bf16_f32 v72, v72, v73
  v_cvt_pk_bf16_f32 v73, v74, v75
  v_cvt_pk_bf16_f32 v74, v76, v77
  v_mfma_f32_16x16x32_bf16 v[156:159], a[212:215], a[76:79], v[156:159]
  v_cvt_pk_bf16_f32 v75, v78, v79
  buffer_store_dwordx4 v[72:75], v251, s[12:15], s26 offen offset:3072 sc1
  s_waitcnt vmcnt(14) lgkmcnt(0)
  v_mfma_f32_16x16x32_bf16 v[88:91], a[144:147], a[80:83], v[88:91]
  ds_read_b128 a[180:183], v253 offset:9216
  v_fma_f32 v80, v80, v192, v200
  v_mfma_f32_16x16x32_bf16 v[92:95], a[144:147], a[84:87], v[92:95]
  ds_read_b128 a[184:187], v253 offset:10240
  s_add_u32 m0, s30, 4096
  s_add_u32 s21, s29, 640
  v_mfma_f32_16x16x32_bf16 v[96:99], a[148:151], a[80:83], v[96:99]
  ds_read_b128 a[188:191], v253 offset:11264
  buffer_load_dwordx4 v241, s[16:19], s21 offen offset:0 lds
  v_mfma_f32_16x16x32_bf16 v[100:103], a[148:151], a[84:87], v[100:103]
  ds_read_b128 a[192:195], v253 offset:12288
  v_fma_f32 v81, v81, v193, v201
  v_mfma_f32_16x16x32_bf16 v[104:107], a[152:155], a[80:83], v[104:107]
  ds_read_b128 a[196:199], v253 offset:13312
  v_fma_f32 v82, v82, v194, v202
  v_mfma_f32_16x16x32_bf16 v[108:111], a[152:155], a[84:87], v[108:111]
  ds_read_b128 a[200:203], v253 offset:14336
  v_fma_f32 v83, v83, v195, v203
  v_mfma_f32_16x16x32_bf16 v[112:115], a[156:159], a[80:83], v[112:115]
  ds_read_b128 a[204:207], v253 offset:15360
  buffer_load_dwordx4 v243, s[16:19], s21 offen offset:1024 lds
  v_mfma_f32_16x16x32_bf16 v[116:119], a[156:159], a[84:87], v[116:119]
  ds_read_b128 a[208:211], v253 offset:16384
  v_fma_f32 v84, v84, v196, v204
  v_mfma_f32_16x16x32_bf16 v[120:123], a[160:163], a[80:83], v[120:123]
  ds_read_b128 a[212:215], v253 offset:17408
  v_fma_f32 v85, v85, v197, v205
  v_mfma_f32_16x16x32_bf16 v[124:127], a[160:163], a[84:87], v[124:127]
  ds_read_b128 a[64:67], v4 offset:0
  v_fma_f32 v86, v86, v198, v206
  v_mfma_f32_16x16x32_bf16 v[128:131], a[164:167], a[80:83], v[128:131]
  ds_read_b128 a[68:71], v4 offset:2048
  buffer_load_dwordx4 v245, s[16:19], s21 offen offset:2048 lds
  v_mfma_f32_16x16x32_bf16 v[132:135], a[164:167], a[84:87], v[132:135]
  ds_read_b128 a[72:75], v8 offset:0
  v_fma_f32 v87, v87, v199, v207
  v_mfma_f32_16x16x32_bf16 v[136:139], a[168:171], a[80:83], v[136:139]
  ds_read_b128 a[76:79], v8 offset:2048
  v_cvt_pk_bf16_f32 v80, v80, v81
  v_mfma_f32_16x16x32_bf16 v[140:143], a[168:171], a[84:87], v[140:143]
  v_cvt_pk_bf16_f32 v81, v82, v83
  v_cvt_pk_bf16_f32 v82, v84, v85
  v_mfma_f32_16x16x32_bf16 v[144:147], a[172:175], a[80:83], v[144:147]
  buffer_load_dwordx4 v247, s[16:19], s21 offen offset:3072 lds
  v_mfma_f32_16x16x32_bf16 v[148:151], a[172:175], a[84:87], v[148:151]
  v_cvt_pk_bf16_f32 v83, v86, v87
  v_mfma_f32_16x16x32_bf16 v[152:155], a[176:179], a[80:83], v[152:155]
  buffer_store_dwordx4 v[80:83], v208, s[12:15], s26 offen offset:0 sc1
  v_mfma_f32_16x16x32_bf16 v[156:159], a[176:179], a[84:87], v[156:159]
  s_waitcnt lgkmcnt(0)
  v_mfma_f32_16x16x32_bf16 v[88:91], a[180:183], a[88:91], v[88:91]
  ds_read_b128 a[144:147], v253 offset:18432
  v_mfma_f32_16x16x32_bf16 v[92:95], a[180:183], a[92:95], v[92:95]
  ds_read_b128 a[148:151], v253 offset:19456
  s_add_u32 m0, s30, 8192
  s_add_u32 s21, s29, 768
  v_mfma_f32_16x16x32_bf16 v[96:99], a[184:187], a[88:91], v[96:99]
  ds_read_b128 a[152:155], v253 offset:20480
  buffer_load_dwordx4 v241, s[16:19], s21 offen offset:0 lds
  v_mfma_f32_16x16x32_bf16 v[100:103], a[184:187], a[92:95], v[100:103]
  ds_read_b128 a[156:159], v253 offset:21504
  v_mfma_f32_16x16x32_bf16 v[104:107], a[188:191], a[88:91], v[104:107]
  ds_read_b128 a[160:163], v253 offset:22528
  v_mfma_f32_16x16x32_bf16 v[108:111], a[188:191], a[92:95], v[108:111]
  ds_read_b128 a[164:167], v253 offset:23552
  v_mfma_f32_16x16x32_bf16 v[112:115], a[192:195], a[88:91], v[112:115]
  ds_read_b128 a[168:171], v253 offset:24576
  buffer_load_dwordx4 v243, s[16:19], s21 offen offset:1024 lds
  v_mfma_f32_16x16x32_bf16 v[116:119], a[192:195], a[92:95], v[116:119]
  ds_read_b128 a[172:175], v253 offset:25600
  v_mfma_f32_16x16x32_bf16 v[120:123], a[196:199], a[88:91], v[120:123]
  ds_read_b128 a[176:179], v253 offset:26624
  v_mfma_f32_16x16x32_bf16 v[124:127], a[196:199], a[92:95], v[124:127]
  v_mfma_f32_16x16x32_bf16 v[128:131], a[200:203], a[88:91], v[128:131]
  buffer_load_dwordx4 v245, s[16:19], s21 offen offset:2048 lds
  v_mfma_f32_16x16x32_bf16 v[132:135], a[200:203], a[92:95], v[132:135]
  v_mfma_f32_16x16x32_bf16 v[136:139], a[204:207], a[88:91], v[136:139]
  v_mfma_f32_16x16x32_bf16 v[140:143], a[204:207], a[92:95], v[140:143]
  v_mfma_f32_16x16x32_bf16 v[144:147], a[208:211], a[88:91], v[144:147]
  buffer_load_dwordx4 v247, s[16:19], s21 offen offset:3072 lds
  v_mfma_f32_16x16x32_bf16 v[148:151], a[208:211], a[92:95], v[148:151]
  v_mfma_f32_16x16x32_bf16 v[152:155], a[212:215], a[88:91], v[152:155]
  v_mfma_f32_16x16x32_bf16 v[156:159], a[212:215], a[92:95], v[156:159]
  s_waitcnt lgkmcnt(0)
  v_mfma_f32_16x16x32_bf16 v[88:91], a[144:147], a[96:99], v[88:91]
  ds_read_b128 a[180:183], v253 offset:27648
  s_lshl_b32 s24, s6, 4
  v_mfma_f32_16x16x32_bf16 v[92:95], a[144:147], a[100:103], v[92:95]
  ds_read_b128 a[184:187], v253 offset:28672
  s_add_u32 m0, s7, 0
  s_add_u32 s21, s29, 896
  v_mfma_f32_16x16x32_bf16 v[96:99], a[148:151], a[96:99], v[96:99]
  ds_read_b128 a[188:191], v253 offset:29696
  buffer_load_dwordx4 v241, s[16:19], s21 offen offset:0 lds
  v_mfma_f32_16x16x32_bf16 v[100:103], a[148:151], a[100:103], v[100:103]
  ds_read_b128 a[192:195], v253 offset:30720
  s_add_u32 s24, s24, s5
  v_mfma_f32_16x16x32_bf16 v[104:107], a[152:155], a[96:99], v[104:107]
  ds_read_b128 a[196:199], v253 offset:31744
  buffer_load_dwordx4 v243, s[16:19], s21 offen offset:1024 lds
  v_mfma_f32_16x16x32_bf16 v[108:111], a[152:155], a[100:103], v[108:111]
  ds_read_b128 a[200:203], v253 offset:32768
  s_lshl_b32 s24, s24, 7
  v_mfma_f32_16x16x32_bf16 v[112:115], a[156:159], a[96:99], v[112:115]
  ds_read_b128 a[204:207], v253 offset:33792
  buffer_load_dwordx4 v245, s[16:19], s21 offen offset:2048 lds
  v_mfma_f32_16x16x32_bf16 v[116:119], a[156:159], a[100:103], v[116:119]
  ds_read_b128 a[208:211], v253 offset:34816
  s_add_u32 s24, s24, 7864320
  v_mfma_f32_16x16x32_bf16 v[120:123], a[160:163], a[96:99], v[120:123]
  ds_read_b128 a[212:215], v253 offset:35840
  buffer_load_dwordx4 v247, s[16:19], s21 offen offset:3072 lds
  v_mfma_f32_16x16x32_bf16 v[124:127], a[160:163], a[100:103], v[124:127]
  ds_read_b128 v[160:163], v9 offset:0
  s_add_u32 m0, s7, 4096
  s_add_u32 s21, s29, 1024
  v_mfma_f32_16x16x32_bf16 v[128:131], a[164:167], a[96:99], v[128:131]
  ds_read_b128 v[164:167], v9 offset:1024
  buffer_load_dwordx4 v241, s[16:19], s21 offen offset:0 lds
  v_mfma_f32_16x16x32_bf16 v[132:135], a[164:167], a[100:103], v[132:135]
  ds_read_b128 v[168:171], v9 offset:64
  v_cmp_eq_u32 vcc, 0, v2
  v_mfma_f32_16x16x32_bf16 v[136:139], a[168:171], a[96:99], v[136:139]
  ds_read_b128 v[172:175], v9 offset:1088
  buffer_load_dwordx4 v243, s[16:19], s21 offen offset:1024 lds
  v_mfma_f32_16x16x32_bf16 v[140:143], a[168:171], a[100:103], v[140:143]
  ds_read_b128 v[176:179], v9 offset:128
  v_mov_b32 v13, 2147483392
  v_mfma_f32_16x16x32_bf16 v[144:147], a[172:175], a[96:99], v[144:147]
  buffer_load_dwordx4 v245, s[16:19], s21 offen offset:2048 lds
  v_mfma_f32_16x16x32_bf16 v[148:151], a[172:175], a[100:103], v[148:151]
  v_mov_b32 v5, 1
  v_cndmask_b32 v13, v13, 0, vcc
  s_lshl_b32 s23, s3, 4
  v_mfma_f32_16x16x32_bf16 v[152:155], a[176:179], a[96:99], v[152:155]
  buffer_load_dwordx4 v247, s[16:19], s21 offen offset:3072 lds
  s_add_u32 s23, s23, s5
  v_mfma_f32_16x16x32_bf16 v[156:159], a[176:179], a[100:103], v[156:159]
  s_lshl_b32 s23, s23, 7
  s_add_u32 s23, s23, 7864320
  v_lshlrev_b32 v10, 13, v3
  s_waitcnt vmcnt(12) lgkmcnt(0)
  s_barrier
  v_mfma_f32_16x16x32_bf16 v[88:91], a[180:183], a[104:107], v[88:91]
  ds_read_b128 a[144:147], v254 offset:0
  v_mfma_f32_16x16x32_bf16 v[92:95], a[180:183], a[108:111], v[92:95]
  ds_read_b128 a[148:151], v254 offset:1024
  v_mfma_f32_16x16x32_bf16 v[96:99], a[184:187], a[104:107], v[96:99]
  ds_read_b128 a[152:155], v254 offset:2048
  buffer_store_dword v5, v13, s[8:11], s24 offen sc1
  v_mfma_f32_16x16x32_bf16 v[100:103], a[184:187], a[108:111], v[100:103]
  ds_read_b128 a[156:159], v254 offset:3072
  v_mfma_f32_16x16x32_bf16 v[104:107], a[188:191], a[104:107], v[104:107]
  ds_read_b128 a[160:163], v254 offset:4096
  s_add_u32 m0, s7, 36864
  s_add_u32 s21, s29, 1152
  v_mfma_f32_16x16x32_bf16 v[108:111], a[188:191], a[108:111], v[108:111]
  ds_read_b128 a[164:167], v254 offset:5120
  buffer_load_dwordx4 v241, s[16:19], s21 offen offset:0 lds
  v_mfma_f32_16x16x32_bf16 v[112:115], a[192:195], a[104:107], v[112:115]
  ds_read_b128 a[168:171], v254 offset:6144
  v_mfma_f32_16x16x32_bf16 v[116:119], a[192:195], a[108:111], v[116:119]
  ds_read_b128 a[172:175], v254 offset:7168
  v_mfma_f32_16x16x32_bf16 v[120:123], a[196:199], a[104:107], v[120:123]
  ds_read_b128 a[176:179], v254 offset:8192
  buffer_load_dwordx4 v243, s[16:19], s21 offen offset:1024 lds
  v_mfma_f32_16x16x32_bf16 v[124:127], a[196:199], a[108:111], v[124:127]
  ds_read_b128 v[180:183], v9 offset:1152
  v_mfma_f32_16x16x32_bf16 v[128:131], a[200:203], a[104:107], v[128:131]
  ds_read_b128 v[184:187], v9 offset:192
  v_mfma_f32_16x16x32_bf16 v[132:135], a[200:203], a[108:111], v[132:135]
  ds_read_b128 v[188:191], v9 offset:1216
  buffer_load_dwordx4 v245, s[16:19], s21 offen offset:2048 lds
  v_mfma_f32_16x16x32_bf16 v[136:139], a[204:207], a[104:107], v[136:139]
  ds_read_b128 v[192:195], v9 offset:256
  v_mfma_f32_16x16x32_bf16 v[140:143], a[204:207], a[108:111], v[140:143]
  ds_read_b128 v[196:199], v9 offset:1280
  v_mfma_f32_16x16x32_bf16 v[144:147], a[208:211], a[104:107], v[144:147]
  buffer_load_dwordx4 v247, s[16:19], s21 offen offset:3072 lds
  v_mfma_f32_16x16x32_bf16 v[148:151], a[208:211], a[108:111], v[148:151]
  v_mfma_f32_16x16x32_bf16 v[152:155], a[212:215], a[104:107], v[152:155]
  v_mfma_f32_16x16x32_bf16 v[156:159], a[212:215], a[108:111], v[156:159]
  s_waitcnt lgkmcnt(0)
  v_mfma_f32_16x16x32_bf16 v[88:91], a[144:147], a[112:115], v[88:91]
  ds_read_b128 a[180:183], v254 offset:9216
  v_mfma_f32_16x16x32_bf16 v[92:95], a[144:147], a[116:119], v[92:95]
  ds_read_b128 a[184:187], v254 offset:10240
  s_add_u32 m0, s7, 40960
  s_add_u32 s21, s29, 1280
  v_mfma_f32_16x16x32_bf16 v[96:99], a[148:151], a[112:115], v[96:99]
  ds_read_b128 a[188:191], v254 offset:11264
  buffer_load_dwordx4 v241, s[16:19], s21 offen offset:0 lds
  v_mfma_f32_16x16x32_bf16 v[100:103], a[148:151], a[116:119], v[100:103]
  ds_read_b128 a[192:195], v254 offset:12288
  v_mfma_f32_16x16x32_bf16 v[104:107], a[152:155], a[112:115], v[104:107]
  ds_read_b128 a[196:199], v254 offset:13312
  v_mfma_f32_16x16x32_bf16 v[108:111], a[152:155], a[116:119], v[108:111]
  ds_read_b128 a[200:203], v254 offset:14336
  v_mfma_f32_16x16x32_bf16 v[112:115], a[156:159], a[112:115], v[112:115]
  ds_read_b128 a[204:207], v254 offset:15360
  buffer_load_dwordx4 v243, s[16:19], s21 offen offset:1024 lds
  v_mfma_f32_16x16x32_bf16 v[116:119], a[156:159], a[116:119], v[116:119]
  ds_read_b128 a[208:211], v254 offset:16384
  v_mfma_f32_16x16x32_bf16 v[120:123], a[160:163], a[112:115], v[120:123]
  ds_read_b128 a[212:215], v254 offset:17408
  v_mfma_f32_16x16x32_bf16 v[124:127], a[160:163], a[116:119], v[124:127]
  v_mfma_f32_16x16x32_bf16 v[128:131], a[164:167], a[112:115], v[128:131]
  buffer_load_dwordx4 v245, s[16:19], s21 offen offset:2048 lds
  v_mfma_f32_16x16x32_bf16 v[132:135], a[164:167], a[116:119], v[132:135]
  v_mfma_f32_16x16x32_bf16 v[136:139], a[168:171], a[112:115], v[136:139]
  v_mfma_f32_16x16x32_bf16 v[140:143], a[168:171], a[116:119], v[140:143]
  v_mfma_f32_16x16x32_bf16 v[144:147], a[172:175], a[112:115], v[144:147]
  buffer_load_dwordx4 v247, s[16:19], s21 offen offset:3072 lds
  v_mfma_f32_16x16x32_bf16 v[148:151], a[172:175], a[116:119], v[148:151]
  v_mfma_f32_16x16x32_bf16 v[152:155], a[176:179], a[112:115], v[152:155]
  v_mfma_f32_16x16x32_bf16 v[156:159], a[176:179], a[116:119], v[156:159]
  s_waitcnt vmcnt(22) lgkmcnt(0)
  v_mfma_f32_16x16x32_bf16 v[88:91], a[180:183], a[120:123], v[88:91]
  ds_read_b128 a[144:147], v254 offset:18432
  v_mfma_f32_16x16x32_bf16 v[92:95], a[180:183], a[124:127], v[92:95]
  ds_read_b128 a[148:151], v254 offset:19456
  s_add_u32 m0, s30, 0
  s_add_u32 s21, s29, 1408
  v_mfma_f32_16x16x32_bf16 v[96:99], a[184:187], a[120:123], v[96:99]
  ds_read_b128 a[152:155], v254 offset:20480
  buffer_load_dwordx4 v241, s[16:19], s21 offen offset:0 lds
  v_mfma_f32_16x16x32_bf16 v[100:103], a[184:187], a[124:127], v[100:103]
  ds_read_b128 a[156:159], v254 offset:21504
  v_mfma_f32_16x16x32_bf16 v[104:107], a[188:191], a[120:123], v[104:107]
  ds_read_b128 a[160:163], v254 offset:22528
  v_mfma_f32_16x16x32_bf16 v[108:111], a[188:191], a[124:127], v[108:111]
  ds_read_b128 a[164:167], v254 offset:23552
  v_mfma_f32_16x16x32_bf16 v[112:115], a[192:195], a[120:123], v[112:115]
  ds_read_b128 a[168:171], v254 offset:24576
  buffer_load_dwordx4 v243, s[16:19], s21 offen offset:1024 lds
  v_mfma_f32_16x16x32_bf16 v[116:119], a[192:195], a[124:127], v[116:119]
  ds_read_b128 a[172:175], v254 offset:25600
  v_mfma_f32_16x16x32_bf16 v[120:123], a[196:199], a[120:123], v[120:123]
  ds_read_b128 a[176:179], v254 offset:26624
  v_mfma_f32_16x16x32_bf16 v[124:127], a[196:199], a[124:127], v[124:127]
  ds_read_b128 a[80:83], v4 offset:4096
  v_mfma_f32_16x16x32_bf16 v[128:131], a[200:203], a[120:123], v[128:131]
  ds_read_b128 a[84:87], v4 offset:6144
  buffer_load_dwordx4 v245, s[16:19], s21 offen offset:2048 lds
  v_mfma_f32_16x16x32_bf16 v[132:135], a[200:203], a[124:127], v[132:135]
  ds_read_b128 a[88:91], v8 offset:4096
  v_mfma_f32_16x16x32_bf16 v[136:139], a[204:207], a[120:123], v[136:139]
  ds_read_b128 a[92:95], v8 offset:6144
  v_mfma_f32_16x16x32_bf16 v[140:143], a[204:207], a[124:127], v[140:143]
  v_mfma_f32_16x16x32_bf16 v[144:147], a[208:211], a[120:123], v[144:147]
  buffer_load_dwordx4 v247, s[16:19], s21 offen offset:3072 lds
  v_mfma_f32_16x16x32_bf16 v[148:151], a[208:211], a[124:127], v[148:151]
  v_mfma_f32_16x16x32_bf16 v[152:155], a[212:215], a[120:123], v[152:155]
  v_mfma_f32_16x16x32_bf16 v[156:159], a[212:215], a[124:127], v[156:159]
  s_waitcnt vmcnt(21) lgkmcnt(0)
  v_mfma_f32_16x16x32_bf16 v[88:91], a[144:147], a[128:131], v[88:91]
  ds_read_b128 a[180:183], v254 offset:27648
  v_mfma_f32_16x16x32_bf16 v[92:95], a[144:147], a[132:135], v[92:95]
  ds_read_b128 a[184:187], v254 offset:28672
  s_add_u32 m0, s30, 4096
  s_add_u32 s21, s29, 1536
  v_mfma_f32_16x16x32_bf16 v[96:99], a[148:151], a[128:131], v[96:99]
  ds_read_b128 a[188:191], v254 offset:29696
  buffer_load_dwordx4 v241, s[16:19], s21 offen offset:0 lds
  v_mfma_f32_16x16x32_bf16 v[100:103], a[148:151], a[132:135], v[100:103]
  ds_read_b128 a[192:195], v254 offset:30720
  v_mfma_f32_16x16x32_bf16 v[104:107], a[152:155], a[128:131], v[104:107]
  ds_read_b128 a[196:199], v254 offset:31744
  v_mfma_f32_16x16x32_bf16 v[108:111], a[152:155], a[132:135], v[108:111]
  ds_read_b128 a[200:203], v254 offset:32768
  v_mfma_f32_16x16x32_bf16 v[112:115], a[156:159], a[128:131], v[112:115]
  ds_read_b128 a[204:207], v254 offset:33792
  buffer_load_dwordx4 v243, s[16:19], s21 offen offset:1024 lds
  v_mfma_f32_16x16x32_bf16 v[116:119], a[156:159], a[132:135], v[116:119]
  ds_read_b128 a[208:211], v254 offset:34816
  v_mfma_f32_16x16x32_bf16 v[120:123], a[160:163], a[128:131], v[120:123]
  ds_read_b128 a[212:215], v254 offset:35840
  v_mfma_f32_16x16x32_bf16 v[124:127], a[160:163], a[132:135], v[124:127]
  ds_read_b128 a[96:99], v4 offset:8192
  v_mfma_f32_16x16x32_bf16 v[128:131], a[164:167], a[128:131], v[128:131]
  ds_read_b128 a[100:103], v4 offset:10240
  buffer_load_dwordx4 v245, s[16:19], s21 offen offset:2048 lds
  v_mfma_f32_16x16x32_bf16 v[132:135], a[164:167], a[132:135], v[132:135]
  ds_read_b128 a[104:107], v8 offset:8192
  v_mfma_f32_16x16x32_bf16 v[136:139], a[168:171], a[128:131], v[136:139]
  ds_read_b128 a[108:111], v8 offset:10240
  v_mfma_f32_16x16x32_bf16 v[140:143], a[168:171], a[132:135], v[140:143]
  v_mfma_f32_16x16x32_bf16 v[144:147], a[172:175], a[128:131], v[144:147]
  buffer_load_dwordx4 v247, s[16:19], s21 offen offset:3072 lds
  v_mfma_f32_16x16x32_bf16 v[148:151], a[172:175], a[132:135], v[148:151]
  v_mfma_f32_16x16x32_bf16 v[152:155], a[176:179], a[128:131], v[152:155]
  v_mfma_f32_16x16x32_bf16 v[156:159], a[176:179], a[132:135], v[156:159]
  s_waitcnt vmcnt(21) lgkmcnt(0)
  v_mfma_f32_16x16x32_bf16 v[88:91], a[180:183], a[136:139], v[88:91]
  ds_read_b128 v[200:203], v9 offset:320
  v_mfma_f32_16x16x32_bf16 v[92:95], a[180:183], a[140:143], v[92:95]
  ds_read_b128 v[204:207], v9 offset:1344
  v_mfma_f32_16x16x32_bf16 v[96:99], a[184:187], a[136:139], v[96:99]
  ds_read_b128 v[208:211], v9 offset:384
  buffer_load_dword v11, v10, s[8:11], s23 offen sc1
  v_mfma_f32_16x16x32_bf16 v[100:103], a[184:187], a[140:143], v[100:103]
  ds_read_b128 v[212:215], v9 offset:1408
  v_mfma_f32_16x16x32_bf16 v[104:107], a[188:191], a[136:139], v[104:107]
  ds_read_b128 v[216:219], v9 offset:448
  s_add_u32 m0, s30, 8192
  s_add_u32 s21, s29, 1664
  v_mfma_f32_16x16x32_bf16 v[108:111], a[188:191], a[140:143], v[108:111]
  ds_read_b128 v[220:223], v9 offset:1472
  buffer_load_dwordx4 v241, s[16:19], s21 offen offset:0 lds
  v_mfma_f32_16x16x32_bf16 v[112:115], a[192:195], a[136:139], v[112:115]
  ds_read_b128 v[224:227], v9 offset:512
  v_mfma_f32_16x16x32_bf16 v[116:119], a[192:195], a[140:143], v[116:119]
  ds_read_b128 v[228:231], v9 offset:1536
  v_mfma_f32_16x16x32_bf16 v[120:123], a[196:199], a[136:139], v[120:123]
  ds_read_b128 a[112:115], v249 offset:0
  buffer_load_dwordx4 v243, s[16:19], s21 offen offset:1024 lds
  v_mfma_f32_16x16x32_bf16 v[124:127], a[196:199], a[140:143], v[124:127]
  ds_read_b128 a[116:119], v249 offset:2048
  v_mfma_f32_16x16x32_bf16 v[128:131], a[200:203], a[136:139], v[128:131]
  ds_read_b128 a[120:123], v250 offset:0
  v_mfma_f32_16x16x32_bf16 v[132:135], a[200:203], a[140:143], v[132:135]
  ds_read_b128 a[124:127], v250 offset:2048
  buffer_load_dwordx4 v245, s[16:19], s21 offen offset:2048 lds
  v_mfma_f32_16x16x32_bf16 v[136:139], a[204:207], a[136:139], v[136:139]
  v_mfma_f32_16x16x32_bf16 v[140:143], a[204:207], a[140:143], v[140:143]
  v_mfma_f32_16x16x32_bf16 v[144:147], a[208:211], a[136:139], v[144:147]
  buffer_load_dwordx4 v247, s[16:19], s21 offen offset:3072 lds
  v_mfma_f32_16x16x32_bf16 v[148:151], a[208:211], a[140:143], v[148:151]
  v_mfma_f32_16x16x32_bf16 v[152:155], a[212:215], a[136:139], v[152:155]
  v_mfma_f32_16x16x32_bf16 v[156:159], a[212:215], a[140:143], v[156:159]
  s_mov_b32 s20, s7
  s_waitcnt vmcnt(13) lgkmcnt(0)
  ds_read_b128 a[128:131], v249 offset:4096
  ds_read_b128 a[132:135], v249 offset:6144
  ds_read_b128 a[136:139], v250 offset:4096
  ds_read_b128 a[140:143], v250 offset:6144
  ds_read_b128 a[144:147], v249 offset:36864
  ds_read_b128 a[148:151], v249 offset:38912
  ds_read_b128 a[152:155], v250 offset:36864
  ds_read_b128 a[156:159], v250 offset:38912
  ds_read_b128 a[160:163], v249 offset:40960
  ds_read_b128 a[164:167], v249 offset:43008
  ds_read_b128 a[168:171], v250 offset:40960
  ds_read_b128 a[172:175], v250 offset:43008
  v_pk_fma_f32 v[232:233], v[160:161], v[242:243], v[164:165] op_sel_hi:[1,0,1]
  v_pk_fma_f32 v[234:235], v[162:163], v[242:243], v[166:167] op_sel_hi:[1,0,1]
  v_pk_fma_f32 v[236:237], v[160:161], v[246:247], v[164:165] op_sel_hi:[1,0,1]
  v_pk_fma_f32 v[238:239], v[162:163], v[246:247], v[166:167] op_sel_hi:[1,0,1]
  v_pk_fma_f32 v[88:89], v[88:89], v[240:241], v[232:233] op_sel_hi:[1,0,1]
  v_pk_fma_f32 v[90:91], v[90:91], v[240:241], v[234:235] op_sel_hi:[1,0,1]
  v_pk_fma_f32 v[92:93], v[92:93], v[244:245], v[236:237] op_sel_hi:[1,0,1]
  v_pk_fma_f32 v[94:95], v[94:95], v[244:245], v[238:239] op_sel_hi:[1,0,1]
  v_pk_fma_f32 v[232:233], v[168:169], v[242:243], v[172:173] op_sel_hi:[1,0,1]
  v_pk_fma_f32 v[234:235], v[170:171], v[242:243], v[174:175] op_sel_hi:[1,0,1]
  v_pk_fma_f32 v[236:237], v[168:169], v[246:247], v[172:173] op_sel_hi:[1,0,1]
  v_pk_fma_f32 v[238:239], v[170:171], v[246:247], v[174:175] op_sel_hi:[1,0,1]
  v_pk_fma_f32 v[96:97], v[96:97], v[240:241], v[232:233] op_sel_hi:[1,0,1]
  v_pk_fma_f32 v[98:99], v[98:99], v[240:241], v[234:235] op_sel_hi:[1,0,1]
  v_pk_fma_f32 v[100:101], v[100:101], v[244:245], v[236:237] op_sel_hi:[1,0,1]
  v_pk_fma_f32 v[102:103], v[102:103], v[244:245], v[238:239] op_sel_hi:[1,0,1]
  s_waitcnt vmcnt(4)
  v_cmp_eq_u32 vcc, 0, v11
  s_waitcnt lgkmcnt(0)
  s_nop 3
  s_cbranch_vccz GM_B_GO
  s_mov_b32 s27, 0
GM_B_POLL:
  buffer_load_dword v11, v10, s[8:11], s23 offen sc1
  s_waitcnt vmcnt(0)
  v_cmp_eq_u32 vcc, 0, v11
  s_add_u32 s27, s27, 1
  s_cmp_ge_u32 s27, 0x80000
  s_cbranch_scc1 GM_B_GO
  s_nop 2
  s_cbranch_vccz GM_B_GO
  s_sleep 2
  s_branch GM_B_POLL
GM_B_GO:
  s_add_u32 m0, s7, 0
  s_nop 0
  buffer_load_dwordx4 v1, s[12:15], s20 offen offset:0 sc1 lds
  buffer_load_dwordx4 v1, s[12:15], s20 offen offset:1024 sc1 lds
  buffer_load_dwordx4 v1, s[12:15], s20 offen offset:2048 sc1 lds
  s_add_u32 s20, s20, 3072
  s_add_u32 m0, s7, 3072
  s_nop 0
  buffer_load_dwordx4 v1, s[12:15], s20 offen offset:0 sc1 lds
  buffer_load_dwordx4 v1, s[12:15], s20 offen offset:1024 sc1 lds
  s_add_u32 s20, s20, 2048
  s_add_u32 m0, s7, 5120
  s_nop 0
  buffer_load_dwordx4 v1, s[12:15], s20 offen offset:0 sc1 lds
  buffer_load_dwordx4 v1, s[12:15], s20 offen offset:1024 sc1 lds
  s_add_u32 s20, s20, 2048
  s_add_u32 m0, s7, 7168
  s_nop 0
  buffer_load_dwordx4 v1, s[12:15], s20 offen offset:0 sc1 lds
  buffer_load_dwordx4 v1, s[12:15], s20 offen offset:1024 sc1 lds
  s_add_u32 s20, s20, 29696
  v_pk_fma_f32 v[232:233], v[176:177], v[242:243], v[180:181] op_sel_hi:[1,0,1]
  s_add_u32 m0, s7, 36864
  v_pk_fma_f32 v[234:235], v[178:179], v[242:243], v[182:183] op_sel_hi:[1,0,1]
  v_pk_fma_f32 v[236:237], v[176:177], v[246:247], v[180:181] op_sel_hi:[1,0,1]
  v_pk_fma_f32 v[238:239], v[178:179], v[246:247], v[182:183] op_sel_hi:[1,0,1]
  v_pk_fma_f32 v[104:105], v[104:105], v[240:241], v[232:233] op_sel_hi:[1,0,1]
  v_pk_fma_f32 v[106:107], v[106:107], v[240:241], v[234:235] op_sel_hi:[1,0,1]
  s_nop 0
  v_pk_fma_f32 v[108:109], v[108:109], v[244:245], v[236:237] op_sel_hi:[1,0,1]
  v_pk_fma_f32 v[110:111], v[110:111], v[244:245], v[238:239] op_sel_hi:[1,0,1]
  v_pk_fma_f32 v[232:233], v[184:185], v[242:243], v[188:189] op_sel_hi:[1,0,1]
  v_pk_fma_f32 v[234:235], v[186:187], v[242:243], v[190:191] op_sel_hi:[1,0,1]
  v_pk_fma_f32 v[236:237], v[184:185], v[246:247], v[188:189] op_sel_hi:[1,0,1]
  buffer_load_dwordx4 v1, s[12:15], s20 offen offset:0 sc1 lds
  v_pk_fma_f32 v[238:239], v[186:187], v[246:247], v[190:191] op_sel_hi:[1,0,1]
  v_pk_fma_f32 v[112:113], v[112:113], v[240:241], v[232:233] op_sel_hi:[1,0,1]
  v_pk_fma_f32 v[114:115], v[114:115], v[240:241], v[234:235] op_sel_hi:[1,0,1]
  v_pk_fma_f32 v[116:117], v[116:117], v[244:245], v[236:237] op_sel_hi:[1,0,1]
  v_pk_fma_f32 v[118:119], v[118:119], v[244:245], v[238:239] op_sel_hi:[1,0,1]
  buffer_load_dwordx4 v1, s[12:15], s20 offen offset:1024 sc1 lds
  v_pk_fma_f32 v[232:233], v[192:193], v[242:243], v[196:197] op_sel_hi:[1,0,1]
  v_pk_fma_f32 v[234:235], v[194:195], v[242:243], v[198:199] op_sel_hi:[1,0,1]
  v_pk_fma_f32 v[236:237], v[192:193], v[246:247], v[196:197] op_sel_hi:[1,0,1]
  v_pk_fma_f32 v[238:239], v[194:195], v[246:247], v[198:199] op_sel_hi:[1,0,1]
  v_pk_fma_f32 v[120:121], v[120:121], v[240:241], v[232:233] op_sel_hi:[1,0,1]
  buffer_load_dwordx4 v1, s[12:15], s20 offen offset:2048 sc1 lds
  v_pk_fma_f32 v[122:123], v[122:123], v[240:241], v[234:235] op_sel_hi:[1,0,1]
  v_pk_fma_f32 v[124:125], v[124:125], v[244:245], v[236:237] op_sel_hi:[1,0,1]
  v_pk_fma_f32 v[126:127], v[126:127], v[244:245], v[238:239] op_sel_hi:[1,0,1]
  v_pk_fma_f32 v[232:233], v[200:201], v[242:243], v[204:205] op_sel_hi:[1,0,1]
  v_pk_fma_f32 v[234:235], v[202:203], v[242:243], v[206:207] op_sel_hi:[1,0,1]
  s_add_u32 s20, s20, 3072
  v_pk_fma_f32 v[236:237], v[200:201], v[246:247], v[204:205] op_sel_hi:[1,0,1]
  v_pk_fma_f32 v[238:239], v[202:203], v[246:247], v[206:207] op_sel_hi:[1,0,1]
  v_pk_fma_f32 v[128:129], v[128:129], v[240:241], v[232:233] op_sel_hi:[1,0,1]
  v_pk_fma_f32 v[130:131], v[130:131], v[240:241], v[234:235] op_sel_hi:[1,0,1]
  v_pk_fma_f32 v[132:133], v[132:133], v[244:245], v[236:237] op_sel_hi:[1,0,1]
  s_add_u32 m0, s7, 39936
  v_pk_fma_f32 v[134:135], v[134:135], v[244:245], v[238:239] op_sel_hi:[1,0,1]
  v_pk_fma_f32 v[232:233], v[208:209], v[242:243], v[212:213] op_sel_hi:[1,0,1]
  v_pk_fma_f32 v[234:235], v[210:211], v[242:243], v[214:215] op_sel_hi:[1,0,1]
  v_pk_fma_f32 v[236:237], v[208:209], v[246:247], v[212:213] op_sel_hi:[1,0,1]
  v_pk_fma_f32 v[238:239], v[210:211], v[246:247], v[214:215] op_sel_hi:[1,0,1]
  s_nop 0
  v_pk_fma_f32 v[136:137], v[136:137], v[240:241], v[232:233] op_sel_hi:[1,0,1]
  v_pk_fma_f32 v[138:139], v[138:139], v[240:241], v[234:235] op_sel_hi:[1,0,1]
  v_pk_fma_f32 v[140:141], v[140:141], v[244:245], v[236:237] op_sel_hi:[1,0,1]
  v_pk_fma_f32 v[142:143], v[142:143], v[244:245], v[238:239] op_sel_hi:[1,0,1]
  v_pk_fma_f32 v[232:233], v[216:217], v[242:243], v[220:221] op_sel_hi:[1,0,1]
  buffer_load_dwordx4 v1, s[12:15], s20 offen offset:0 sc1 lds
  v_pk_fma_f32 v[234:235], v[218:219], v[242:243], v[222:223] op_sel_hi:[1,0,1]
  v_pk_fma_f32 v[236:237], v[216:217], v[246:247], v[220:221] op_sel_hi:[1,0,1]
  v_pk_fma_f32 v[238:239], v[218:219], v[246:247], v[222:223] op_sel_hi:[1,0,1]
  v_pk_fma_f32 v[144:145], v[144:145], v[240:241], v[232:233] op_sel_hi:[1,0,1]
  v_pk_fma_f32 v[146:147], v[146:147], v[240:241], v[234:235] op_sel_hi:[1,0,1]
  buffer_load_dwordx4 v1, s[12:15], s20 offen offset:1024 sc1 lds
  v_pk_fma_f32 v[148:149], v[148:149], v[244:245], v[236:237] op_sel_hi:[1,0,1]
  v_pk_fma_f32 v[150:151], v[150:151], v[244:245], v[238:239] op_sel_hi:[1,0,1]
  v_pk_fma_f32 v[232:233], v[224:225], v[242:243], v[228:229] op_sel_hi:[1,0,1]
  v_pk_fma_f32 v[234:235], v[226:227], v[242:243], v[230:231] op_sel_hi:[1,0,1]
  v_pk_fma_f32 v[236:237], v[224:225], v[246:247], v[228:229] op_sel_hi:[1,0,1]
  s_add_u32 s20, s20, 2048
  v_pk_fma_f32 v[238:239], v[226:227], v[246:247], v[230:231] op_sel_hi:[1,0,1]
  v_pk_fma_f32 v[152:153], v[152:153], v[240:241], v[232:233] op_sel_hi:[1,0,1]
  v_pk_fma_f32 v[154:155], v[154:155], v[240:241], v[234:235] op_sel_hi:[1,0,1]
  v_pk_fma_f32 v[156:157], v[156:157], v[244:245], v[236:237] op_sel_hi:[1,0,1]
  v_pk_fma_f32 v[158:159], v[158:159], v[244:245], v[238:239] op_sel_hi:[1,0,1]
  v_lshlrev_b32 v232, 16, v6
  v_lshlrev_b32 v233, 16, v6
  v_lshlrev_b32 v234, 16, v6
  v_lshlrev_b32 v235, 16, v6
  v_lshlrev_b32 v236, 16, v7
  v_lshlrev_b32 v237, 16, v7
  v_lshlrev_b32 v238, 16, v7
  v_lshlrev_b32 v239, 16, v7
  s_waitcnt vmcnt(5)
  s_barrier
  ds_read_b128 v[160:163], v252 offset:0
  ds_read_b128 v[164:167], v252 offset:1024
  ds_read_b128 v[168:171], v252 offset:2048
  ds_read_b128 v[172:175], v252 offset:3072
  ds_read_b128 v[176:179], v252 offset:4096
  ds_read_b128 v[180:183], v252 offset:5120
  ds_read_b128 v[184:187], v252 offset:6144
  ds_read_b128 v[188:191], v252 offset:7168
  ds_read_b128 v[192:195], v252 offset:8192
  s_waitcnt lgkmcnt(0)
  v_mfma_f32_16x16x32_bf16 v[16:19], v[160:163], a[0:3], v[232:235]
  ds_read_b128 v[196:199], v252 offset:9216
  v_mfma_f32_16x16x32_bf16 v[20:23], v[160:163], a[4:7], v[236:239]
  ds_read_b128 v[200:203], v252 offset:10240
  s_add_u32 m0, s7, 41984
  v_mfma_f32_16x16x32_bf16 v[24:27], v[164:167], a[0:3], v[232:235]
  ds_read_b128 v[204:207], v252 offset:11264
  buffer_load_dwordx4 v1, s[12:15], s20 offen offset:0 sc1 lds
  v_mfma_f32_16x16x32_bf16 v[28:31], v[164:167], a[4:7], v[236:239]
  ds_read_b128 v[208:211], v252 offset:12288
  s_and_b32 s44, s2, 7
  v_mfma_f32_16x16x32_bf16 v[32:35], v[168:171], a[0:3], v[232:235]
  ds_read_b128 v[212:215], v252 offset:13312
  s_lshl_b32 s44, s44, 2
  v_mfma_f32_16x16x32_bf16 v[36:39], v[168:171], a[4:7], v[236:239]
  ds_read_b128 v[216:219], v252 offset:14336
  s_lshr_b32 s45, s2, 3
  v_mfma_f32_16x16x32_bf16 v[40:43], v[172:175], a[0:3], v[232:235]
  ds_read_b128 v[220:223], v252 offset:15360
  buffer_load_dwordx4 v1, s[12:15], s20 offen offset:1024 sc1 lds
  v_mfma_f32_16x16x32_bf16 v[44:47], v[172:175], a[4:7], v[236:239]
  ds_read_b128 v[224:227], v252 offset:16384
  s_and_b32 s38, s45, 3
  v_mfma_f32_16x16x32_bf16 v[48:51], v[176:179], a[0:3], v[232:235]
  ds_read_b128 v[228:231], v252 offset:17408
  s_add_u32 s44, s44, s38
  v_mfma_f32_16x16x32_bf16 v[52:55], v[176:179], a[4:7], v[236:239]
  s_add_u32 s20, s20, 2048
  s_add_u32 m0, s7, 44032
  v_mfma_f32_16x16x32_bf16 v[56:59], v[180:183], a[0:3], v[232:235]
  buffer_load_dwordx4 v1, s[12:15], s20 offen offset:0 sc1 lds
  v_mfma_f32_16x16x32_bf16 v[60:63], v[180:183], a[4:7], v[236:239]
  s_lshr_b32 s45, s45, 2
  s_mul_i32 s45, s45, 9
  v_mfma_f32_16x16x32_bf16 v[64:67], v[184:187], a[0:3], v[232:235]
  s_lshr_b32 s45, s45, 1
  s_mul_i32 s39, s3, 663552
  v_mfma_f32_16x16x32_bf16 v[68:71], v[184:187], a[4:7], v[236:239]
  s_lshl_b32 s38, s45, 10
  s_add_u32 s39, s39, s38
  v_mfma_f32_16x16x32_bf16 v[72:75], v[188:191], a[0:3], v[232:235]
  buffer_load_dwordx4 v1, s[12:15], s20 offen offset:1024 sc1 lds
  s_add_u32 s39, s39, 14680064
  v_mfma_f32_16x16x32_bf16 v[76:79], v[188:191], a[4:7], v[236:239]
  s_bitcmp1_b32 s2, 5
  s_cselect_b32 s46, 0, 16
  s_cselect_b32 s47, 16, 8
  v_and_b32 v250, 8, v3
  v_mov_b32 v11, 2147483392
  v_mfma_f32_16x16x32_bf16 v[80:83], v[192:195], a[0:3], v[232:235]
  v_cmp_eq_u32 vcc, s46, v250
  s_nop 1
  v_cndmask_b32 v3, v1, v11, vcc
  v_mfma_f32_16x16x32_bf16 v[84:87], v[192:195], a[4:7], v[236:239]
  v_cmp_eq_u32 vcc, s47, v250
  s_nop 1
  v_cndmask_b32 v250, v251, v11, vcc
  s_add_u32 s20, s20, 29696
  s_waitcnt lgkmcnt(0)
  v_mfma_f32_16x16x32_bf16 v[16:19], v[196:199], a[8:11], v[16:19]
  ds_read_b128 v[160:163], v252 offset:18432
  s_lshr_b32 s42, s2, 5
  v_mfma_f32_16x16x32_bf16 v[20:23], v[196:199], a[12:15], v[20:23]
  ds_read_b128 v[164:167], v252 offset:19456
  s_add_u32 m0, s7, 73728
  v_mfma_f32_16x16x32_bf16 v[24:27], v[200:203], a[8:11], v[24:27]
  ds_read_b128 v[168:171], v252 offset:20480
  buffer_load_dwordx4 v1, s[12:15], s20 offen offset:0 sc1 lds
  v_mfma_f32_16x16x32_bf16 v[28:31], v[200:203], a[12:15], v[28:31]
  ds_read_b128 v[172:175], v252 offset:21504
  s_mul_i32 s42, s42, 9
  v_mfma_f32_16x16x32_bf16 v[32:35], v[204:207], a[8:11], v[32:35]
  ds_read_b128 v[176:179], v252 offset:22528
  buffer_load_dwordx4 v1, s[12:15], s20 offen offset:1024 sc1 lds
  v_mfma_f32_16x16x32_bf16 v[36:39], v[204:207], a[12:15], v[36:39]
  ds_read_b128 v[180:183], v252 offset:23552
  s_lshr_b32 s42, s42, 1
  v_mfma_f32_16x16x32_bf16 v[40:43], v[208:211], a[8:11], v[40:43]
  ds_read_b128 v[184:187], v252 offset:24576
  s_lshl_b32 s42, s42, 7
  v_mfma_f32_16x16x32_bf16 v[44:47], v[208:211], a[12:15], v[44:47]
  ds_read_b128 v[188:191], v252 offset:25600
  buffer_load_dwordx4 v1, s[12:15], s20 offen offset:2048 sc1 lds
  v_mfma_f32_16x16x32_bf16 v[48:51], v[212:215], a[8:11], v[48:51]
  ds_read_b128 v[192:195], v252 offset:26624
  s_add_u32 s42, s42, 8149504
  v_mfma_f32_16x16x32_bf16 v[52:55], v[212:215], a[12:15], v[52:55]
  s_add_u32 s20, s20, 3072
  s_add_u32 m0, s7, 76800
  v_mfma_f32_16x16x32_bf16 v[56:59], v[216:219], a[8:11], v[56:59]
  buffer_load_dwordx4 v1, s[12:15], s20 offen offset:0 sc1 lds
  v_mfma_f32_16x16x32_bf16 v[60:63], v[216:219], a[12:15], v[60:63]
  s_add_u32 s43, s42, 27648
  v_lshlrev_b32 v9, 3, v2
  v_mfma_f32_16x16x32_bf16 v[64:67], v[220:223], a[8:11], v[64:67]
  buffer_load_dwordx4 v1, s[12:15], s20 offen offset:1024 sc1 lds
  v_mfma_f32_16x16x32_bf16 v[68:71], v[220:223], a[12:15], v[68:71]
  v_mfma_f32_16x16x32_bf16 v[72:75], v[224:227], a[8:11], v[72:75]
  s_add_u32 s20, s20, 2048
  v_mfma_f32_16x16x32_bf16 v[76:79], v[224:227], a[12:15], v[76:79]
  buffer_load_dword v15, v255, s[32:35], 0 offen
  v_mfma_f32_16x16x32_bf16 v[80:83], v[228:231], a[8:11], v[80:83]
  v_mfma_f32_16x16x32_bf16 v[84:87], v[228:231], a[12:15], v[84:87]
  s_waitcnt vmcnt(32) lgkmcnt(0)
  v_mfma_f32_16x16x32_bf16 v[16:19], v[160:163], a[16:19], v[16:19]
  ds_read_b128 v[196:199], v252 offset:27648
  v_mul_f32 v236, v92, v92
  v_mfma_f32_16x16x32_bf16 v[20:23], v[160:163], a[20:23], v[20:23]
  ds_read_b128 v[200:203], v252 offset:28672
  s_add_u32 m0, s7, 78848
  v_mfma_f32_16x16x32_bf16 v[24:27], v[164:167], a[16:19], v[24:27]
  ds_read_b128 v[204:207], v252 offset:29696
  buffer_load_dwordx4 v1, s[12:15], s20 offen offset:0 sc1 lds
  v_mfma_f32_16x16x32_bf16 v[28:31], v[164:167], a[20:23], v[28:31]
  ds_read_b128 v[208:211], v252 offset:30720
  v_mul_f32 v237, v93, v93
  v_mfma_f32_16x16x32_bf16 v[32:35], v[168:171], a[16:19], v[32:35]
  ds_read_b128 v[212:215], v252 offset:31744
  v_mul_f32 v238, v94, v94
  v_mfma_f32_16x16x32_bf16 v[36:39], v[168:171], a[20:23], v[36:39]
  ds_read_b128 v[216:219], v252 offset:32768
  v_mul_f32 v239, v95, v95
  v_mfma_f32_16x16x32_bf16 v[40:43], v[172:175], a[16:19], v[40:43]
  ds_read_b128 v[220:223], v252 offset:33792
  buffer_load_dwordx4 v1, s[12:15], s20 offen offset:1024 sc1 lds
  v_mfma_f32_16x16x32_bf16 v[44:47], v[172:175], a[20:23], v[44:47]
  ds_read_b128 v[224:227], v252 offset:34816
  v_fma_f32 v236, v236, s40, v14
  v_mfma_f32_16x16x32_bf16 v[48:51], v[176:179], a[16:19], v[48:51]
  ds_read_b128 v[228:231], v252 offset:35840
  v_fma_f32 v237, v237, s40, v14
  v_mfma_f32_16x16x32_bf16 v[52:55], v[176:179], a[20:23], v[52:55]
  ds_read_b128 a[176:179], v4 offset:0
  s_add_u32 s20, s20, 2048
  s_add_u32 m0, s7, 80896
  v_mfma_f32_16x16x32_bf16 v[56:59], v[180:183], a[16:19], v[56:59]
  ds_read_b128 a[180:183], v4 offset:2048
  buffer_load_dwordx4 v1, s[12:15], s20 offen offset:0 sc1 lds
  v_mfma_f32_16x16x32_bf16 v[60:63], v[180:183], a[20:23], v[60:63]
  ds_read_b128 a[184:187], v8 offset:0
  v_fma_f32 v238, v238, s40, v14
  v_mfma_f32_16x16x32_bf16 v[64:67], v[184:187], a[16:19], v[64:67]
  ds_read_b128 a[188:191], v8 offset:2048
  v_fma_f32 v239, v239, s40, v14
  v_mfma_f32_16x16x32_bf16 v[68:71], v[184:187], a[20:23], v[68:71]
  v_mul_f32 v236, v236, v92
  v_mul_f32 v237, v237, v93
  v_mfma_f32_16x16x32_bf16 v[72:75], v[188:191], a[16:19], v[72:75]
  buffer_load_dwordx4 v1, s[12:15], s20 offen offset:1024 sc1 lds
  v_mfma_f32_16x16x32_bf16 v[76:79], v[188:191], a[20:23], v[76:79]
  v_mfma_f32_16x16x32_bf16 v[80:83], v[192:195], a[16:19], v[80:83]
  v_mfma_f32_16x16x32_bf16 v[84:87], v[192:195], a[20:23], v[84:87]
  s_add_u32 s20, s20, 29696
  s_waitcnt vmcnt(10) lgkmcnt(0)
  s_barrier
  v_mfma_f32_16x16x32_bf16 v[16:19], v[196:199], a[24:27], v[16:19]
  ds_read_b128 v[160:163], v253 offset:0
  v_mul_f32 v238, v238, v94
  v_mfma_f32_16x16x32_bf16 v[20:23], v[196:199], a[28:31], v[20:23]
  ds_read_b128 v[164:167], v253 offset:1024
  s_add_u32 m0, s7, 0
  v_mfma_f32_16x16x32_bf16 v[24:27], v[200:203], a[24:27], v[24:27]
  ds_read_b128 v[168:171], v253 offset:2048
  buffer_load_dwordx4 v1, s[12:15], s20 offen offset:0 sc1 lds
  v_mfma_f32_16x16x32_bf16 v[28:31], v[200:203], a[28:31], v[28:31]
  ds_read_b128 v[172:175], v253 offset:3072
  v_mul_f32 v239, v239, v95
  v_mfma_f32_16x16x32_bf16 v[32:35], v[204:207], a[24:27], v[32:35]
  ds_read_b128 v[176:179], v253 offset:4096
  v_mfma_f32_16x16x32_bf16 v[36:39], v[204:207], a[28:31], v[36:39]
  ds_read_b128 v[180:183], v253 offset:5120
  buffer_load_dwordx4 v1, s[12:15], s20 offen offset:1024 sc1 lds
  v_mfma_f32_16x16x32_bf16 v[40:43], v[208:211], a[24:27], v[40:43]
  ds_read_b128 v[184:187], v253 offset:6144
  v_mfma_f32_16x16x32_bf16 v[44:47], v[208:211], a[28:31], v[44:47]
  ds_read_b128 v[188:191], v253 offset:7168
  v_mfma_f32_16x16x32_bf16 v[48:51], v[212:215], a[24:27], v[48:51]
  ds_read_b128 v[192:195], v253 offset:8192
  buffer_load_dwordx4 v1, s[12:15], s20 offen offset:2048 sc1 lds
  v_mfma_f32_16x16x32_bf16 v[52:55], v[212:215], a[28:31], v[52:55]
  v_exp_f32 v236, v236
  v_mfma_f32_16x16x32_bf16 v[56:59], v[216:219], a[24:27], v[56:59]
  s_add_u32 s20, s20, 3072
  s_add_u32 s21, s29, 2048
  s_add_u32 m0, s30, 0
  v_mfma_f32_16x16x32_bf16 v[60:63], v[216:219], a[28:31], v[60:63]
  buffer_load_dwordx4 v241, s[16:19], s21 offen offset:0 lds
  v_mfma_f32_16x16x32_bf16 v[64:67], v[220:223], a[24:27], v[64:67]
  v_exp_f32 v237, v237
  v_mfma_f32_16x16x32_bf16 v[68:71], v[220:223], a[28:31], v[68:71]
  v_exp_f32 v238, v238
  v_mfma_f32_16x16x32_bf16 v[72:75], v[224:227], a[24:27], v[72:75]
  buffer_load_dwordx4 v243, s[16:19], s21 offen offset:1024 lds
  v_mfma_f32_16x16x32_bf16 v[76:79], v[224:227], a[28:31], v[76:79]
  v_exp_f32 v239, v239
  v_mfma_f32_16x16x32_bf16 v[80:83], v[228:231], a[24:27], v[80:83]
  v_add_f32 v236, 1.0, v236
  v_add_f32 v237, 1.0, v237
  v_mfma_f32_16x16x32_bf16 v[84:87], v[228:231], a[28:31], v[84:87]
  v_add_f32 v238, 1.0, v238
  v_add_f32 v239, 1.0, v239
  s_waitcnt vmcnt(37) lgkmcnt(0)
  v_mfma_f32_16x16x32_bf16 v[16:19], v[160:163], a[32:35], v[16:19]
  ds_read_b128 v[196:199], v253 offset:9216
  v_mfma_f32_16x16x32_bf16 v[20:23], v[160:163], a[36:39], v[20:23]
  ds_read_b128 v[200:203], v253 offset:10240
  s_add_u32 m0, s7, 3072
  v_mfma_f32_16x16x32_bf16 v[24:27], v[164:167], a[32:35], v[24:27]
  ds_read_b128 v[204:207], v253 offset:11264
  buffer_load_dwordx4 v1, s[12:15], s20 offen offset:0 sc1 lds
  v_mfma_f32_16x16x32_bf16 v[28:31], v[164:167], a[36:39], v[28:31]
  ds_read_b128 v[208:211], v253 offset:12288
  v_mfma_f32_16x16x32_bf16 v[32:35], v[168:171], a[32:35], v[32:35]
  ds_read_b128 v[212:215], v253 offset:13312
  v_mfma_f32_16x16x32_bf16 v[36:39], v[168:171], a[36:39], v[36:39]
  ds_read_b128 v[216:219], v253 offset:14336
  v_mfma_f32_16x16x32_bf16 v[40:43], v[172:175], a[32:35], v[40:43]
  ds_read_b128 v[220:223], v253 offset:15360
  buffer_load_dwordx4 v1, s[12:15], s20 offen offset:1024 sc1 lds
  v_mfma_f32_16x16x32_bf16 v[44:47], v[172:175], a[36:39], v[44:47]
  ds_read_b128 v[224:227], v253 offset:16384
  v_mfma_f32_16x16x32_bf16 v[48:51], v[176:179], a[32:35], v[48:51]
  ds_read_b128 v[228:231], v253 offset:17408
  v_mfma_f32_16x16x32_bf16 v[52:55], v[176:179], a[36:39], v[52:55]
  ds_read_b128 a[192:195], v4 offset:4096
  s_add_u32 s20, s20, 2048
  s_add_u32 m0, s30, 0
  v_mfma_f32_16x16x32_bf16 v[56:59], v[180:183], a[32:35], v[56:59]
  ds_read_b128 a[196:199], v4 offset:6144
  buffer_load_dwordx4 v245, s[16:19], s21 offen offset:2048 lds
  v_mfma_f32_16x16x32_bf16 v[60:63], v[180:183], a[36:39], v[60:63]
  ds_read_b128 a[200:203], v8 offset:4096
  v_rcp_f32 v236, v236
  v_mfma_f32_16x16x32_bf16 v[64:67], v[184:187], a[32:35], v[64:67]
  ds_read_b128 a[204:207], v8 offset:6144
  v_rcp_f32 v237, v237
  v_mfma_f32_16x16x32_bf16 v[68:71], v[184:187], a[36:39], v[68:71]
  v_rcp_f32 v238, v238
  v_mfma_f32_16x16x32_bf16 v[72:75], v[188:191], a[32:35], v[72:75]
  buffer_load_dwordx4 v247, s[16:19], s21 offen offset:3072 lds
  v_mfma_f32_16x16x32_bf16 v[76:79], v[188:191], a[36:39], v[76:79]
  v_rcp_f32 v239, v239
  v_mul_f32 v92, v92, v236
  v_mfma_f32_16x16x32_bf16 v[80:83], v[192:195], a[32:35], v[80:83]
  v_mul_f32 v93, v93, v237
  v_mul_f32 v94, v94, v238
  v_mul_f32 v95, v95, v239
  v_mfma_f32_16x16x32_bf16 v[84:87], v[192:195], a[36:39], v[84:87]
  v_mul_f32 v232, v88, v88
  v_mul_f32 v233, v89, v89
  s_waitcnt lgkmcnt(0)
  v_mfma_f32_16x16x32_bf16 v[16:19], v[196:199], a[40:43], v[16:19]
  ds_read_b128 v[160:163], v253 offset:18432
  v_mul_f32 v234, v90, v90
  v_mfma_f32_16x16x32_bf16 v[20:23], v[196:199], a[44:47], v[20:23]
  ds_read_b128 v[164:167], v253 offset:19456
  s_add_u32 m0, s7, 5120
  v_mfma_f32_16x16x32_bf16 v[24:27], v[200:203], a[40:43], v[24:27]
  ds_read_b128 v[168:171], v253 offset:20480
  buffer_load_dwordx4 v1, s[12:15], s20 offen offset:0 sc1 lds
  v_mfma_f32_16x16x32_bf16 v[28:31], v[200:203], a[44:47], v[28:31]
  ds_read_b128 v[172:175], v253 offset:21504
  v_mul_f32 v235, v91, v91
  v_mfma_f32_16x16x32_bf16 v[32:35], v[204:207], a[40:43], v[32:35]
  ds_read_b128 v[176:179], v253 offset:22528
  v_fma_f32 v232, v232, s40, v14
  v_mfma_f32_16x16x32_bf16 v[36:39], v[204:207], a[44:47], v[36:39]
  ds_read_b128 v[180:183], v253 offset:23552
  v_fma_f32 v233, v233, s40, v14
  v_mfma_f32_16x16x32_bf16 v[40:43], v[208:211], a[40:43], v[40:43]
  ds_read_b128 v[184:187], v253 offset:24576
  buffer_load_dwordx4 v1, s[12:15], s20 offen offset:1024 sc1 lds
  v_mfma_f32_16x16x32_bf16 v[44:47], v[208:211], a[44:47], v[44:47]
  ds_read_b128 v[188:191], v253 offset:25600
  v_fma_f32 v234, v234, s40, v14
  v_mfma_f32_16x16x32_bf16 v[48:51], v[212:215], a[40:43], v[48:51]
  ds_read_b128 v[192:195], v253 offset:26624
  v_fma_f32 v235, v235, s40, v14
  v_mfma_f32_16x16x32_bf16 v[52:55], v[212:215], a[44:47], v[52:55]
  s_add_u32 s20, s20, 2048
  s_add_u32 s21, s29, 2176
  s_add_u32 m0, s30, 4096
  v_mfma_f32_16x16x32_bf16 v[56:59], v[216:219], a[40:43], v[56:59]
  buffer_load_dwordx4 v241, s[16:19], s21 offen offset:0 lds
  v_mfma_f32_16x16x32_bf16 v[60:63], v[216:219], a[44:47], v[60:63]
  v_mul_f32 v232, v232, v88
  v_mul_f32 v233, v233, v89
  v_mfma_f32_16x16x32_bf16 v[64:67], v[220:223], a[40:43], v[64:67]
  v_mul_f32 v234, v234, v90
  v_mul_f32 v235, v235, v91
  v_mfma_f32_16x16x32_bf16 v[68:71], v[220:223], a[44:47], v[68:71]
  v_mfma_f32_16x16x32_bf16 v[72:75], v[224:227], a[40:43], v[72:75]
  buffer_load_dwordx4 v243, s[16:19], s21 offen offset:1024 lds
  v_mfma_f32_16x16x32_bf16 v[76:79], v[224:227], a[44:47], v[76:79]
  v_mfma_f32_16x16x32_bf16 v[80:83], v[228:231], a[40:43], v[80:83]
  v_mfma_f32_16x16x32_bf16 v[84:87], v[228:231], a[44:47], v[84:87]
  s_waitcnt vmcnt(41) lgkmcnt(0)
  v_mfma_f32_16x16x32_bf16 v[16:19], v[160:163], a[48:51], v[16:19]
  ds_read_b128 v[196:199], v253 offset:27648
  v_mfma_f32_16x16x32_bf16 v[20:23], v[160:163], a[52:55], v[20:23]
  ds_read_b128 v[200:203], v253 offset:28672
  s_add_u32 m0, s7, 7168
  v_mfma_f32_16x16x32_bf16 v[24:27], v[164:167], a[48:51], v[24:27]
  ds_read_b128 v[204:207], v253 offset:29696
  buffer_load_dwordx4 v1, s[12:15], s20 offen offset:0 sc1 lds
  v_mfma_f32_16x16x32_bf16 v[28:31], v[164:167], a[52:55], v[28:31]
  ds_read_b128 v[208:211], v253 offset:30720
  v_mfma_f32_16x16x32_bf16 v[32:35], v[168:171], a[48:51], v[32:35]
  ds_read_b128 v[212:215], v253 offset:31744
  v_mfma_f32_16x16x32_bf16 v[36:39], v[168:171], a[52:55], v[36:39]
  ds_read_b128 v[216:219], v253 offset:32768
  v_mfma_f32_16x16x32_bf16 v[40:43], v[172:175], a[48:51], v[40:43]
  ds_read_b128 v[220:223], v253 offset:33792
  buffer_load_dwordx4 v1, s[12:15], s20 offen offset:1024 sc1 lds
  v_mfma_f32_16x16x32_bf16 v[44:47], v[172:175], a[52:55], v[44:47]
  ds_read_b128 v[224:227], v253 offset:34816
  v_mfma_f32_16x16x32_bf16 v[48:51], v[176:179], a[48:51], v[48:51]
  ds_read_b128 v[228:231], v253 offset:35840
  v_exp_f32 v232, v232
  v_mfma_f32_16x16x32_bf16 v[52:55], v[176:179], a[52:55], v[52:55]
  ds_read_b128 a[208:211], v4 offset:8192
  s_add_u32 s20, s20, 29696
  s_add_u32 m0, s30, 4096
  v_mfma_f32_16x16x32_bf16 v[56:59], v[180:183], a[48:51], v[56:59]
  ds_read_b128 a[212:215], v4 offset:10240
  buffer_load_dwordx4 v245, s[16:19], s21 offen offset:2048 lds
  v_mfma_f32_16x16x32_bf16 v[60:63], v[180:183], a[52:55], v[60:63]
  ds_read_b128 a[216:219], v8 offset:8192
  v_exp_f32 v233, v233
  v_mfma_f32_16x16x32_bf16 v[64:67], v[184:187], a[48:51], v[64:67]
  ds_read_b128 a[220:223], v8 offset:10240
  v_exp_f32 v234, v234
  v_mfma_f32_16x16x32_bf16 v[68:71], v[184:187], a[52:55], v[68:71]
  v_exp_f32 v235, v235
  v_add_f32 v232, 1.0, v232
  v_mfma_f32_16x16x32_bf16 v[72:75], v[188:191], a[48:51], v[72:75]
  buffer_load_dwordx4 v247, s[16:19], s21 offen offset:3072 lds
  v_add_f32 v233, 1.0, v233
  v_mfma_f32_16x16x32_bf16 v[76:79], v[188:191], a[52:55], v[76:79]
  v_add_f32 v234, 1.0, v234
  v_add_f32 v235, 1.0, v235
  v_mfma_f32_16x16x32_bf16 v[80:83], v[192:195], a[48:51], v[80:83]
  v_rcp_f32 v232, v232
  v_mfma_f32_16x16x32_bf16 v[84:87], v[192:195], a[52:55], v[84:87]
  v_rcp_f32 v233, v233
  s_waitcnt vmcnt(17) lgkmcnt(0)
  s_barrier
  v_mfma_f32_16x16x32_bf16 v[16:19], v[196:199], a[56:59], v[16:19]
  ds_read_b128 v[160:163], v254 offset:0
  v_mfma_f32_16x16x32_bf16 v[20:23], v[196:199], a[60:63], v[20:23]
  ds_read_b128 v[164:167], v254 offset:1024
  s_add_u32 m0, s7, 36864
  v_mfma_f32_16x16x32_bf16 v[24:27], v[200:203], a[56:59], v[24:27]
  ds_read_b128 v[168:171], v254 offset:2048
  buffer_load_dwordx4 v1, s[12:15], s20 offen offset:0 sc1 lds
  v_mfma_f32_16x16x32_bf16 v[28:31], v[200:203], a[60:63], v[28:31]
  ds_read_b128 v[172:175], v254 offset:3072
  v_mfma_f32_16x16x32_bf16 v[32:35], v[204:207], a[56:59], v[32:35]
  ds_read_b128 v[176:179], v254 offset:4096
  v_mfma_f32_16x16x32_bf16 v[36:39], v[204:207], a[60:63], v[36:39]
  ds_read_b128 v[180:183], v254 offset:5120
  buffer_load_dwordx4 v1, s[12:15], s20 offen offset:1024 sc1 lds
  v_mfma_f32_16x16x32_bf16 v[40:43], v[208:211], a[56:59], v[40:43]
  ds_read_b128 v[184:187], v254 offset:6144
  v_mfma_f32_16x16x32_bf16 v[44:47], v[208:211], a[60:63], v[44:47]
  ds_read_b128 v[188:191], v254 offset:7168
  v_mfma_f32_16x16x32_bf16 v[48:51], v[212:215], a[56:59], v[48:51]
  ds_read_b128 v[192:195], v254 offset:8192
  buffer_load_dwordx4 v1, s[12:15], s20 offen offset:2048 sc1 lds
  v_mfma_f32_16x16x32_bf16 v[52:55], v[212:215], a[60:63], v[52:55]
  v_rcp_f32 v234, v234
  v_mfma_f32_16x16x32_bf16 v[56:59], v[216:219], a[56:59], v[56:59]
  s_add_u32 s20, s20, 3072
  s_add_u32 s21, s29, 2304
  s_add_u32 m0, s30, 8192
  v_mfma_f32_16x16x32_bf16 v[60:63], v[216:219], a[60:63], v[60:63]
  buffer_load_dwordx4 v241, s[16:19], s21 offen offset:0 lds
  v_mfma_f32_16x16x32_bf16 v[64:67], v[220:223], a[56:59], v[64:67]
  v_rcp_f32 v235, v235
  v_mfma_f32_16x16x32_bf16 v[68:71], v[220:223], a[60:63], v[68:71]
  v_mul_f32 v88, v88, v232
  v_mul_f32 v89, v89, v233
  v_mfma_f32_16x16x32_bf16 v[72:75], v[224:227], a[56:59], v[72:75]
  buffer_load_dwordx4 v243, s[16:19], s21 offen offset:1024 lds
  v_mfma_f32_16x16x32_bf16 v[76:79], v[224:227], a[60:63], v[76:79]
  v_mul_f32 v90, v90, v234
  v_mul_f32 v91, v91, v235
  v_mfma_f32_16x16x32_bf16 v[80:83], v[228:231], a[56:59], v[80:83]
  v_mul_f32 v236, v100, v100
  v_mul_f32 v237, v101, v101
  v_mfma_f32_16x16x32_bf16 v[84:87], v[228:231], a[60:63], v[84:87]
  v_mul_f32 v238, v102, v102
  v_mul_f32 v239, v103, v103
  s_waitcnt lgkmcnt(0)
  v_mfma_f32_16x16x32_bf16 v[16:19], v[160:163], a[64:67], v[16:19]
  ds_read_b128 v[196:199], v254 offset:9216
  v_fma_f32 v236, v236, s40, v14
  v_mfma_f32_16x16x32_bf16 v[20:23], v[160:163], a[68:71], v[20:23]
  ds_read_b128 v[200:203], v254 offset:10240
  s_add_u32 m0, s7, 39936
  v_mfma_f32_16x16x32_bf16 v[24:27], v[164:167], a[64:67], v[24:27]
  ds_read_b128 v[204:207], v254 offset:11264
  buffer_load_dwordx4 v1, s[12:15], s20 offen offset:0 sc1 lds
  v_mfma_f32_16x16x32_bf16 v[28:31], v[164:167], a[68:71], v[28:31]
  ds_read_b128 v[208:211], v254 offset:12288
  v_fma_f32 v237, v237, s40, v14
  v_mfma_f32_16x16x32_bf16 v[32:35], v[168:171], a[64:67], v[32:35]
  ds_read_b128 v[212:215], v254 offset:13312
  v_fma_f32 v238, v238, s40, v14
  v_mfma_f32_16x16x32_bf16 v[36:39], v[168:171], a[68:71], v[36:39]
  ds_read_b128 v[216:219], v254 offset:14336
  v_fma_f32 v239, v239, s40, v14
  v_mfma_f32_16x16x32_bf16 v[40:43], v[172:175], a[64:67], v[40:43]
  ds_read_b128 v[220:223], v254 offset:15360
  buffer_load_dwordx4 v1, s[12:15], s20 offen offset:1024 sc1 lds
  v_mfma_f32_16x16x32_bf16 v[44:47], v[172:175], a[68:71], v[44:47]
  ds_read_b128 v[224:227], v254 offset:16384
  v_mul_f32 v236, v236, v100
  v_mfma_f32_16x16x32_bf16 v[48:51], v[176:179], a[64:67], v[48:51]
  ds_read_b128 v[228:231], v254 offset:17408
  v_mul_f32 v237, v237, v101
  v_mfma_f32_16x16x32_bf16 v[52:55], v[176:179], a[68:71], v[52:55]
  s_add_u32 s20, s20, 2048
  s_add_u32 m0, s30, 8192
  v_mfma_f32_16x16x32_bf16 v[56:59], v[180:183], a[64:67], v[56:59]
  buffer_load_dwordx4 v245, s[16:19], s21 offen offset:2048 lds
  v_mfma_f32_16x16x32_bf16 v[60:63], v[180:183], a[68:71], v[60:63]
  v_mul_f32 v238, v238, v102
  v_mul_f32 v239, v239, v103
  v_mfma_f32_16x16x32_bf16 v[64:67], v[184:187], a[64:67], v[64:67]
  v_exp_f32 v236, v236
  v_mfma_f32_16x16x32_bf16 v[68:71], v[184:187], a[68:71], v[68:71]
  v_exp_f32 v237, v237
  v_mfma_f32_16x16x32_bf16 v[72:75], v[188:191], a[64:67], v[72:75]
  buffer_load_dwordx4 v247, s[16:19], s21 offen offset:3072 lds
  v_mfma_f32_16x16x32_bf16 v[76:79], v[188:191], a[68:71], v[76:79]
  v_mfma_f32_16x16x32_bf16 v[80:83], v[192:195], a[64:67], v[80:83]
  v_mfma_f32_16x16x32_bf16 v[84:87], v[192:195], a[68:71], v[84:87]
  s_waitcnt vmcnt(17) lgkmcnt(0)
  v_mfma_f32_16x16x32_bf16 v[16:19], v[196:199], a[72:75], v[16:19]
  ds_read_b128 v[160:163], v254 offset:18432
  v_mfma_f32_16x16x32_bf16 v[20:23], v[196:199], a[76:79], v[20:23]
  ds_read_b128 v[164:167], v254 offset:19456
  s_add_u32 m0, s7, 41984
  v_mfma_f32_16x16x32_bf16 v[24:27], v[200:203], a[72:75], v[24:27]
  ds_read_b128 v[168:171], v254 offset:20480
  buffer_load_dwordx4 v1, s[12:15], s20 offen offset:0 sc1 lds
  v_mfma_f32_16x16x32_bf16 v[28:31], v[200:203], a[76:79], v[28:31]
  ds_read_b128 v[172:175], v254 offset:21504
  v_mfma_f32_16x16x32_bf16 v[32:35], v[204:207], a[72:75], v[32:35]
  ds_read_b128 v[176:179], v254 offset:22528
  v_mfma_f32_16x16x32_bf16 v[36:39], v[204:207], a[76:79], v[36:39]
  ds_read_b128 v[180:183], v254 offset:23552
  v_mfma_f32_16x16x32_bf16 v[40:43], v[208:211], a[72:75], v[40:43]
  ds_read_b128 v[184:187], v254 offset:24576
  v_mfma_f32_16x16x32_bf16 v[44:47], v[208:211], a[76:79], v[44:47]
  ds_read_b128 v[188:191], v254 offset:25600
  buffer_load_dwordx4 v1, s[12:15], s20 offen offset:1024 sc1 lds
  v_mfma_f32_16x16x32_bf16 v[48:51], v[212:215], a[72:75], v[48:51]
  ds_read_b128 v[192:195], v254 offset:26624
  v_mfma_f32_16x16x32_bf16 v[52:55], v[212:215], a[76:79], v[52:55]
  ds_read_b128 a[0:3], v4 offset:0
  v_exp_f32 v238, v238
  v_mfma_f32_16x16x32_bf16 v[56:59], v[216:219], a[72:75], v[56:59]
  ds_read_b128 a[4:7], v4 offset:2048
  v_exp_f32 v239, v239
  v_mfma_f32_16x16x32_bf16 v[60:63], v[216:219], a[76:79], v[60:63]
  ds_read_b128 a[8:11], v8 offset:0
  s_add_u32 s20, s20, 2048
  v_add_f32 v236, 1.0, v236
  v_mfma_f32_16x16x32_bf16 v[64:67], v[220:223], a[72:75], v[64:67]
  ds_read_b128 a[12:15], v8 offset:2048
  buffer_load_dword v15, v255, s[32:35], 0 offen
  v_mfma_f32_16x16x32_bf16 v[68:71], v[220:223], a[76:79], v[68:71]
  v_add_f32 v237, 1.0, v237
  v_add_f32 v238, 1.0, v238
  v_add_f32 v239, 1.0, v239
  v_mfma_f32_16x16x32_bf16 v[72:75], v[224:227], a[72:75], v[72:75]
  v_rcp_f32 v236, v236
  v_mfma_f32_16x16x32_bf16 v[76:79], v[224:227], a[76:79], v[76:79]
  v_rcp_f32 v237, v237
  v_mfma_f32_16x16x32_bf16 v[80:83], v[228:231], a[72:75], v[80:83]
  v_rcp_f32 v238, v238
  v_mfma_f32_16x16x32_bf16 v[84:87], v[228:231], a[76:79], v[84:87]
  v_rcp_f32 v239, v239
  s_waitcnt lgkmcnt(0)
  v_mfma_f32_16x16x32_bf16 v[16:19], v[160:163], a[80:83], v[16:19]
  ds_read_b128 v[196:199], v254 offset:27648
  v_mul_f32 v100, v100, v236
  v_mfma_f32_16x16x32_bf16 v[20:23], v[160:163], a[84:87], v[20:23]
  ds_read_b128 v[200:203], v254 offset:28672
  s_add_u32 m0, s7, 44032
  v_mfma_f32_16x16x32_bf16 v[24:27], v[164:167], a[80:83], v[24:27]
  ds_read_b128 v[204:207], v254 offset:29696
  buffer_load_dwordx4 v1, s[12:15], s20 offen offset:0 sc1 lds
  v_mfma_f32_16x16x32_bf16 v[28:31], v[164:167], a[84:87], v[28:31]
  ds_read_b128 v[208:211], v254 offset:30720
  v_mul_f32 v101, v101, v237
  v_mfma_f32_16x16x32_bf16 v[32:35], v[168:171], a[80:83], v[32:35]
  ds_read_b128 v[212:215], v254 offset:31744
  v_mul_f32 v102, v102, v238
  v_mfma_f32_16x16x32_bf16 v[36:39], v[168:171], a[84:87], v[36:39]
  ds_read_b128 v[216:219], v254 offset:32768
  v_mul_f32 v103, v103, v239
  v_mfma_f32_16x16x32_bf16 v[40:43], v[172:175], a[80:83], v[40:43]
  ds_read_b128 v[220:223], v254 offset:33792
  buffer_load_dwordx4 v1, s[12:15], s20 offen offset:1024 sc1 lds
  v_mfma_f32_16x16x32_bf16 v[44:47], v[172:175], a[84:87], v[44:47]
  ds_read_b128 v[224:227], v254 offset:34816
  v_mul_f32 v232, v96, v96
  v_mfma_f32_16x16x32_bf16 v[48:51], v[176:179], a[80:83], v[48:51]
  ds_read_b128 v[228:231], v254 offset:35840
  v_mul_f32 v233, v97, v97
  v_mfma_f32_16x16x32_bf16 v[52:55], v[176:179], a[84:87], v[52:55]
  s_add_u32 s20, s20, 29696
  s_add_u32 s21, s29, 2432
  s_add_u32 m0, s30, 0
  v_mfma_f32_16x16x32_bf16 v[56:59], v[180:183], a[80:83], v[56:59]
  buffer_load_dwordx4 v241, s[16:19], s21 offen offset:0 lds
  v_mfma_f32_16x16x32_bf16 v[60:63], v[180:183], a[84:87], v[60:63]
  v_mul_f32 v234, v98, v98
  v_mul_f32 v235, v99, v99
  v_mfma_f32_16x16x32_bf16 v[64:67], v[184:187], a[80:83], v[64:67]
  v_fma_f32 v232, v232, s40, v14
  v_fma_f32 v233, v233, s40, v14
  v_mfma_f32_16x16x32_bf16 v[68:71], v[184:187], a[84:87], v[68:71]
  v_mfma_f32_16x16x32_bf16 v[72:75], v[188:191], a[80:83], v[72:75]
  buffer_load_dwordx4 v243, s[16:19], s21 offen offset:1024 lds
  v_mfma_f32_16x16x32_bf16 v[76:79], v[188:191], a[84:87], v[76:79]
  v_mfma_f32_16x16x32_bf16 v[80:83], v[192:195], a[80:83], v[80:83]
  v_mfma_f32_16x16x32_bf16 v[84:87], v[192:195], a[84:87], v[84:87]
  s_waitcnt vmcnt(16) lgkmcnt(0)
  s_barrier
  v_mfma_f32_16x16x32_bf16 v[16:19], v[196:199], a[88:91], v[16:19]
  ds_read_b128 v[160:163], v252 offset:0
  v_fma_f32 v234, v234, s40, v14
  v_mfma_f32_16x16x32_bf16 v[20:23], v[196:199], a[92:95], v[20:23]
  ds_read_b128 v[164:167], v252 offset:1024
  s_add_u32 m0, s7, 73728
  v_mfma_f32_16x16x32_bf16 v[24:27], v[200:203], a[88:91], v[24:27]
  ds_read_b128 v[168:171], v252 offset:2048
  buffer_load_dwordx4 v1, s[12:15], s20 offen offset:0 sc1 lds
  v_mfma_f32_16x16x32_bf16 v[28:31], v[200:203], a[92:95], v[28:31]
  ds_read_b128 v[172:175], v252 offset:3072
  v_fma_f32 v235, v235, s40, v14
  v_mfma_f32_16x16x32_bf16 v[32:35], v[204:207], a[88:91], v[32:35]
  ds_read_b128 v[176:179], v252 offset:4096
  v_mul_f32 v232, v232, v96
  v_mfma_f32_16x16x32_bf16 v[36:39], v[204:207], a[92:95], v[36:39]
  ds_read_b128 v[180:183], v252 offset:5120
  buffer_load_dwordx4 v1, s[12:15], s20 offen offset:1024 sc1 lds
  v_mfma_f32_16x16x32_bf16 v[40:43], v[208:211], a[88:91], v[40:43]
  ds_read_b128 v[184:187], v252 offset:6144
  v_mul_f32 v233, v233, v97
  v_mfma_f32_16x16x32_bf16 v[44:47], v[208:211], a[92:95], v[44:47]
  ds_read_b128 v[188:191], v252 offset:7168
  v_mul_f32 v234, v234, v98
  v_mfma_f32_16x16x32_bf16 v[48:51], v[212:215], a[88:91], v[48:51]
  ds_read_b128 v[192:195], v252 offset:8192
  buffer_load_dwordx4 v1, s[12:15], s20 offen offset:2048 sc1 lds
  v_mfma_f32_16x16x32_bf16 v[52:55], v[212:215], a[92:95], v[52:55]
  ds_read_b128 a[16:19], v4 offset:4096
  v_mul_f32 v235, v235, v99
  v_mfma_f32_16x16x32_bf16 v[56:59], v[216:219], a[88:91], v[56:59]
  ds_read_b128 a[20:23], v4 offset:6144
  s_add_u32 s20, s20, 3072
  s_add_u32 m0, s30, 0
  v_mfma_f32_16x16x32_bf16 v[60:63], v[216:219], a[92:95], v[60:63]
  ds_read_b128 a[24:27], v8 offset:4096
  buffer_load_dwordx4 v245, s[16:19], s21 offen offset:2048 lds
  v_mfma_f32_16x16x32_bf16 v[64:67], v[220:223], a[88:91], v[64:67]
  ds_read_b128 a[28:31], v8 offset:6144
  v_mfma_f32_16x16x32_bf16 v[68:71], v[220:223], a[92:95], v[68:71]
  v_exp_f32 v232, v232
  v_mfma_f32_16x16x32_bf16 v[72:75], v[224:227], a[88:91], v[72:75]
  buffer_load_dwordx4 v247, s[16:19], s21 offen offset:3072 lds
  v_mfma_f32_16x16x32_bf16 v[76:79], v[224:227], a[92:95], v[76:79]
  v_exp_f32 v233, v233
  v_mfma_f32_16x16x32_bf16 v[80:83], v[228:231], a[88:91], v[80:83]
  v_exp_f32 v234, v234
  v_mfma_f32_16x16x32_bf16 v[84:87], v[228:231], a[92:95], v[84:87]
  v_exp_f32 v235, v235
  s_waitcnt lgkmcnt(0)
  v_mfma_f32_16x16x32_bf16 v[16:19], v[160:163], a[96:99], v[16:19]
  ds_read_b128 v[196:199], v252 offset:9216
  v_add_f32 v232, 1.0, v232
  v_mfma_f32_16x16x32_bf16 v[20:23], v[160:163], a[100:103], v[20:23]
  ds_read_b128 v[200:203], v252 offset:10240
  s_add_u32 m0, s7, 76800
  v_mfma_f32_16x16x32_bf16 v[24:27], v[164:167], a[96:99], v[24:27]
  ds_read_b128 v[204:207], v252 offset:11264
  buffer_load_dwordx4 v1, s[12:15], s20 offen offset:0 sc1 lds
  v_mfma_f32_16x16x32_bf16 v[28:31], v[164:167], a[100:103], v[28:31]
  ds_read_b128 v[208:211], v252 offset:12288
  v_add_f32 v233, 1.0, v233
  v_mfma_f32_16x16x32_bf16 v[32:35], v[168:171], a[96:99], v[32:35]
  ds_read_b128 v[212:215], v252 offset:13312
  v_add_f32 v234, 1.0, v234
  v_mfma_f32_16x16x32_bf16 v[36:39], v[168:171], a[100:103], v[36:39]
  ds_read_b128 v[216:219], v252 offset:14336
  v_add_f32 v235, 1.0, v235
  v_mfma_f32_16x16x32_bf16 v[40:43], v[172:175], a[96:99], v[40:43]
  ds_read_b128 v[220:223], v252 offset:15360
  buffer_load_dwordx4 v1, s[12:15], s20 offen offset:1024 sc1 lds
  v_mfma_f32_16x16x32_bf16 v[44:47], v[172:175], a[100:103], v[44:47]
  ds_read_b128 v[224:227], v252 offset:16384
  v_mfma_f32_16x16x32_bf16 v[48:51], v[176:179], a[96:99], v[48:51]
  ds_read_b128 v[228:231], v252 offset:17408
  v_mfma_f32_16x16x32_bf16 v[52:55], v[176:179], a[100:103], v[52:55]
  s_add_u32 s20, s20, 2048
  s_add_u32 s21, s29, 2560
  s_add_u32 m0, s30, 4096
  v_mfma_f32_16x16x32_bf16 v[56:59], v[180:183], a[96:99], v[56:59]
  buffer_load_dwordx4 v241, s[16:19], s21 offen offset:0 lds
  v_mfma_f32_16x16x32_bf16 v[60:63], v[180:183], a[100:103], v[60:63]
  v_rcp_f32 v232, v232
  v_mfma_f32_16x16x32_bf16 v[64:67], v[184:187], a[96:99], v[64:67]
  v_rcp_f32 v233, v233
  v_mfma_f32_16x16x32_bf16 v[68:71], v[184:187], a[100:103], v[68:71]
  v_rcp_f32 v234, v234
  v_mfma_f32_16x16x32_bf16 v[72:75], v[188:191], a[96:99], v[72:75]
  buffer_load_dwordx4 v243, s[16:19], s21 offen offset:1024 lds
  v_mfma_f32_16x16x32_bf16 v[76:79], v[188:191], a[100:103], v[76:79]
  v_rcp_f32 v235, v235
  v_mfma_f32_16x16x32_bf16 v[80:83], v[192:195], a[96:99], v[80:83]
  v_mul_f32 v96, v96, v232
  v_mul_f32 v97, v97, v233
  v_mfma_f32_16x16x32_bf16 v[84:87], v[192:195], a[100:103], v[84:87]
  s_waitcnt lgkmcnt(0)
  v_mfma_f32_16x16x32_bf16 v[16:19], v[196:199], a[104:107], v[16:19]
  ds_read_b128 v[160:163], v252 offset:18432
  v_mul_f32 v98, v98, v234
  v_mfma_f32_16x16x32_bf16 v[20:23], v[196:199], a[108:111], v[20:23]
  ds_read_b128 v[164:167], v252 offset:19456
  s_add_u32 m0, s7, 78848
  v_mfma_f32_16x16x32_bf16 v[24:27], v[200:203], a[104:107], v[24:27]
  ds_read_b128 v[168:171], v252 offset:20480
  buffer_load_dwordx4 v1, s[12:15], s20 offen offset:0 sc1 lds
  v_mfma_f32_16x16x32_bf16 v[28:31], v[200:203], a[108:111], v[28:31]
  ds_read_b128 v[172:175], v252 offset:21504
  v_mul_f32 v99, v99, v235
  v_mfma_f32_16x16x32_bf16 v[32:35], v[204:207], a[104:107], v[32:35]
  ds_read_b128 v[176:179], v252 offset:22528
  v_mul_f32 v236, v108, v108
  v_mfma_f32_16x16x32_bf16 v[36:39], v[204:207], a[108:111], v[36:39]
  ds_read_b128 v[180:183], v252 offset:23552
  v_mul_f32 v237, v109, v109
  v_mfma_f32_16x16x32_bf16 v[40:43], v[208:211], a[104:107], v[40:43]
  ds_read_b128 v[184:187], v252 offset:24576
  buffer_load_dwordx4 v1, s[12:15], s20 offen offset:1024 sc1 lds
  v_mfma_f32_16x16x32_bf16 v[44:47], v[208:211], a[108:111], v[44:47]
  ds_read_b128 v[188:191], v252 offset:25600
  v_mul_f32 v238, v110, v110
  v_mfma_f32_16x16x32_bf16 v[48:51], v[212:215], a[104:107], v[48:51]
  ds_read_b128 v[192:195], v252 offset:26624
  v_mul_f32 v239, v111, v111
  v_mfma_f32_16x16x32_bf16 v[52:55], v[212:215], a[108:111], v[52:55]
  s_add_u32 s20, s20, 2048
  s_add_u32 m0, s30, 4096
  v_mfma_f32_16x16x32_bf16 v[56:59], v[216:219], a[104:107], v[56:59]
  buffer_load_dwordx4 v245, s[16:19], s21 offen offset:2048 lds
  v_mfma_f32_16x16x32_bf16 v[60:63], v[216:219], a[108:111], v[60:63]
  v_fma_f32 v236, v236, s40, v14
  v_fma_f32 v237, v237, s40, v14
  v_mfma_f32_16x16x32_bf16 v[64:67], v[220:223], a[104:107], v[64:67]
  v_fma_f32 v238, v238, s40, v14
  v_fma_f32 v239, v239, s40, v14
  v_mfma_f32_16x16x32_bf16 v[68:71], v[220:223], a[108:111], v[68:71]
  v_mfma_f32_16x16x32_bf16 v[72:75], v[224:227], a[104:107], v[72:75]
  buffer_load_dwordx4 v247, s[16:19], s21 offen offset:3072 lds
  v_mfma_f32_16x16x32_bf16 v[76:79], v[224:227], a[108:111], v[76:79]
  v_mfma_f32_16x16x32_bf16 v[80:83], v[228:231], a[104:107], v[80:83]
  v_mfma_f32_16x16x32_bf16 v[84:87], v[228:231], a[108:111], v[84:87]
  s_waitcnt vmcnt(20) lgkmcnt(0)
  v_mfma_f32_16x16x32_bf16 v[16:19], v[160:163], a[112:115], v[16:19]
  ds_read_b128 v[196:199], v252 offset:27648
  v_mul_f32 v236, v236, v108
  v_mfma_f32_16x16x32_bf16 v[20:23], v[160:163], a[116:119], v[20:23]
  ds_read_b128 v[200:203], v252 offset:28672
  s_add_u32 m0, s7, 80896
  v_mfma_f32_16x16x32_bf16 v[24:27], v[164:167], a[112:115], v[24:27]
  ds_read_b128 v[204:207], v252 offset:29696
  buffer_load_dwordx4 v1, s[12:15], s20 offen offset:0 sc1 lds
  v_mfma_f32_16x16x32_bf16 v[28:31], v[164:167], a[116:119], v[28:31]
  ds_read_b128 v[208:211], v252 offset:30720
  v_mul_f32 v237, v237, v109
  v_mfma_f32_16x16x32_bf16 v[32:35], v[168:171], a[112:115], v[32:35]
  ds_read_b128 v[212:215], v252 offset:31744
  v_mul_f32 v238, v238, v110
  v_mfma_f32_16x16x32_bf16 v[36:39], v[168:171], a[116:119], v[36:39]
  ds_read_b128 v[216:219], v252 offset:32768
  v_mul_f32 v239, v239, v111
  v_mfma_f32_16x16x32_bf16 v[40:43], v[172:175], a[112:115], v[40:43]
  ds_read_b128 v[220:223], v252 offset:33792
  v_mfma_f32_16x16x32_bf16 v[44:47], v[172:175], a[116:119], v[44:47]
  ds_read_b128 v[224:227], v252 offset:34816
  v_mfma_f32_16x16x32_bf16 v[48:51], v[176:179], a[112:115], v[48:51]
  ds_read_b128 v[228:231], v252 offset:35840
  v_mfma_f32_16x16x32_bf16 v[52:55], v[176:179], a[116:119], v[52:55]
  ds_read_b128 a[32:35], v4 offset:8192
  v_mfma_f32_16x16x32_bf16 v[56:59], v[180:183], a[112:115], v[56:59]
  ds_read_b128 a[36:39], v4 offset:10240
  buffer_load_dwordx4 v1, s[12:15], s20 offen offset:1024 sc1 lds
  v_mfma_f32_16x16x32_bf16 v[60:63], v[180:183], a[116:119], v[60:63]
  ds_read_b128 a[40:43], v8 offset:8192
  v_mfma_f32_16x16x32_bf16 v[64:67], v[184:187], a[112:115], v[64:67]
  ds_read_b128 a[44:47], v8 offset:10240
  v_mfma_f32_16x16x32_bf16 v[68:71], v[184:187], a[116:119], v[68:71]
  v_exp_f32 v236, v236
  v_mfma_f32_16x16x32_bf16 v[72:75], v[188:191], a[112:115], v[72:75]
  v_exp_f32 v237, v237
  v_mfma_f32_16x16x32_bf16 v[76:79], v[188:191], a[116:119], v[76:79]
  v_exp_f32 v238, v238
  v_mfma_f32_16x16x32_bf16 v[80:83], v[192:195], a[112:115], v[80:83]
  v_exp_f32 v239, v239
  v_mfma_f32_16x16x32_bf16 v[84:87], v[192:195], a[116:119], v[84:87]
  v_add_f32 v236, 1.0, v236
  v_add_f32 v237, 1.0, v237
  v_add_f32 v238, 1.0, v238
  s_add_u32 s20, s20, 29696
  s_waitcnt vmcnt(17) lgkmcnt(0)
  s_barrier
  v_mfma_f32_16x16x32_bf16 v[16:19], v[196:199], a[120:123], v[16:19]
  ds_read_b128 v[160:163], v253 offset:0
  v_add_f32 v239, 1.0, v239
  v_mfma_f32_16x16x32_bf16 v[20:23], v[196:199], a[124:127], v[20:23]
  ds_read_b128 v[164:167], v253 offset:1024
  s_add_u32 m0, s7, 0
  v_mfma_f32_16x16x32_bf16 v[24:27], v[200:203], a[120:123], v[24:27]
  ds_read_b128 v[168:171], v253 offset:2048
  buffer_load_dwordx4 v1, s[12:15], s20 offen offset:0 sc1 lds
  v_mfma_f32_16x16x32_bf16 v[28:31], v[200:203], a[124:127], v[28:31]
  ds_read_b128 v[172:175], v253 offset:3072
  v_mfma_f32_16x16x32_bf16 v[32:35], v[204:207], a[120:123], v[32:35]
  ds_read_b128 v[176:179], v253 offset:4096
  v_mfma_f32_16x16x32_bf16 v[36:39], v[204:207], a[124:127], v[36:39]
  ds_read_b128 v[180:183], v253 offset:5120
  buffer_load_dwordx4 v1, s[12:15], s20 offen offset:1024 sc1 lds
  v_mfma_f32_16x16x32_bf16 v[40:43], v[208:211], a[120:123], v[40:43]
  ds_read_b128 v[184:187], v253 offset:6144
  v_mfma_f32_16x16x32_bf16 v[44:47], v[208:211], a[124:127], v[44:47]
  ds_read_b128 v[188:191], v253 offset:7168
  v_mfma_f32_16x16x32_bf16 v[48:51], v[212:215], a[120:123], v[48:51]
  ds_read_b128 v[192:195], v253 offset:8192
  buffer_load_dwordx4 v1, s[12:15], s20 offen offset:2048 sc1 lds
  v_mfma_f32_16x16x32_bf16 v[52:55], v[212:215], a[124:127], v[52:55]
  v_rcp_f32 v236, v236
  v_mfma_f32_16x16x32_bf16 v[56:59], v[216:219], a[120:123], v[56:59]
  s_add_u32 s20, s20, 3072
  s_add_u32 s21, s29, 2688
  s_add_u32 m0, s30, 8192
  v_mfma_f32_16x16x32_bf16 v[60:63], v[216:219], a[124:127], v[60:63]
  buffer_load_dwordx4 v241, s[16:19], s21 offen offset:0 lds
  v_mfma_f32_16x16x32_bf16 v[64:67], v[220:223], a[120:123], v[64:67]
  v_rcp_f32 v237, v237
  v_mfma_f32_16x16x32_bf16 v[68:71], v[220:223], a[124:127], v[68:71]
  v_rcp_f32 v238, v238
  v_mfma_f32_16x16x32_bf16 v[72:75], v[224:227], a[120:123], v[72:75]
  buffer_load_dwordx4 v243, s[16:19], s21 offen offset:1024 lds
  v_mfma_f32_16x16x32_bf16 v[76:79], v[224:227], a[124:127], v[76:79]
  v_rcp_f32 v239, v239
  v_mfma_f32_16x16x32_bf16 v[80:83], v[228:231], a[120:123], v[80:83]
  v_mul_f32 v108, v108, v236
  v_mul_f32 v109, v109, v237
  v_mfma_f32_16x16x32_bf16 v[84:87], v[228:231], a[124:127], v[84:87]
  v_mul_f32 v110, v110, v238
  v_mul_f32 v111, v111, v239
  v_mul_f32 v232, v104, v104
  s_waitcnt vmcnt(15) lgkmcnt(0)
  v_mfma_f32_16x16x32_bf16 v[16:19], v[160:163], a[128:131], v[16:19]
  ds_read_b128 v[196:199], v253 offset:9216
  v_mul_f32 v233, v105, v105
  v_mfma_f32_16x16x32_bf16 v[20:23], v[160:163], a[132:135], v[20:23]
  ds_read_b128 v[200:203], v253 offset:10240
  s_add_u32 m0, s7, 3072
  v_mfma_f32_16x16x32_bf16 v[24:27], v[164:167], a[128:131], v[24:27]
  ds_read_b128 v[204:207], v253 offset:11264
  buffer_load_dwordx4 v1, s[12:15], s20 offen offset:0 sc1 lds
  v_mfma_f32_16x16x32_bf16 v[28:31], v[164:167], a[132:135], v[28:31]
  ds_read_b128 v[208:211], v253 offset:12288
  v_mul_f32 v234, v106, v106
  v_mfma_f32_16x16x32_bf16 v[32:35], v[168:171], a[128:131], v[32:35]
  ds_read_b128 v[212:215], v253 offset:13312
  v_mul_f32 v235, v107, v107
  v_mfma_f32_16x16x32_bf16 v[36:39], v[168:171], a[132:135], v[36:39]
  ds_read_b128 v[216:219], v253 offset:14336
  v_fma_f32 v232, v232, s40, v14
  v_mfma_f32_16x16x32_bf16 v[40:43], v[172:175], a[128:131], v[40:43]
  ds_read_b128 v[220:223], v253 offset:15360
  buffer_load_dwordx4 v1, s[12:15], s20 offen offset:1024 sc1 lds
  v_mfma_f32_16x16x32_bf16 v[44:47], v[172:175], a[132:135], v[44:47]
  ds_read_b128 v[224:227], v253 offset:16384
  v_fma_f32 v233, v233, s40, v14
  v_mfma_f32_16x16x32_bf16 v[48:51], v[176:179], a[128:131], v[48:51]
  ds_read_b128 v[228:231], v253 offset:17408
  v_fma_f32 v234, v234, s40, v14
  v_mfma_f32_16x16x32_bf16 v[52:55], v[176:179], a[132:135], v[52:55]
  ds_read_b128 a[48:51], v4 offset:0
  s_add_u32 s20, s20, 2048
  s_add_u32 m0, s30, 8192
  v_mfma_f32_16x16x32_bf16 v[56:59], v[180:183], a[128:131], v[56:59]
  ds_read_b128 a[52:55], v4 offset:2048
  buffer_load_dwordx4 v245, s[16:19], s21 offen offset:2048 lds
  v_mfma_f32_16x16x32_bf16 v[60:63], v[180:183], a[132:135], v[60:63]
  ds_read_b128 a[56:59], v8 offset:0
  v_fma_f32 v235, v235, s40, v14
  v_mfma_f32_16x16x32_bf16 v[64:67], v[184:187], a[128:131], v[64:67]
  ds_read_b128 a[60:63], v8 offset:2048
  v_mul_f32 v232, v232, v104
  v_mfma_f32_16x16x32_bf16 v[68:71], v[184:187], a[132:135], v[68:71]
  v_mul_f32 v233, v233, v105
  v_mul_f32 v234, v234, v106
  v_mfma_f32_16x16x32_bf16 v[72:75], v[188:191], a[128:131], v[72:75]
  buffer_load_dwordx4 v247, s[16:19], s21 offen offset:3072 lds
  v_mfma_f32_16x16x32_bf16 v[76:79], v[188:191], a[132:135], v[76:79]
  v_mfma_f32_16x16x32_bf16 v[80:83], v[192:195], a[128:131], v[80:83]
  v_mfma_f32_16x16x32_bf16 v[84:87], v[192:195], a[132:135], v[84:87]
  s_waitcnt lgkmcnt(0)
  v_mfma_f32_16x16x32_bf16 v[16:19], v[196:199], a[136:139], v[16:19]
  ds_read_b128 v[160:163], v253 offset:18432
  v_mul_f32 v235, v235, v107
  v_mfma_f32_16x16x32_bf16 v[20:23], v[196:199], a[140:143], v[20:23]
  ds_read_b128 v[164:167], v253 offset:19456
  s_add_u32 m0, s7, 5120
  v_mfma_f32_16x16x32_bf16 v[24:27], v[200:203], a[136:139], v[24:27]
  ds_read_b128 v[168:171], v253 offset:20480
  buffer_load_dwordx4 v1, s[12:15], s20 offen offset:0 sc1 lds
  v_mfma_f32_16x16x32_bf16 v[28:31], v[200:203], a[140:143], v[28:31]
  ds_read_b128 v[172:175], v253 offset:21504
  v_mfma_f32_16x16x32_bf16 v[32:35], v[204:207], a[136:139], v[32:35]
  ds_read_b128 v[176:179], v253 offset:22528
  v_mfma_f32_16x16x32_bf16 v[36:39], v[204:207], a[140:143], v[36:39]
  ds_read_b128 v[180:183], v253 offset:23552
  buffer_load_dwordx4 v1, s[12:15], s20 offen offset:1024 sc1 lds
  v_mfma_f32_16x16x32_bf16 v[40:43], v[208:211], a[136:139], v[40:43]
  ds_read_b128 v[184:187], v253 offset:24576
  v_mfma_f32_16x16x32_bf16 v[44:47], v[208:211], a[140:143], v[44:47]
  ds_read_b128 v[188:191], v253 offset:25600
  s_add_u32 s20, s20, 2048
  s_add_u32 s21, s29, 2816
  s_add_u32 m0, s30, 0
  v_mfma_f32_16x16x32_bf16 v[48:51], v[212:215], a[136:139], v[48:51]
  ds_read_b128 v[192:195], v253 offset:26624
  buffer_load_dwordx4 v241, s[16:19], s21 offen offset:0 lds
  v_mfma_f32_16x16x32_bf16 v[52:55], v[212:215], a[140:143], v[52:55]
  v_exp_f32 v232, v232
  v_mfma_f32_16x16x32_bf16 v[56:59], v[216:219], a[136:139], v[56:59]
  v_exp_f32 v233, v233
  v_mfma_f32_16x16x32_bf16 v[60:63], v[216:219], a[140:143], v[60:63]
  buffer_load_dwordx4 v243, s[16:19], s21 offen offset:1024 lds
  v_mfma_f32_16x16x32_bf16 v[64:67], v[220:223], a[136:139], v[64:67]
  v_exp_f32 v234, v234
  v_mfma_f32_16x16x32_bf16 v[68:71], v[220:223], a[140:143], v[68:71]
  v_exp_f32 v235, v235
  v_mfma_f32_16x16x32_bf16 v[72:75], v[224:227], a[136:139], v[72:75]
  buffer_load_dword v15, v255, s[32:35], 0 offen
  v_mfma_f32_16x16x32_bf16 v[76:79], v[224:227], a[140:143], v[76:79]
  v_add_f32 v232, 1.0, v232
  v_add_f32 v233, 1.0, v233
  v_mfma_f32_16x16x32_bf16 v[80:83], v[228:231], a[136:139], v[80:83]
  v_add_f32 v234, 1.0, v234
  v_add_f32 v235, 1.0, v235
  v_mfma_f32_16x16x32_bf16 v[84:87], v[228:231], a[140:143], v[84:87]
  v_rcp_f32 v232, v232
  s_waitcnt lgkmcnt(0)
  v_mfma_f32_16x16x32_bf16 v[16:19], v[160:163], a[144:147], v[16:19]
  ds_read_b128 v[196:199], v253 offset:27648
  v_mfma_f32_16x16x32_bf16 v[20:23], v[160:163], a[148:151], v[20:23]
  ds_read_b128 v[200:203], v253 offset:28672
  s_add_u32 m0, s7, 7168
  v_mfma_f32_16x16x32_bf16 v[24:27], v[164:167], a[144:147], v[24:27]
  ds_read_b128 v[204:207], v253 offset:29696
  buffer_load_dwordx4 v1, s[12:15], s20 offen offset:0 sc1 lds
  v_mfma_f32_16x16x32_bf16 v[28:31], v[164:167], a[148:151], v[28:31]
  ds_read_b128 v[208:211], v253 offset:30720
  v_mfma_f32_16x16x32_bf16 v[32:35], v[168:171], a[144:147], v[32:35]
  ds_read_b128 v[212:215], v253 offset:31744
  v_mfma_f32_16x16x32_bf16 v[36:39], v[168:171], a[148:151], v[36:39]
  ds_read_b128 v[216:219], v253 offset:32768
  v_mfma_f32_16x16x32_bf16 v[40:43], v[172:175], a[144:147], v[40:43]
  ds_read_b128 v[220:223], v253 offset:33792
  buffer_load_dwordx4 v1, s[12:15], s20 offen offset:1024 sc1 lds
  v_mfma_f32_16x16x32_bf16 v[44:47], v[172:175], a[148:151], v[44:47]
  ds_read_b128 v[224:227], v253 offset:34816
  v_mfma_f32_16x16x32_bf16 v[48:51], v[176:179], a[144:147], v[48:51]
  ds_read_b128 v[228:231], v253 offset:35840
  v_mfma_f32_16x16x32_bf16 v[52:55], v[176:179], a[148:151], v[52:55]
  s_add_u32 s20, s20, 29696
  s_add_u32 m0, s30, 0
  v_mfma_f32_16x16x32_bf16 v[56:59], v[180:183], a[144:147], v[56:59]
  buffer_load_dwordx4 v245, s[16:19], s21 offen offset:2048 lds
  v_mfma_f32_16x16x32_bf16 v[60:63], v[180:183], a[148:151], v[60:63]
  v_rcp_f32 v233, v233
  v_mfma_f32_16x16x32_bf16 v[64:67], v[184:187], a[144:147], v[64:67]
  v_rcp_f32 v234, v234
  v_mfma_f32_16x16x32_bf16 v[68:71], v[184:187], a[148:151], v[68:71]
  v_rcp_f32 v235, v235
  v_mfma_f32_16x16x32_bf16 v[72:75], v[188:191], a[144:147], v[72:75]
  buffer_load_dwordx4 v247, s[16:19], s21 offen offset:3072 lds
  v_mfma_f32_16x16x32_bf16 v[76:79], v[188:191], a[148:151], v[76:79]
  v_mul_f32 v104, v104, v232
  v_mul_f32 v105, v105, v233
  v_mfma_f32_16x16x32_bf16 v[80:83], v[192:195], a[144:147], v[80:83]
  v_mul_f32 v106, v106, v234
  v_mul_f32 v107, v107, v235
  v_mfma_f32_16x16x32_bf16 v[84:87], v[192:195], a[148:151], v[84:87]
  v_mul_f32 v236, v116, v116
  v_mul_f32 v237, v117, v117
  v_mul_f32 v238, v118, v118
  s_waitcnt vmcnt(18) lgkmcnt(0)
  s_barrier
  v_mfma_f32_16x16x32_bf16 v[16:19], v[196:199], a[152:155], v[16:19]
  ds_read_b128 v[160:163], v254 offset:0
  v_mul_f32 v239, v119, v119
  v_mfma_f32_16x16x32_bf16 v[20:23], v[196:199], a[156:159], v[20:23]
  ds_read_b128 v[164:167], v254 offset:1024
  s_add_u32 m0, s7, 36864
  v_mfma_f32_16x16x32_bf16 v[24:27], v[200:203], a[152:155], v[24:27]
  ds_read_b128 v[168:171], v254 offset:2048
  buffer_load_dwordx4 v1, s[12:15], s20 offen offset:0 sc1 lds
  v_mfma_f32_16x16x32_bf16 v[28:31], v[200:203], a[156:159], v[28:31]
  ds_read_b128 v[172:175], v254 offset:3072
  v_fma_f32 v236, v236, s40, v14
  v_mfma_f32_16x16x32_bf16 v[32:35], v[204:207], a[152:155], v[32:35]
  ds_read_b128 v[176:179], v254 offset:4096
  v_fma_f32 v237, v237, s40, v14
  v_mfma_f32_16x16x32_bf16 v[36:39], v[204:207], a[156:159], v[36:39]
  ds_read_b128 v[180:183], v254 offset:5120
  v_fma_f32 v238, v238, s40, v14
  v_mfma_f32_16x16x32_bf16 v[40:43], v[208:211], a[152:155], v[40:43]
  ds_read_b128 v[184:187], v254 offset:6144
  v_fma_f32 v239, v239, s40, v14
  v_mfma_f32_16x16x32_bf16 v[44:47], v[208:211], a[156:159], v[44:47]
  ds_read_b128 v[188:191], v254 offset:7168
  buffer_load_dwordx4 v1, s[12:15], s20 offen offset:1024 sc1 lds
  v_mfma_f32_16x16x32_bf16 v[48:51], v[212:215], a[152:155], v[48:51]
  ds_read_b128 v[192:195], v254 offset:8192
  v_mul_f32 v236, v236, v116
  v_mfma_f32_16x16x32_bf16 v[52:55], v[212:215], a[156:159], v[52:55]
  ds_read_b128 a[64:67], v4 offset:4096
  v_mul_f32 v237, v237, v117
  v_mfma_f32_16x16x32_bf16 v[56:59], v[216:219], a[152:155], v[56:59]
  ds_read_b128 a[68:71], v4 offset:6144
  v_mul_f32 v238, v238, v118
  v_mfma_f32_16x16x32_bf16 v[60:63], v[216:219], a[156:159], v[60:63]
  ds_read_b128 a[72:75], v8 offset:4096
  v_mul_f32 v239, v239, v119
  v_mfma_f32_16x16x32_bf16 v[64:67], v[220:223], a[152:155], v[64:67]
  ds_read_b128 a[76:79], v8 offset:6144
  buffer_load_dwordx4 v1, s[12:15], s20 offen offset:2048 sc1 lds
  v_mfma_f32_16x16x32_bf16 v[68:71], v[220:223], a[156:159], v[68:71]
  v_exp_f32 v236, v236
  v_mfma_f32_16x16x32_bf16 v[72:75], v[224:227], a[152:155], v[72:75]
  v_mfma_f32_16x16x32_bf16 v[76:79], v[224:227], a[156:159], v[76:79]
  v_mfma_f32_16x16x32_bf16 v[80:83], v[228:231], a[152:155], v[80:83]
  v_mfma_f32_16x16x32_bf16 v[84:87], v[228:231], a[156:159], v[84:87]
  s_add_u32 s20, s20, 3072
  s_waitcnt lgkmcnt(0)
  v_mfma_f32_16x16x32_bf16 v[16:19], v[160:163], a[160:163], v[16:19]
  ds_read_b128 v[196:199], v254 offset:9216
  v_mfma_f32_16x16x32_bf16 v[20:23], v[160:163], a[164:167], v[20:23]
  ds_read_b128 v[200:203], v254 offset:10240
  s_add_u32 m0, s7, 39936
  v_mfma_f32_16x16x32_bf16 v[24:27], v[164:167], a[160:163], v[24:27]
  ds_read_b128 v[204:207], v254 offset:11264
  buffer_load_dwordx4 v1, s[12:15], s20 offen offset:0 sc1 lds
  v_mfma_f32_16x16x32_bf16 v[28:31], v[164:167], a[164:167], v[28:31]
  ds_read_b128 v[208:211], v254 offset:12288
  v_mfma_f32_16x16x32_bf16 v[32:35], v[168:171], a[160:163], v[32:35]
  ds_read_b128 v[212:215], v254 offset:13312
  v_mfma_f32_16x16x32_bf16 v[36:39], v[168:171], a[164:167], v[36:39]
  ds_read_b128 v[216:219], v254 offset:14336
  v_mfma_f32_16x16x32_bf16 v[40:43], v[172:175], a[160:163], v[40:43]
  ds_read_b128 v[220:223], v254 offset:15360
  buffer_load_dwordx4 v1, s[12:15], s20 offen offset:1024 sc1 lds
  v_mfma_f32_16x16x32_bf16 v[44:47], v[172:175], a[164:167], v[44:47]
  ds_read_b128 v[224:227], v254 offset:16384
  v_mfma_f32_16x16x32_bf16 v[48:51], v[176:179], a[160:163], v[48:51]
  ds_read_b128 v[228:231], v254 offset:17408
  v_exp_f32 v237, v237
  v_mfma_f32_16x16x32_bf16 v[52:55], v[176:179], a[164:167], v[52:55]
  s_add_u32 s20, s20, 2048
  s_add_u32 s21, s29, 2944
  s_add_u32 m0, s30, 4096
  v_mfma_f32_16x16x32_bf16 v[56:59], v[180:183], a[160:163], v[56:59]
  buffer_load_dwordx4 v241, s[16:19], s21 offen offset:0 lds
  v_mfma_f32_16x16x32_bf16 v[60:63], v[180:183], a[164:167], v[60:63]
  v_exp_f32 v238, v238
  v_mfma_f32_16x16x32_bf16 v[64:67], v[184:187], a[160:163], v[64:67]
  v_exp_f32 v239, v239
  v_add_f32 v236, 1.0, v236
  v_mfma_f32_16x16x32_bf16 v[68:71], v[184:187], a[164:167], v[68:71]
  v_add_f32 v237, 1.0, v237
  v_add_f32 v238, 1.0, v238
  v_add_f32 v239, 1.0, v239
  v_mfma_f32_16x16x32_bf16 v[72:75], v[188:191], a[160:163], v[72:75]
  buffer_load_dwordx4 v243, s[16:19], s21 offen offset:1024 lds
  v_mfma_f32_16x16x32_bf16 v[76:79], v[188:191], a[164:167], v[76:79]
  v_rcp_f32 v236, v236
  v_mfma_f32_16x16x32_bf16 v[80:83], v[192:195], a[160:163], v[80:83]
  v_rcp_f32 v237, v237
  v_mfma_f32_16x16x32_bf16 v[84:87], v[192:195], a[164:167], v[84:87]
  v_rcp_f32 v238, v238
  s_waitcnt vmcnt(16) lgkmcnt(0)
  v_mfma_f32_16x16x32_bf16 v[16:19], v[196:199], a[168:171], v[16:19]
  ds_read_b128 v[160:163], v254 offset:18432
  v_mfma_f32_16x16x32_bf16 v[20:23], v[196:199], a[172:175], v[20:23]
  ds_read_b128 v[164:167], v254 offset:19456
  s_add_u32 m0, s7, 41984
  v_mfma_f32_16x16x32_bf16 v[24:27], v[200:203], a[168:171], v[24:27]
  ds_read_b128 v[168:171], v254 offset:20480
  buffer_load_dwordx4 v1, s[12:15], s20 offen offset:0 sc1 lds
  v_mfma_f32_16x16x32_bf16 v[28:31], v[200:203], a[172:175], v[28:31]
  ds_read_b128 v[172:175], v254 offset:21504
  v_mfma_f32_16x16x32_bf16 v[32:35], v[204:207], a[168:171], v[32:35]
  ds_read_b128 v[176:179], v254 offset:22528
  v_mfma_f32_16x16x32_bf16 v[36:39], v[204:207], a[172:175], v[36:39]
  ds_read_b128 v[180:183], v254 offset:23552
  v_mfma_f32_16x16x32_bf16 v[40:43], v[208:211], a[168:171], v[40:43]
  ds_read_b128 v[184:187], v254 offset:24576
  buffer_load_dwordx4 v1, s[12:15], s20 offen offset:1024 sc1 lds
  v_mfma_f32_16x16x32_bf16 v[44:47], v[208:211], a[172:175], v[44:47]
  ds_read_b128 v[188:191], v254 offset:25600
  v_mfma_f32_16x16x32_bf16 v[48:51], v[212:215], a[168:171], v[48:51]
  ds_read_b128 v[192:195], v254 offset:26624
  v_mfma_f32_16x16x32_bf16 v[52:55], v[212:215], a[172:175], v[52:55]
  ds_read_b128 a[80:83], v4 offset:8192
  s_add_u32 s20, s20, 2048
  s_add_u32 m0, s30, 4096
  v_mfma_f32_16x16x32_bf16 v[56:59], v[216:219], a[168:171], v[56:59]
  ds_read_b128 a[84:87], v4 offset:10240
  buffer_load_dwordx4 v245, s[16:19], s21 offen offset:2048 lds
  v_mfma_f32_16x16x32_bf16 v[60:63], v[216:219], a[172:175], v[60:63]
  ds_read_b128 a[88:91], v8 offset:8192
  v_mfma_f32_16x16x32_bf16 v[64:67], v[220:223], a[168:171], v[64:67]
  ds_read_b128 a[92:95], v8 offset:10240
  v_mfma_f32_16x16x32_bf16 v[68:71], v[220:223], a[172:175], v[68:71]
  v_rcp_f32 v239, v239
  v_mfma_f32_16x16x32_bf16 v[72:75], v[224:227], a[168:171], v[72:75]
  buffer_load_dwordx4 v247, s[16:19], s21 offen offset:3072 lds
  v_mfma_f32_16x16x32_bf16 v[76:79], v[224:227], a[172:175], v[76:79]
  v_mul_f32 v116, v116, v236
  v_mul_f32 v117, v117, v237
  v_mul_f32 v118, v118, v238
  v_mfma_f32_16x16x32_bf16 v[80:83], v[228:231], a[168:171], v[80:83]
  v_mul_f32 v119, v119, v239
  v_mul_f32 v232, v112, v112
  v_mul_f32 v233, v113, v113
  v_mfma_f32_16x16x32_bf16 v[84:87], v[228:231], a[172:175], v[84:87]
  v_mul_f32 v234, v114, v114
  v_mul_f32 v235, v115, v115
  v_fma_f32 v232, v232, s40, v14
  s_waitcnt lgkmcnt(0)
  v_mfma_f32_16x16x32_bf16 v[16:19], v[160:163], a[176:179], v[16:19]
  ds_read_b128 v[196:199], v254 offset:27648
  v_fma_f32 v233, v233, s40, v14
  v_mfma_f32_16x16x32_bf16 v[20:23], v[160:163], a[180:183], v[20:23]
  ds_read_b128 v[200:203], v254 offset:28672
  s_add_u32 m0, s7, 44032
  v_mfma_f32_16x16x32_bf16 v[24:27], v[164:167], a[176:179], v[24:27]
  ds_read_b128 v[204:207], v254 offset:29696
  buffer_load_dwordx4 v1, s[12:15], s20 offen offset:0 sc1 lds
  v_mfma_f32_16x16x32_bf16 v[28:31], v[164:167], a[180:183], v[28:31]
  ds_read_b128 v[208:211], v254 offset:30720
  v_fma_f32 v234, v234, s40, v14
  v_mfma_f32_16x16x32_bf16 v[32:35], v[168:171], a[176:179], v[32:35]
  ds_read_b128 v[212:215], v254 offset:31744
  v_fma_f32 v235, v235, s40, v14
  v_mfma_f32_16x16x32_bf16 v[36:39], v[168:171], a[180:183], v[36:39]
  ds_read_b128 v[216:219], v254 offset:32768
  v_mul_f32 v232, v232, v112
  v_mfma_f32_16x16x32_bf16 v[40:43], v[172:175], a[176:179], v[40:43]
  ds_read_b128 v[220:223], v254 offset:33792
  buffer_load_dwordx4 v1, s[12:15], s20 offen offset:1024 sc1 lds
  v_mfma_f32_16x16x32_bf16 v[44:47], v[172:175], a[180:183], v[44:47]
  ds_read_b128 v[224:227], v254 offset:34816
  v_mul_f32 v233, v233, v113
  v_mfma_f32_16x16x32_bf16 v[48:51], v[176:179], a[176:179], v[48:51]
  ds_read_b128 v[228:231], v254 offset:35840
  v_mul_f32 v234, v234, v114
  v_mfma_f32_16x16x32_bf16 v[52:55], v[176:179], a[180:183], v[52:55]
  s_add_u32 s20, s20, 29696
  s_add_u32 s21, s29, 3072
  s_add_u32 m0, s30, 8192
  v_mfma_f32_16x16x32_bf16 v[56:59], v[180:183], a[176:179], v[56:59]
  buffer_load_dwordx4 v241, s[16:19], s21 offen offset:0 lds
  v_mfma_f32_16x16x32_bf16 v[60:63], v[180:183], a[180:183], v[60:63]
  v_mul_f32 v235, v235, v115
  v_mfma_f32_16x16x32_bf16 v[64:67], v[184:187], a[176:179], v[64:67]
  v_exp_f32 v232, v232
  v_mfma_f32_16x16x32_bf16 v[68:71], v[184:187], a[180:183], v[68:71]
  v_exp_f32 v233, v233
  v_mfma_f32_16x16x32_bf16 v[72:75], v[188:191], a[176:179], v[72:75]
  buffer_load_dwordx4 v243, s[16:19], s21 offen offset:1024 lds
  v_mfma_f32_16x16x32_bf16 v[76:79], v[188:191], a[180:183], v[76:79]
  v_exp_f32 v234, v234
  v_mfma_f32_16x16x32_bf16 v[80:83], v[192:195], a[176:179], v[80:83]
  v_mfma_f32_16x16x32_bf16 v[84:87], v[192:195], a[180:183], v[84:87]
  s_waitcnt vmcnt(17) lgkmcnt(0)
  s_barrier
  v_mfma_f32_16x16x32_bf16 v[16:19], v[196:199], a[184:187], v[16:19]
  ds_read_b128 v[160:163], v252 offset:0
  v_mfma_f32_16x16x32_bf16 v[20:23], v[196:199], a[188:191], v[20:23]
  ds_read_b128 v[164:167], v252 offset:1024
  s_add_u32 m0, s7, 73728
  v_mfma_f32_16x16x32_bf16 v[24:27], v[200:203], a[184:187], v[24:27]
  ds_read_b128 v[168:171], v252 offset:2048
  buffer_load_dwordx4 v1, s[12:15], s20 offen offset:0 sc1 lds
  v_mfma_f32_16x16x32_bf16 v[28:31], v[200:203], a[188:191], v[28:31]
  ds_read_b128 v[172:175], v252 offset:3072
  v_mfma_f32_16x16x32_bf16 v[32:35], v[204:207], a[184:187], v[32:35]
  ds_read_b128 v[176:179], v252 offset:4096
  v_mfma_f32_16x16x32_bf16 v[36:39], v[204:207], a[188:191], v[36:39]
  ds_read_b128 v[180:183], v252 offset:5120
  buffer_load_dwordx4 v1, s[12:15], s20 offen offset:1024 sc1 lds
  v_mfma_f32_16x16x32_bf16 v[40:43], v[208:211], a[184:187], v[40:43]
  ds_read_b128 v[184:187], v252 offset:6144
  v_mfma_f32_16x16x32_bf16 v[44:47], v[208:211], a[188:191], v[44:47]
  ds_read_b128 v[188:191], v252 offset:7168
  v_mfma_f32_16x16x32_bf16 v[48:51], v[212:215], a[184:187], v[48:51]
  ds_read_b128 v[192:195], v252 offset:8192
  buffer_load_dwordx4 v1, s[12:15], s20 offen offset:2048 sc1 lds
  v_mfma_f32_16x16x32_bf16 v[52:55], v[212:215], a[188:191], v[52:55]
  v_exp_f32 v235, v235
  v_mfma_f32_16x16x32_bf16 v[56:59], v[216:219], a[184:187], v[56:59]
  s_add_u32 s20, s20, 3072
  s_add_u32 m0, s30, 8192
  v_mfma_f32_16x16x32_bf16 v[60:63], v[216:219], a[188:191], v[60:63]
  buffer_load_dwordx4 v245, s[16:19], s21 offen offset:2048 lds
  v_mfma_f32_16x16x32_bf16 v[64:67], v[220:223], a[184:187], v[64:67]
  v_add_f32 v232, 1.0, v232
  v_add_f32 v233, 1.0, v233
  v_add_f32 v234, 1.0, v234
  v_mfma_f32_16x16x32_bf16 v[68:71], v[220:223], a[188:191], v[68:71]
  v_add_f32 v235, 1.0, v235
  v_rcp_f32 v232, v232
  v_mfma_f32_16x16x32_bf16 v[72:75], v[224:227], a[184:187], v[72:75]
  buffer_load_dwordx4 v247, s[16:19], s21 offen offset:3072 lds
  v_mfma_f32_16x16x32_bf16 v[76:79], v[224:227], a[188:191], v[76:79]
  v_rcp_f32 v233, v233
  v_mfma_f32_16x16x32_bf16 v[80:83], v[228:231], a[184:187], v[80:83]
  v_rcp_f32 v234, v234
  v_mfma_f32_16x16x32_bf16 v[84:87], v[228:231], a[188:191], v[84:87]
  v_rcp_f32 v235, v235
  v_mul_f32 v112, v112, v232
  s_waitcnt vmcnt(20) lgkmcnt(0)
  v_mfma_f32_16x16x32_bf16 v[16:19], v[160:163], a[192:195], v[16:19]
  ds_read_b128 v[196:199], v252 offset:9216
  v_mul_f32 v113, v113, v233
  v_mfma_f32_16x16x32_bf16 v[20:23], v[160:163], a[196:199], v[20:23]
  ds_read_b128 v[200:203], v252 offset:10240
  s_add_u32 m0, s7, 76800
  v_mfma_f32_16x16x32_bf16 v[24:27], v[164:167], a[192:195], v[24:27]
  ds_read_b128 v[204:207], v252 offset:11264
  buffer_load_dwordx4 v1, s[12:15], s20 offen offset:0 sc1 lds
  v_mfma_f32_16x16x32_bf16 v[28:31], v[164:167], a[196:199], v[28:31]
  ds_read_b128 v[208:211], v252 offset:12288
  v_mul_f32 v114, v114, v234
  v_mfma_f32_16x16x32_bf16 v[32:35], v[168:171], a[192:195], v[32:35]
  ds_read_b128 v[212:215], v252 offset:13312
  v_mul_f32 v115, v115, v235
  v_mfma_f32_16x16x32_bf16 v[36:39], v[168:171], a[196:199], v[36:39]
  ds_read_b128 v[216:219], v252 offset:14336
  v_mul_f32 v236, v124, v124
  v_mfma_f32_16x16x32_bf16 v[40:43], v[172:175], a[192:195], v[40:43]
  ds_read_b128 v[220:223], v252 offset:15360
  v_mul_f32 v237, v125, v125
  v_mfma_f32_16x16x32_bf16 v[44:47], v[172:175], a[196:199], v[44:47]
  ds_read_b128 v[224:227], v252 offset:16384
  v_mul_f32 v238, v126, v126
  v_mfma_f32_16x16x32_bf16 v[48:51], v[176:179], a[192:195], v[48:51]
  ds_read_b128 v[228:231], v252 offset:17408
  v_mul_f32 v239, v127, v127
  v_mfma_f32_16x16x32_bf16 v[52:55], v[176:179], a[196:199], v[52:55]
  ds_read_b128 a[96:99], v4 offset:0
  v_fma_f32 v236, v236, s40, v14
  v_mfma_f32_16x16x32_bf16 v[56:59], v[180:183], a[192:195], v[56:59]
  ds_read_b128 a[100:103], v4 offset:2048
  buffer_load_dwordx4 v1, s[12:15], s20 offen offset:1024 sc1 lds
  v_mfma_f32_16x16x32_bf16 v[60:63], v[180:183], a[196:199], v[60:63]
  ds_read_b128 a[104:107], v8 offset:0
  v_fma_f32 v237, v237, s40, v14
  v_mfma_f32_16x16x32_bf16 v[64:67], v[184:187], a[192:195], v[64:67]
  ds_read_b128 a[108:111], v8 offset:2048
  v_fma_f32 v238, v238, s40, v14
  v_mfma_f32_16x16x32_bf16 v[68:71], v[184:187], a[196:199], v[68:71]
  v_mfma_f32_16x16x32_bf16 v[72:75], v[188:191], a[192:195], v[72:75]
  v_mfma_f32_16x16x32_bf16 v[76:79], v[188:191], a[196:199], v[76:79]
  v_mfma_f32_16x16x32_bf16 v[80:83], v[192:195], a[192:195], v[80:83]
  v_mfma_f32_16x16x32_bf16 v[84:87], v[192:195], a[196:199], v[84:87]
  s_add_u32 s20, s20, 2048
  s_waitcnt lgkmcnt(0)
  v_mfma_f32_16x16x32_bf16 v[16:19], v[196:199], a[200:203], v[16:19]
  ds_read_b128 v[160:163], v252 offset:18432
  v_fma_f32 v239, v239, s40, v14
  v_mfma_f32_16x16x32_bf16 v[20:23], v[196:199], a[204:207], v[20:23]
  ds_read_b128 v[164:167], v252 offset:19456
  s_add_u32 m0, s7, 78848
  v_mfma_f32_16x16x32_bf16 v[24:27], v[200:203], a[200:203], v[24:27]
  ds_read_b128 v[168:171], v252 offset:20480
  buffer_load_dwordx4 v1, s[12:15], s20 offen offset:0 sc1 lds
  v_mfma_f32_16x16x32_bf16 v[28:31], v[200:203], a[204:207], v[28:31]
  ds_read_b128 v[172:175], v252 offset:21504
  v_mul_f32 v236, v236, v124
  v_mfma_f32_16x16x32_bf16 v[32:35], v[204:207], a[200:203], v[32:35]
  ds_read_b128 v[176:179], v252 offset:22528
  v_mul_f32 v237, v237, v125
  v_mfma_f32_16x16x32_bf16 v[36:39], v[204:207], a[204:207], v[36:39]
  ds_read_b128 v[180:183], v252 offset:23552
  buffer_load_dwordx4 v1, s[12:15], s20 offen offset:1024 sc1 lds
  v_mfma_f32_16x16x32_bf16 v[40:43], v[208:211], a[200:203], v[40:43]
  ds_read_b128 v[184:187], v252 offset:24576
  v_mul_f32 v238, v238, v126
  v_mfma_f32_16x16x32_bf16 v[44:47], v[208:211], a[204:207], v[44:47]
  ds_read_b128 v[188:191], v252 offset:25600
  s_add_u32 s20, s20, 2048
  s_add_u32 s21, s29, 3200
  s_add_u32 m0, s30, 0
  v_mfma_f32_16x16x32_bf16 v[48:51], v[212:215], a[200:203], v[48:51]
  ds_read_b128 v[192:195], v252 offset:26624
  buffer_load_dwordx4 v241, s[16:19], s21 offen offset:0 lds
  v_mfma_f32_16x16x32_bf16 v[52:55], v[212:215], a[204:207], v[52:55]
  v_mul_f32 v239, v239, v127
  v_mfma_f32_16x16x32_bf16 v[56:59], v[216:219], a[200:203], v[56:59]
  v_exp_f32 v236, v236
  v_mfma_f32_16x16x32_bf16 v[60:63], v[216:219], a[204:207], v[60:63]
  buffer_load_dwordx4 v243, s[16:19], s21 offen offset:1024 lds
  v_mfma_f32_16x16x32_bf16 v[64:67], v[220:223], a[200:203], v[64:67]
  v_exp_f32 v237, v237
  v_mfma_f32_16x16x32_bf16 v[68:71], v[220:223], a[204:207], v[68:71]
  v_exp_f32 v238, v238
  v_mfma_f32_16x16x32_bf16 v[72:75], v[224:227], a[200:203], v[72:75]
  buffer_load_dword v15, v255, s[32:35], 0 offen
  v_mfma_f32_16x16x32_bf16 v[76:79], v[224:227], a[204:207], v[76:79]
  v_exp_f32 v239, v239
  v_mfma_f32_16x16x32_bf16 v[80:83], v[228:231], a[200:203], v[80:83]
  v_add_f32 v236, 1.0, v236
  v_mfma_f32_16x16x32_bf16 v[84:87], v[228:231], a[204:207], v[84:87]
  s_waitcnt vmcnt(16) lgkmcnt(0)
  v_mfma_f32_16x16x32_bf16 v[16:19], v[160:163], a[208:211], v[16:19]
  ds_read_b128 v[196:199], v252 offset:27648
  v_add_f32 v237, 1.0, v237
  v_mfma_f32_16x16x32_bf16 v[20:23], v[160:163], a[212:215], v[20:23]
  ds_read_b128 v[200:203], v252 offset:28672
  s_add_u32 m0, s7, 80896
  v_mfma_f32_16x16x32_bf16 v[24:27], v[164:167], a[208:211], v[24:27]
  ds_read_b128 v[204:207], v252 offset:29696
  buffer_load_dwordx4 v1, s[12:15], s20 offen offset:0 sc1 lds
  v_mfma_f32_16x16x32_bf16 v[28:31], v[164:167], a[212:215], v[28:31]
  ds_read_b128 v[208:211], v252 offset:30720
  v_add_f32 v238, 1.0, v238
  v_mfma_f32_16x16x32_bf16 v[32:35], v[168:171], a[208:211], v[32:35]
  ds_read_b128 v[212:215], v252 offset:31744
  v_add_f32 v239, 1.0, v239
  v_mfma_f32_16x16x32_bf16 v[36:39], v[168:171], a[212:215], v[36:39]
  ds_read_b128 v[216:219], v252 offset:32768
  v_mfma_f32_16x16x32_bf16 v[40:43], v[172:175], a[208:211], v[40:43]
  ds_read_b128 v[220:223], v252 offset:33792
  buffer_load_dwordx4 v1, s[12:15], s20 offen offset:1024 sc1 lds
  v_mfma_f32_16x16x32_bf16 v[44:47], v[172:175], a[212:215], v[44:47]
  ds_read_b128 v[224:227], v252 offset:34816
  v_mfma_f32_16x16x32_bf16 v[48:51], v[176:179], a[208:211], v[48:51]
  ds_read_b128 v[228:231], v252 offset:35840
  v_mfma_f32_16x16x32_bf16 v[52:55], v[176:179], a[212:215], v[52:55]
  ds_read_b128 a[112:115], v4 offset:4096
  s_add_u32 s20, s20, 29696
  s_add_u32 m0, s30, 0
  v_mfma_f32_16x16x32_bf16 v[56:59], v[180:183], a[208:211], v[56:59]
  ds_read_b128 a[116:119], v4 offset:6144
  buffer_load_dwordx4 v245, s[16:19], s21 offen offset:2048 lds
  v_mfma_f32_16x16x32_bf16 v[60:63], v[180:183], a[212:215], v[60:63]
  ds_read_b128 a[120:123], v8 offset:4096
  v_mfma_f32_16x16x32_bf16 v[64:67], v[184:187], a[208:211], v[64:67]
  ds_read_b128 a[124:127], v8 offset:6144
  v_rcp_f32 v236, v236
  v_mfma_f32_16x16x32_bf16 v[68:71], v[184:187], a[212:215], v[68:71]
  v_rcp_f32 v237, v237
  v_mfma_f32_16x16x32_bf16 v[72:75], v[188:191], a[208:211], v[72:75]
  buffer_load_dwordx4 v247, s[16:19], s21 offen offset:3072 lds
  v_mfma_f32_16x16x32_bf16 v[76:79], v[188:191], a[212:215], v[76:79]
  v_rcp_f32 v238, v238
  v_mfma_f32_16x16x32_bf16 v[80:83], v[192:195], a[208:211], v[80:83]
  v_rcp_f32 v239, v239
  v_mul_f32 v124, v124, v236
  v_mfma_f32_16x16x32_bf16 v[84:87], v[192:195], a[212:215], v[84:87]
  v_mul_f32 v125, v125, v237
  v_mul_f32 v126, v126, v238
  v_mul_f32 v127, v127, v239
  s_waitcnt vmcnt(18) lgkmcnt(0)
  s_barrier
  v_mfma_f32_16x16x32_bf16 v[16:19], v[196:199], a[216:219], v[16:19]
  ds_read_b128 v[160:163], v253 offset:0
  v_mul_f32 v232, v120, v120
  v_mfma_f32_16x16x32_bf16 v[20:23], v[196:199], a[220:223], v[20:23]
  ds_read_b128 v[164:167], v253 offset:1024
  s_add_u32 m0, s7, 0
  v_mfma_f32_16x16x32_bf16 v[24:27], v[200:203], a[216:219], v[24:27]
  ds_read_b128 v[168:171], v253 offset:2048
  buffer_load_dwordx4 v1, s[12:15], s20 offen offset:0 sc1 lds
  v_mfma_f32_16x16x32_bf16 v[28:31], v[200:203], a[220:223], v[28:31]
  ds_read_b128 v[172:175], v253 offset:3072
  v_mul_f32 v233, v121, v121
  v_mfma_f32_16x16x32_bf16 v[32:35], v[204:207], a[216:219], v[32:35]
  ds_read_b128 v[176:179], v253 offset:4096
  v_mul_f32 v234, v122, v122
  v_mfma_f32_16x16x32_bf16 v[36:39], v[204:207], a[220:223], v[36:39]
  ds_read_b128 v[180:183], v253 offset:5120
  buffer_load_dwordx4 v1, s[12:15], s20 offen offset:1024 sc1 lds
  v_mfma_f32_16x16x32_bf16 v[40:43], v[208:211], a[216:219], v[40:43]
  ds_read_b128 v[184:187], v253 offset:6144
  v_mul_f32 v235, v123, v123
  v_mfma_f32_16x16x32_bf16 v[44:47], v[208:211], a[220:223], v[44:47]
  ds_read_b128 v[188:191], v253 offset:7168
  v_fma_f32 v232, v232, s40, v14
  v_mfma_f32_16x16x32_bf16 v[48:51], v[212:215], a[216:219], v[48:51]
  ds_read_b128 v[192:195], v253 offset:8192
  buffer_load_dwordx4 v1, s[12:15], s20 offen offset:2048 sc1 lds
  v_mfma_f32_16x16x32_bf16 v[52:55], v[212:215], a[220:223], v[52:55]
  v_fma_f32 v233, v233, s40, v14
  v_fma_f32 v234, v234, s40, v14
  v_mfma_f32_16x16x32_bf16 v[56:59], v[216:219], a[216:219], v[56:59]
  s_add_u32 s20, s20, 3072
  s_add_u32 s21, s29, 3328
  s_add_u32 m0, s30, 4096
  v_mfma_f32_16x16x32_bf16 v[60:63], v[216:219], a[220:223], v[60:63]
  buffer_load_dwordx4 v241, s[16:19], s21 offen offset:0 lds
  v_mfma_f32_16x16x32_bf16 v[64:67], v[220:223], a[216:219], v[64:67]
  v_fma_f32 v235, v235, s40, v14
  v_mul_f32 v232, v232, v120
  v_mfma_f32_16x16x32_bf16 v[68:71], v[220:223], a[220:223], v[68:71]
  v_mul_f32 v233, v233, v121
  v_mfma_f32_16x16x32_bf16 v[72:75], v[224:227], a[216:219], v[72:75]
  buffer_load_dwordx4 v243, s[16:19], s21 offen offset:1024 lds
  v_mfma_f32_16x16x32_bf16 v[76:79], v[224:227], a[220:223], v[76:79]
  v_mfma_f32_16x16x32_bf16 v[80:83], v[228:231], a[216:219], v[80:83]
  v_mfma_f32_16x16x32_bf16 v[84:87], v[228:231], a[220:223], v[84:87]
  s_waitcnt vmcnt(16) lgkmcnt(0)
  v_mfma_f32_16x16x32_bf16 v[16:19], v[160:163], a[224:227], v[16:19]
  ds_read_b128 v[196:199], v253 offset:9216
  v_mul_f32 v234, v234, v122
  v_mfma_f32_16x16x32_bf16 v[20:23], v[160:163], a[228:231], v[20:23]
  ds_read_b128 v[200:203], v253 offset:10240
  s_add_u32 m0, s7, 3072
  v_mfma_f32_16x16x32_bf16 v[24:27], v[164:167], a[224:227], v[24:27]
  ds_read_b128 v[204:207], v253 offset:11264
  buffer_load_dwordx4 v1, s[12:15], s20 offen offset:0 sc1 lds
  v_mfma_f32_16x16x32_bf16 v[28:31], v[164:167], a[228:231], v[28:31]
  ds_read_b128 v[208:211], v253 offset:12288
  v_mul_f32 v235, v235, v123
  v_mfma_f32_16x16x32_bf16 v[32:35], v[168:171], a[224:227], v[32:35]
  ds_read_b128 v[212:215], v253 offset:13312
  v_mfma_f32_16x16x32_bf16 v[36:39], v[168:171], a[228:231], v[36:39]
  ds_read_b128 v[216:219], v253 offset:14336
  v_mfma_f32_16x16x32_bf16 v[40:43], v[172:175], a[224:227], v[40:43]
  ds_read_b128 v[220:223], v253 offset:15360
  buffer_load_dwordx4 v1, s[12:15], s20 offen offset:1024 sc1 lds
  v_mfma_f32_16x16x32_bf16 v[44:47], v[172:175], a[228:231], v[44:47]
  ds_read_b128 v[224:227], v253 offset:16384
  v_mfma_f32_16x16x32_bf16 v[48:51], v[176:179], a[224:227], v[48:51]
  ds_read_b128 v[228:231], v253 offset:17408
  v_mfma_f32_16x16x32_bf16 v[52:55], v[176:179], a[228:231], v[52:55]
  ds_read_b128 a[128:131], v4 offset:8192
  s_add_u32 s20, s20, 2048
  s_add_u32 m0, s30, 4096
  v_mfma_f32_16x16x32_bf16 v[56:59], v[180:183], a[224:227], v[56:59]
  ds_read_b128 a[132:135], v4 offset:10240
  buffer_load_dwordx4 v245, s[16:19], s21 offen offset:2048 lds
  v_mfma_f32_16x16x32_bf16 v[60:63], v[180:183], a[228:231], v[60:63]
  ds_read_b128 a[136:139], v8 offset:8192
  v_mfma_f32_16x16x32_bf16 v[64:67], v[184:187], a[224:227], v[64:67]
  ds_read_b128 a[140:143], v8 offset:10240
  v_exp_f32 v232, v232
  v_mfma_f32_16x16x32_bf16 v[68:71], v[184:187], a[228:231], v[68:71]
  v_exp_f32 v233, v233
  v_mfma_f32_16x16x32_bf16 v[72:75], v[188:191], a[224:227], v[72:75]
  buffer_load_dwordx4 v247, s[16:19], s21 offen offset:3072 lds
  v_mfma_f32_16x16x32_bf16 v[76:79], v[188:191], a[228:231], v[76:79]
  v_exp_f32 v234, v234
  v_mfma_f32_16x16x32_bf16 v[80:83], v[192:195], a[224:227], v[80:83]
  v_exp_f32 v235, v235
  v_add_f32 v232, 1.0, v232
  v_mfma_f32_16x16x32_bf16 v[84:87], v[192:195], a[228:231], v[84:87]
  v_add_f32 v233, 1.0, v233
  v_add_f32 v234, 1.0, v234
  v_add_f32 v235, 1.0, v235
  s_waitcnt lgkmcnt(0)
  v_mfma_f32_16x16x32_bf16 v[16:19], v[196:199], a[232:235], v[16:19]
  ds_read_b128 v[160:163], v253 offset:18432
  v_mfma_f32_16x16x32_bf16 v[20:23], v[196:199], a[236:239], v[20:23]
  ds_read_b128 v[164:167], v253 offset:19456
  s_add_u32 m0, s7, 5120
  v_mfma_f32_16x16x32_bf16 v[24:27], v[200:203], a[232:235], v[24:27]
  ds_read_b128 v[168:171], v253 offset:20480
  buffer_load_dwordx4 v1, s[12:15], s20 offen offset:0 sc1 lds
  v_mfma_f32_16x16x32_bf16 v[28:31], v[200:203], a[236:239], v[28:31]
  ds_read_b128 v[172:175], v253 offset:21504
  v_mfma_f32_16x16x32_bf16 v[32:35], v[204:207], a[232:235], v[32:35]
  ds_read_b128 v[176:179], v253 offset:22528
  v_mfma_f32_16x16x32_bf16 v[36:39], v[204:207], a[236:239], v[36:39]
  ds_read_b128 v[180:183], v253 offset:23552
  v_mfma_f32_16x16x32_bf16 v[40:43], v[208:211], a[232:235], v[40:43]
  ds_read_b128 v[184:187], v253 offset:24576
  buffer_load_dwordx4 v1, s[12:15], s20 offen offset:1024 sc1 lds
  v_mfma_f32_16x16x32_bf16 v[44:47], v[208:211], a[236:239], v[44:47]
  ds_read_b128 v[188:191], v253 offset:25600
  v_mfma_f32_16x16x32_bf16 v[48:51], v[212:215], a[232:235], v[48:51]
  ds_read_b128 v[192:195], v253 offset:26624
  v_mfma_f32_16x16x32_bf16 v[52:55], v[212:215], a[236:239], v[52:55]
  s_add_u32 s20, s20, 2048
  s_add_u32 s21, s29, 3456
  s_add_u32 m0, s30, 8192
  v_mfma_f32_16x16x32_bf16 v[56:59], v[216:219], a[232:235], v[56:59]
  buffer_load_dwordx4 v241, s[16:19], s21 offen offset:0 lds
  v_mfma_f32_16x16x32_bf16 v[60:63], v[216:219], a[236:239], v[60:63]
  v_rcp_f32 v232, v232
  v_mfma_f32_16x16x32_bf16 v[64:67], v[220:223], a[232:235], v[64:67]
  v_rcp_f32 v233, v233
  v_mfma_f32_16x16x32_bf16 v[68:71], v[220:223], a[236:239], v[68:71]
  v_rcp_f32 v234, v234
  v_mfma_f32_16x16x32_bf16 v[72:75], v[224:227], a[232:235], v[72:75]
  buffer_load_dwordx4 v243, s[16:19], s21 offen offset:1024 lds
  v_mfma_f32_16x16x32_bf16 v[76:79], v[224:227], a[236:239], v[76:79]
  v_rcp_f32 v235, v235
  v_mfma_f32_16x16x32_bf16 v[80:83], v[228:231], a[232:235], v[80:83]
  v_mul_f32 v120, v120, v232
  v_mul_f32 v121, v121, v233
  v_mul_f32 v122, v122, v234
  v_mfma_f32_16x16x32_bf16 v[84:87], v[228:231], a[236:239], v[84:87]
  v_mul_f32 v123, v123, v235
  v_mul_f32 v236, v132, v132
  v_mul_f32 v237, v133, v133
  s_waitcnt lgkmcnt(0)
  v_mfma_f32_16x16x32_bf16 v[16:19], v[160:163], a[240:243], v[16:19]
  ds_read_b128 v[196:199], v253 offset:27648
  v_mul_f32 v238, v134, v134
  v_mfma_f32_16x16x32_bf16 v[20:23], v[160:163], a[244:247], v[20:23]
  ds_read_b128 v[200:203], v253 offset:28672
  s_add_u32 m0, s7, 7168
  v_mfma_f32_16x16x32_bf16 v[24:27], v[164:167], a[240:243], v[24:27]
  ds_read_b128 v[204:207], v253 offset:29696
  buffer_load_dwordx4 v1, s[12:15], s20 offen offset:0 sc1 lds
  v_mfma_f32_16x16x32_bf16 v[28:31], v[164:167], a[244:247], v[28:31]
  ds_read_b128 v[208:211], v253 offset:30720
  v_mul_f32 v239, v135, v135
  v_mfma_f32_16x16x32_bf16 v[32:35], v[168:171], a[240:243], v[32:35]
  ds_read_b128 v[212:215], v253 offset:31744
  v_fma_f32 v236, v236, s40, v14
  v_mfma_f32_16x16x32_bf16 v[36:39], v[168:171], a[244:247], v[36:39]
  ds_read_b128 v[216:219], v253 offset:32768
  v_fma_f32 v237, v237, s40, v14
  v_mfma_f32_16x16x32_bf16 v[40:43], v[172:175], a[240:243], v[40:43]
  ds_read_b128 v[220:223], v253 offset:33792
  buffer_load_dwordx4 v1, s[12:15], s20 offen offset:1024 sc1 lds
  v_mfma_f32_16x16x32_bf16 v[44:47], v[172:175], a[244:247], v[44:47]
  ds_read_b128 v[224:227], v253 offset:34816
  v_fma_f32 v238, v238, s40, v14
  v_mfma_f32_16x16x32_bf16 v[48:51], v[176:179], a[240:243], v[48:51]
  ds_read_b128 v[228:231], v253 offset:35840
  v_fma_f32 v239, v239, s40, v14
  v_mfma_f32_16x16x32_bf16 v[52:55], v[176:179], a[244:247], v[52:55]
  s_add_u32 s20, s20, 29696
  s_add_u32 m0, s30, 8192
  v_mfma_f32_16x16x32_bf16 v[56:59], v[180:183], a[240:243], v[56:59]
  buffer_load_dwordx4 v245, s[16:19], s21 offen offset:2048 lds
  v_mfma_f32_16x16x32_bf16 v[60:63], v[180:183], a[244:247], v[60:63]
  v_mul_f32 v236, v236, v132
  v_mul_f32 v237, v237, v133
  v_mfma_f32_16x16x32_bf16 v[64:67], v[184:187], a[240:243], v[64:67]
  v_mul_f32 v238, v238, v134
  v_mul_f32 v239, v239, v135
  v_mfma_f32_16x16x32_bf16 v[68:71], v[184:187], a[244:247], v[68:71]
  v_mfma_f32_16x16x32_bf16 v[72:75], v[188:191], a[240:243], v[72:75]
  buffer_load_dwordx4 v247, s[16:19], s21 offen offset:3072 lds
  v_mfma_f32_16x16x32_bf16 v[76:79], v[188:191], a[244:247], v[76:79]
  v_mfma_f32_16x16x32_bf16 v[80:83], v[192:195], a[240:243], v[80:83]
  v_mfma_f32_16x16x32_bf16 v[84:87], v[192:195], a[244:247], v[84:87]
  s_waitcnt vmcnt(17) lgkmcnt(0)
  s_barrier
  v_mfma_f32_16x16x32_bf16 v[16:19], v[196:199], a[248:251], v[16:19]
  ds_read_b128 v[160:163], v254 offset:0
  v_mfma_f32_16x16x32_bf16 v[20:23], v[196:199], a[252:255], v[20:23]
  ds_read_b128 v[164:167], v254 offset:1024
  s_add_u32 m0, s7, 36864
  v_mfma_f32_16x16x32_bf16 v[24:27], v[200:203], a[248:251], v[24:27]
  ds_read_b128 v[168:171], v254 offset:2048
  buffer_load_dwordx4 v1, s[12:15], s20 offen offset:0 sc1 lds
  v_mfma_f32_16x16x32_bf16 v[28:31], v[200:203], a[252:255], v[28:31]
  ds_read_b128 v[172:175], v254 offset:3072
  v_mfma_f32_16x16x32_bf16 v[32:35], v[204:207], a[248:251], v[32:35]
  ds_read_b128 v[176:179], v254 offset:4096
  v_mfma_f32_16x16x32_bf16 v[36:39], v[204:207], a[252:255], v[36:39]
  ds_read_b128 v[180:183], v254 offset:5120
  v_mfma_f32_16x16x32_bf16 v[40:43], v[208:211], a[248:251], v[40:43]
  ds_read_b128 v[184:187], v254 offset:6144
  v_mfma_f32_16x16x32_bf16 v[44:47], v[208:211], a[252:255], v[44:47]
  ds_read_b128 v[188:191], v254 offset:7168
  buffer_load_dwordx4 v1, s[12:15], s20 offen offset:1024 sc1 lds
  v_mfma_f32_16x16x32_bf16 v[48:51], v[212:215], a[248:251], v[48:51]
  ds_read_b128 v[192:195], v254 offset:8192
  v_mfma_f32_16x16x32_bf16 v[52:55], v[212:215], a[252:255], v[52:55]
  ds_read_b128 a[144:147], v4 offset:0
  v_mfma_f32_16x16x32_bf16 v[56:59], v[216:219], a[248:251], v[56:59]
  ds_read_b128 a[148:151], v4 offset:2048
  v_exp_f32 v236, v236
  v_mfma_f32_16x16x32_bf16 v[60:63], v[216:219], a[252:255], v[60:63]
  ds_read_b128 a[152:155], v8 offset:0
  v_exp_f32 v237, v237
  v_mfma_f32_16x16x32_bf16 v[64:67], v[220:223], a[248:251], v[64:67]
  ds_read_b128 a[156:159], v8 offset:2048
  buffer_load_dwordx4 v1, s[12:15], s20 offen offset:2048 sc1 lds
  v_mfma_f32_16x16x32_bf16 v[68:71], v[220:223], a[252:255], v[68:71]
  v_exp_f32 v238, v238
  v_mfma_f32_16x16x32_bf16 v[72:75], v[224:227], a[248:251], v[72:75]
  v_exp_f32 v239, v239
  v_add_f32 v236, 1.0, v236
  v_mfma_f32_16x16x32_bf16 v[76:79], v[224:227], a[252:255], v[76:79]
  v_add_f32 v237, 1.0, v237
  v_add_f32 v238, 1.0, v238
  v_add_f32 v239, 1.0, v239
  v_mfma_f32_16x16x32_bf16 v[80:83], v[228:231], a[248:251], v[80:83]
  v_rcp_f32 v236, v236
  v_mfma_f32_16x16x32_bf16 v[84:87], v[228:231], a[252:255], v[84:87]
  v_rcp_f32 v237, v237
  s_add_u32 s20, s20, 3072
  s_waitcnt lgkmcnt(0)
  v_mfma_f32_16x16x32_bf16 v[16:19], v[160:163], a[0:3], v[16:19]
  ds_read_b128 v[196:199], v254 offset:9216
  v_mfma_f32_16x16x32_bf16 v[20:23], v[160:163], a[4:7], v[20:23]
  ds_read_b128 v[200:203], v254 offset:10240
  s_add_u32 m0, s7, 39936
  v_mfma_f32_16x16x32_bf16 v[24:27], v[164:167], a[0:3], v[24:27]
  ds_read_b128 v[204:207], v254 offset:11264
  buffer_load_dwordx4 v1, s[12:15], s20 offen offset:0 sc1 lds
  v_mfma_f32_16x16x32_bf16 v[28:31], v[164:167], a[4:7], v[28:31]
  ds_read_b128 v[208:211], v254 offset:12288
  v_mfma_f32_16x16x32_bf16 v[32:35], v[168:171], a[0:3], v[32:35]
  ds_read_b128 v[212:215], v254 offset:13312
  v_mfma_f32_16x16x32_bf16 v[36:39], v[168:171], a[4:7], v[36:39]
  ds_read_b128 v[216:219], v254 offset:14336
  v_mfma_f32_16x16x32_bf16 v[40:43], v[172:175], a[0:3], v[40:43]
  ds_read_b128 v[220:223], v254 offset:15360
  buffer_load_dwordx4 v1, s[12:15], s20 offen offset:1024 sc1 lds
  v_mfma_f32_16x16x32_bf16 v[44:47], v[172:175], a[4:7], v[44:47]
  ds_read_b128 v[224:227], v254 offset:16384
  v_mfma_f32_16x16x32_bf16 v[48:51], v[176:179], a[0:3], v[48:51]
  ds_read_b128 v[228:231], v254 offset:17408
  v_mfma_f32_16x16x32_bf16 v[52:55], v[176:179], a[4:7], v[52:55]
  s_add_u32 s20, s20, 2048
  s_add_u32 s21, s29, 3584
  s_add_u32 m0, s30, 0
  v_mfma_f32_16x16x32_bf16 v[56:59], v[180:183], a[0:3], v[56:59]
  buffer_load_dwordx4 v241, s[16:19], s21 offen offset:0 lds
  v_mfma_f32_16x16x32_bf16 v[60:63], v[180:183], a[4:7], v[60:63]
  v_rcp_f32 v238, v238
  v_mfma_f32_16x16x32_bf16 v[64:67], v[184:187], a[0:3], v[64:67]
  v_rcp_f32 v239, v239
  v_mfma_f32_16x16x32_bf16 v[68:71], v[184:187], a[4:7], v[68:71]
  v_mul_f32 v132, v132, v236
  v_mul_f32 v133, v133, v237
  v_mfma_f32_16x16x32_bf16 v[72:75], v[188:191], a[0:3], v[72:75]
  buffer_load_dwordx4 v243, s[16:19], s21 offen offset:1024 lds
  v_mfma_f32_16x16x32_bf16 v[76:79], v[188:191], a[4:7], v[76:79]
  v_mul_f32 v134, v134, v238
  v_mul_f32 v135, v135, v239
  v_mfma_f32_16x16x32_bf16 v[80:83], v[192:195], a[0:3], v[80:83]
  v_mul_f32 v232, v128, v128
  v_mul_f32 v233, v129, v129
  v_mfma_f32_16x16x32_bf16 v[84:87], v[192:195], a[4:7], v[84:87]
  v_mul_f32 v234, v130, v130
  v_mul_f32 v235, v131, v131
  s_waitcnt vmcnt(15) lgkmcnt(0)
  v_mfma_f32_16x16x32_bf16 v[16:19], v[196:199], a[8:11], v[16:19]
  ds_read_b128 v[160:163], v254 offset:18432
  v_fma_f32 v232, v232, s40, v14
  v_mfma_f32_16x16x32_bf16 v[20:23], v[196:199], a[12:15], v[20:23]
  ds_read_b128 v[164:167], v254 offset:19456
  s_add_u32 m0, s7, 41984
  v_mfma_f32_16x16x32_bf16 v[24:27], v[200:203], a[8:11], v[24:27]
  ds_read_b128 v[168:171], v254 offset:20480
  buffer_load_dwordx4 v1, s[12:15], s20 offen offset:0 sc1 lds
  v_mfma_f32_16x16x32_bf16 v[28:31], v[200:203], a[12:15], v[28:31]
  ds_read_b128 v[172:175], v254 offset:21504
  v_fma_f32 v233, v233, s40, v14
  v_mfma_f32_16x16x32_bf16 v[32:35], v[204:207], a[8:11], v[32:35]
  ds_read_b128 v[176:179], v254 offset:22528
  v_fma_f32 v234, v234, s40, v14
  v_mfma_f32_16x16x32_bf16 v[36:39], v[204:207], a[12:15], v[36:39]
  ds_read_b128 v[180:183], v254 offset:23552
  buffer_load_dwordx4 v1, s[12:15], s20 offen offset:1024 sc1 lds
  v_mfma_f32_16x16x32_bf16 v[40:43], v[208:211], a[8:11], v[40:43]
  ds_read_b128 v[184:187], v254 offset:24576
  v_fma_f32 v235, v235, s40, v14
  v_mfma_f32_16x16x32_bf16 v[44:47], v[208:211], a[12:15], v[44:47]
  ds_read_b128 v[188:191], v254 offset:25600
  s_add_u32 s20, s20, 2048
  s_add_u32 m0, s30, 0
  v_mfma_f32_16x16x32_bf16 v[48:51], v[212:215], a[8:11], v[48:51]
  ds_read_b128 v[192:195], v254 offset:26624
  buffer_load_dwordx4 v245, s[16:19], s21 offen offset:2048 lds
  v_mfma_f32_16x16x32_bf16 v[52:55], v[212:215], a[12:15], v[52:55]
  ds_read_b128 a[160:163], v4 offset:4096
  v_mul_f32 v232, v232, v128
  v_mfma_f32_16x16x32_bf16 v[56:59], v[216:219], a[8:11], v[56:59]
  ds_read_b128 a[164:167], v4 offset:6144
  v_mul_f32 v233, v233, v129
  v_mfma_f32_16x16x32_bf16 v[60:63], v[216:219], a[12:15], v[60:63]
  ds_read_b128 a[168:171], v8 offset:4096
  buffer_load_dwordx4 v247, s[16:19], s21 offen offset:3072 lds
  v_mfma_f32_16x16x32_bf16 v[64:67], v[220:223], a[8:11], v[64:67]
  ds_read_b128 a[172:175], v8 offset:6144
  v_mul_f32 v234, v234, v130
  v_mfma_f32_16x16x32_bf16 v[68:71], v[220:223], a[12:15], v[68:71]
  v_mul_f32 v235, v235, v131
  v_mfma_f32_16x16x32_bf16 v[72:75], v[224:227], a[8:11], v[72:75]
  buffer_load_dword v15, v255, s[32:35], 0 offen
  v_mfma_f32_16x16x32_bf16 v[76:79], v[224:227], a[12:15], v[76:79]
  v_exp_f32 v232, v232
  v_mfma_f32_16x16x32_bf16 v[80:83], v[228:231], a[8:11], v[80:83]
  v_exp_f32 v233, v233
  v_mfma_f32_16x16x32_bf16 v[84:87], v[228:231], a[12:15], v[84:87]
  s_waitcnt lgkmcnt(0)
  v_mfma_f32_16x16x32_bf16 v[16:19], v[160:163], a[16:19], v[16:19]
  ds_read_b128 v[196:199], v254 offset:27648
  v_mfma_f32_16x16x32_bf16 v[20:23], v[160:163], a[20:23], v[20:23]
  ds_read_b128 v[200:203], v254 offset:28672
  s_add_u32 m0, s7, 44032
  v_mfma_f32_16x16x32_bf16 v[24:27], v[164:167], a[16:19], v[24:27]
  ds_read_b128 v[204:207], v254 offset:29696
  buffer_load_dwordx4 v1, s[12:15], s20 offen offset:0 sc1 lds
  v_mfma_f32_16x16x32_bf16 v[28:31], v[164:167], a[20:23], v[28:31]
  ds_read_b128 v[208:211], v254 offset:30720
  v_mfma_f32_16x16x32_bf16 v[32:35], v[168:171], a[16:19], v[32:35]
  ds_read_b128 v[212:215], v254 offset:31744
  v_mfma_f32_16x16x32_bf16 v[36:39], v[168:171], a[20:23], v[36:39]
  ds_read_b128 v[216:219], v254 offset:32768
  v_mfma_f32_16x16x32_bf16 v[40:43], v[172:175], a[16:19], v[40:43]
  ds_read_b128 v[220:223], v254 offset:33792
  buffer_load_dwordx4 v1, s[12:15], s20 offen offset:1024 sc1 lds
  v_mfma_f32_16x16x32_bf16 v[44:47], v[172:175], a[20:23], v[44:47]
  ds_read_b128 v[224:227], v254 offset:34816
  v_mfma_f32_16x16x32_bf16 v[48:51], v[176:179], a[16:19], v[48:51]
  ds_read_b128 v[228:231], v254 offset:35840
  v_exp_f32 v234, v234
  v_mfma_f32_16x16x32_bf16 v[52:55], v[176:179], a[20:23], v[52:55]
  s_add_u32 s20, s20, 29696
  s_add_u32 s21, s29, 3712
  s_add_u32 m0, s30, 4096
  v_mfma_f32_16x16x32_bf16 v[56:59], v[180:183], a[16:19], v[56:59]
  buffer_load_dwordx4 v241, s[16:19], s21 offen offset:0 lds
  v_mfma_f32_16x16x32_bf16 v[60:63], v[180:183], a[20:23], v[60:63]
  v_exp_f32 v235, v235
  v_add_f32 v232, 1.0, v232
  v_mfma_f32_16x16x32_bf16 v[64:67], v[184:187], a[16:19], v[64:67]
  v_add_f32 v233, 1.0, v233
  v_add_f32 v234, 1.0, v234
  v_add_f32 v235, 1.0, v235
  v_mfma_f32_16x16x32_bf16 v[68:71], v[184:187], a[20:23], v[68:71]
  v_rcp_f32 v232, v232
  v_mfma_f32_16x16x32_bf16 v[72:75], v[188:191], a[16:19], v[72:75]
  buffer_load_dwordx4 v243, s[16:19], s21 offen offset:1024 lds
  v_mfma_f32_16x16x32_bf16 v[76:79], v[188:191], a[20:23], v[76:79]
  v_rcp_f32 v233, v233
  v_mfma_f32_16x16x32_bf16 v[80:83], v[192:195], a[16:19], v[80:83]
  v_rcp_f32 v234, v234
  v_mfma_f32_16x16x32_bf16 v[84:87], v[192:195], a[20:23], v[84:87]
  v_rcp_f32 v235, v235
  s_waitcnt vmcnt(18) lgkmcnt(0)
  s_barrier
  v_mfma_f32_16x16x32_bf16 v[16:19], v[196:199], a[24:27], v[16:19]
  ds_read_b128 v[160:163], v252 offset:0
  v_mul_f32 v128, v128, v232
  v_mfma_f32_16x16x32_bf16 v[20:23], v[196:199], a[28:31], v[20:23]
  ds_read_b128 v[164:167], v252 offset:1024
  s_add_u32 m0, s7, 73728
  v_mfma_f32_16x16x32_bf16 v[24:27], v[200:203], a[24:27], v[24:27]
  ds_read_b128 v[168:171], v252 offset:2048
  buffer_load_dwordx4 v1, s[12:15], s20 offen offset:0 sc1 lds
  v_mfma_f32_16x16x32_bf16 v[28:31], v[200:203], a[28:31], v[28:31]
  ds_read_b128 v[172:175], v252 offset:3072
  v_mul_f32 v129, v129, v233
  v_mfma_f32_16x16x32_bf16 v[32:35], v[204:207], a[24:27], v[32:35]
  ds_read_b128 v[176:179], v252 offset:4096
  v_mul_f32 v130, v130, v234
  v_mfma_f32_16x16x32_bf16 v[36:39], v[204:207], a[28:31], v[36:39]
  ds_read_b128 v[180:183], v252 offset:5120
  buffer_load_dwordx4 v1, s[12:15], s20 offen offset:1024 sc1 lds
  v_mfma_f32_16x16x32_bf16 v[40:43], v[208:211], a[24:27], v[40:43]
  ds_read_b128 v[184:187], v252 offset:6144
  v_mul_f32 v131, v131, v235
  v_mfma_f32_16x16x32_bf16 v[44:47], v[208:211], a[28:31], v[44:47]
  ds_read_b128 v[188:191], v252 offset:7168
  v_mul_f32 v236, v140, v140
  v_mfma_f32_16x16x32_bf16 v[48:51], v[212:215], a[24:27], v[48:51]
  ds_read_b128 v[192:195], v252 offset:8192
  buffer_load_dwordx4 v1, s[12:15], s20 offen offset:2048 sc1 lds
  v_mfma_f32_16x16x32_bf16 v[52:55], v[212:215], a[28:31], v[52:55]
  v_mul_f32 v237, v141, v141
  v_mul_f32 v238, v142, v142
  v_mfma_f32_16x16x32_bf16 v[56:59], v[216:219], a[24:27], v[56:59]
  s_add_u32 s20, s20, 3072
  s_add_u32 m0, s30, 4096
  v_mfma_f32_16x16x32_bf16 v[60:63], v[216:219], a[28:31], v[60:63]
  buffer_load_dwordx4 v245, s[16:19], s21 offen offset:2048 lds
  v_mfma_f32_16x16x32_bf16 v[64:67], v[220:223], a[24:27], v[64:67]
  v_mul_f32 v239, v143, v143
  v_fma_f32 v236, v236, s40, v14
  v_mfma_f32_16x16x32_bf16 v[68:71], v[220:223], a[28:31], v[68:71]
  v_fma_f32 v237, v237, s40, v14
  v_mfma_f32_16x16x32_bf16 v[72:75], v[224:227], a[24:27], v[72:75]
  buffer_load_dwordx4 v247, s[16:19], s21 offen offset:3072 lds
  v_mfma_f32_16x16x32_bf16 v[76:79], v[224:227], a[28:31], v[76:79]
  v_mfma_f32_16x16x32_bf16 v[80:83], v[228:231], a[24:27], v[80:83]
  v_mfma_f32_16x16x32_bf16 v[84:87], v[228:231], a[28:31], v[84:87]
  s_waitcnt vmcnt(21) lgkmcnt(0)
  v_mfma_f32_16x16x32_bf16 v[16:19], v[160:163], a[32:35], v[16:19]
  ds_read_b128 v[196:199], v252 offset:9216
  v_fma_f32 v238, v238, s40, v14
  v_mfma_f32_16x16x32_bf16 v[20:23], v[160:163], a[36:39], v[20:23]
  ds_read_b128 v[200:203], v252 offset:10240
  s_add_u32 m0, s7, 76800
  v_mfma_f32_16x16x32_bf16 v[24:27], v[164:167], a[32:35], v[24:27]
  ds_read_b128 v[204:207], v252 offset:11264
  buffer_load_dwordx4 v1, s[12:15], s20 offen offset:0 sc1 lds
  v_mfma_f32_16x16x32_bf16 v[28:31], v[164:167], a[36:39], v[28:31]
  ds_read_b128 v[208:211], v252 offset:12288
  v_fma_f32 v239, v239, s40, v14
  v_mfma_f32_16x16x32_bf16 v[32:35], v[168:171], a[32:35], v[32:35]
  ds_read_b128 v[212:215], v252 offset:13312
  v_mul_f32 v236, v236, v140
  v_mfma_f32_16x16x32_bf16 v[36:39], v[168:171], a[36:39], v[36:39]
  ds_read_b128 v[216:219], v252 offset:14336
  v_mul_f32 v237, v237, v141
  v_mfma_f32_16x16x32_bf16 v[40:43], v[172:175], a[32:35], v[40:43]
  ds_read_b128 v[220:223], v252 offset:15360
  v_mul_f32 v238, v238, v142
  v_mfma_f32_16x16x32_bf16 v[44:47], v[172:175], a[36:39], v[44:47]
  ds_read_b128 v[224:227], v252 offset:16384
  v_mul_f32 v239, v239, v143
  v_mfma_f32_16x16x32_bf16 v[48:51], v[176:179], a[32:35], v[48:51]
  ds_read_b128 v[228:231], v252 offset:17408
  v_mfma_f32_16x16x32_bf16 v[52:55], v[176:179], a[36:39], v[52:55]
  ds_read_b128 a[176:179], v4 offset:8192
  v_mfma_f32_16x16x32_bf16 v[56:59], v[180:183], a[32:35], v[56:59]
  ds_read_b128 a[180:183], v4 offset:10240
  buffer_load_dwordx4 v1, s[12:15], s20 offen offset:1024 sc1 lds
  v_mfma_f32_16x16x32_bf16 v[60:63], v[180:183], a[36:39], v[60:63]
  ds_read_b128 a[184:187], v8 offset:8192
  v_mfma_f32_16x16x32_bf16 v[64:67], v[184:187], a[32:35], v[64:67]
  ds_read_b128 a[188:191], v8 offset:10240
  v_mfma_f32_16x16x32_bf16 v[68:71], v[184:187], a[36:39], v[68:71]
  v_exp_f32 v236, v236
  v_mfma_f32_16x16x32_bf16 v[72:75], v[188:191], a[32:35], v[72:75]
  v_exp_f32 v237, v237
  v_mfma_f32_16x16x32_bf16 v[76:79], v[188:191], a[36:39], v[76:79]
  v_exp_f32 v238, v238
  v_mfma_f32_16x16x32_bf16 v[80:83], v[192:195], a[32:35], v[80:83]
  v_exp_f32 v239, v239
  v_mfma_f32_16x16x32_bf16 v[84:87], v[192:195], a[36:39], v[84:87]
  s_add_u32 s20, s20, 2048
  s_waitcnt lgkmcnt(0)
  v_mfma_f32_16x16x32_bf16 v[16:19], v[196:199], a[40:43], v[16:19]
  ds_read_b128 v[160:163], v252 offset:18432
  v_add_f32 v236, 1.0, v236
  v_mfma_f32_16x16x32_bf16 v[20:23], v[196:199], a[44:47], v[20:23]
  ds_read_b128 v[164:167], v252 offset:19456
  s_add_u32 m0, s7, 78848
  v_mfma_f32_16x16x32_bf16 v[24:27], v[200:203], a[40:43], v[24:27]
  ds_read_b128 v[168:171], v252 offset:20480
  buffer_load_dwordx4 v1, s[12:15], s20 offen offset:0 sc1 lds
  v_mfma_f32_16x16x32_bf16 v[28:31], v[200:203], a[44:47], v[28:31]
  ds_read_b128 v[172:175], v252 offset:21504
  v_add_f32 v237, 1.0, v237
  v_mfma_f32_16x16x32_bf16 v[32:35], v[204:207], a[40:43], v[32:35]
  ds_read_b128 v[176:179], v252 offset:22528
  v_add_f32 v238, 1.0, v238
  v_mfma_f32_16x16x32_bf16 v[36:39], v[204:207], a[44:47], v[36:39]
  ds_read_b128 v[180:183], v252 offset:23552
  v_add_f32 v239, 1.0, v239
  v_mfma_f32_16x16x32_bf16 v[40:43], v[208:211], a[40:43], v[40:43]
  ds_read_b128 v[184:187], v252 offset:24576
  buffer_load_dwordx4 v1, s[12:15], s20 offen offset:1024 sc1 lds
  v_mfma_f32_16x16x32_bf16 v[44:47], v[208:211], a[44:47], v[44:47]
  ds_read_b128 v[188:191], v252 offset:25600
  v_mfma_f32_16x16x32_bf16 v[48:51], v[212:215], a[40:43], v[48:51]
  ds_read_b128 v[192:195], v252 offset:26624
  v_mfma_f32_16x16x32_bf16 v[52:55], v[212:215], a[44:47], v[52:55]
  s_add_u32 s20, s20, 2048
  s_add_u32 s21, s29, 3840
  s_add_u32 m0, s30, 8192
  v_mfma_f32_16x16x32_bf16 v[56:59], v[216:219], a[40:43], v[56:59]
  buffer_load_dwordx4 v241, s[16:19], s21 offen offset:0 lds
  v_mfma_f32_16x16x32_bf16 v[60:63], v[216:219], a[44:47], v[60:63]
  v_rcp_f32 v236, v236
  v_mfma_f32_16x16x32_bf16 v[64:67], v[220:223], a[40:43], v[64:67]
  v_rcp_f32 v237, v237
  v_mfma_f32_16x16x32_bf16 v[68:71], v[220:223], a[44:47], v[68:71]
  v_rcp_f32 v238, v238
  v_mfma_f32_16x16x32_bf16 v[72:75], v[224:227], a[40:43], v[72:75]
  buffer_load_dwordx4 v243, s[16:19], s21 offen offset:1024 lds
  v_mfma_f32_16x16x32_bf16 v[76:79], v[224:227], a[44:47], v[76:79]
  v_rcp_f32 v239, v239
  v_mfma_f32_16x16x32_bf16 v[80:83], v[228:231], a[40:43], v[80:83]
  v_mul_f32 v140, v140, v236
  v_mul_f32 v141, v141, v237
  v_mfma_f32_16x16x32_bf16 v[84:87], v[228:231], a[44:47], v[84:87]
  s_waitcnt vmcnt(16) lgkmcnt(0)
  v_mfma_f32_16x16x32_bf16 v[16:19], v[160:163], a[48:51], v[16:19]
  ds_read_b128 v[196:199], v252 offset:27648
  v_mul_f32 v142, v142, v238
  v_mfma_f32_16x16x32_bf16 v[20:23], v[160:163], a[52:55], v[20:23]
  ds_read_b128 v[200:203], v252 offset:28672
  s_add_u32 m0, s7, 80896
  v_mfma_f32_16x16x32_bf16 v[24:27], v[164:167], a[48:51], v[24:27]
  ds_read_b128 v[204:207], v252 offset:29696
  buffer_load_dwordx4 v1, s[12:15], s20 offen offset:0 sc1 lds
  v_mfma_f32_16x16x32_bf16 v[28:31], v[164:167], a[52:55], v[28:31]
  ds_read_b128 v[208:211], v252 offset:30720
  v_mul_f32 v143, v143, v239
  v_mfma_f32_16x16x32_bf16 v[32:35], v[168:171], a[48:51], v[32:35]
  ds_read_b128 v[212:215], v252 offset:31744
  v_mul_f32 v232, v136, v136
  v_mfma_f32_16x16x32_bf16 v[36:39], v[168:171], a[52:55], v[36:39]
  ds_read_b128 v[216:219], v252 offset:32768
  v_mul_f32 v233, v137, v137
  v_mfma_f32_16x16x32_bf16 v[40:43], v[172:175], a[48:51], v[40:43]
  ds_read_b128 v[220:223], v252 offset:33792
  buffer_load_dwordx4 v1, s[12:15], s20 offen offset:1024 sc1 lds
  v_mfma_f32_16x16x32_bf16 v[44:47], v[172:175], a[52:55], v[44:47]
  ds_read_b128 v[224:227], v252 offset:34816
  v_mul_f32 v234, v138, v138
  v_mfma_f32_16x16x32_bf16 v[48:51], v[176:179], a[48:51], v[48:51]
  ds_read_b128 v[228:231], v252 offset:35840
  v_mul_f32 v235, v139, v139
  v_mfma_f32_16x16x32_bf16 v[52:55], v[176:179], a[52:55], v[52:55]
  ds_read_b128 a[192:195], v4 offset:0
  s_add_u32 s20, s20, 29696
  s_add_u32 m0, s30, 8192
  v_mfma_f32_16x16x32_bf16 v[56:59], v[180:183], a[48:51], v[56:59]
  ds_read_b128 a[196:199], v4 offset:2048
  buffer_load_dwordx4 v245, s[16:19], s21 offen offset:2048 lds
  v_mfma_f32_16x16x32_bf16 v[60:63], v[180:183], a[52:55], v[60:63]
  ds_read_b128 a[200:203], v8 offset:0
  v_fma_f32 v232, v232, s40, v14
  v_mfma_f32_16x16x32_bf16 v[64:67], v[184:187], a[48:51], v[64:67]
  ds_read_b128 a[204:207], v8 offset:2048
  v_fma_f32 v233, v233, s40, v14
  v_mfma_f32_16x16x32_bf16 v[68:71], v[184:187], a[52:55], v[68:71]
  v_fma_f32 v234, v234, s40, v14
  v_fma_f32 v235, v235, s40, v14
  v_mfma_f32_16x16x32_bf16 v[72:75], v[188:191], a[48:51], v[72:75]
  buffer_load_dwordx4 v247, s[16:19], s21 offen offset:3072 lds
  v_mfma_f32_16x16x32_bf16 v[76:79], v[188:191], a[52:55], v[76:79]
  v_mfma_f32_16x16x32_bf16 v[80:83], v[192:195], a[48:51], v[80:83]
  v_mfma_f32_16x16x32_bf16 v[84:87], v[192:195], a[52:55], v[84:87]
  s_waitcnt vmcnt(17) lgkmcnt(0)
  s_barrier
  v_mfma_f32_16x16x32_bf16 v[16:19], v[196:199], a[56:59], v[16:19]
  ds_read_b128 v[160:163], v253 offset:0
  v_mul_f32 v232, v232, v136
  v_mfma_f32_16x16x32_bf16 v[20:23], v[196:199], a[60:63], v[20:23]
  ds_read_b128 v[164:167], v253 offset:1024
  s_add_u32 m0, s7, 0
  v_mfma_f32_16x16x32_bf16 v[24:27], v[200:203], a[56:59], v[24:27]
  ds_read_b128 v[168:171], v253 offset:2048
  buffer_load_dwordx4 v1, s[12:15], s20 offen offset:0 sc1 lds
  v_mfma_f32_16x16x32_bf16 v[28:31], v[200:203], a[60:63], v[28:31]
  ds_read_b128 v[172:175], v253 offset:3072
  v_mul_f32 v233, v233, v137
  v_mfma_f32_16x16x32_bf16 v[32:35], v[204:207], a[56:59], v[32:35]
  ds_read_b128 v[176:179], v253 offset:4096
  v_mul_f32 v234, v234, v138
  v_mfma_f32_16x16x32_bf16 v[36:39], v[204:207], a[60:63], v[36:39]
  ds_read_b128 v[180:183], v253 offset:5120
  buffer_load_dwordx4 v1, s[12:15], s20 offen offset:1024 sc1 lds
  v_mfma_f32_16x16x32_bf16 v[40:43], v[208:211], a[56:59], v[40:43]
  ds_read_b128 v[184:187], v253 offset:6144
  v_mul_f32 v235, v235, v139
  v_mfma_f32_16x16x32_bf16 v[44:47], v[208:211], a[60:63], v[44:47]
  ds_read_b128 v[188:191], v253 offset:7168
  v_mfma_f32_16x16x32_bf16 v[48:51], v[212:215], a[56:59], v[48:51]
  ds_read_b128 v[192:195], v253 offset:8192
  buffer_load_dwordx4 v1, s[12:15], s20 offen offset:2048 sc1 lds
  v_mfma_f32_16x16x32_bf16 v[52:55], v[212:215], a[60:63], v[52:55]
  v_exp_f32 v232, v232
  v_mfma_f32_16x16x32_bf16 v[56:59], v[216:219], a[56:59], v[56:59]
  s_add_u32 s20, s20, 3072
  s_add_u32 s21, s29, 3968
  s_add_u32 m0, s30, 0
  v_mfma_f32_16x16x32_bf16 v[60:63], v[216:219], a[60:63], v[60:63]
  buffer_load_dwordx4 v241, s[16:19], s21 offen offset:0 lds
  v_mfma_f32_16x16x32_bf16 v[64:67], v[220:223], a[56:59], v[64:67]
  v_exp_f32 v233, v233
  v_mfma_f32_16x16x32_bf16 v[68:71], v[220:223], a[60:63], v[68:71]
  v_exp_f32 v234, v234
  v_mfma_f32_16x16x32_bf16 v[72:75], v[224:227], a[56:59], v[72:75]
  buffer_load_dwordx4 v243, s[16:19], s21 offen offset:1024 lds
  v_mfma_f32_16x16x32_bf16 v[76:79], v[224:227], a[60:63], v[76:79]
  v_exp_f32 v235, v235
  v_mfma_f32_16x16x32_bf16 v[80:83], v[228:231], a[56:59], v[80:83]
  v_add_f32 v232, 1.0, v232
  v_add_f32 v233, 1.0, v233
  v_mfma_f32_16x16x32_bf16 v[84:87], v[228:231], a[60:63], v[84:87]
  v_add_f32 v234, 1.0, v234
  s_waitcnt lgkmcnt(0)
  v_mfma_f32_16x16x32_bf16 v[16:19], v[160:163], a[64:67], v[16:19]
  ds_read_b128 v[196:199], v253 offset:9216
  v_add_f32 v235, 1.0, v235
  v_mfma_f32_16x16x32_bf16 v[20:23], v[160:163], a[68:71], v[20:23]
  ds_read_b128 v[200:203], v253 offset:10240
  s_add_u32 m0, s7, 3072
  v_mfma_f32_16x16x32_bf16 v[24:27], v[164:167], a[64:67], v[24:27]
  ds_read_b128 v[204:207], v253 offset:11264
  buffer_load_dwordx4 v1, s[12:15], s20 offen offset:0 sc1 lds
  v_mfma_f32_16x16x32_bf16 v[28:31], v[164:167], a[68:71], v[28:31]
  ds_read_b128 v[208:211], v253 offset:12288
  v_mfma_f32_16x16x32_bf16 v[32:35], v[168:171], a[64:67], v[32:35]
  ds_read_b128 v[212:215], v253 offset:13312
  v_mfma_f32_16x16x32_bf16 v[36:39], v[168:171], a[68:71], v[36:39]
  ds_read_b128 v[216:219], v253 offset:14336
  v_mfma_f32_16x16x32_bf16 v[40:43], v[172:175], a[64:67], v[40:43]
  ds_read_b128 v[220:223], v253 offset:15360
  buffer_load_dwordx4 v1, s[12:15], s20 offen offset:1024 sc1 lds
  v_mfma_f32_16x16x32_bf16 v[44:47], v[172:175], a[68:71], v[44:47]
  ds_read_b128 v[224:227], v253 offset:16384
  v_mfma_f32_16x16x32_bf16 v[48:51], v[176:179], a[64:67], v[48:51]
  ds_read_b128 v[228:231], v253 offset:17408
  v_mfma_f32_16x16x32_bf16 v[52:55], v[176:179], a[68:71], v[52:55]
  s_add_u32 s20, s20, 2048
  s_add_u32 m0, s30, 0
  v_mfma_f32_16x16x32_bf16 v[56:59], v[180:183], a[64:67], v[56:59]
  buffer_load_dwordx4 v245, s[16:19], s21 offen offset:2048 lds
  v_mfma_f32_16x16x32_bf16 v[60:63], v[180:183], a[68:71], v[60:63]
  v_rcp_f32 v232, v232
  v_mfma_f32_16x16x32_bf16 v[64:67], v[184:187], a[64:67], v[64:67]
  v_rcp_f32 v233, v233
  v_mfma_f32_16x16x32_bf16 v[68:71], v[184:187], a[68:71], v[68:71]
  v_rcp_f32 v234, v234
  v_mfma_f32_16x16x32_bf16 v[72:75], v[188:191], a[64:67], v[72:75]
  buffer_load_dwordx4 v247, s[16:19], s21 offen offset:3072 lds
  v_mfma_f32_16x16x32_bf16 v[76:79], v[188:191], a[68:71], v[76:79]
  v_rcp_f32 v235, v235
  v_mfma_f32_16x16x32_bf16 v[80:83], v[192:195], a[64:67], v[80:83]
  v_mul_f32 v136, v136, v232
  v_mul_f32 v137, v137, v233
  v_mfma_f32_16x16x32_bf16 v[84:87], v[192:195], a[68:71], v[84:87]
  v_mul_f32 v138, v138, v234
  v_mul_f32 v139, v139, v235
  v_mul_f32 v236, v148, v148
  s_waitcnt vmcnt(19) lgkmcnt(0)
  v_mfma_f32_16x16x32_bf16 v[16:19], v[196:199], a[72:75], v[16:19]
  ds_read_b128 v[160:163], v253 offset:18432
  v_mul_f32 v237, v149, v149
  v_mfma_f32_16x16x32_bf16 v[20:23], v[196:199], a[76:79], v[20:23]
  ds_read_b128 v[164:167], v253 offset:19456
  s_add_u32 m0, s7, 5120
  v_mfma_f32_16x16x32_bf16 v[24:27], v[200:203], a[72:75], v[24:27]
  ds_read_b128 v[168:171], v253 offset:20480
  buffer_load_dwordx4 v1, s[12:15], s20 offen offset:0 sc1 lds
  v_mfma_f32_16x16x32_bf16 v[28:31], v[200:203], a[76:79], v[28:31]
  ds_read_b128 v[172:175], v253 offset:21504
  v_mul_f32 v238, v150, v150
  v_mfma_f32_16x16x32_bf16 v[32:35], v[204:207], a[72:75], v[32:35]
  ds_read_b128 v[176:179], v253 offset:22528
  v_mul_f32 v239, v151, v151
  v_mfma_f32_16x16x32_bf16 v[36:39], v[204:207], a[76:79], v[36:39]
  ds_read_b128 v[180:183], v253 offset:23552
  v_fma_f32 v236, v236, s40, v14
  v_mfma_f32_16x16x32_bf16 v[40:43], v[208:211], a[72:75], v[40:43]
  ds_read_b128 v[184:187], v253 offset:24576
  v_fma_f32 v237, v237, s40, v14
  v_mfma_f32_16x16x32_bf16 v[44:47], v[208:211], a[76:79], v[44:47]
  ds_read_b128 v[188:191], v253 offset:25600
  buffer_load_dwordx4 v1, s[12:15], s20 offen offset:1024 sc1 lds
  v_mfma_f32_16x16x32_bf16 v[48:51], v[212:215], a[72:75], v[48:51]
  ds_read_b128 v[192:195], v253 offset:26624
  v_fma_f32 v238, v238, s40, v14
  v_mfma_f32_16x16x32_bf16 v[52:55], v[212:215], a[76:79], v[52:55]
  ds_read_b128 a[208:211], v4 offset:4096
  v_fma_f32 v239, v239, s40, v14
  v_mfma_f32_16x16x32_bf16 v[56:59], v[216:219], a[72:75], v[56:59]
  ds_read_b128 a[212:215], v4 offset:6144
  v_mul_f32 v236, v236, v148
  v_mfma_f32_16x16x32_bf16 v[60:63], v[216:219], a[76:79], v[60:63]
  ds_read_b128 a[216:219], v8 offset:4096
  s_add_u32 s20, s20, 2048
  v_mfma_f32_16x16x32_bf16 v[64:67], v[220:223], a[72:75], v[64:67]
  ds_read_b128 a[220:223], v8 offset:6144
  buffer_load_dword v15, v255, s[32:35], 0 offen
  v_mfma_f32_16x16x32_bf16 v[68:71], v[220:223], a[76:79], v[68:71]
  v_mul_f32 v237, v237, v149
  v_mul_f32 v238, v238, v150
  v_mfma_f32_16x16x32_bf16 v[72:75], v[224:227], a[72:75], v[72:75]
  v_mfma_f32_16x16x32_bf16 v[76:79], v[224:227], a[76:79], v[76:79]
  v_mfma_f32_16x16x32_bf16 v[80:83], v[228:231], a[72:75], v[80:83]
  v_mfma_f32_16x16x32_bf16 v[84:87], v[228:231], a[76:79], v[84:87]
  s_waitcnt lgkmcnt(0)
  v_mfma_f32_16x16x32_bf16 v[16:19], v[160:163], a[80:83], v[16:19]
  ds_read_b128 v[196:199], v253 offset:27648
  v_mul_f32 v239, v239, v151
  v_mfma_f32_16x16x32_bf16 v[20:23], v[160:163], a[84:87], v[20:23]
  ds_read_b128 v[200:203], v253 offset:28672
  s_add_u32 m0, s7, 7168
  v_mfma_f32_16x16x32_bf16 v[24:27], v[164:167], a[80:83], v[24:27]
  ds_read_b128 v[204:207], v253 offset:29696
  buffer_load_dwordx4 v1, s[12:15], s20 offen offset:0 sc1 lds
  v_mfma_f32_16x16x32_bf16 v[28:31], v[164:167], a[84:87], v[28:31]
  ds_read_b128 v[208:211], v253 offset:30720
  v_mfma_f32_16x16x32_bf16 v[32:35], v[168:171], a[80:83], v[32:35]
  ds_read_b128 v[212:215], v253 offset:31744
  v_mfma_f32_16x16x32_bf16 v[36:39], v[168:171], a[84:87], v[36:39]
  ds_read_b128 v[216:219], v253 offset:32768
  v_mfma_f32_16x16x32_bf16 v[40:43], v[172:175], a[80:83], v[40:43]
  ds_read_b128 v[220:223], v253 offset:33792
  v_mfma_f32_16x16x32_bf16 v[44:47], v[172:175], a[84:87], v[44:47]
  ds_read_b128 v[224:227], v253 offset:34816
  v_mfma_f32_16x16x32_bf16 v[48:51], v[176:179], a[80:83], v[48:51]
  ds_read_b128 v[228:231], v253 offset:35840
  v_mfma_f32_16x16x32_bf16 v[52:55], v[176:179], a[84:87], v[52:55]
  v_exp_f32 v236, v236
  v_mfma_f32_16x16x32_bf16 v[56:59], v[180:183], a[80:83], v[56:59]
  buffer_load_dwordx4 v1, s[12:15], s20 offen offset:1024 sc1 lds
  v_mfma_f32_16x16x32_bf16 v[60:63], v[180:183], a[84:87], v[60:63]
  v_exp_f32 v237, v237
  v_mfma_f32_16x16x32_bf16 v[64:67], v[184:187], a[80:83], v[64:67]
  v_exp_f32 v238, v238
  v_mfma_f32_16x16x32_bf16 v[68:71], v[184:187], a[84:87], v[68:71]
  v_exp_f32 v239, v239
  v_mfma_f32_16x16x32_bf16 v[72:75], v[188:191], a[80:83], v[72:75]
  v_add_f32 v236, 1.0, v236
  v_add_f32 v237, 1.0, v237
  v_mfma_f32_16x16x32_bf16 v[76:79], v[188:191], a[84:87], v[76:79]
  v_add_f32 v238, 1.0, v238
  v_add_f32 v239, 1.0, v239
  v_mfma_f32_16x16x32_bf16 v[80:83], v[192:195], a[80:83], v[80:83]
  v_rcp_f32 v236, v236
  v_mfma_f32_16x16x32_bf16 v[84:87], v[192:195], a[84:87], v[84:87]
  s_add_u32 s20, s20, 29696
  s_waitcnt vmcnt(14) lgkmcnt(0)
  s_barrier
  v_mfma_f32_16x16x32_bf16 v[16:19], v[196:199], a[88:91], v[16:19]
  ds_read_b128 v[160:163], v254 offset:0
  v_mfma_f32_16x16x32_bf16 v[20:23], v[196:199], a[92:95], v[20:23]
  ds_read_b128 v[164:167], v254 offset:1024
  s_add_u32 m0, s7, 36864
  v_mfma_f32_16x16x32_bf16 v[24:27], v[200:203], a[88:91], v[24:27]
  ds_read_b128 v[168:171], v254 offset:2048
  buffer_load_dwordx4 v1, s[12:15], s20 offen offset:0 sc1 lds
  v_mfma_f32_16x16x32_bf16 v[28:31], v[200:203], a[92:95], v[28:31]
  ds_read_b128 v[172:175], v254 offset:3072
  v_mfma_f32_16x16x32_bf16 v[32:35], v[204:207], a[88:91], v[32:35]
  ds_read_b128 v[176:179], v254 offset:4096
  buffer_load_dwordx4 v1, s[12:15], s20 offen offset:1024 sc1 lds
  v_mfma_f32_16x16x32_bf16 v[36:39], v[204:207], a[92:95], v[36:39]
  ds_read_b128 v[180:183], v254 offset:5120
  v_mfma_f32_16x16x32_bf16 v[40:43], v[208:211], a[88:91], v[40:43]
  ds_read_b128 v[184:187], v254 offset:6144
  buffer_load_dwordx4 v1, s[12:15], s20 offen offset:2048 sc1 lds
  v_mfma_f32_16x16x32_bf16 v[44:47], v[208:211], a[92:95], v[44:47]
  ds_read_b128 v[188:191], v254 offset:7168
  s_add_u32 s20, s20, 3072
  s_add_u32 s36, s39, 0
  v_mfma_f32_16x16x32_bf16 v[48:51], v[212:215], a[88:91], v[48:51]
  ds_read_b128 v[192:195], v254 offset:8192
  buffer_load_dwordx4 a[0:3], v3, s[8:11], s36 offen offset:0 sc1
  v_mfma_f32_16x16x32_bf16 v[52:55], v[212:215], a[92:95], v[52:55]
  ds_read_b128 a[224:227], v4 offset:8192
  v_rcp_f32 v237, v237
  v_mfma_f32_16x16x32_bf16 v[56:59], v[216:219], a[88:91], v[56:59]
  ds_read_b128 a[228:231], v4 offset:10240
  buffer_load_dwordx4 a[4:7], v1, s[8:11], s36 offen offset:1024 sc1
  v_mfma_f32_16x16x32_bf16 v[60:63], v[216:219], a[92:95], v[60:63]
  ds_read_b128 a[232:235], v8 offset:8192
  v_rcp_f32 v238, v238
  v_mfma_f32_16x16x32_bf16 v[64:67], v[220:223], a[88:91], v[64:67]
  ds_read_b128 a[236:239], v8 offset:10240
  buffer_load_dwordx4 a[8:11], v1, s[8:11], s36 offen offset:2048 sc1
  v_mfma_f32_16x16x32_bf16 v[68:71], v[220:223], a[92:95], v[68:71]
  v_rcp_f32 v239, v239
  v_mul_f32 v148, v148, v236
  v_mfma_f32_16x16x32_bf16 v[72:75], v[224:227], a[88:91], v[72:75]
  buffer_load_dwordx4 a[12:15], v1, s[8:11], s36 offen offset:3072 sc1
  v_mul_f32 v149, v149, v237
  v_mfma_f32_16x16x32_bf16 v[76:79], v[224:227], a[92:95], v[76:79]
  v_mul_f32 v150, v150, v238
  v_mul_f32 v151, v151, v239
  v_mul_f32 v232, v144, v144
  v_mfma_f32_16x16x32_bf16 v[80:83], v[228:231], a[88:91], v[80:83]
  buffer_load_dwordx4 a[16:19], v250, s[8:11], s36 offen offset:0 sc1
  v_mul_f32 v233, v145, v145
  v_mfma_f32_16x16x32_bf16 v[84:87], v[228:231], a[92:95], v[84:87]
  v_mul_f32 v234, v146, v146
  s_waitcnt lgkmcnt(0)
  v_mfma_f32_16x16x32_bf16 v[16:19], v[160:163], a[96:99], v[16:19]
  ds_read_b128 v[196:199], v254 offset:9216
  v_mul_f32 v235, v147, v147
  v_mfma_f32_16x16x32_bf16 v[20:23], v[160:163], a[100:103], v[20:23]
  ds_read_b128 v[200:203], v254 offset:10240
  s_add_u32 m0, s7, 39936
  v_mfma_f32_16x16x32_bf16 v[24:27], v[164:167], a[96:99], v[24:27]
  ds_read_b128 v[204:207], v254 offset:11264
  buffer_load_dwordx4 v1, s[12:15], s20 offen offset:0 sc1 lds
  v_mfma_f32_16x16x32_bf16 v[28:31], v[164:167], a[100:103], v[28:31]
  ds_read_b128 v[208:211], v254 offset:12288
  v_fma_f32 v232, v232, s40, v14
  v_mfma_f32_16x16x32_bf16 v[32:35], v[168:171], a[96:99], v[32:35]
  ds_read_b128 v[212:215], v254 offset:13312
  buffer_load_dwordx4 v1, s[12:15], s20 offen offset:1024 sc1 lds
  v_mfma_f32_16x16x32_bf16 v[36:39], v[168:171], a[100:103], v[36:39]
  ds_read_b128 v[216:219], v254 offset:14336
  v_fma_f32 v233, v233, s40, v14
  v_mfma_f32_16x16x32_bf16 v[40:43], v[172:175], a[96:99], v[40:43]
  ds_read_b128 v[220:223], v254 offset:15360
  s_add_u32 s20, s20, 2048
  v_mfma_f32_16x16x32_bf16 v[44:47], v[172:175], a[100:103], v[44:47]
  ds_read_b128 v[224:227], v254 offset:16384
  buffer_load_dword v240, v9, s[8:11], s42 offen offset:0 sc1
  v_mfma_f32_16x16x32_bf16 v[48:51], v[176:179], a[96:99], v[48:51]
  ds_read_b128 v[228:231], v254 offset:17408
  v_fma_f32 v234, v234, s40, v14
  v_mfma_f32_16x16x32_bf16 v[52:55], v[176:179], a[100:103], v[52:55]
  v_fma_f32 v235, v235, s40, v14
  v_mul_f32 v232, v232, v144
  v_mfma_f32_16x16x32_bf16 v[56:59], v[180:183], a[96:99], v[56:59]
  buffer_load_dword v242, v9, s[8:11], s43 offen offset:0 sc1
  v_mfma_f32_16x16x32_bf16 v[60:63], v[180:183], a[100:103], v[60:63]
  v_mul_f32 v233, v233, v145
  v_mul_f32 v234, v234, v146
  v_mfma_f32_16x16x32_bf16 v[64:67], v[184:187], a[96:99], v[64:67]
  buffer_load_dword v244, v9, s[8:11], s42 offen offset:512 sc1
  v_mfma_f32_16x16x32_bf16 v[68:71], v[184:187], a[100:103], v[68:71]
  v_mul_f32 v235, v235, v147
  v_mfma_f32_16x16x32_bf16 v[72:75], v[188:191], a[96:99], v[72:75]
  v_exp_f32 v232, v232
  v_mfma_f32_16x16x32_bf16 v[76:79], v[188:191], a[100:103], v[76:79]
  buffer_load_dword v246, v9, s[8:11], s43 offen offset:512 sc1
  v_mfma_f32_16x16x32_bf16 v[80:83], v[192:195], a[96:99], v[80:83]
  v_mfma_f32_16x16x32_bf16 v[84:87], v[192:195], a[100:103], v[84:87]
  s_waitcnt lgkmcnt(0)
  v_mfma_f32_16x16x32_bf16 v[16:19], v[196:199], a[104:107], v[16:19]
  ds_read_b128 v[160:163], v254 offset:18432
  v_mfma_f32_16x16x32_bf16 v[20:23], v[196:199], a[108:111], v[20:23]
  ds_read_b128 v[164:167], v254 offset:19456
  s_add_u32 m0, s7, 41984
  v_mfma_f32_16x16x32_bf16 v[24:27], v[200:203], a[104:107], v[24:27]
  ds_read_b128 v[168:171], v254 offset:20480
  buffer_load_dwordx4 v1, s[12:15], s20 offen offset:0 sc1 lds
  v_mfma_f32_16x16x32_bf16 v[28:31], v[200:203], a[108:111], v[28:31]
  ds_read_b128 v[172:175], v254 offset:21504
  v_mfma_f32_16x16x32_bf16 v[32:35], v[204:207], a[104:107], v[32:35]
  ds_read_b128 v[176:179], v254 offset:22528
  buffer_load_dwordx4 v1, s[12:15], s20 offen offset:1024 sc1 lds
  v_mfma_f32_16x16x32_bf16 v[36:39], v[204:207], a[108:111], v[36:39]
  ds_read_b128 v[180:183], v254 offset:23552
  s_add_u32 s20, s20, 2048
  s_add_u32 s36, s39, 36864
  v_mfma_f32_16x16x32_bf16 v[40:43], v[208:211], a[104:107], v[40:43]
  ds_read_b128 v[184:187], v254 offset:24576
  buffer_load_dwordx4 a[20:23], v3, s[8:11], s36 offen offset:0 sc1
  v_mfma_f32_16x16x32_bf16 v[44:47], v[208:211], a[108:111], v[44:47]
  ds_read_b128 v[188:191], v254 offset:25600
  v_exp_f32 v233, v233
  v_mfma_f32_16x16x32_bf16 v[48:51], v[212:215], a[104:107], v[48:51]
  ds_read_b128 v[192:195], v254 offset:26624
  buffer_load_dwordx4 a[24:27], v1, s[8:11], s36 offen offset:1024 sc1
  v_mfma_f32_16x16x32_bf16 v[52:55], v[212:215], a[108:111], v[52:55]
  v_exp_f32 v234, v234
  v_mfma_f32_16x16x32_bf16 v[56:59], v[216:219], a[104:107], v[56:59]
  v_exp_f32 v235, v235
  v_add_f32 v232, 1.0, v232
  v_mfma_f32_16x16x32_bf16 v[60:63], v[216:219], a[108:111], v[60:63]
  buffer_load_dwordx4 a[28:31], v1, s[8:11], s36 offen offset:2048 sc1
  v_add_f32 v233, 1.0, v233
  v_mfma_f32_16x16x32_bf16 v[64:67], v[220:223], a[104:107], v[64:67]
  v_add_f32 v234, 1.0, v234
  v_add_f32 v235, 1.0, v235
  v_mfma_f32_16x16x32_bf16 v[68:71], v[220:223], a[108:111], v[68:71]
  buffer_load_dwordx4 a[32:35], v1, s[8:11], s36 offen offset:3072 sc1
  v_mfma_f32_16x16x32_bf16 v[72:75], v[224:227], a[104:107], v[72:75]
  v_rcp_f32 v232, v232
  v_mfma_f32_16x16x32_bf16 v[76:79], v[224:227], a[108:111], v[76:79]
  buffer_load_dwordx4 a[36:39], v250, s[8:11], s36 offen offset:0 sc1
  v_mfma_f32_16x16x32_bf16 v[80:83], v[228:231], a[104:107], v[80:83]
  v_rcp_f32 v233, v233
  v_mfma_f32_16x16x32_bf16 v[84:87], v[228:231], a[108:111], v[84:87]
  v_rcp_f32 v234, v234
  s_waitcnt vmcnt(26) lgkmcnt(0)
  v_mfma_f32_16x16x32_bf16 v[16:19], v[160:163], a[112:115], v[16:19]
  ds_read_b128 v[196:199], v254 offset:27648
  s_add_u32 s21, s7, 552960
  v_mfma_f32_16x16x32_bf16 v[20:23], v[160:163], a[116:119], v[20:23]
  ds_read_b128 v[200:203], v254 offset:28672
  s_add_u32 m0, s7, 44032
  v_mfma_f32_16x16x32_bf16 v[24:27], v[164:167], a[112:115], v[24:27]
  ds_read_b128 v[204:207], v254 offset:29696
  buffer_load_dwordx4 v1, s[12:15], s20 offen offset:0 sc1 lds
  v_mfma_f32_16x16x32_bf16 v[28:31], v[164:167], a[116:119], v[28:31]
  ds_read_b128 v[208:211], v254 offset:30720
  v_mfma_f32_16x16x32_bf16 v[32:35], v[168:171], a[112:115], v[32:35]
  ds_read_b128 v[212:215], v254 offset:31744
  v_mfma_f32_16x16x32_bf16 v[36:39], v[168:171], a[116:119], v[36:39]
  ds_read_b128 v[216:219], v254 offset:32768
  v_mfma_f32_16x16x32_bf16 v[40:43], v[172:175], a[112:115], v[40:43]
  ds_read_b128 v[220:223], v254 offset:33792
  v_mfma_f32_16x16x32_bf16 v[44:47], v[172:175], a[116:119], v[44:47]
  ds_read_b128 v[224:227], v254 offset:34816
  v_mfma_f32_16x16x32_bf16 v[48:51], v[176:179], a[112:115], v[48:51]
  ds_read_b128 v[228:231], v254 offset:35840
  v_mfma_f32_16x16x32_bf16 v[52:55], v[176:179], a[116:119], v[52:55]
  ds_read_b128 a[240:243], v4 offset:0
  v_mfma_f32_16x16x32_bf16 v[56:59], v[180:183], a[112:115], v[56:59]
  ds_read_b128 a[244:247], v4 offset:2048
  buffer_load_dwordx4 v1, s[12:15], s20 offen offset:1024 sc1 lds
  v_mfma_f32_16x16x32_bf16 v[60:63], v[180:183], a[116:119], v[60:63]
  ds_read_b128 a[248:251], v8 offset:0
  v_mfma_f32_16x16x32_bf16 v[64:67], v[184:187], a[112:115], v[64:67]
  ds_read_b128 a[252:255], v8 offset:2048
  v_mfma_f32_16x16x32_bf16 v[68:71], v[184:187], a[116:119], v[68:71]
  v_rcp_f32 v235, v235
  v_mfma_f32_16x16x32_bf16 v[72:75], v[188:191], a[112:115], v[72:75]
  v_mul_f32 v144, v144, v232
  v_mul_f32 v145, v145, v233
  v_mfma_f32_16x16x32_bf16 v[76:79], v[188:191], a[116:119], v[76:79]
  v_mul_f32 v146, v146, v234
  v_mul_f32 v147, v147, v235
  v_mfma_f32_16x16x32_bf16 v[80:83], v[192:195], a[112:115], v[80:83]
  v_mul_f32 v236, v156, v156
  v_mul_f32 v237, v157, v157
  v_mfma_f32_16x16x32_bf16 v[84:87], v[192:195], a[116:119], v[84:87]
  v_mul_f32 v238, v158, v158
  v_mul_f32 v239, v159, v159
  v_fma_f32 v236, v236, s40, v14
  s_add_u32 s20, s20, 29696
  s_waitcnt vmcnt(23) lgkmcnt(0)
  s_barrier
  v_mfma_f32_16x16x32_bf16 v[16:19], v[196:199], a[120:123], v[16:19]
  ds_read_b128 v[160:163], v252 offset:0
  v_fma_f32 v237, v237, s40, v14
  v_mfma_f32_16x16x32_bf16 v[20:23], v[196:199], a[124:127], v[20:23]
  ds_read_b128 v[164:167], v252 offset:1024
  s_add_u32 m0, s7, 110592
  v_mfma_f32_16x16x32_bf16 v[24:27], v[200:203], a[120:123], v[24:27]
  ds_read_b128 v[168:171], v252 offset:2048
  buffer_load_dwordx4 v1, s[12:15], s21 offen offset:0 sc1 lds
  v_mfma_f32_16x16x32_bf16 v[28:31], v[200:203], a[124:127], v[28:31]
  ds_read_b128 v[172:175], v252 offset:3072
  v_fma_f32 v238, v238, s40, v14
  v_mfma_f32_16x16x32_bf16 v[32:35], v[204:207], a[120:123], v[32:35]
  ds_read_b128 v[176:179], v252 offset:4096
  buffer_load_dwordx4 v1, s[12:15], s21 offen offset:1024 sc1 lds
  v_mfma_f32_16x16x32_bf16 v[36:39], v[204:207], a[124:127], v[36:39]
  ds_read_b128 v[180:183], v252 offset:5120
  v_fma_f32 v239, v239, s40, v14
  v_mfma_f32_16x16x32_bf16 v[40:43], v[208:211], a[120:123], v[40:43]
  ds_read_b128 v[184:187], v252 offset:6144
  buffer_load_dwordx4 v1, s[12:15], s21 offen offset:2048 sc1 lds
  v_mfma_f32_16x16x32_bf16 v[44:47], v[208:211], a[124:127], v[44:47]
  ds_read_b128 v[188:191], v252 offset:7168
  s_add_u32 s21, s21, 3072
  s_add_u32 m0, s7, 113664
  v_mfma_f32_16x16x32_bf16 v[48:51], v[212:215], a[120:123], v[48:51]
  ds_read_b128 v[192:195], v252 offset:8192
  buffer_load_dwordx4 v1, s[12:15], s21 offen offset:0 sc1 lds
  v_mfma_f32_16x16x32_bf16 v[52:55], v[212:215], a[124:127], v[52:55]
  v_mul_f32 v236, v236, v156
  v_mul_f32 v237, v237, v157
  v_mfma_f32_16x16x32_bf16 v[56:59], v[216:219], a[120:123], v[56:59]
  buffer_load_dwordx4 v1, s[12:15], s21 offen offset:1024 sc1 lds
  v_mfma_f32_16x16x32_bf16 v[60:63], v[216:219], a[124:127], v[60:63]
  s_add_u32 s21, s21, 2048
  s_add_u32 m0, s7, 73728
  v_mfma_f32_16x16x32_bf16 v[64:67], v[220:223], a[120:123], v[64:67]
  buffer_load_dwordx4 v1, s[12:15], s20 offen offset:0 sc1 lds
  v_mul_f32 v238, v238, v158
  v_mfma_f32_16x16x32_bf16 v[68:71], v[220:223], a[124:127], v[68:71]
  v_mul_f32 v239, v239, v159
  v_exp_f32 v236, v236
  v_mfma_f32_16x16x32_bf16 v[72:75], v[224:227], a[120:123], v[72:75]
  buffer_load_dwordx4 v1, s[12:15], s20 offen offset:1024 sc1 lds
  v_mfma_f32_16x16x32_bf16 v[76:79], v[224:227], a[124:127], v[76:79]
  v_exp_f32 v237, v237
  v_mfma_f32_16x16x32_bf16 v[80:83], v[228:231], a[120:123], v[80:83]
  buffer_load_dwordx4 v1, s[12:15], s20 offen offset:2048 sc1 lds
  v_mfma_f32_16x16x32_bf16 v[84:87], v[228:231], a[124:127], v[84:87]
  v_exp_f32 v238, v238
  s_add_u32 s20, s20, 3072
  s_waitcnt lgkmcnt(0)
  v_mfma_f32_16x16x32_bf16 v[16:19], v[160:163], a[128:131], v[16:19]
  ds_read_b128 v[196:199], v252 offset:9216
  v_add_u32 v4, 110592, v1
  v_mfma_f32_16x16x32_bf16 v[20:23], v[160:163], a[132:135], v[20:23]
  ds_read_b128 v[200:203], v252 offset:10240
  s_add_u32 m0, s7, 115712
  v_lshlrev_b32 v8, 3, v2
  v_mfma_f32_16x16x32_bf16 v[24:27], v[164:167], a[128:131], v[24:27]
  ds_read_b128 v[204:207], v252 offset:11264
  buffer_load_dwordx4 v1, s[12:15], s21 offen offset:0 sc1 lds
  v_mfma_f32_16x16x32_bf16 v[28:31], v[164:167], a[132:135], v[28:31]
  ds_read_b128 v[208:211], v252 offset:12288
  s_lshr_b32 s22, s5, 1
  s_mul_i32 s22, s22, 9216
  v_mfma_f32_16x16x32_bf16 v[32:35], v[168:171], a[128:131], v[32:35]
  ds_read_b128 v[212:215], v252 offset:13312
  buffer_load_dwordx4 v1, s[12:15], s21 offen offset:1024 sc1 lds
  v_mfma_f32_16x16x32_bf16 v[36:39], v[168:171], a[132:135], v[36:39]
  ds_read_b128 v[216:219], v252 offset:14336
  s_mul_i32 s23, s6, 147456
  s_add_u32 s22, s22, s23
  v_mfma_f32_16x16x32_bf16 v[40:43], v[172:175], a[128:131], v[40:43]
  ds_read_b128 v[220:223], v252 offset:15360
  s_add_u32 s21, s21, 2048
  s_add_u32 m0, s7, 117760
  v_mfma_f32_16x16x32_bf16 v[44:47], v[172:175], a[132:135], v[44:47]
  ds_read_b128 v[224:227], v252 offset:16384
  buffer_load_dwordx4 v1, s[12:15], s21 offen offset:0 sc1 lds
  v_mfma_f32_16x16x32_bf16 v[48:51], v[176:179], a[128:131], v[48:51]
  ds_read_b128 v[228:231], v252 offset:17408
  s_add_u32 s22, s22, 45088768
  s_and_b32 s23, s5, 1
  v_mfma_f32_16x16x32_bf16 v[52:55], v[176:179], a[132:135], v[52:55]
  s_lshl_b32 s28, s23, 12
  s_add_u32 s28, s28, s22
  s_add_u32 s29, s28, 73728
  v_mfma_f32_16x16x32_bf16 v[56:59], v[180:183], a[128:131], v[56:59]
  buffer_load_dwordx4 v1, s[12:15], s21 offen offset:1024 sc1 lds
  s_lshl_b32 s23, s23, 9
  v_mfma_f32_16x16x32_bf16 v[60:63], v[180:183], a[132:135], v[60:63]
  s_add_u32 s21, s21, 2048
  s_add_u32 m0, s7, 76800
  s_add_u32 s30, s22, s23
  v_mfma_f32_16x16x32_bf16 v[64:67], v[184:187], a[128:131], v[64:67]
  buffer_load_dwordx4 v1, s[12:15], s20 offen offset:0 sc1 lds
  s_add_u32 s30, s30, 8192
  v_mfma_f32_16x16x32_bf16 v[68:71], v[184:187], a[132:135], v[68:71]
  s_add_u32 s31, s30, 73728
  s_add_u32 s24, s24, 131072
  v_exp_f32 v239, v239
  v_mfma_f32_16x16x32_bf16 v[72:75], v[188:191], a[128:131], v[72:75]
  v_add_f32 v236, 1.0, v236
  v_add_f32 v237, 1.0, v237
  v_add_f32 v238, 1.0, v238
  v_add_f32 v239, 1.0, v239
  v_mfma_f32_16x16x32_bf16 v[76:79], v[188:191], a[132:135], v[76:79]
  buffer_load_dwordx4 v1, s[12:15], s20 offen offset:1024 sc1 lds
  v_rcp_f32 v236, v236
  v_mfma_f32_16x16x32_bf16 v[80:83], v[192:195], a[128:131], v[80:83]
  v_rcp_f32 v237, v237
  v_rcp_f32 v238, v238
  v_mfma_f32_16x16x32_bf16 v[84:87], v[192:195], a[132:135], v[84:87]
  v_rcp_f32 v239, v239
  v_mul_f32 v156, v156, v236
  s_add_u32 s20, s20, 2048
  s_waitcnt lgkmcnt(0)
  v_mfma_f32_16x16x32_bf16 v[16:19], v[196:199], a[136:139], v[16:19]
  ds_read_b128 v[160:163], v252 offset:18432
  v_mul_f32 v157, v157, v237
  v_mfma_f32_16x16x32_bf16 v[20:23], v[196:199], a[140:143], v[20:23]
  ds_read_b128 v[164:167], v252 offset:19456
  s_add_u32 m0, s7, 78848
  v_mfma_f32_16x16x32_bf16 v[24:27], v[200:203], a[136:139], v[24:27]
  ds_read_b128 v[168:171], v252 offset:20480
  buffer_load_dwordx4 v1, s[12:15], s20 offen offset:0 sc1 lds
  v_mfma_f32_16x16x32_bf16 v[28:31], v[200:203], a[140:143], v[28:31]
  ds_read_b128 v[172:175], v252 offset:21504
  v_mul_f32 v158, v158, v238
  v_mfma_f32_16x16x32_bf16 v[32:35], v[204:207], a[136:139], v[32:35]
  ds_read_b128 v[176:179], v252 offset:22528
  v_mul_f32 v159, v159, v239
  v_mfma_f32_16x16x32_bf16 v[36:39], v[204:207], a[140:143], v[36:39]
  ds_read_b128 v[180:183], v252 offset:23552
  v_mul_f32 v232, v152, v152
  v_mfma_f32_16x16x32_bf16 v[40:43], v[208:211], a[136:139], v[40:43]
  ds_read_b128 v[184:187], v252 offset:24576
  v_mul_f32 v233, v153, v153
  v_mfma_f32_16x16x32_bf16 v[44:47], v[208:211], a[140:143], v[44:47]
  ds_read_b128 v[188:191], v252 offset:25600
  buffer_load_dwordx4 v1, s[12:15], s20 offen offset:1024 sc1 lds
  v_mfma_f32_16x16x32_bf16 v[48:51], v[212:215], a[136:139], v[48:51]
  ds_read_b128 v[192:195], v252 offset:26624
  v_mul_f32 v234, v154, v154
  v_mfma_f32_16x16x32_bf16 v[52:55], v[212:215], a[140:143], v[52:55]
  v_mul_f32 v235, v155, v155
  v_fma_f32 v232, v232, s40, v14
  v_mfma_f32_16x16x32_bf16 v[56:59], v[216:219], a[136:139], v[56:59]
  v_fma_f32 v233, v233, s40, v14
  v_fma_f32 v234, v234, s40, v14
  v_mfma_f32_16x16x32_bf16 v[60:63], v[216:219], a[140:143], v[60:63]
  s_add_u32 s20, s20, 2048
  v_mfma_f32_16x16x32_bf16 v[64:67], v[220:223], a[136:139], v[64:67]
  buffer_load_dword v15, v255, s[32:35], 0 offen
  v_mfma_f32_16x16x32_bf16 v[68:71], v[220:223], a[140:143], v[68:71]
  v_mfma_f32_16x16x32_bf16 v[72:75], v[224:227], a[136:139], v[72:75]
  v_mfma_f32_16x16x32_bf16 v[76:79], v[224:227], a[140:143], v[76:79]
  v_mfma_f32_16x16x32_bf16 v[80:83], v[228:231], a[136:139], v[80:83]
  v_mfma_f32_16x16x32_bf16 v[84:87], v[228:231], a[140:143], v[84:87]
  s_waitcnt lgkmcnt(0)
  v_mfma_f32_16x16x32_bf16 v[16:19], v[160:163], a[144:147], v[16:19]
  ds_read_b128 v[196:199], v252 offset:27648
  v_fma_f32 v235, v235, s40, v14
  v_mfma_f32_16x16x32_bf16 v[20:23], v[160:163], a[148:151], v[20:23]
  ds_read_b128 v[200:203], v252 offset:28672
  s_add_u32 m0, s7, 80896
  v_mfma_f32_16x16x32_bf16 v[24:27], v[164:167], a[144:147], v[24:27]
  ds_read_b128 v[204:207], v252 offset:29696
  buffer_load_dwordx4 v1, s[12:15], s20 offen offset:0 sc1 lds
  v_mfma_f32_16x16x32_bf16 v[28:31], v[164:167], a[148:151], v[28:31]
  ds_read_b128 v[208:211], v252 offset:30720
  v_mul_f32 v232, v232, v152
  v_mfma_f32_16x16x32_bf16 v[32:35], v[168:171], a[144:147], v[32:35]
  ds_read_b128 v[212:215], v252 offset:31744
  v_mul_f32 v233, v233, v153
  v_mfma_f32_16x16x32_bf16 v[36:39], v[168:171], a[148:151], v[36:39]
  ds_read_b128 v[216:219], v252 offset:32768
  v_mul_f32 v234, v234, v154
  v_mfma_f32_16x16x32_bf16 v[40:43], v[172:175], a[144:147], v[40:43]
  ds_read_b128 v[220:223], v252 offset:33792
  v_mul_f32 v235, v235, v155
  v_mfma_f32_16x16x32_bf16 v[44:47], v[172:175], a[148:151], v[44:47]
  ds_read_b128 v[224:227], v252 offset:34816
  v_mfma_f32_16x16x32_bf16 v[48:51], v[176:179], a[144:147], v[48:51]
  ds_read_b128 v[228:231], v252 offset:35840
  v_mfma_f32_16x16x32_bf16 v[52:55], v[176:179], a[148:151], v[52:55]
  v_exp_f32 v232, v232
  v_mfma_f32_16x16x32_bf16 v[56:59], v[180:183], a[144:147], v[56:59]
  buffer_load_dwordx4 v1, s[12:15], s20 offen offset:1024 sc1 lds
  v_mfma_f32_16x16x32_bf16 v[60:63], v[180:183], a[148:151], v[60:63]
  v_exp_f32 v233, v233
  v_mfma_f32_16x16x32_bf16 v[64:67], v[184:187], a[144:147], v[64:67]
  v_exp_f32 v234, v234
  v_mfma_f32_16x16x32_bf16 v[68:71], v[184:187], a[148:151], v[68:71]
  v_exp_f32 v235, v235
  v_mfma_f32_16x16x32_bf16 v[72:75], v[188:191], a[144:147], v[72:75]
  v_add_f32 v232, 1.0, v232
  v_mfma_f32_16x16x32_bf16 v[76:79], v[188:191], a[148:151], v[76:79]
  v_mfma_f32_16x16x32_bf16 v[80:83], v[192:195], a[144:147], v[80:83]
  v_mfma_f32_16x16x32_bf16 v[84:87], v[192:195], a[148:151], v[84:87]
  s_add_u32 s20, s20, 29696
  s_waitcnt vmcnt(7) lgkmcnt(0)
  s_barrier
  v_mfma_f32_16x16x32_bf16 v[16:19], v[196:199], a[152:155], v[16:19]
  ds_read_b128 v[160:163], v253 offset:0
  v_add_f32 v6, v240, v242
  v_mfma_f32_16x16x32_bf16 v[20:23], v[196:199], a[156:159], v[20:23]
  ds_read_b128 v[164:167], v253 offset:9216
  v_add_f32 v7, v244, v246
  v_mfma_f32_16x16x32_bf16 v[24:27], v[200:203], a[152:155], v[24:27]
  ds_read_b128 v[168:171], v253 offset:18432
  v_cvt_pk_bf16_f32 v6, v6, v7
  v_mfma_f32_16x16x32_bf16 v[28:31], v[200:203], a[156:159], v[28:31]
  ds_read_b128 v[172:175], v253 offset:27648
  v_and_b32 v7, 0xffff0000, v6
  v_mfma_f32_16x16x32_bf16 v[32:35], v[204:207], a[152:155], v[32:35]
  ds_read_b128 v[176:179], v4 offset:0
  v_lshlrev_b32 v6, 16, v6
  v_mfma_f32_16x16x32_bf16 v[36:39], v[204:207], a[156:159], v[36:39]
  ds_read_b128 v[180:183], v4 offset:9216
  v_add_f32 v233, 1.0, v233
  v_mfma_f32_16x16x32_bf16 v[40:43], v[208:211], a[152:155], v[40:43]
  v_add_f32 v234, 1.0, v234
  v_add_f32 v235, 1.0, v235
  v_mfma_f32_16x16x32_bf16 v[44:47], v[208:211], a[156:159], v[44:47]
  v_rcp_f32 v232, v232
  v_mfma_f32_16x16x32_bf16 v[48:51], v[212:215], a[152:155], v[48:51]
  v_rcp_f32 v233, v233
  v_mfma_f32_16x16x32_bf16 v[52:55], v[212:215], a[156:159], v[52:55]
  v_rcp_f32 v234, v234
  v_mfma_f32_16x16x32_bf16 v[56:59], v[216:219], a[152:155], v[56:59]
  v_rcp_f32 v235, v235
  v_mfma_f32_16x16x32_bf16 v[60:63], v[216:219], a[156:159], v[60:63]
  v_mul_f32 v152, v152, v232
  v_mul_f32 v153, v153, v233
  v_mfma_f32_16x16x32_bf16 v[64:67], v[220:223], a[152:155], v[64:67]
  v_mul_f32 v154, v154, v234
  v_mul_f32 v155, v155, v235
  v_mfma_f32_16x16x32_bf16 v[68:71], v[220:223], a[156:159], v[68:71]
  v_mfma_f32_16x16x32_bf16 v[72:75], v[224:227], a[152:155], v[72:75]
  v_mfma_f32_16x16x32_bf16 v[76:79], v[224:227], a[156:159], v[76:79]
  v_mfma_f32_16x16x32_bf16 v[80:83], v[228:231], a[152:155], v[80:83]
  v_mfma_f32_16x16x32_bf16 v[84:87], v[228:231], a[156:159], v[84:87]
  s_waitcnt vmcnt(0) lgkmcnt(0)
  s_barrier
  ds_read_b128 v[184:187], v4 offset:18432
  ds_read_b128 v[188:191], v4 offset:27648
  ds_read_b128 v[192:195], v254 offset:0
  ds_read_b128 v[196:199], v254 offset:9216
  ds_read_b128 v[200:203], v254 offset:18432
  ds_read_b128 v[204:207], v254 offset:27648
  v_mfma_f32_16x16x32_bf16 v[16:19], v[160:163], a[160:163], v[16:19]
  ds_read_b128 v[208:211], v253 offset:1024
  v_mfma_f32_16x16x32_bf16 v[20:23], v[160:163], a[164:167], v[20:23]
  ds_read_b128 v[212:215], v253 offset:10240
  v_mfma_f32_16x16x32_bf16 v[16:19], v[164:167], a[168:171], v[16:19]
  ds_read_b128 v[216:219], v253 offset:19456
  v_mfma_f32_16x16x32_bf16 v[20:23], v[164:167], a[172:175], v[20:23]
  ds_read_b128 v[220:223], v253 offset:28672
  v_mfma_f32_16x16x32_bf16 v[16:19], v[168:171], a[176:179], v[16:19]
  ds_read_b128 v[224:227], v4 offset:1024
  v_mfma_f32_16x16x32_bf16 v[20:23], v[168:171], a[180:183], v[20:23]
  ds_read_b128 v[228:231], v4 offset:10240
  v_mfma_f32_16x16x32_bf16 v[16:19], v[172:175], a[184:187], v[16:19]
  v_mfma_f32_16x16x32_bf16 v[20:23], v[172:175], a[188:191], v[20:23]
  v_mfma_f32_16x16x32_bf16 v[16:19], v[176:179], a[224:227], v[16:19]
  v_mfma_f32_16x16x32_bf16 v[20:23], v[176:179], a[228:231], v[20:23]
  v_mfma_f32_16x16x32_bf16 v[16:19], v[180:183], a[232:235], v[16:19]
  v_mfma_f32_16x16x32_bf16 v[20:23], v[180:183], a[236:239], v[20:23]
  s_waitcnt lgkmcnt(6)
  v_mfma_f32_16x16x32_bf16 v[16:19], v[184:187], a[240:243], v[16:19]
  ds_read_b128 v[160:163], v4 offset:19456
  s_add_u32 s36, s39, 147456
  v_mfma_f32_16x16x32_bf16 v[20:23], v[184:187], a[244:247], v[20:23]
  ds_read_b128 v[164:167], v4 offset:28672
  buffer_load_dwordx4 a[40:43], v3, s[8:11], s36 offen offset:0 sc1
  v_mfma_f32_16x16x32_bf16 v[16:19], v[188:191], a[248:251], v[16:19]
  ds_read_b128 v[168:171], v254 offset:1024
  s_mul_i32 s20, s44, 294912
  v_mfma_f32_16x16x32_bf16 v[20:23], v[188:191], a[252:255], v[20:23]
  ds_read_b128 v[172:175], v254 offset:10240
  buffer_load_dwordx4 a[44:47], v1, s[8:11], s36 offen offset:1024 sc1
  v_mfma_f32_16x16x32_bf16 v[16:19], v[192:195], a[192:195], v[16:19]
  ds_read_b128 v[176:179], v254 offset:19456
  s_mul_i32 s6, s3, 18432
  v_mfma_f32_16x16x32_bf16 v[20:23], v[192:195], a[196:199], v[20:23]
  ds_read_b128 v[180:183], v254 offset:28672
  buffer_load_dwordx4 a[48:51], v1, s[8:11], s36 offen offset:2048 sc1
  v_mfma_f32_16x16x32_bf16 v[16:19], v[196:199], a[200:203], v[16:19]
  s_add_u32 s20, s20, s6
  s_add_u32 s20, s20, 45088768
  v_mfma_f32_16x16x32_bf16 v[20:23], v[196:199], a[204:207], v[20:23]
  buffer_load_dwordx4 a[52:55], v1, s[8:11], s36 offen offset:3072 sc1
  v_mfma_f32_16x16x32_bf16 v[16:19], v[200:203], a[208:211], v[16:19]
  s_lshl_b32 s23, s44, 12
  s_lshl_b32 s6, s3, 9
  v_mfma_f32_16x16x32_bf16 v[20:23], v[200:203], a[212:215], v[20:23]
  buffer_load_dwordx4 a[56:59], v250, s[8:11], s36 offen offset:0 sc1
  v_mfma_f32_16x16x32_bf16 v[16:19], v[204:207], a[216:219], v[16:19]
  s_add_u32 s23, s23, s6
  v_mfma_f32_16x16x32_bf16 v[20:23], v[204:207], a[220:223], v[20:23]
  s_waitcnt lgkmcnt(6)
  v_mfma_f32_16x16x32_bf16 v[24:27], v[208:211], a[160:163], v[24:27]
  ds_read_b128 v[184:187], v253 offset:2048
  v_mfma_f32_16x16x32_bf16 v[28:31], v[208:211], a[164:167], v[28:31]
  ds_read_b128 v[188:191], v253 offset:11264
  v_mfma_f32_16x16x32_bf16 v[24:27], v[212:215], a[168:171], v[24:27]
  ds_read_b128 v[192:195], v253 offset:20480
  v_mfma_f32_16x16x32_bf16 v[28:31], v[212:215], a[172:175], v[28:31]
  ds_read_b128 v[196:199], v253 offset:29696
  v_mfma_f32_16x16x32_bf16 v[24:27], v[216:219], a[176:179], v[24:27]
  ds_read_b128 v[200:203], v4 offset:2048
  v_mfma_f32_16x16x32_bf16 v[28:31], v[216:219], a[180:183], v[28:31]
  ds_read_b128 v[204:207], v4 offset:11264
  v_mfma_f32_16x16x32_bf16 v[24:27], v[220:223], a[184:187], v[24:27]
  v_mul_f32 v16, v16, v88
  v_mul_f32 v17, v17, v89
  v_mfma_f32_16x16x32_bf16 v[28:31], v[220:223], a[188:191], v[28:31]
  v_mul_f32 v18, v18, v90
  v_mul_f32 v19, v19, v91
  v_mfma_f32_16x16x32_bf16 v[24:27], v[224:227], a[224:227], v[24:27]
  v_cvt_pk_bf16_f32 v16, v16, v17
  v_cvt_pk_bf16_f32 v17, v18, v19
  v_mfma_f32_16x16x32_bf16 v[28:31], v[224:227], a[228:231], v[28:31]
  v_mul_f32 v20, v20, v92
  v_mul_f32 v21, v21, v93
  v_mfma_f32_16x16x32_bf16 v[24:27], v[228:231], a[232:235], v[24:27]
  v_mul_f32 v22, v22, v94
  v_mul_f32 v23, v23, v95
  v_mfma_f32_16x16x32_bf16 v[28:31], v[228:231], a[236:239], v[28:31]
  v_cvt_pk_bf16_f32 v20, v20, v21
  v_cvt_pk_bf16_f32 v21, v22, v23
  s_waitcnt lgkmcnt(6)
  v_mfma_f32_16x16x32_bf16 v[24:27], v[160:163], a[240:243], v[24:27]
  ds_read_b128 v[208:211], v4 offset:20480
  s_add_u32 s36, s39, 184320
  v_mfma_f32_16x16x32_bf16 v[28:31], v[160:163], a[244:247], v[28:31]
  ds_read_b128 v[212:215], v4 offset:29696
  buffer_load_dwordx4 a[60:63], v3, s[8:11], s36 offen offset:0 sc1
  v_mfma_f32_16x16x32_bf16 v[24:27], v[164:167], a[248:251], v[24:27]
  ds_read_b128 v[216:219], v254 offset:2048
  s_add_u32 s23, s23, 7995392
  v_mfma_f32_16x16x32_bf16 v[28:31], v[164:167], a[252:255], v[28:31]
  ds_read_b128 v[220:223], v254 offset:11264
  buffer_load_dwordx4 a[64:67], v1, s[8:11], s36 offen offset:1024 sc1
  v_mfma_f32_16x16x32_bf16 v[24:27], v[168:171], a[192:195], v[24:27]
  ds_read_b128 v[224:227], v254 offset:20480
  v_and_b32 v10, 3, v2
  v_mfma_f32_16x16x32_bf16 v[28:31], v[168:171], a[196:199], v[28:31]
  ds_read_b128 v[228:231], v254 offset:29696
  buffer_load_dwordx4 a[68:71], v1, s[8:11], s36 offen offset:2048 sc1
  v_mfma_f32_16x16x32_bf16 v[24:27], v[172:175], a[200:203], v[24:27]
  v_bfe_u32 v11, v2, 2, 1
  v_lshl_add_u32 v10, v11, 4, v10
  v_mfma_f32_16x16x32_bf16 v[28:31], v[172:175], a[204:207], v[28:31]
  buffer_load_dwordx4 a[72:75], v1, s[8:11], s36 offen offset:3072 sc1
  v_mfma_f32_16x16x32_bf16 v[24:27], v[176:179], a[208:211], v[24:27]
  v_lshlrev_b32 v10, 7, v10
  s_lshl_b32 s22, s44, 2
  v_mfma_f32_16x16x32_bf16 v[28:31], v[176:179], a[212:215], v[28:31]
  buffer_load_dwordx4 a[76:79], v250, s[8:11], s36 offen offset:0 sc1
  v_mfma_f32_16x16x32_bf16 v[24:27], v[180:183], a[216:219], v[24:27]
  s_add_u32 s22, s22, s3
  v_mfma_f32_16x16x32_bf16 v[28:31], v[180:183], a[220:223], v[28:31]
  s_waitcnt lgkmcnt(6)
  v_mfma_f32_16x16x32_bf16 v[32:35], v[184:187], a[160:163], v[32:35]
  ds_read_b128 v[160:163], v253 offset:3072
  v_mfma_f32_16x16x32_bf16 v[36:39], v[184:187], a[164:167], v[36:39]
  ds_read_b128 v[164:167], v253 offset:12288
  v_mfma_f32_16x16x32_bf16 v[32:35], v[188:191], a[168:171], v[32:35]
  ds_read_b128 v[168:171], v253 offset:21504
  v_mfma_f32_16x16x32_bf16 v[36:39], v[188:191], a[172:175], v[36:39]
  ds_read_b128 v[172:175], v253 offset:30720
  v_mfma_f32_16x16x32_bf16 v[32:35], v[192:195], a[176:179], v[32:35]
  ds_read_b128 v[176:179], v4 offset:3072
  v_mfma_f32_16x16x32_bf16 v[36:39], v[192:195], a[180:183], v[36:39]
  ds_read_b128 v[180:183], v4 offset:12288
  v_mfma_f32_16x16x32_bf16 v[32:35], v[196:199], a[184:187], v[32:35]
  v_mul_f32 v24, v24, v96
  v_mul_f32 v25, v25, v97
  v_mul_f32 v26, v26, v98
  v_mfma_f32_16x16x32_bf16 v[36:39], v[196:199], a[188:191], v[36:39]
  v_mul_f32 v27, v27, v99
  v_cvt_pk_bf16_f32 v18, v24, v25
  v_mfma_f32_16x16x32_bf16 v[32:35], v[200:203], a[224:227], v[32:35]
  v_cvt_pk_bf16_f32 v19, v26, v27
  buffer_store_dwordx4 v[16:19], v1, s[8:11], s28 offen offset:0 sc1
  v_mfma_f32_16x16x32_bf16 v[36:39], v[200:203], a[228:231], v[36:39]
  v_mul_f32 v28, v28, v100
  v_mul_f32 v29, v29, v101
  v_mul_f32 v30, v30, v102
  v_mfma_f32_16x16x32_bf16 v[32:35], v[204:207], a[232:235], v[32:35]
  v_mul_f32 v31, v31, v103
  v_cvt_pk_bf16_f32 v22, v28, v29
  v_mfma_f32_16x16x32_bf16 v[36:39], v[204:207], a[236:239], v[36:39]
  v_cvt_pk_bf16_f32 v23, v30, v31
  buffer_store_dwordx4 v[20:23], v1, s[8:11], s29 offen offset:0 sc1
  s_waitcnt lgkmcnt(6)
  v_mfma_f32_16x16x32_bf16 v[32:35], v[208:211], a[240:243], v[32:35]
  ds_read_b128 v[184:187], v4 offset:21504
  s_add_u32 s36, s39, 331776
  v_mfma_f32_16x16x32_bf16 v[36:39], v[208:211], a[244:247], v[36:39]
  ds_read_b128 v[188:191], v4 offset:30720
  buffer_load_dwordx4 a[80:83], v3, s[8:11], s36 offen offset:0 sc1
  v_mfma_f32_16x16x32_bf16 v[32:35], v[212:215], a[248:251], v[32:35]
  ds_read_b128 v[192:195], v254 offset:3072
  s_mul_i32 s25, s22, 18432
  v_mfma_f32_16x16x32_bf16 v[36:39], v[212:215], a[252:255], v[36:39]
  ds_read_b128 v[196:199], v254 offset:12288
  buffer_load_dwordx4 a[84:87], v1, s[8:11], s36 offen offset:1024 sc1
  v_mfma_f32_16x16x32_bf16 v[32:35], v[216:219], a[192:195], v[32:35]
  ds_read_b128 v[200:203], v254 offset:21504
  s_lshl_b32 s26, s45, 9
  v_mfma_f32_16x16x32_bf16 v[36:39], v[216:219], a[196:199], v[36:39]
  ds_read_b128 v[204:207], v254 offset:30720
  buffer_load_dwordx4 a[88:91], v1, s[8:11], s36 offen offset:2048 sc1
  v_mfma_f32_16x16x32_bf16 v[32:35], v[220:223], a[200:203], v[32:35]
  s_add_u32 s25, s25, s26
  s_add_u32 s25, s25, 5242880
  v_mfma_f32_16x16x32_bf16 v[36:39], v[220:223], a[204:207], v[36:39]
  buffer_load_dwordx4 a[92:95], v1, s[8:11], s36 offen offset:3072 sc1
  v_mfma_f32_16x16x32_bf16 v[32:35], v[224:227], a[208:211], v[32:35]
  v_lshlrev_b32 v249, 4, v12
  s_add_u32 s6, s3, 0
  v_mfma_f32_16x16x32_bf16 v[36:39], v[224:227], a[212:215], v[36:39]
  buffer_load_dwordx4 a[96:99], v250, s[8:11], s36 offen offset:0 sc1
  v_mfma_f32_16x16x32_bf16 v[32:35], v[228:231], a[216:219], v[32:35]
  s_and_b32 s6, s6, 3
  s_mul_i32 s7, s6, 73728
  v_mfma_f32_16x16x32_bf16 v[36:39], v[228:231], a[220:223], v[36:39]
  s_waitcnt lgkmcnt(6)
  v_mfma_f32_16x16x32_bf16 v[40:43], v[160:163], a[160:163], v[40:43]
  ds_read_b128 v[208:211], v253 offset:4096
  v_mfma_f32_16x16x32_bf16 v[44:47], v[160:163], a[164:167], v[44:47]
  ds_read_b128 v[212:215], v253 offset:13312
  v_mfma_f32_16x16x32_bf16 v[40:43], v[164:167], a[168:171], v[40:43]
  ds_read_b128 v[216:219], v253 offset:22528
  v_mfma_f32_16x16x32_bf16 v[44:47], v[164:167], a[172:175], v[44:47]
  ds_read_b128 v[220:223], v253 offset:31744
  v_mfma_f32_16x16x32_bf16 v[40:43], v[168:171], a[176:179], v[40:43]
  ds_read_b128 v[224:227], v4 offset:4096
  v_mfma_f32_16x16x32_bf16 v[44:47], v[168:171], a[180:183], v[44:47]
  ds_read_b128 v[228:231], v4 offset:13312
  v_mfma_f32_16x16x32_bf16 v[40:43], v[172:175], a[184:187], v[40:43]
  v_mul_f32 v32, v32, v104
  v_mul_f32 v33, v33, v105
  v_mfma_f32_16x16x32_bf16 v[44:47], v[172:175], a[188:191], v[44:47]
  v_mul_f32 v34, v34, v106
  v_mul_f32 v35, v35, v107
  v_mfma_f32_16x16x32_bf16 v[40:43], v[176:179], a[224:227], v[40:43]
  v_cvt_pk_bf16_f32 v32, v32, v33
  v_cvt_pk_bf16_f32 v33, v34, v35
  v_mfma_f32_16x16x32_bf16 v[44:47], v[176:179], a[228:231], v[44:47]
  v_mul_f32 v36, v36, v108
  v_mul_f32 v37, v37, v109
  v_mfma_f32_16x16x32_bf16 v[40:43], v[180:183], a[232:235], v[40:43]
  v_mul_f32 v38, v38, v110
  v_mul_f32 v39, v39, v111
  v_mfma_f32_16x16x32_bf16 v[44:47], v[180:183], a[236:239], v[44:47]
  v_cvt_pk_bf16_f32 v36, v36, v37
  v_cvt_pk_bf16_f32 v37, v38, v39
  s_waitcnt lgkmcnt(6)
  v_mfma_f32_16x16x32_bf16 v[40:43], v[184:187], a[240:243], v[40:43]
  ds_read_b128 v[160:163], v4 offset:22528
  v_add_u32 v240, s7, v1
  v_mfma_f32_16x16x32_bf16 v[44:47], v[184:187], a[244:247], v[44:47]
  ds_read_b128 v[164:167], v4 offset:31744
  s_add_u32 s6, s3, 1
  v_mfma_f32_16x16x32_bf16 v[40:43], v[188:191], a[248:251], v[40:43]
  ds_read_b128 v[168:171], v254 offset:4096
  s_and_b32 s6, s6, 3
  v_mfma_f32_16x16x32_bf16 v[44:47], v[188:191], a[252:255], v[44:47]
  ds_read_b128 v[172:175], v254 offset:13312
  s_mul_i32 s7, s6, 73728
  v_mfma_f32_16x16x32_bf16 v[40:43], v[192:195], a[192:195], v[40:43]
  ds_read_b128 v[176:179], v254 offset:22528
  v_add_u32 v241, s7, v1
  v_mfma_f32_16x16x32_bf16 v[44:47], v[192:195], a[196:199], v[44:47]
  ds_read_b128 v[180:183], v254 offset:31744
  s_mul_i32 s7, s6, 15360
  v_mfma_f32_16x16x32_bf16 v[40:43], v[196:199], a[200:203], v[40:43]
  s_add_u32 s7, s7, 0
  v_mfma_f32_16x16x32_bf16 v[44:47], v[196:199], a[204:207], v[44:47]
  v_mfma_f32_16x16x32_bf16 v[40:43], v[200:203], a[208:211], v[40:43]
  v_mfma_f32_16x16x32_bf16 v[44:47], v[200:203], a[212:215], v[44:47]
  v_mfma_f32_16x16x32_bf16 v[40:43], v[204:207], a[216:219], v[40:43]
  v_mfma_f32_16x16x32_bf16 v[44:47], v[204:207], a[220:223], v[44:47]
  s_waitcnt lgkmcnt(6)
  v_mfma_f32_16x16x32_bf16 v[48:51], v[208:211], a[160:163], v[48:51]
  ds_read_b128 v[184:187], v253 offset:5120
  v_mfma_f32_16x16x32_bf16 v[52:55], v[208:211], a[164:167], v[52:55]
  ds_read_b128 v[188:191], v253 offset:14336
  v_mfma_f32_16x16x32_bf16 v[48:51], v[212:215], a[168:171], v[48:51]
  ds_read_b128 v[192:195], v253 offset:23552
  v_mfma_f32_16x16x32_bf16 v[52:55], v[212:215], a[172:175], v[52:55]
  ds_read_b128 v[196:199], v253 offset:32768
  v_mfma_f32_16x16x32_bf16 v[48:51], v[216:219], a[176:179], v[48:51]
  ds_read_b128 v[200:203], v4 offset:5120
  v_mfma_f32_16x16x32_bf16 v[52:55], v[216:219], a[180:183], v[52:55]
  ds_read_b128 v[204:207], v4 offset:14336
  v_mfma_f32_16x16x32_bf16 v[48:51], v[220:223], a[184:187], v[48:51]
  v_mul_f32 v40, v40, v112
  v_mul_f32 v41, v41, v113
  v_mul_f32 v42, v42, v114
  v_mfma_f32_16x16x32_bf16 v[52:55], v[220:223], a[188:191], v[52:55]
  v_mul_f32 v43, v43, v115
  v_cvt_pk_bf16_f32 v34, v40, v41
  v_mfma_f32_16x16x32_bf16 v[48:51], v[224:227], a[224:227], v[48:51]
  v_cvt_pk_bf16_f32 v35, v42, v43
  buffer_store_dwordx4 v[32:35], v1, s[8:11], s28 offen offset:1024 sc1
  v_mfma_f32_16x16x32_bf16 v[52:55], v[224:227], a[228:231], v[52:55]
  v_mul_f32 v44, v44, v116
  v_mul_f32 v45, v45, v117
  v_mul_f32 v46, v46, v118
  v_mfma_f32_16x16x32_bf16 v[48:51], v[228:231], a[232:235], v[48:51]
  v_mul_f32 v47, v47, v119
  v_cvt_pk_bf16_f32 v38, v44, v45
  v_mfma_f32_16x16x32_bf16 v[52:55], v[228:231], a[236:239], v[52:55]
  v_cvt_pk_bf16_f32 v39, v46, v47
  buffer_store_dwordx4 v[36:39], v1, s[8:11], s29 offen offset:1024 sc1
  s_waitcnt lgkmcnt(6)
  v_mfma_f32_16x16x32_bf16 v[48:51], v[160:163], a[240:243], v[48:51]
  ds_read_b128 v[208:211], v4 offset:23552
  s_add_u32 s36, s39, 368640
  v_mfma_f32_16x16x32_bf16 v[52:55], v[160:163], a[244:247], v[52:55]
  ds_read_b128 v[212:215], v4 offset:32768
  buffer_load_dwordx4 a[100:103], v3, s[8:11], s36 offen offset:0 sc1
  v_mfma_f32_16x16x32_bf16 v[48:51], v[164:167], a[248:251], v[48:51]
  ds_read_b128 v[216:219], v254 offset:5120
  v_add_u32 v245, s7, v1
  v_mfma_f32_16x16x32_bf16 v[52:55], v[164:167], a[252:255], v[52:55]
  ds_read_b128 v[220:223], v254 offset:14336
  buffer_load_dwordx4 a[104:107], v1, s[8:11], s36 offen offset:1024 sc1
  v_mfma_f32_16x16x32_bf16 v[48:51], v[168:171], a[192:195], v[48:51]
  ds_read_b128 v[224:227], v254 offset:23552
  s_add_u32 s6, s3, 2
  v_mfma_f32_16x16x32_bf16 v[52:55], v[168:171], a[196:199], v[52:55]
  ds_read_b128 v[228:231], v254 offset:32768
  buffer_load_dwordx4 a[108:111], v1, s[8:11], s36 offen offset:2048 sc1
  v_mfma_f32_16x16x32_bf16 v[48:51], v[172:175], a[200:203], v[48:51]
  s_and_b32 s6, s6, 3
  s_mul_i32 s7, s6, 73728
  v_mfma_f32_16x16x32_bf16 v[52:55], v[172:175], a[204:207], v[52:55]
  buffer_load_dwordx4 a[112:115], v1, s[8:11], s36 offen offset:3072 sc1
  v_mfma_f32_16x16x32_bf16 v[48:51], v[176:179], a[208:211], v[48:51]
  v_add_u32 v242, s7, v1
  s_mul_i32 s7, s6, 15360
  v_mfma_f32_16x16x32_bf16 v[52:55], v[176:179], a[212:215], v[52:55]
  buffer_load_dwordx4 a[116:119], v250, s[8:11], s36 offen offset:0 sc1
  v_mfma_f32_16x16x32_bf16 v[48:51], v[180:183], a[216:219], v[48:51]
  s_add_u32 s7, s7, 5120
  v_mfma_f32_16x16x32_bf16 v[52:55], v[180:183], a[220:223], v[52:55]
  s_waitcnt lgkmcnt(6)
  v_mfma_f32_16x16x32_bf16 v[56:59], v[184:187], a[160:163], v[56:59]
  ds_read_b128 v[160:163], v253 offset:6144
  v_mfma_f32_16x16x32_bf16 v[60:63], v[184:187], a[164:167], v[60:63]
  ds_read_b128 v[164:167], v253 offset:15360
  v_mfma_f32_16x16x32_bf16 v[56:59], v[188:191], a[168:171], v[56:59]
  ds_read_b128 v[168:171], v253 offset:24576
  v_mfma_f32_16x16x32_bf16 v[60:63], v[188:191], a[172:175], v[60:63]
  ds_read_b128 v[172:175], v253 offset:33792
  v_mfma_f32_16x16x32_bf16 v[56:59], v[192:195], a[176:179], v[56:59]
  ds_read_b128 v[176:179], v4 offset:6144
  v_mfma_f32_16x16x32_bf16 v[60:63], v[192:195], a[180:183], v[60:63]
  ds_read_b128 v[180:183], v4 offset:15360
  v_mfma_f32_16x16x32_bf16 v[56:59], v[196:199], a[184:187], v[56:59]
  v_mul_f32 v48, v48, v120
  v_mul_f32 v49, v49, v121
  v_mfma_f32_16x16x32_bf16 v[60:63], v[196:199], a[188:191], v[60:63]
  v_mul_f32 v50, v50, v122
  v_mul_f32 v51, v51, v123
  v_mfma_f32_16x16x32_bf16 v[56:59], v[200:203], a[224:227], v[56:59]
  v_cvt_pk_bf16_f32 v48, v48, v49
  v_cvt_pk_bf16_f32 v49, v50, v51
  v_mfma_f32_16x16x32_bf16 v[60:63], v[200:203], a[228:231], v[60:63]
  v_mul_f32 v52, v52, v124
  v_mul_f32 v53, v53, v125
  v_mfma_f32_16x16x32_bf16 v[56:59], v[204:207], a[232:235], v[56:59]
  v_mul_f32 v54, v54, v126
  v_mul_f32 v55, v55, v127
  v_mfma_f32_16x16x32_bf16 v[60:63], v[204:207], a[236:239], v[60:63]
  v_cvt_pk_bf16_f32 v52, v52, v53
  v_cvt_pk_bf16_f32 v53, v54, v55
  s_waitcnt lgkmcnt(6)
  s_waitcnt vmcnt(5)
  buffer_store_dword v5, v13, s[8:11], s24 offen sc1
  v_mfma_f32_16x16x32_bf16 v[56:59], v[208:211], a[240:243], v[56:59]
  ds_read_b128 v[184:187], v4 offset:24576
  s_add_u32 s36, s39, 479232
  v_mfma_f32_16x16x32_bf16 v[60:63], v[208:211], a[244:247], v[60:63]
  ds_read_b128 v[188:191], v4 offset:33792
  buffer_load_dwordx4 a[120:123], v3, s[8:11], s36 offen offset:0 sc1
  v_mfma_f32_16x16x32_bf16 v[56:59], v[212:215], a[248:251], v[56:59]
  ds_read_b128 v[192:195], v254 offset:6144
  v_add_u32 v246, s7, v1
  v_mfma_f32_16x16x32_bf16 v[60:63], v[212:215], a[252:255], v[60:63]
  ds_read_b128 v[196:199], v254 offset:15360
  buffer_load_dwordx4 a[124:127], v1, s[8:11], s36 offen offset:1024 sc1
  v_mfma_f32_16x16x32_bf16 v[56:59], v[216:219], a[192:195], v[56:59]
  ds_read_b128 v[200:203], v254 offset:24576
  s_add_u32 s6, s3, 3
  v_mfma_f32_16x16x32_bf16 v[60:63], v[216:219], a[196:199], v[60:63]
  ds_read_b128 v[204:207], v254 offset:33792
  buffer_load_dwordx4 a[128:131], v1, s[8:11], s36 offen offset:2048 sc1
  v_mfma_f32_16x16x32_bf16 v[56:59], v[220:223], a[200:203], v[56:59]
  s_and_b32 s6, s6, 3
  s_mul_i32 s7, s6, 73728
  v_mfma_f32_16x16x32_bf16 v[60:63], v[220:223], a[204:207], v[60:63]
  buffer_load_dwordx4 a[132:135], v1, s[8:11], s36 offen offset:3072 sc1
  v_mfma_f32_16x16x32_bf16 v[56:59], v[224:227], a[208:211], v[56:59]
  v_add_u32 v243, s7, v1
  s_mul_i32 s7, s6, 15360
  v_mfma_f32_16x16x32_bf16 v[60:63], v[224:227], a[212:215], v[60:63]
  buffer_load_dwordx4 a[136:139], v250, s[8:11], s36 offen offset:0 sc1
  v_mfma_f32_16x16x32_bf16 v[56:59], v[228:231], a[216:219], v[56:59]
  s_add_u32 s7, s7, 10240
  v_add_u32 v247, s7, v1
  v_mfma_f32_16x16x32_bf16 v[60:63], v[228:231], a[220:223], v[60:63]
  s_waitcnt lgkmcnt(6)
  v_mfma_f32_16x16x32_bf16 v[64:67], v[160:163], a[160:163], v[64:67]
  ds_read_b128 v[208:211], v253 offset:7168
  v_mfma_f32_16x16x32_bf16 v[68:71], v[160:163], a[164:167], v[68:71]
  ds_read_b128 v[212:215], v253 offset:16384
  v_mfma_f32_16x16x32_bf16 v[64:67], v[164:167], a[168:171], v[64:67]
  ds_read_b128 v[216:219], v253 offset:25600
  v_mfma_f32_16x16x32_bf16 v[68:71], v[164:167], a[172:175], v[68:71]
  ds_read_b128 v[220:223], v253 offset:34816
  v_mfma_f32_16x16x32_bf16 v[64:67], v[168:171], a[176:179], v[64:67]
  ds_read_b128 v[224:227], v4 offset:7168
  v_mfma_f32_16x16x32_bf16 v[68:71], v[168:171], a[180:183], v[68:71]
  ds_read_b128 v[228:231], v4 offset:16384
  v_mfma_f32_16x16x32_bf16 v[64:67], v[172:175], a[184:187], v[64:67]
  v_mul_f32 v56, v56, v128
  v_mul_f32 v57, v57, v129
  v_mul_f32 v58, v58, v130
  v_mfma_f32_16x16x32_bf16 v[68:71], v[172:175], a[188:191], v[68:71]
  v_mul_f32 v59, v59, v131
  v_cvt_pk_bf16_f32 v50, v56, v57
  v_mfma_f32_16x16x32_bf16 v[64:67], v[176:179], a[224:227], v[64:67]
  v_cvt_pk_bf16_f32 v51, v58, v59
  buffer_store_dwordx4 v[48:51], v1, s[8:11], s28 offen offset:2048 sc1
  v_mfma_f32_16x16x32_bf16 v[68:71], v[176:179], a[228:231], v[68:71]
  v_mul_f32 v60, v60, v132
  v_mul_f32 v61, v61, v133
  v_mul_f32 v62, v62, v134
  v_mfma_f32_16x16x32_bf16 v[64:67], v[180:183], a[232:235], v[64:67]
  v_mul_f32 v63, v63, v135
  v_cvt_pk_bf16_f32 v54, v60, v61
  v_mfma_f32_16x16x32_bf16 v[68:71], v[180:183], a[236:239], v[68:71]
  v_cvt_pk_bf16_f32 v55, v62, v63
  buffer_store_dwordx4 v[52:55], v1, s[8:11], s29 offen offset:2048 sc1
  s_waitcnt lgkmcnt(6)
  v_mfma_f32_16x16x32_bf16 v[64:67], v[184:187], a[240:243], v[64:67]
  ds_read_b128 v[160:163], v4 offset:25600
  s_add_u32 s36, s39, 516096
  v_mfma_f32_16x16x32_bf16 v[68:71], v[184:187], a[244:247], v[68:71]
  ds_read_b128 v[164:167], v4 offset:34816
  buffer_load_dwordx4 a[140:143], v3, s[8:11], s36 offen offset:0 sc1
  v_mfma_f32_16x16x32_bf16 v[64:67], v[188:191], a[248:251], v[64:67]
  ds_read_b128 v[168:171], v254 offset:7168
  v_mfma_f32_16x16x32_bf16 v[68:71], v[188:191], a[252:255], v[68:71]
  ds_read_b128 v[172:175], v254 offset:16384
  buffer_load_dwordx4 a[144:147], v1, s[8:11], s36 offen offset:1024 sc1
  v_mfma_f32_16x16x32_bf16 v[64:67], v[192:195], a[192:195], v[64:67]
  ds_read_b128 v[176:179], v254 offset:25600
  v_mfma_f32_16x16x32_bf16 v[68:71], v[192:195], a[196:199], v[68:71]
  ds_read_b128 v[180:183], v254 offset:34816
  buffer_load_dwordx4 a[148:151], v1, s[8:11], s36 offen offset:2048 sc1
  v_mfma_f32_16x16x32_bf16 v[64:67], v[196:199], a[200:203], v[64:67]
  v_mfma_f32_16x16x32_bf16 v[68:71], v[196:199], a[204:207], v[68:71]
  buffer_load_dwordx4 a[152:155], v1, s[8:11], s36 offen offset:3072 sc1
  v_mfma_f32_16x16x32_bf16 v[64:67], v[200:203], a[208:211], v[64:67]
  v_mfma_f32_16x16x32_bf16 v[68:71], v[200:203], a[212:215], v[68:71]
  buffer_load_dwordx4 a[156:159], v250, s[8:11], s36 offen offset:0 sc1
  v_mfma_f32_16x16x32_bf16 v[64:67], v[204:207], a[216:219], v[64:67]
  v_mfma_f32_16x16x32_bf16 v[68:71], v[204:207], a[220:223], v[68:71]
  s_waitcnt lgkmcnt(6)
  v_mfma_f32_16x16x32_bf16 v[72:75], v[208:211], a[160:163], v[72:75]
  ds_read_b128 v[184:187], v253 offset:8192
  v_mfma_f32_16x16x32_bf16 v[76:79], v[208:211], a[164:167], v[76:79]
  ds_read_b128 v[188:191], v253 offset:17408
  v_mfma_f32_16x16x32_bf16 v[72:75], v[212:215], a[168:171], v[72:75]
  ds_read_b128 v[192:195], v253 offset:26624
  v_mfma_f32_16x16x32_bf16 v[76:79], v[212:215], a[172:175], v[76:79]
  ds_read_b128 v[196:199], v253 offset:35840
  v_mfma_f32_16x16x32_bf16 v[72:75], v[216:219], a[176:179], v[72:75]
  ds_read_b128 v[200:203], v4 offset:8192
  v_mfma_f32_16x16x32_bf16 v[76:79], v[216:219], a[180:183], v[76:79]
  ds_read_b128 v[204:207], v4 offset:17408
  v_mfma_f32_16x16x32_bf16 v[72:75], v[220:223], a[184:187], v[72:75]
  v_mul_f32 v64, v64, v136
  v_mul_f32 v65, v65, v137
  v_mfma_f32_16x16x32_bf16 v[76:79], v[220:223], a[188:191], v[76:79]
  v_mul_f32 v66, v66, v138
  v_mul_f32 v67, v67, v139
  v_mfma_f32_16x16x32_bf16 v[72:75], v[224:227], a[224:227], v[72:75]
  v_cvt_pk_bf16_f32 v64, v64, v65
  v_cvt_pk_bf16_f32 v65, v66, v67
  v_mfma_f32_16x16x32_bf16 v[76:79], v[224:227], a[228:231], v[76:79]
  v_mul_f32 v68, v68, v140
  v_mul_f32 v69, v69, v141
  v_mfma_f32_16x16x32_bf16 v[72:75], v[228:231], a[232:235], v[72:75]
  v_mul_f32 v70, v70, v142
  v_mul_f32 v71, v71, v143
  v_mfma_f32_16x16x32_bf16 v[76:79], v[228:231], a[236:239], v[76:79]
  v_cvt_pk_bf16_f32 v68, v68, v69
  v_cvt_pk_bf16_f32 v69, v70, v71
  s_waitcnt lgkmcnt(6)
  v_mfma_f32_16x16x32_bf16 v[72:75], v[160:163], a[240:243], v[72:75]
  ds_read_b128 v[208:211], v4 offset:26624
  v_mfma_f32_16x16x32_bf16 v[76:79], v[160:163], a[244:247], v[76:79]
  ds_read_b128 v[212:215], v4 offset:35840
  v_mfma_f32_16x16x32_bf16 v[72:75], v[164:167], a[248:251], v[72:75]
  ds_read_b128 v[216:219], v254 offset:8192
  v_mfma_f32_16x16x32_bf16 v[76:79], v[164:167], a[252:255], v[76:79]
  ds_read_b128 v[220:223], v254 offset:17408
  v_mfma_f32_16x16x32_bf16 v[72:75], v[168:171], a[192:195], v[72:75]
  ds_read_b128 v[224:227], v254 offset:26624
  v_mfma_f32_16x16x32_bf16 v[76:79], v[168:171], a[196:199], v[76:79]
  ds_read_b128 v[228:231], v254 offset:35840
  v_mfma_f32_16x16x32_bf16 v[72:75], v[172:175], a[200:203], v[72:75]
  v_mfma_f32_16x16x32_bf16 v[76:79], v[172:175], a[204:207], v[76:79]
  v_mfma_f32_16x16x32_bf16 v[72:75], v[176:179], a[208:211], v[72:75]
  v_mfma_f32_16x16x32_bf16 v[76:79], v[176:179], a[212:215], v[76:79]
  v_mfma_f32_16x16x32_bf16 v[72:75], v[180:183], a[216:219], v[72:75]
  v_mfma_f32_16x16x32_bf16 v[76:79], v[180:183], a[220:223], v[76:79]
  s_waitcnt lgkmcnt(6)
  v_mfma_f32_16x16x32_bf16 v[80:83], v[184:187], a[160:163], v[80:83]
  s_nop 1
  v_mfma_f32_16x16x32_bf16 v[84:87], v[184:187], a[164:167], v[84:87]
  v_mfma_f32_16x16x32_bf16 v[80:83], v[188:191], a[168:171], v[80:83]
  v_mfma_f32_16x16x32_bf16 v[84:87], v[188:191], a[172:175], v[84:87]
  v_mfma_f32_16x16x32_bf16 v[80:83], v[192:195], a[176:179], v[80:83]
  v_mfma_f32_16x16x32_bf16 v[84:87], v[192:195], a[180:183], v[84:87]
  v_mfma_f32_16x16x32_bf16 v[80:83], v[196:199], a[184:187], v[80:83]
  v_mul_f32 v72, v72, v144
  v_mul_f32 v73, v73, v145
  v_mul_f32 v74, v74, v146
  v_mfma_f32_16x16x32_bf16 v[84:87], v[196:199], a[188:191], v[84:87]
  v_mul_f32 v75, v75, v147
  v_cvt_pk_bf16_f32 v66, v72, v73
  v_mfma_f32_16x16x32_bf16 v[80:83], v[200:203], a[224:227], v[80:83]
  v_cvt_pk_bf16_f32 v67, v74, v75
  buffer_store_dwordx4 v[64:67], v1, s[8:11], s28 offen offset:3072 sc1
  v_mfma_f32_16x16x32_bf16 v[84:87], v[200:203], a[228:231], v[84:87]
  v_mul_f32 v76, v76, v148
  v_mul_f32 v77, v77, v149
  v_mul_f32 v78, v78, v150
  v_mfma_f32_16x16x32_bf16 v[80:83], v[204:207], a[232:235], v[80:83]
  v_mul_f32 v79, v79, v151
  v_cvt_pk_bf16_f32 v70, v76, v77
  v_mfma_f32_16x16x32_bf16 v[84:87], v[204:207], a[236:239], v[84:87]
  v_cvt_pk_bf16_f32 v71, v78, v79
  buffer_store_dwordx4 v[68:71], v1, s[8:11], s29 offen offset:3072 sc1
  s_waitcnt lgkmcnt(0)
  buffer_load_dword v11, v10, s[8:11], s23 offen sc1
  v_mov_b32 v5, 2
  v_mfma_f32_16x16x32_bf16 v[80:83], v[208:211], a[240:243], v[80:83]
  v_mfma_f32_16x16x32_bf16 v[84:87], v[208:211], a[244:247], v[84:87]
  v_mfma_f32_16x16x32_bf16 v[80:83], v[212:215], a[248:251], v[80:83]
  v_mfma_f32_16x16x32_bf16 v[84:87], v[212:215], a[252:255], v[84:87]
  v_mfma_f32_16x16x32_bf16 v[80:83], v[216:219], a[192:195], v[80:83]
  v_mfma_f32_16x16x32_bf16 v[84:87], v[216:219], a[196:199], v[84:87]
  v_mfma_f32_16x16x32_bf16 v[80:83], v[220:223], a[200:203], v[80:83]
  v_mfma_f32_16x16x32_bf16 v[84:87], v[220:223], a[204:207], v[84:87]
  v_mfma_f32_16x16x32_bf16 v[80:83], v[224:227], a[208:211], v[80:83]
  v_mfma_f32_16x16x32_bf16 v[84:87], v[224:227], a[212:215], v[84:87]
  v_mfma_f32_16x16x32_bf16 v[80:83], v[228:231], a[216:219], v[80:83]
  v_mfma_f32_16x16x32_bf16 v[84:87], v[228:231], a[220:223], v[84:87]
  s_nop 7
  v_mul_f32 v80, v80, v152
  v_mul_f32 v81, v81, v153
  v_mul_f32 v82, v82, v154
  v_mul_f32 v83, v83, v155
  v_cvt_pk_bf16_f32 v80, v80, v81
  v_cvt_pk_bf16_f32 v81, v82, v83
  buffer_store_dwordx2 v[80:81], v8, s[8:11], s30 offen sc1
  v_mul_f32 v84, v84, v156
  v_mul_f32 v85, v85, v157
  v_mul_f32 v86, v86, v158
  v_mul_f32 v87, v87, v159
  v_cvt_pk_bf16_f32 v84, v84, v85
  v_cvt_pk_bf16_f32 v85, v86, v87
  buffer_store_dwordx2 v[84:85], v8, s[8:11], s31 offen sc1
  s_add_u32 s36, s39, 73728
  buffer_load_dwordx4 a[160:163], v3, s[8:11], s36 offen offset:0 sc1
  buffer_load_dwordx4 a[164:167], v1, s[8:11], s36 offen offset:1024 sc1
  buffer_load_dwordx4 a[168:171], v1, s[8:11], s36 offen offset:2048 sc1
  buffer_load_dwordx4 a[172:175], v1, s[8:11], s36 offen offset:3072 sc1
  buffer_load_dwordx4 a[176:179], v250, s[8:11], s36 offen offset:0 sc1
  s_add_u32 s36, s39, 110592
  buffer_load_dwordx4 a[180:183], v3, s[8:11], s36 offen offset:0 sc1
  buffer_load_dwordx4 a[184:187], v1, s[8:11], s36 offen offset:1024 sc1
  buffer_load_dwordx4 a[188:191], v1, s[8:11], s36 offen offset:2048 sc1
  buffer_load_dwordx4 a[192:195], v1, s[8:11], s36 offen offset:3072 sc1
  buffer_load_dwordx4 a[196:199], v250, s[8:11], s36 offen offset:0 sc1
  s_waitcnt vmcnt(12)
  v_cmp_gt_u32 vcc, 1, v11
  s_mov_b32 s27, 0
  s_nop 3
  s_cbranch_vccz GM_P1_GO
  s_waitcnt vmcnt(0)
  buffer_store_dword v5, v13, s[8:11], s24 offen sc1
GM_P1_POLL:
  buffer_load_dword v11, v10, s[8:11], s23 offen sc1
  s_waitcnt vmcnt(0)
  v_cmp_gt_u32 vcc, 1, v11
  s_add_u32 s27, s27, 1
  s_cmp_ge_u32 s27, 0x80000
  s_cbranch_scc1 GM_P1_GO
  s_nop 2
  s_cbranch_vccz GM_P1_GO
  s_sleep 1
  s_branch GM_P1_POLL
GM_P1_GO:
  s_add_u32 s21, s20, 0
  buffer_load_dwordx4 v[96:99], v240, s[8:11], s21 offen sc1
  buffer_load_dwordx4 v[100:103], v241, s[8:11], s21 offen sc1
  buffer_load_dwordx4 v[104:107], v242, s[8:11], s21 offen sc1
  buffer_load_dwordx4 v[108:111], v243, s[8:11], s21 offen sc1
  s_add_u32 s21, s20, 1024
  buffer_load_dwordx4 v[112:115], v240, s[8:11], s21 offen sc1
  buffer_load_dwordx4 v[116:119], v241, s[8:11], s21 offen sc1
  buffer_load_dwordx4 v[120:123], v242, s[8:11], s21 offen sc1
  buffer_load_dwordx4 v[124:127], v243, s[8:11], s21 offen sc1
  s_waitcnt vmcnt(18)
  buffer_store_dword v5, v13, s[8:11], s24 offen sc1
  s_add_u32 s21, s20, 4096
  buffer_load_dwordx4 v[128:131], v240, s[8:11], s21 offen sc1
  buffer_load_dwordx4 v[132:135], v241, s[8:11], s21 offen sc1
  buffer_load_dwordx4 v[136:139], v242, s[8:11], s21 offen sc1
  buffer_load_dwordx4 v[140:143], v243, s[8:11], s21 offen sc1
  s_add_u32 s21, s20, 5120
  buffer_load_dwordx4 v[144:147], v240, s[8:11], s21 offen sc1
  buffer_load_dwordx4 v[148:151], v241, s[8:11], s21 offen sc1
  buffer_load_dwordx4 v[152:155], v242, s[8:11], s21 offen sc1
  buffer_load_dwordx4 v[156:159], v243, s[8:11], s21 offen sc1
  s_add_u32 s21, s20, 9216
  buffer_load_dwordx4 v[160:163], v240, s[8:11], s21 offen sc1
  buffer_load_dwordx4 v[164:167], v241, s[8:11], s21 offen sc1
  buffer_load_dwordx4 v[168:171], v242, s[8:11], s21 offen sc1
  buffer_load_dwordx4 v[172:175], v243, s[8:11], s21 offen sc1
  s_mov_b32 s12, s90
  s_and_b32 s13, s91, 0xffff
  s_mov_b32 s14, 2359296
  s_mov_b32 s15, 0x20000
  ds_bpermute_b32 v204, v249, v6 offset:0
  ds_bpermute_b32 v205, v249, v6 offset:4
  ds_bpermute_b32 v206, v249, v6 offset:8
  ds_bpermute_b32 v207, v249, v6 offset:12
  ds_bpermute_b32 v208, v249, v6 offset:64
  ds_bpermute_b32 v209, v249, v6 offset:68
  ds_bpermute_b32 v210, v249, v6 offset:72
  ds_bpermute_b32 v211, v249, v6 offset:76
  ds_bpermute_b32 v212, v249, v6 offset:128
  ds_bpermute_b32 v213, v249, v6 offset:132
  ds_bpermute_b32 v214, v249, v6 offset:136
  ds_bpermute_b32 v215, v249, v6 offset:140
  s_waitcnt lgkmcnt(0)
  ds_bpermute_b32 v216, v249, v6 offset:192
  ds_bpermute_b32 v217, v249, v6 offset:196
  ds_bpermute_b32 v218, v249, v6 offset:200
  ds_bpermute_b32 v219, v249, v6 offset:204
  ds_bpermute_b32 v220, v249, v7 offset:0
  ds_bpermute_b32 v221, v249, v7 offset:4
  ds_bpermute_b32 v222, v249, v7 offset:8
  ds_bpermute_b32 v223, v249, v7 offset:12
  s_waitcnt vmcnt(17)
  v_mfma_f32_16x16x32_bf16 v[16:19], a[0:3], v[96:99], 0
  s_add_u32 s21, s20, 10240
  v_mfma_f32_16x16x32_bf16 v[20:23], a[4:7], v[96:99], 0
  buffer_load_dwordx4 v[176:179], v240, s[8:11], s21 offen sc1
  v_mfma_f32_16x16x32_bf16 v[24:27], a[8:11], v[96:99], 0
  v_mfma_f32_16x16x32_bf16 v[28:31], a[12:15], v[96:99], 0
  buffer_load_dwordx4 v[180:183], v241, s[8:11], s21 offen sc1
  v_mfma_f32_16x16x32_bf16 v[32:35], a[16:19], v[96:99], 0
  v_mfma_f32_16x16x32_bf16 v[36:39], a[0:3], v[100:103], 0
  buffer_load_dwordx4 v[184:187], v242, s[8:11], s21 offen sc1
  v_mfma_f32_16x16x32_bf16 v[40:43], a[4:7], v[100:103], 0
  v_mfma_f32_16x16x32_bf16 v[44:47], a[8:11], v[100:103], 0
  buffer_load_dwordx4 v[188:191], v243, s[8:11], s21 offen sc1
  v_mfma_f32_16x16x32_bf16 v[48:51], a[12:15], v[100:103], 0
  s_add_u32 s36, s39, 221184
  v_mfma_f32_16x16x32_bf16 v[52:55], a[16:19], v[100:103], 0
  buffer_load_dwordx4 a[200:203], v3, s[8:11], s36 offen offset:0 sc1
  v_mfma_f32_16x16x32_bf16 v[56:59], a[0:3], v[104:107], 0
  v_mfma_f32_16x16x32_bf16 v[60:63], a[4:7], v[104:107], 0
  buffer_load_dwordx4 a[204:207], v1, s[8:11], s36 offen offset:1024 sc1
  v_mfma_f32_16x16x32_bf16 v[64:67], a[8:11], v[104:107], 0
  v_mfma_f32_16x16x32_bf16 v[68:71], a[12:15], v[104:107], 0
  buffer_load_dwordx4 a[208:211], v1, s[8:11], s36 offen offset:2048 sc1
  v_mfma_f32_16x16x32_bf16 v[72:75], a[16:19], v[104:107], 0
  v_mfma_f32_16x16x32_bf16 v[76:79], a[0:3], v[108:111], 0
  buffer_load_dwordx4 a[212:215], v1, s[8:11], s36 offen offset:3072 sc1
  v_mfma_f32_16x16x32_bf16 v[80:83], a[4:7], v[108:111], 0
  v_mfma_f32_16x16x32_bf16 v[84:87], a[8:11], v[108:111], 0
  buffer_load_dwordx4 a[216:219], v250, s[8:11], s36 offen offset:0 sc1
  v_mfma_f32_16x16x32_bf16 v[88:91], a[12:15], v[108:111], 0
  v_mfma_f32_16x16x32_bf16 v[92:95], a[16:19], v[108:111], 0
  s_waitcnt vmcnt(22)
  v_mfma_f32_16x16x32_bf16 v[16:19], a[20:23], v[112:115], v[16:19]
  s_add_u32 s21, s20, 13312
  v_mfma_f32_16x16x32_bf16 v[20:23], a[24:27], v[112:115], v[20:23]
  buffer_load_dwordx4 v[96:99], v240, s[8:11], s21 offen sc1
  v_mfma_f32_16x16x32_bf16 v[24:27], a[28:31], v[112:115], v[24:27]
  v_mfma_f32_16x16x32_bf16 v[28:31], a[32:35], v[112:115], v[28:31]
  buffer_load_dwordx4 v[100:103], v241, s[8:11], s21 offen sc1
  v_mfma_f32_16x16x32_bf16 v[32:35], a[36:39], v[112:115], v[32:35]
  v_mfma_f32_16x16x32_bf16 v[36:39], a[20:23], v[116:119], v[36:39]
  buffer_load_dwordx4 v[104:107], v242, s[8:11], s21 offen sc1
  v_mfma_f32_16x16x32_bf16 v[40:43], a[24:27], v[116:119], v[40:43]
  v_mfma_f32_16x16x32_bf16 v[44:47], a[28:31], v[116:119], v[44:47]
  buffer_load_dwordx4 v[108:111], v243, s[8:11], s21 offen sc1
  v_mfma_f32_16x16x32_bf16 v[48:51], a[32:35], v[116:119], v[48:51]
  s_add_u32 s36, s39, 258048
  v_mfma_f32_16x16x32_bf16 v[52:55], a[36:39], v[116:119], v[52:55]
  buffer_load_dwordx4 a[220:223], v3, s[8:11], s36 offen offset:0 sc1
  v_mfma_f32_16x16x32_bf16 v[56:59], a[20:23], v[120:123], v[56:59]
  v_mfma_f32_16x16x32_bf16 v[60:63], a[24:27], v[120:123], v[60:63]
  buffer_load_dwordx4 a[224:227], v1, s[8:11], s36 offen offset:1024 sc1
  v_mfma_f32_16x16x32_bf16 v[64:67], a[28:31], v[120:123], v[64:67]
  v_mfma_f32_16x16x32_bf16 v[68:71], a[32:35], v[120:123], v[68:71]
  buffer_load_dwordx4 a[228:231], v1, s[8:11], s36 offen offset:2048 sc1
  v_mfma_f32_16x16x32_bf16 v[72:75], a[36:39], v[120:123], v[72:75]
  v_mfma_f32_16x16x32_bf16 v[76:79], a[20:23], v[124:127], v[76:79]
  buffer_load_dwordx4 a[232:235], v1, s[8:11], s36 offen offset:3072 sc1
  v_mfma_f32_16x16x32_bf16 v[80:83], a[24:27], v[124:127], v[80:83]
  v_mfma_f32_16x16x32_bf16 v[84:87], a[28:31], v[124:127], v[84:87]
  buffer_load_dwordx4 a[236:239], v250, s[8:11], s36 offen offset:0 sc1
  v_mfma_f32_16x16x32_bf16 v[88:91], a[32:35], v[124:127], v[88:91]
  v_mfma_f32_16x16x32_bf16 v[92:95], a[36:39], v[124:127], v[92:95]
  s_waitcnt vmcnt(26)
  v_mfma_f32_16x16x32_bf16 v[16:19], a[40:43], v[128:131], v[16:19]
  s_add_u32 s21, s20, 14336
  v_mfma_f32_16x16x32_bf16 v[20:23], a[44:47], v[128:131], v[20:23]
  buffer_load_dwordx4 v[112:115], v240, s[8:11], s21 offen sc1
  v_mfma_f32_16x16x32_bf16 v[24:27], a[48:51], v[128:131], v[24:27]
  v_mfma_f32_16x16x32_bf16 v[28:31], a[52:55], v[128:131], v[28:31]
  buffer_load_dwordx4 v[116:119], v241, s[8:11], s21 offen sc1
  v_mfma_f32_16x16x32_bf16 v[32:35], a[56:59], v[128:131], v[32:35]
  v_mfma_f32_16x16x32_bf16 v[36:39], a[40:43], v[132:135], v[36:39]
  buffer_load_dwordx4 v[120:123], v242, s[8:11], s21 offen sc1
  v_mfma_f32_16x16x32_bf16 v[40:43], a[44:47], v[132:135], v[40:43]
  v_mfma_f32_16x16x32_bf16 v[44:47], a[48:51], v[132:135], v[44:47]
  buffer_load_dwordx4 v[124:127], v243, s[8:11], s21 offen sc1
  v_mfma_f32_16x16x32_bf16 v[48:51], a[52:55], v[132:135], v[48:51]
  s_add_u32 s36, s39, 405504
  v_mfma_f32_16x16x32_bf16 v[52:55], a[56:59], v[132:135], v[52:55]
  buffer_load_dwordx4 a[0:3], v3, s[8:11], s36 offen offset:0 sc1
  v_mfma_f32_16x16x32_bf16 v[56:59], a[40:43], v[136:139], v[56:59]
  v_mfma_f32_16x16x32_bf16 v[60:63], a[44:47], v[136:139], v[60:63]
  buffer_load_dwordx4 a[4:7], v1, s[8:11], s36 offen offset:1024 sc1
  v_mfma_f32_16x16x32_bf16 v[64:67], a[48:51], v[136:139], v[64:67]
  v_mfma_f32_16x16x32_bf16 v[68:71], a[52:55], v[136:139], v[68:71]
  buffer_load_dwordx4 a[8:11], v1, s[8:11], s36 offen offset:2048 sc1
  v_mfma_f32_16x16x32_bf16 v[72:75], a[56:59], v[136:139], v[72:75]
  v_mfma_f32_16x16x32_bf16 v[76:79], a[40:43], v[140:143], v[76:79]
  buffer_load_dwordx4 a[12:15], v1, s[8:11], s36 offen offset:3072 sc1
  v_mfma_f32_16x16x32_bf16 v[80:83], a[44:47], v[140:143], v[80:83]
  v_mfma_f32_16x16x32_bf16 v[84:87], a[48:51], v[140:143], v[84:87]
  buffer_load_dwordx4 a[16:19], v250, s[8:11], s36 offen offset:0 sc1
  v_mfma_f32_16x16x32_bf16 v[88:91], a[52:55], v[140:143], v[88:91]
  v_mfma_f32_16x16x32_bf16 v[92:95], a[56:59], v[140:143], v[92:95]
  s_waitcnt vmcnt(31)
  v_mfma_f32_16x16x32_bf16 v[16:19], a[60:63], v[144:147], v[16:19]
  v_mfma_f32_16x16x32_bf16 v[20:23], a[64:67], v[144:147], v[20:23]
  buffer_load_dword v11, v10, s[8:11], s23 offen sc1
  s_add_u32 s36, s39, 442368
  v_mfma_f32_16x16x32_bf16 v[24:27], a[68:71], v[144:147], v[24:27]
  buffer_load_dwordx4 a[20:23], v3, s[8:11], s36 offen offset:0 sc1
  v_mfma_f32_16x16x32_bf16 v[28:31], a[72:75], v[144:147], v[28:31]
  v_mfma_f32_16x16x32_bf16 v[32:35], a[76:79], v[144:147], v[32:35]
  buffer_load_dwordx4 a[24:27], v1, s[8:11], s36 offen offset:1024 sc1
  v_mfma_f32_16x16x32_bf16 v[36:39], a[60:63], v[148:151], v[36:39]
  v_mfma_f32_16x16x32_bf16 v[40:43], a[64:67], v[148:151], v[40:43]
  buffer_load_dwordx4 a[28:31], v1, s[8:11], s36 offen offset:2048 sc1
  v_mfma_f32_16x16x32_bf16 v[44:47], a[68:71], v[148:151], v[44:47]
  buffer_load_dwordx4 a[32:35], v1, s[8:11], s36 offen offset:3072 sc1
  v_mfma_f32_16x16x32_bf16 v[48:51], a[72:75], v[148:151], v[48:51]
  v_mfma_f32_16x16x32_bf16 v[52:55], a[76:79], v[148:151], v[52:55]
  buffer_load_dwordx4 a[36:39], v250, s[8:11], s36 offen offset:0 sc1
  v_mfma_f32_16x16x32_bf16 v[56:59], a[60:63], v[152:155], v[56:59]
  s_add_u32 s36, s39, 552960
  v_mfma_f32_16x16x32_bf16 v[60:63], a[64:67], v[152:155], v[60:63]
  buffer_load_dwordx4 a[40:43], v3, s[8:11], s36 offen offset:0 sc1
  v_mfma_f32_16x16x32_bf16 v[64:67], a[68:71], v[152:155], v[64:67]
  v_mfma_f32_16x16x32_bf16 v[68:71], a[72:75], v[152:155], v[68:71]
  buffer_load_dwordx4 a[44:47], v1, s[8:11], s36 offen offset:1024 sc1
  v_mfma_f32_16x16x32_bf16 v[72:75], a[76:79], v[152:155], v[72:75]
  buffer_load_dwordx4 a[48:51], v1, s[8:11], s36 offen offset:2048 sc1
  v_mfma_f32_16x16x32_bf16 v[76:79], a[60:63], v[156:159], v[76:79]
  v_mfma_f32_16x16x32_bf16 v[80:83], a[64:67], v[156:159], v[80:83]
  buffer_load_dwordx4 a[52:55], v1, s[8:11], s36 offen offset:3072 sc1
  v_mfma_f32_16x16x32_bf16 v[84:87], a[68:71], v[156:159], v[84:87]
  v_mfma_f32_16x16x32_bf16 v[88:91], a[72:75], v[156:159], v[88:91]
  buffer_load_dwordx4 a[56:59], v250, s[8:11], s36 offen offset:0 sc1
  v_mfma_f32_16x16x32_bf16 v[92:95], a[76:79], v[156:159], v[92:95]
  s_waitcnt vmcnt(38)
  v_mfma_f32_16x16x32_bf16 v[16:19], a[80:83], v[160:163], v[16:19]
  s_add_u32 s36, s39, 589824
  v_mfma_f32_16x16x32_bf16 v[20:23], a[84:87], v[160:163], v[20:23]
  buffer_load_dwordx4 a[60:63], v3, s[8:11], s36 offen offset:0 sc1
  v_mfma_f32_16x16x32_bf16 v[24:27], a[88:91], v[160:163], v[24:27]
  v_mfma_f32_16x16x32_bf16 v[28:31], a[92:95], v[160:163], v[28:31]
  v_mfma_f32_16x16x32_bf16 v[32:35], a[96:99], v[160:163], v[32:35]
  buffer_load_dwordx4 a[64:67], v1, s[8:11], s36 offen offset:1024 sc1
  v_mfma_f32_16x16x32_bf16 v[36:39], a[80:83], v[164:167], v[36:39]
  v_mfma_f32_16x16x32_bf16 v[40:43], a[84:87], v[164:167], v[40:43]
  v_mfma_f32_16x16x32_bf16 v[44:47], a[88:91], v[164:167], v[44:47]
  v_mfma_f32_16x16x32_bf16 v[48:51], a[92:95], v[164:167], v[48:51]
  buffer_load_dwordx4 a[68:71], v1, s[8:11], s36 offen offset:2048 sc1
  v_mfma_f32_16x16x32_bf16 v[52:55], a[96:99], v[164:167], v[52:55]
  v_mfma_f32_16x16x32_bf16 v[56:59], a[80:83], v[168:171], v[56:59]
  v_mfma_f32_16x16x32_bf16 v[60:63], a[84:87], v[168:171], v[60:63]
  v_mfma_f32_16x16x32_bf16 v[64:67], a[88:91], v[168:171], v[64:67]
  buffer_load_dwordx4 a[72:75], v1, s[8:11], s36 offen offset:3072 sc1
  v_mfma_f32_16x16x32_bf16 v[68:71], a[92:95], v[168:171], v[68:71]
  v_mfma_f32_16x16x32_bf16 v[72:75], a[96:99], v[168:171], v[72:75]
  v_mfma_f32_16x16x32_bf16 v[76:79], a[80:83], v[172:175], v[76:79]
  v_mfma_f32_16x16x32_bf16 v[80:83], a[84:87], v[172:175], v[80:83]
  buffer_load_dwordx4 a[76:79], v250, s[8:11], s36 offen offset:0 sc1
  v_mfma_f32_16x16x32_bf16 v[84:87], a[88:91], v[172:175], v[84:87]
  v_mfma_f32_16x16x32_bf16 v[88:91], a[92:95], v[172:175], v[88:91]
  v_mfma_f32_16x16x32_bf16 v[92:95], a[96:99], v[172:175], v[92:95]
  s_waitcnt vmcnt(15)
  v_cmp_gt_u32 vcc, 2, v11
  s_mov_b32 s27, 0
  s_nop 3
  s_cbranch_vccz GM_P2_GO
GM_P2_POLL:
  buffer_load_dword v11, v10, s[8:11], s23 offen sc1
  s_waitcnt vmcnt(0)
  v_cmp_gt_u32 vcc, 2, v11
  s_add_u32 s27, s27, 1
  s_cmp_ge_u32 s27, 0x80000
  s_cbranch_scc1 GM_P2_GO
  s_nop 2
  s_cbranch_vccz GM_P2_GO
  s_sleep 1
  s_branch GM_P2_POLL
GM_P2_GO:
  s_waitcnt vmcnt(39)
  v_mfma_f32_16x16x32_bf16 v[16:19], a[100:103], v[176:179], v[16:19]
  s_add_u32 s21, s20, 2048
  v_mfma_f32_16x16x32_bf16 v[20:23], a[104:107], v[176:179], v[20:23]
  buffer_load_dwordx4 v[128:131], v240, s[8:11], s21 offen sc1
  v_mfma_f32_16x16x32_bf16 v[24:27], a[108:111], v[176:179], v[24:27]
  v_mfma_f32_16x16x32_bf16 v[28:31], a[112:115], v[176:179], v[28:31]
  buffer_load_dwordx4 v[132:135], v241, s[8:11], s21 offen sc1
  v_mfma_f32_16x16x32_bf16 v[32:35], a[116:119], v[176:179], v[32:35]
  v_mfma_f32_16x16x32_bf16 v[36:39], a[100:103], v[180:183], v[36:39]
  buffer_load_dwordx4 v[136:139], v242, s[8:11], s21 offen sc1
  v_mfma_f32_16x16x32_bf16 v[40:43], a[104:107], v[180:183], v[40:43]
  v_mfma_f32_16x16x32_bf16 v[44:47], a[108:111], v[180:183], v[44:47]
  v_mfma_f32_16x16x32_bf16 v[48:51], a[112:115], v[180:183], v[48:51]
  buffer_load_dwordx4 v[140:143], v243, s[8:11], s21 offen sc1
  v_mfma_f32_16x16x32_bf16 v[52:55], a[116:119], v[180:183], v[52:55]
  s_add_u32 s21, s20, 3072
  v_mfma_f32_16x16x32_bf16 v[56:59], a[100:103], v[184:187], v[56:59]
  buffer_load_dwordx4 v[144:147], v240, s[8:11], s21 offen sc1
  v_mfma_f32_16x16x32_bf16 v[60:63], a[104:107], v[184:187], v[60:63]
  v_mfma_f32_16x16x32_bf16 v[64:67], a[108:111], v[184:187], v[64:67]
  buffer_load_dwordx4 v[148:151], v241, s[8:11], s21 offen sc1
  v_mfma_f32_16x16x32_bf16 v[68:71], a[112:115], v[184:187], v[68:71]
  v_mfma_f32_16x16x32_bf16 v[72:75], a[116:119], v[184:187], v[72:75]
  v_mfma_f32_16x16x32_bf16 v[76:79], a[100:103], v[188:191], v[76:79]
  buffer_load_dwordx4 v[152:155], v242, s[8:11], s21 offen sc1
  v_mfma_f32_16x16x32_bf16 v[80:83], a[104:107], v[188:191], v[80:83]
  v_mfma_f32_16x16x32_bf16 v[84:87], a[108:111], v[188:191], v[84:87]
  buffer_load_dwordx4 v[156:159], v243, s[8:11], s21 offen sc1
  v_mfma_f32_16x16x32_bf16 v[88:91], a[112:115], v[188:191], v[88:91]
  v_mfma_f32_16x16x32_bf16 v[92:95], a[116:119], v[188:191], v[92:95]
  s_waitcnt vmcnt(38)
  v_mfma_f32_16x16x32_bf16 v[16:19], a[120:123], v[96:99], v[16:19]
  s_add_u32 s21, s20, 6144
  v_mfma_f32_16x16x32_bf16 v[20:23], a[124:127], v[96:99], v[20:23]
  buffer_load_dwordx4 v[160:163], v240, s[8:11], s21 offen sc1
  v_mfma_f32_16x16x32_bf16 v[24:27], a[128:131], v[96:99], v[24:27]
  v_mfma_f32_16x16x32_bf16 v[28:31], a[132:135], v[96:99], v[28:31]
  buffer_load_dwordx4 v[164:167], v241, s[8:11], s21 offen sc1
  v_mfma_f32_16x16x32_bf16 v[32:35], a[136:139], v[96:99], v[32:35]
  v_mfma_f32_16x16x32_bf16 v[36:39], a[120:123], v[100:103], v[36:39]
  buffer_load_dwordx4 v[168:171], v242, s[8:11], s21 offen sc1
  v_mfma_f32_16x16x32_bf16 v[40:43], a[124:127], v[100:103], v[40:43]
  v_mfma_f32_16x16x32_bf16 v[44:47], a[128:131], v[100:103], v[44:47]
  v_mfma_f32_16x16x32_bf16 v[48:51], a[132:135], v[100:103], v[48:51]
  buffer_load_dwordx4 v[172:175], v243, s[8:11], s21 offen sc1
  v_mfma_f32_16x16x32_bf16 v[52:55], a[136:139], v[100:103], v[52:55]
  s_add_u32 s21, s20, 7168
  v_mfma_f32_16x16x32_bf16 v[56:59], a[120:123], v[104:107], v[56:59]
  buffer_load_dwordx4 v[176:179], v240, s[8:11], s21 offen sc1
  v_mfma_f32_16x16x32_bf16 v[60:63], a[124:127], v[104:107], v[60:63]
  v_mfma_f32_16x16x32_bf16 v[64:67], a[128:131], v[104:107], v[64:67]
  buffer_load_dwordx4 v[180:183], v241, s[8:11], s21 offen sc1
  v_mfma_f32_16x16x32_bf16 v[68:71], a[132:135], v[104:107], v[68:71]
  v_mfma_f32_16x16x32_bf16 v[72:75], a[136:139], v[104:107], v[72:75]
  v_mfma_f32_16x16x32_bf16 v[76:79], a[120:123], v[108:111], v[76:79]
  buffer_load_dwordx4 v[184:187], v242, s[8:11], s21 offen sc1
  v_mfma_f32_16x16x32_bf16 v[80:83], a[124:127], v[108:111], v[80:83]
  v_mfma_f32_16x16x32_bf16 v[84:87], a[128:131], v[108:111], v[84:87]
  buffer_load_dwordx4 v[188:191], v243, s[8:11], s21 offen sc1
  v_mfma_f32_16x16x32_bf16 v[88:91], a[132:135], v[108:111], v[88:91]
  v_mfma_f32_16x16x32_bf16 v[92:95], a[136:139], v[108:111], v[92:95]
  s_waitcnt vmcnt(37)
  v_mfma_f32_16x16x32_bf16 v[16:19], a[140:143], v[112:115], v[16:19]
  s_add_u32 s21, s20, 11264
  v_mfma_f32_16x16x32_bf16 v[20:23], a[144:147], v[112:115], v[20:23]
  buffer_load_dwordx4 v[96:99], v240, s[8:11], s21 offen sc1
  v_mfma_f32_16x16x32_bf16 v[24:27], a[148:151], v[112:115], v[24:27]
  v_mfma_f32_16x16x32_bf16 v[28:31], a[152:155], v[112:115], v[28:31]
  buffer_load_dwordx4 v[100:103], v241, s[8:11], s21 offen sc1
  v_mfma_f32_16x16x32_bf16 v[32:35], a[156:159], v[112:115], v[32:35]
  v_mfma_f32_16x16x32_bf16 v[36:39], a[140:143], v[116:119], v[36:39]
  buffer_load_dwordx4 v[104:107], v242, s[8:11], s21 offen sc1
  v_mfma_f32_16x16x32_bf16 v[40:43], a[144:147], v[116:119], v[40:43]
  v_mfma_f32_16x16x32_bf16 v[44:47], a[148:151], v[116:119], v[44:47]
  buffer_load_dwordx4 v[108:111], v243, s[8:11], s21 offen sc1
  v_mfma_f32_16x16x32_bf16 v[48:51], a[152:155], v[116:119], v[48:51]
  s_add_u32 s36, s39, 294912
  v_mfma_f32_16x16x32_bf16 v[52:55], a[156:159], v[116:119], v[52:55]
  buffer_load_dwordx4 a[80:83], v3, s[8:11], s36 offen offset:0 sc1
  v_mfma_f32_16x16x32_bf16 v[56:59], a[140:143], v[120:123], v[56:59]
  v_mfma_f32_16x16x32_bf16 v[60:63], a[144:147], v[120:123], v[60:63]
  buffer_load_dwordx4 a[84:87], v1, s[8:11], s36 offen offset:1024 sc1
  v_mfma_f32_16x16x32_bf16 v[64:67], a[148:151], v[120:123], v[64:67]
  v_mfma_f32_16x16x32_bf16 v[68:71], a[152:155], v[120:123], v[68:71]
  buffer_load_dwordx4 a[88:91], v1, s[8:11], s36 offen offset:2048 sc1
  v_mfma_f32_16x16x32_bf16 v[72:75], a[156:159], v[120:123], v[72:75]
  v_mfma_f32_16x16x32_bf16 v[76:79], a[140:143], v[124:127], v[76:79]
  buffer_load_dwordx4 a[92:95], v1, s[8:11], s36 offen offset:3072 sc1
  v_mfma_f32_16x16x32_bf16 v[80:83], a[144:147], v[124:127], v[80:83]
  v_mfma_f32_16x16x32_bf16 v[84:87], a[148:151], v[124:127], v[84:87]
  buffer_load_dwordx4 a[96:99], v250, s[8:11], s36 offen offset:0 sc1
  v_mfma_f32_16x16x32_bf16 v[88:91], a[152:155], v[124:127], v[88:91]
  v_mfma_f32_16x16x32_bf16 v[92:95], a[156:159], v[124:127], v[92:95]
  s_waitcnt vmcnt(21)
  v_mfma_f32_16x16x32_bf16 v[16:19], a[160:163], v[128:131], v[16:19]
  s_add_u32 s21, s20, 12288
  v_mfma_f32_16x16x32_bf16 v[20:23], a[164:167], v[128:131], v[20:23]
  buffer_load_dwordx4 v[112:115], v240, s[8:11], s21 offen sc1
  v_mfma_f32_16x16x32_bf16 v[24:27], a[168:171], v[128:131], v[24:27]
  v_mfma_f32_16x16x32_bf16 v[28:31], a[172:175], v[128:131], v[28:31]
  buffer_load_dwordx4 v[116:119], v241, s[8:11], s21 offen sc1
  v_mfma_f32_16x16x32_bf16 v[32:35], a[176:179], v[128:131], v[32:35]
  v_mfma_f32_16x16x32_bf16 v[36:39], a[160:163], v[132:135], v[36:39]
  buffer_load_dwordx4 v[120:123], v242, s[8:11], s21 offen sc1
  v_mfma_f32_16x16x32_bf16 v[40:43], a[164:167], v[132:135], v[40:43]
  v_mfma_f32_16x16x32_bf16 v[44:47], a[168:171], v[132:135], v[44:47]
  buffer_load_dwordx4 v[124:127], v243, s[8:11], s21 offen sc1
  v_mfma_f32_16x16x32_bf16 v[48:51], a[172:175], v[132:135], v[48:51]
  s_add_u32 s36, s39, 626688
  v_mfma_f32_16x16x32_bf16 v[52:55], a[176:179], v[132:135], v[52:55]
  buffer_load_dwordx4 a[100:103], v3, s[8:11], s36 offen offset:0 sc1
  v_mfma_f32_16x16x32_bf16 v[56:59], a[160:163], v[136:139], v[56:59]
  v_mfma_f32_16x16x32_bf16 v[60:63], a[164:167], v[136:139], v[60:63]
  buffer_load_dwordx4 a[104:107], v1, s[8:11], s36 offen offset:1024 sc1
  v_mfma_f32_16x16x32_bf16 v[64:67], a[168:171], v[136:139], v[64:67]
  v_mfma_f32_16x16x32_bf16 v[68:71], a[172:175], v[136:139], v[68:71]
  buffer_load_dwordx4 a[108:111], v1, s[8:11], s36 offen offset:2048 sc1
  v_mfma_f32_16x16x32_bf16 v[72:75], a[176:179], v[136:139], v[72:75]
  v_mfma_f32_16x16x32_bf16 v[76:79], a[160:163], v[140:143], v[76:79]
  buffer_load_dwordx4 a[112:115], v1, s[8:11], s36 offen offset:3072 sc1
  v_mfma_f32_16x16x32_bf16 v[80:83], a[164:167], v[140:143], v[80:83]
  v_mfma_f32_16x16x32_bf16 v[84:87], a[168:171], v[140:143], v[84:87]
  buffer_load_dwordx4 a[116:119], v250, s[8:11], s36 offen offset:0 sc1
  v_mfma_f32_16x16x32_bf16 v[88:91], a[172:175], v[140:143], v[88:91]
  v_mfma_f32_16x16x32_bf16 v[92:95], a[176:179], v[140:143], v[92:95]
  s_waitcnt vmcnt(26)
  v_mfma_f32_16x16x32_bf16 v[16:19], a[180:183], v[144:147], v[16:19]
  s_add_u32 s21, s20, 15360
  v_mfma_f32_16x16x32_bf16 v[20:23], a[184:187], v[144:147], v[20:23]
  buffer_load_dwordx4 v[128:131], v240, s[8:11], s21 offen sc1
  v_mfma_f32_16x16x32_bf16 v[24:27], a[188:191], v[144:147], v[24:27]
  v_mfma_f32_16x16x32_bf16 v[28:31], a[192:195], v[144:147], v[28:31]
  v_mfma_f32_16x16x32_bf16 v[32:35], a[196:199], v[144:147], v[32:35]
  v_mfma_f32_16x16x32_bf16 v[36:39], a[180:183], v[148:151], v[36:39]
  buffer_load_dwordx4 v[132:135], v241, s[8:11], s21 offen sc1
  v_mfma_f32_16x16x32_bf16 v[40:43], a[184:187], v[148:151], v[40:43]
  v_mfma_f32_16x16x32_bf16 v[44:47], a[188:191], v[148:151], v[44:47]
  v_mfma_f32_16x16x32_bf16 v[48:51], a[192:195], v[148:151], v[48:51]
  v_mfma_f32_16x16x32_bf16 v[52:55], a[196:199], v[148:151], v[52:55]
  v_mfma_f32_16x16x32_bf16 v[56:59], a[180:183], v[152:155], v[56:59]
  buffer_load_dwordx4 v[136:139], v242, s[8:11], s21 offen sc1
  v_mfma_f32_16x16x32_bf16 v[60:63], a[184:187], v[152:155], v[60:63]
  v_mfma_f32_16x16x32_bf16 v[64:67], a[188:191], v[152:155], v[64:67]
  v_mfma_f32_16x16x32_bf16 v[68:71], a[192:195], v[152:155], v[68:71]
  v_mfma_f32_16x16x32_bf16 v[72:75], a[196:199], v[152:155], v[72:75]
  v_mfma_f32_16x16x32_bf16 v[76:79], a[180:183], v[156:159], v[76:79]
  buffer_load_dwordx4 v[140:143], v243, s[8:11], s21 offen sc1
  v_mfma_f32_16x16x32_bf16 v[80:83], a[184:187], v[156:159], v[80:83]
  v_mfma_f32_16x16x32_bf16 v[84:87], a[188:191], v[156:159], v[84:87]
  v_mfma_f32_16x16x32_bf16 v[88:91], a[192:195], v[156:159], v[88:91]
  v_mfma_f32_16x16x32_bf16 v[92:95], a[196:199], v[156:159], v[92:95]
  s_waitcnt vmcnt(26)
  s_barrier
  v_mfma_f32_16x16x32_bf16 v[16:19], a[200:203], v[160:163], v[16:19]
  s_add_u32 s21, s20, 16384
  v_mfma_f32_16x16x32_bf16 v[20:23], a[204:207], v[160:163], v[20:23]
  buffer_load_dwordx4 v[144:147], v240, s[8:11], s21 offen sc1
  v_mfma_f32_16x16x32_bf16 v[24:27], a[208:211], v[160:163], v[24:27]
  v_mfma_f32_16x16x32_bf16 v[28:31], a[212:215], v[160:163], v[28:31]
  v_mfma_f32_16x16x32_bf16 v[32:35], a[216:219], v[160:163], v[32:35]
  v_mfma_f32_16x16x32_bf16 v[36:39], a[200:203], v[164:167], v[36:39]
  buffer_load_dwordx4 v[148:151], v241, s[8:11], s21 offen sc1
  v_mfma_f32_16x16x32_bf16 v[40:43], a[204:207], v[164:167], v[40:43]
  v_mfma_f32_16x16x32_bf16 v[44:47], a[208:211], v[164:167], v[44:47]
  v_mfma_f32_16x16x32_bf16 v[48:51], a[212:215], v[164:167], v[48:51]
  v_mfma_f32_16x16x32_bf16 v[52:55], a[216:219], v[164:167], v[52:55]
  v_mfma_f32_16x16x32_bf16 v[56:59], a[200:203], v[168:171], v[56:59]
  buffer_load_dwordx4 v[152:155], v242, s[8:11], s21 offen sc1
  v_mfma_f32_16x16x32_bf16 v[60:63], a[204:207], v[168:171], v[60:63]
  v_mfma_f32_16x16x32_bf16 v[64:67], a[208:211], v[168:171], v[64:67]
  v_mfma_f32_16x16x32_bf16 v[68:71], a[212:215], v[168:171], v[68:71]
  v_mfma_f32_16x16x32_bf16 v[72:75], a[216:219], v[168:171], v[72:75]
  v_mfma_f32_16x16x32_bf16 v[76:79], a[200:203], v[172:175], v[76:79]
  buffer_load_dwordx4 v[156:159], v243, s[8:11], s21 offen sc1
  v_mfma_f32_16x16x32_bf16 v[80:83], a[204:207], v[172:175], v[80:83]
  v_mfma_f32_16x16x32_bf16 v[84:87], a[208:211], v[172:175], v[84:87]
  v_mfma_f32_16x16x32_bf16 v[88:91], a[212:215], v[172:175], v[88:91]
  v_mfma_f32_16x16x32_bf16 v[92:95], a[216:219], v[172:175], v[92:95]
  s_waitcnt vmcnt(26)
  v_mfma_f32_16x16x32_bf16 v[16:19], a[220:223], v[176:179], v[16:19]
  s_add_u32 s21, s20, 8192
  v_sub_u32 v8, v240, v9
  v_mfma_f32_16x16x32_bf16 v[20:23], a[224:227], v[176:179], v[20:23]
  buffer_load_dwordx2 v[160:161], v8, s[8:11], s21 offen sc1
  v_mfma_f32_16x16x32_bf16 v[24:27], a[228:231], v[176:179], v[24:27]
  v_mfma_f32_16x16x32_bf16 v[28:31], a[232:235], v[176:179], v[28:31]
  buffer_load_dwordx2 v[162:163], v8, s[8:11], s21 offen offset:512 sc1
  v_mfma_f32_16x16x32_bf16 v[32:35], a[236:239], v[176:179], v[32:35]
  v_sub_u32 v8, v241, v9
  v_mfma_f32_16x16x32_bf16 v[36:39], a[220:223], v[180:183], v[36:39]
  buffer_load_dwordx2 v[164:165], v8, s[8:11], s21 offen sc1
  v_mfma_f32_16x16x32_bf16 v[40:43], a[224:227], v[180:183], v[40:43]
  v_mfma_f32_16x16x32_bf16 v[44:47], a[228:231], v[180:183], v[44:47]
  v_mfma_f32_16x16x32_bf16 v[48:51], a[232:235], v[180:183], v[48:51]
  buffer_load_dwordx2 v[166:167], v8, s[8:11], s21 offen offset:512 sc1
  v_mfma_f32_16x16x32_bf16 v[52:55], a[236:239], v[180:183], v[52:55]
  v_sub_u32 v8, v242, v9
  v_mfma_f32_16x16x32_bf16 v[56:59], a[220:223], v[184:187], v[56:59]
  buffer_load_dwordx2 v[168:169], v8, s[8:11], s21 offen sc1
  v_mfma_f32_16x16x32_bf16 v[60:63], a[224:227], v[184:187], v[60:63]
  v_mfma_f32_16x16x32_bf16 v[64:67], a[228:231], v[184:187], v[64:67]
  buffer_load_dwordx2 v[170:171], v8, s[8:11], s21 offen offset:512 sc1
  v_mfma_f32_16x16x32_bf16 v[68:71], a[232:235], v[184:187], v[68:71]
  v_mfma_f32_16x16x32_bf16 v[72:75], a[236:239], v[184:187], v[72:75]
  v_sub_u32 v8, v243, v9
  v_mfma_f32_16x16x32_bf16 v[76:79], a[220:223], v[188:191], v[76:79]
  buffer_load_dwordx2 v[172:173], v8, s[8:11], s21 offen sc1
  v_mfma_f32_16x16x32_bf16 v[80:83], a[224:227], v[188:191], v[80:83]
  v_mfma_f32_16x16x32_bf16 v[84:87], a[228:231], v[188:191], v[84:87]
  buffer_load_dwordx2 v[174:175], v8, s[8:11], s21 offen offset:512 sc1
  v_mfma_f32_16x16x32_bf16 v[88:91], a[232:235], v[188:191], v[88:91]
  v_mfma_f32_16x16x32_bf16 v[92:95], a[236:239], v[188:191], v[92:95]
  s_waitcnt vmcnt(30)
  v_mfma_f32_16x16x32_bf16 v[16:19], a[0:3], v[96:99], v[16:19]
  s_add_u32 s21, s20, 17408
  v_sub_u32 v8, v240, v9
  v_mfma_f32_16x16x32_bf16 v[20:23], a[4:7], v[96:99], v[20:23]
  buffer_load_dwordx2 v[176:177], v8, s[8:11], s21 offen sc1
  v_mfma_f32_16x16x32_bf16 v[24:27], a[8:11], v[96:99], v[24:27]
  v_mfma_f32_16x16x32_bf16 v[28:31], a[12:15], v[96:99], v[28:31]
  buffer_load_dwordx2 v[178:179], v8, s[8:11], s21 offen offset:512 sc1
  v_mfma_f32_16x16x32_bf16 v[32:35], a[16:19], v[96:99], v[32:35]
  v_sub_u32 v8, v241, v9
  v_mfma_f32_16x16x32_bf16 v[36:39], a[0:3], v[100:103], v[36:39]
  buffer_load_dwordx2 v[180:181], v8, s[8:11], s21 offen sc1
  v_mfma_f32_16x16x32_bf16 v[40:43], a[4:7], v[100:103], v[40:43]
  v_mfma_f32_16x16x32_bf16 v[44:47], a[8:11], v[100:103], v[44:47]
  v_mfma_f32_16x16x32_bf16 v[48:51], a[12:15], v[100:103], v[48:51]
  buffer_load_dwordx2 v[182:183], v8, s[8:11], s21 offen offset:512 sc1
  v_mfma_f32_16x16x32_bf16 v[52:55], a[16:19], v[100:103], v[52:55]
  v_sub_u32 v8, v242, v9
  v_mfma_f32_16x16x32_bf16 v[56:59], a[0:3], v[104:107], v[56:59]
  buffer_load_dwordx2 v[184:185], v8, s[8:11], s21 offen sc1
  v_mfma_f32_16x16x32_bf16 v[60:63], a[4:7], v[104:107], v[60:63]
  v_mfma_f32_16x16x32_bf16 v[64:67], a[8:11], v[104:107], v[64:67]
  buffer_load_dwordx2 v[186:187], v8, s[8:11], s21 offen offset:512 sc1
  v_mfma_f32_16x16x32_bf16 v[68:71], a[12:15], v[104:107], v[68:71]
  v_mfma_f32_16x16x32_bf16 v[72:75], a[16:19], v[104:107], v[72:75]
  v_sub_u32 v8, v243, v9
  v_mfma_f32_16x16x32_bf16 v[76:79], a[0:3], v[108:111], v[76:79]
  buffer_load_dwordx2 v[188:189], v8, s[8:11], s21 offen sc1
  v_mfma_f32_16x16x32_bf16 v[80:83], a[4:7], v[108:111], v[80:83]
  v_mfma_f32_16x16x32_bf16 v[84:87], a[8:11], v[108:111], v[84:87]
  buffer_load_dwordx2 v[190:191], v8, s[8:11], s21 offen offset:512 sc1
  v_mfma_f32_16x16x32_bf16 v[88:91], a[12:15], v[108:111], v[88:91]
  v_mfma_f32_16x16x32_bf16 v[92:95], a[16:19], v[108:111], v[92:95]
  s_waitcnt vmcnt(29)
  v_mfma_f32_16x16x32_bf16 v[16:19], a[20:23], v[112:115], v[16:19]
  v_mfma_f32_16x16x32_bf16 v[20:23], a[24:27], v[112:115], v[20:23]
  buffer_load_dwordx2 v[192:193], v9, s[8:11], s25 offen offset:0 sc1
  v_mfma_f32_16x16x32_bf16 v[24:27], a[28:31], v[112:115], v[24:27]
  v_mfma_f32_16x16x32_bf16 v[28:31], a[32:35], v[112:115], v[28:31]
  v_mfma_f32_16x16x32_bf16 v[32:35], a[36:39], v[112:115], v[32:35]
  buffer_load_dwordx2 v[194:195], v9, s[8:11], s25 offen offset:512 sc1
  v_mfma_f32_16x16x32_bf16 v[36:39], a[20:23], v[116:119], v[36:39]
  v_mfma_f32_16x16x32_bf16 v[40:43], a[24:27], v[116:119], v[40:43]
  v_mfma_f32_16x16x32_bf16 v[44:47], a[28:31], v[116:119], v[44:47]
  v_mfma_f32_16x16x32_bf16 v[48:51], a[32:35], v[116:119], v[48:51]
  buffer_load_dwordx2 v[196:197], v9, s[8:11], s25 offen offset:1024 sc1
  v_mfma_f32_16x16x32_bf16 v[52:55], a[36:39], v[116:119], v[52:55]
  v_mfma_f32_16x16x32_bf16 v[56:59], a[20:23], v[120:123], v[56:59]
  v_mfma_f32_16x16x32_bf16 v[60:63], a[24:27], v[120:123], v[60:63]
  v_mfma_f32_16x16x32_bf16 v[64:67], a[28:31], v[120:123], v[64:67]
  buffer_load_dwordx2 v[198:199], v9, s[8:11], s25 offen offset:1536 sc1
  v_mfma_f32_16x16x32_bf16 v[68:71], a[32:35], v[120:123], v[68:71]
  v_mfma_f32_16x16x32_bf16 v[72:75], a[36:39], v[120:123], v[72:75]
  v_mfma_f32_16x16x32_bf16 v[76:79], a[20:23], v[124:127], v[76:79]
  v_mfma_f32_16x16x32_bf16 v[80:83], a[24:27], v[124:127], v[80:83]
  buffer_load_dwordx2 v[200:201], v9, s[8:11], s25 offen offset:2048 sc1
  v_mfma_f32_16x16x32_bf16 v[84:87], a[28:31], v[124:127], v[84:87]
  v_mfma_f32_16x16x32_bf16 v[88:91], a[32:35], v[124:127], v[88:91]
  v_mfma_f32_16x16x32_bf16 v[92:95], a[36:39], v[124:127], v[92:95]
  s_waitcnt vmcnt(25)
  v_mfma_f32_16x16x32_bf16 v[16:19], a[40:43], v[128:131], v[16:19]
  v_mfma_f32_16x16x32_bf16 v[20:23], a[44:47], v[128:131], v[20:23]
  v_mfma_f32_16x16x32_bf16 v[24:27], a[48:51], v[128:131], v[24:27]
  v_mfma_f32_16x16x32_bf16 v[28:31], a[52:55], v[128:131], v[28:31]
  v_mfma_f32_16x16x32_bf16 v[32:35], a[56:59], v[128:131], v[32:35]
  v_mfma_f32_16x16x32_bf16 v[36:39], a[40:43], v[132:135], v[36:39]
  v_mfma_f32_16x16x32_bf16 v[40:43], a[44:47], v[132:135], v[40:43]
  v_mfma_f32_16x16x32_bf16 v[44:47], a[48:51], v[132:135], v[44:47]
  v_mfma_f32_16x16x32_bf16 v[48:51], a[52:55], v[132:135], v[48:51]
  v_mfma_f32_16x16x32_bf16 v[52:55], a[56:59], v[132:135], v[52:55]
  v_mfma_f32_16x16x32_bf16 v[56:59], a[40:43], v[136:139], v[56:59]
  v_mfma_f32_16x16x32_bf16 v[60:63], a[44:47], v[136:139], v[60:63]
  v_mfma_f32_16x16x32_bf16 v[64:67], a[48:51], v[136:139], v[64:67]
  v_mfma_f32_16x16x32_bf16 v[68:71], a[52:55], v[136:139], v[68:71]
  v_mfma_f32_16x16x32_bf16 v[72:75], a[56:59], v[136:139], v[72:75]
  v_mfma_f32_16x16x32_bf16 v[76:79], a[40:43], v[140:143], v[76:79]
  v_mfma_f32_16x16x32_bf16 v[80:83], a[44:47], v[140:143], v[80:83]
  v_mfma_f32_16x16x32_bf16 v[84:87], a[48:51], v[140:143], v[84:87]
  v_mfma_f32_16x16x32_bf16 v[88:91], a[52:55], v[140:143], v[88:91]
  v_mfma_f32_16x16x32_bf16 v[92:95], a[56:59], v[140:143], v[92:95]
  s_waitcnt vmcnt(21)
  v_mfma_f32_16x16x32_bf16 v[16:19], a[60:63], v[144:147], v[16:19]
  v_mfma_f32_16x16x32_bf16 v[20:23], a[64:67], v[144:147], v[20:23]
  v_mfma_f32_16x16x32_bf16 v[24:27], a[68:71], v[144:147], v[24:27]
  v_mfma_f32_16x16x32_bf16 v[28:31], a[72:75], v[144:147], v[28:31]
  v_mfma_f32_16x16x32_bf16 v[32:35], a[76:79], v[144:147], v[32:35]
  v_mfma_f32_16x16x32_bf16 v[36:39], a[60:63], v[148:151], v[36:39]
  v_mfma_f32_16x16x32_bf16 v[40:43], a[64:67], v[148:151], v[40:43]
  v_mfma_f32_16x16x32_bf16 v[44:47], a[68:71], v[148:151], v[44:47]
  v_mfma_f32_16x16x32_bf16 v[48:51], a[72:75], v[148:151], v[48:51]
  v_mfma_f32_16x16x32_bf16 v[52:55], a[76:79], v[148:151], v[52:55]
  v_mfma_f32_16x16x32_bf16 v[56:59], a[60:63], v[152:155], v[56:59]
  v_mfma_f32_16x16x32_bf16 v[60:63], a[64:67], v[152:155], v[60:63]
  v_mfma_f32_16x16x32_bf16 v[64:67], a[68:71], v[152:155], v[64:67]
  v_mfma_f32_16x16x32_bf16 v[68:71], a[72:75], v[152:155], v[68:71]
  v_mfma_f32_16x16x32_bf16 v[72:75], a[76:79], v[152:155], v[72:75]
  v_mfma_f32_16x16x32_bf16 v[76:79], a[60:63], v[156:159], v[76:79]
  v_mfma_f32_16x16x32_bf16 v[80:83], a[64:67], v[156:159], v[80:83]
  v_mfma_f32_16x16x32_bf16 v[84:87], a[68:71], v[156:159], v[84:87]
  v_mfma_f32_16x16x32_bf16 v[88:91], a[72:75], v[156:159], v[88:91]
  v_mfma_f32_16x16x32_bf16 v[92:95], a[76:79], v[156:159], v[92:95]
  s_waitcnt vmcnt(13)
  v_mfma_f32_16x16x32_bf16 v[16:19], a[80:83], v[160:163], v[16:19]
  v_mfma_f32_16x16x32_bf16 v[20:23], a[84:87], v[160:163], v[20:23]
  v_mfma_f32_16x16x32_bf16 v[24:27], a[88:91], v[160:163], v[24:27]
  v_mfma_f32_16x16x32_bf16 v[28:31], a[92:95], v[160:163], v[28:31]
  v_mfma_f32_16x16x32_bf16 v[32:35], a[96:99], v[160:163], v[32:35]
  v_mfma_f32_16x16x32_bf16 v[36:39], a[80:83], v[164:167], v[36:39]
  v_mfma_f32_16x16x32_bf16 v[40:43], a[84:87], v[164:167], v[40:43]
  v_mfma_f32_16x16x32_bf16 v[44:47], a[88:91], v[164:167], v[44:47]
  v_mfma_f32_16x16x32_bf16 v[48:51], a[92:95], v[164:167], v[48:51]
  v_mfma_f32_16x16x32_bf16 v[52:55], a[96:99], v[164:167], v[52:55]
  v_mfma_f32_16x16x32_bf16 v[56:59], a[80:83], v[168:171], v[56:59]
  v_mfma_f32_16x16x32_bf16 v[60:63], a[84:87], v[168:171], v[60:63]
  v_mfma_f32_16x16x32_bf16 v[64:67], a[88:91], v[168:171], v[64:67]
  v_mfma_f32_16x16x32_bf16 v[68:71], a[92:95], v[168:171], v[68:71]
  v_mfma_f32_16x16x32_bf16 v[72:75], a[96:99], v[168:171], v[72:75]
  v_mfma_f32_16x16x32_bf16 v[76:79], a[80:83], v[172:175], v[76:79]
  v_mfma_f32_16x16x32_bf16 v[80:83], a[84:87], v[172:175], v[80:83]
  v_mfma_f32_16x16x32_bf16 v[84:87], a[88:91], v[172:175], v[84:87]
  v_mfma_f32_16x16x32_bf16 v[88:91], a[92:95], v[172:175], v[88:91]
  v_mfma_f32_16x16x32_bf16 v[92:95], a[96:99], v[172:175], v[92:95]
  s_waitcnt vmcnt(5)
  v_mfma_f32_16x16x32_bf16 v[36:39], a[100:103], v[180:183], v[36:39]
  v_mfma_f32_16x16x32_bf16 v[40:43], a[104:107], v[180:183], v[40:43]
  v_mfma_f32_16x16x32_bf16 v[44:47], a[108:111], v[180:183], v[44:47]
  v_mfma_f32_16x16x32_bf16 v[48:51], a[112:115], v[180:183], v[48:51]
  v_mfma_f32_16x16x32_bf16 v[52:55], a[116:119], v[180:183], v[52:55]
  v_mfma_f32_16x16x32_bf16 v[56:59], a[100:103], v[184:187], v[56:59]
  v_mfma_f32_16x16x32_bf16 v[60:63], a[104:107], v[184:187], v[60:63]
  v_mfma_f32_16x16x32_bf16 v[64:67], a[108:111], v[184:187], v[64:67]
  v_mfma_f32_16x16x32_bf16 v[68:71], a[112:115], v[184:187], v[68:71]
  v_mfma_f32_16x16x32_bf16 v[72:75], a[116:119], v[184:187], v[72:75]
  ds_write_b128 v245, v[36:39] offset:0
  v_mfma_f32_16x16x32_bf16 v[76:79], a[100:103], v[188:191], v[76:79]
  ds_write_b128 v245, v[40:43] offset:1024
  v_mfma_f32_16x16x32_bf16 v[80:83], a[104:107], v[188:191], v[80:83]
  ds_write_b128 v245, v[44:47] offset:2048
  v_mfma_f32_16x16x32_bf16 v[84:87], a[108:111], v[188:191], v[84:87]
  ds_write_b128 v245, v[48:51] offset:3072
  v_mfma_f32_16x16x32_bf16 v[88:91], a[112:115], v[188:191], v[88:91]
  ds_write_b128 v245, v[52:55] offset:4096
  v_mfma_f32_16x16x32_bf16 v[92:95], a[116:119], v[188:191], v[92:95]
  ds_write_b128 v246, v[56:59] offset:0
  v_mfma_f32_16x16x32_bf16 v[16:19], a[100:103], v[176:179], v[16:19]
  ds_write_b128 v246, v[60:63] offset:1024
  v_mfma_f32_16x16x32_bf16 v[20:23], a[104:107], v[176:179], v[20:23]
  ds_write_b128 v246, v[64:67] offset:2048
  v_mfma_f32_16x16x32_bf16 v[24:27], a[108:111], v[176:179], v[24:27]
  ds_write_b128 v246, v[68:71] offset:3072
  v_mfma_f32_16x16x32_bf16 v[28:31], a[112:115], v[176:179], v[28:31]
  ds_write_b128 v246, v[72:75] offset:4096
  v_mfma_f32_16x16x32_bf16 v[32:35], a[116:119], v[176:179], v[32:35]
  ds_write_b128 v247, v[76:79] offset:0
  s_mul_i32 s7, s3, 15360
  v_add_u32 v11, s7, v1
  ds_write_b128 v247, v[80:83] offset:1024
  ds_write_b128 v247, v[84:87] offset:2048
  ds_write_b128 v247, v[88:91] offset:3072
  ds_write_b128 v247, v[92:95] offset:4096
  v_mul_u32_u24 v4, 1152, v248
  v_lshl_add_u32 v4, v12, 3, v4
  s_lshr_b32 s25, s22, 1
  s_mul_i32 s25, s25, 36864
  s_and_b32 s26, s22, 1
  s_mul_i32 s26, s26, 4608
  s_add_u32 s25, s25, s26
  s_lshl_b32 s26, s45, 5
  s_add_u32 s25, s25, s26
  v_lshlrev_b32 v8, 2, v12
  v_and_b32 v8, 8, v8
  v_mov_b32 v9, 2147483392
  v_cmp_eq_u32 vcc, s46, v8
  s_nop 1
  v_cndmask_b32 v5, v4, v9, vcc
  v_cmp_eq_u32 vcc, s47, v8
  s_nop 1
  v_cndmask_b32 v6, v4, v9, vcc
  s_waitcnt lgkmcnt(0)
  s_barrier
  ds_read_b128 v[36:39], v11 offset:0
  ds_read_b128 v[40:43], v11 offset:1024
  ds_read_b128 v[44:47], v11 offset:2048
  ds_read_b128 v[48:51], v11 offset:3072
  ds_read_b128 v[52:55], v11 offset:4096
  ds_read_b128 v[56:59], v11 offset:5120
  ds_read_b128 v[60:63], v11 offset:6144
  ds_read_b128 v[64:67], v11 offset:7168
  ds_read_b128 v[68:71], v11 offset:8192
  ds_read_b128 v[72:75], v11 offset:9216
  ds_read_b128 v[76:79], v11 offset:10240
  ds_read_b128 v[80:83], v11 offset:11264
  ds_read_b128 v[84:87], v11 offset:12288
  ds_read_b128 v[88:91], v11 offset:13312
  s_waitcnt lgkmcnt(8)
  ds_read_b128 v[92:95], v11 offset:14336
  s_waitcnt vmcnt(0) lgkmcnt(0)
  v_pk_add_f32 v[16:17], v[16:17], v[36:37]
  v_pk_add_f32 v[56:57], v[56:57], v[76:77]
  v_lshlrev_b32 v36, 16, v192
  v_and_b32 v37, 0xffff0000, v192
  v_pk_add_f32 v[16:17], v[16:17], v[56:57]
  v_pk_fma_f32 v[16:17], v[16:17], v[204:205], v[36:37]
  v_cvt_pk_bf16_f32 v192, v16, v17
  v_pk_add_f32 v[18:19], v[18:19], v[38:39]
  v_pk_add_f32 v[58:59], v[58:59], v[78:79]
  v_lshlrev_b32 v38, 16, v193
  v_and_b32 v39, 0xffff0000, v193
  v_pk_add_f32 v[18:19], v[18:19], v[58:59]
  v_pk_fma_f32 v[18:19], v[18:19], v[206:207], v[38:39]
  v_cvt_pk_bf16_f32 v193, v18, v19
  buffer_store_dwordx2 v[192:193], v5, s[12:15], s25 offen offset:0
  v_pk_add_f32 v[20:21], v[20:21], v[40:41]
  v_pk_add_f32 v[60:61], v[60:61], v[80:81]
  v_lshlrev_b32 v40, 16, v194
  v_and_b32 v41, 0xffff0000, v194
  v_pk_add_f32 v[20:21], v[20:21], v[60:61]
  v_pk_fma_f32 v[20:21], v[20:21], v[208:209], v[40:41]
  v_cvt_pk_bf16_f32 v194, v20, v21
  v_pk_add_f32 v[22:23], v[22:23], v[42:43]
  v_pk_add_f32 v[62:63], v[62:63], v[82:83]
  v_lshlrev_b32 v42, 16, v195
  v_and_b32 v43, 0xffff0000, v195
  v_pk_add_f32 v[22:23], v[22:23], v[62:63]
  v_pk_fma_f32 v[22:23], v[22:23], v[210:211], v[42:43]
  v_cvt_pk_bf16_f32 v195, v22, v23
  buffer_store_dwordx2 v[194:195], v4, s[12:15], s25 offen offset:32
  v_pk_add_f32 v[24:25], v[24:25], v[44:45]
  v_pk_add_f32 v[64:65], v[64:65], v[84:85]
  v_lshlrev_b32 v44, 16, v196
  v_and_b32 v45, 0xffff0000, v196
  v_pk_add_f32 v[24:25], v[24:25], v[64:65]
  v_pk_fma_f32 v[24:25], v[24:25], v[212:213], v[44:45]
  v_cvt_pk_bf16_f32 v196, v24, v25
  v_pk_add_f32 v[26:27], v[26:27], v[46:47]
  v_pk_add_f32 v[66:67], v[66:67], v[86:87]
  v_lshlrev_b32 v46, 16, v197
  v_and_b32 v47, 0xffff0000, v197
  v_pk_add_f32 v[26:27], v[26:27], v[66:67]
  v_pk_fma_f32 v[26:27], v[26:27], v[214:215], v[46:47]
  v_cvt_pk_bf16_f32 v197, v26, v27
  buffer_store_dwordx2 v[196:197], v4, s[12:15], s25 offen offset:64
  v_pk_add_f32 v[28:29], v[28:29], v[48:49]
  v_pk_add_f32 v[68:69], v[68:69], v[88:89]
  v_lshlrev_b32 v48, 16, v198
  v_and_b32 v49, 0xffff0000, v198
  v_pk_add_f32 v[28:29], v[28:29], v[68:69]
  v_pk_fma_f32 v[28:29], v[28:29], v[216:217], v[48:49]
  v_cvt_pk_bf16_f32 v198, v28, v29
  v_pk_add_f32 v[30:31], v[30:31], v[50:51]
  v_pk_add_f32 v[70:71], v[70:71], v[90:91]
  v_lshlrev_b32 v50, 16, v199
  v_and_b32 v51, 0xffff0000, v199
  v_pk_add_f32 v[30:31], v[30:31], v[70:71]
  v_pk_fma_f32 v[30:31], v[30:31], v[218:219], v[50:51]
  v_cvt_pk_bf16_f32 v199, v30, v31
  buffer_store_dwordx2 v[198:199], v4, s[12:15], s25 offen offset:96
  v_pk_add_f32 v[32:33], v[32:33], v[52:53]
  v_pk_add_f32 v[72:73], v[72:73], v[92:93]
  v_lshlrev_b32 v52, 16, v200
  v_and_b32 v53, 0xffff0000, v200
  v_pk_add_f32 v[32:33], v[32:33], v[72:73]
  v_pk_fma_f32 v[32:33], v[32:33], v[220:221], v[52:53]
  v_cvt_pk_bf16_f32 v200, v32, v33
  v_pk_add_f32 v[34:35], v[34:35], v[54:55]
  v_pk_add_f32 v[74:75], v[74:75], v[94:95]
  v_lshlrev_b32 v54, 16, v201
  v_and_b32 v55, 0xffff0000, v201
  v_pk_add_f32 v[34:35], v[34:35], v[74:75]
  v_pk_fma_f32 v[34:35], v[34:35], v[222:223], v[54:55]
  v_cvt_pk_bf16_f32 v201, v34, v35
  buffer_store_dwordx2 v[200:201], v6, s[12:15], s25 offen offset:128
GM_END:
  s_endpgm
GM_CODE_END:
.section .rodata,"a"
.p2align 6
.amdhsa_kernel adaLN_cond__ssm_conv_h3__mixer_gmlp__prompt_kernel
  .amdhsa_next_free_vgpr 512
  .amdhsa_next_free_sgpr 100
  .amdhsa_accum_offset 256
  .amdhsa_group_segment_fixed_size 0
  .amdhsa_kernarg_size 128
  .amdhsa_user_sgpr_count 2
  .amdhsa_user_sgpr_kernarg_segment_ptr 1
  .amdhsa_system_sgpr_workgroup_id_x 1
.end_amdhsa_kernel
```
